```python
import torch

def _softmax(x, axis=-1):
    return torch.softmax(x, dim=axis)
def _gelu(x):
    return torch.nn.functional.gelu(x, approximate="tanh")
def _silu(x):
    return torch.nn.functional.silu(x)
def _sigmoid(x):
    return torch.sigmoid(x)
def _layernorm(x, axis=-1, eps=1e-5):
    m = x.mean(dim=axis, keepdim=True)
    v = x.var(dim=axis, keepdim=True, unbiased=False)
    return (x - m) / torch.sqrt(v + eps)
def _scatter_add(tgt, idx, src, axis=0):
    return tgt.clone().index_add_(axis, idx, src)
def _segment_sum(src, seg, n):
    out = torch.zeros((n,) + src.shape[1:], dtype=src.dtype)
    return out.index_add_(0, seg, src)
def _pad(x, pw):
    flat = tuple(v for pair in reversed(pw) for v in pair)
    return torch.nn.functional.pad(x, flat)

kernel_name = 'interleave_layers__linear_kernel_hedgehog__dense_activation_squared_relu__prompt'

def setup_inputs():

    _w = (lambda a: (lambda t: t.to(torch.bfloat16) if t.is_floating_point() else t)(torch.as_tensor(a)))
    def _A_setup():
        B, S, D, H = 1, 2048, 640, 32
        Dh = D // H
        return {
            "x": _w((lambda *s: torch.randn(*s, dtype=torch.bfloat16) * 0.05)(B, S, D)),
            "wqkv": _w((lambda *s: torch.randn(*s, dtype=torch.bfloat16) * 0.2)(D, 3 * D)),
            "w_phi": _w((lambda *s: torch.randn(*s, dtype=torch.bfloat16) * 0.2)(H, Dh, Dh) * (Dh ** -0.5)),
            "wo": _w((lambda *s: torch.randn(*s, dtype=torch.bfloat16) * 0.05)(D, D)),
        }
    _A_in = _A_setup()

    def _B_setup():
        B, S, D, F = 1, 2048, 640, 1728
        return {
            "x": _w((lambda *s: torch.randn(*s, dtype=torch.bfloat16) * 0.05)(B, S, D)),
            "w1": _w((lambda *s: torch.randn(*s, dtype=torch.bfloat16) * 0.05)(D, F)),
            "b1": _w((lambda *s: torch.randn(*s, dtype=torch.bfloat16) * 0.2)(F)),
            "w2": _w((lambda *s: torch.randn(*s, dtype=torch.bfloat16) * 0.05)(F, D)),
            "b2": _w((lambda *s: torch.randn(*s, dtype=torch.bfloat16) * 0.8)(D)),
        }
    _B_in = _B_setup()

    return {
        "A_x": _A_in["x"],
        "A_wqkv": _A_in["wqkv"],
        "A_w_phi": _A_in["w_phi"],
        "A_wo": _A_in["wo"],
        "B_x": _B_in["x"],
        "B_w1": _B_in["w1"],
        "B_b1": _B_in["b1"],
        "B_w2": _B_in["w2"],
        "B_b2": _B_in["b2"],
    }

def reference(A_x, A_wqkv, A_w_phi, A_wo, B_x, B_w1, B_b1, B_w2, B_b2):
    def _A_ref(x, wqkv, w_phi, wo):
        B, S, D = x.shape
        H = 32; Dh = D // H
        qkv = (lambda x, *d: x.permute(*d))((x @ wqkv).reshape(B, S, 3, H, Dh), 2, 0, 3, 1, 4)
        q, k, v = qkv[0], qkv[1], qkv[2]
        pq = torch.einsum("bhsd,hdf->bhsf", q, w_phi)
        pk = torch.einsum("bhsd,hdf->bhsf", k, w_phi)
        phi_q = torch.concatenate([_softmax(pq, axis=-1), _softmax(-pq, axis=-1)], axis=-1)
        phi_k = torch.concatenate([_softmax(pk, axis=-1), _softmax(-pk, axis=-1)], axis=-1)
        kv = torch.einsum("bhsf,bhsd->bhfd", phi_k, v)
        z  = torch.einsum("bhsf->bhf", phi_k)
        num = torch.einsum("bhqf,bhfd->bhqd", phi_q, kv)
        den = torch.einsum("bhqf,bhf->bhq", phi_q, z)[..., None] + 1e-6
        o = num / den
        return (lambda x, *d: x.permute(*d))(o, 0, 2, 1, 3).reshape(B, S, D) @ wo

    def _B_ref(x, w1, b1, w2, b2):
        h = torch.einsum("bsd,df->bsf", x, w1) + b1
        zero = torch.zeros_like(h)
        r = torch.where(h > zero, h, zero)
        h = r * r
        out = torch.einsum("bsf,fd->bsd", h, w2) + b2
        return out

    x = A_x
    x = x + _A_ref(_layernorm(x, axis=-1), A_wqkv, A_w_phi, A_wo)
    x = x + _B_ref(_layernorm(x, axis=-1), B_w1, B_b1, B_w2, B_b2)
    x = x + _A_ref(_layernorm(x, axis=-1), A_wqkv, A_w_phi, A_wo)
    x = x + _B_ref(_layernorm(x, axis=-1), B_w1, B_b1, B_w2, B_b2)
    return x
```

```asm
; @launch grid=(256,1,1) block=(256,1,1) lds=163840
.amdgcn_target "amdgcn-amd-amdhsa--gfx950"
.text
.globl interleave_layers__linear_kernel_hedgehog__dense_activation_squared_relu__prompt_kernel
.p2align 8
.type interleave_layers__linear_kernel_hedgehog__dense_activation_squared_relu__prompt_kernel,@function
interleave_layers__linear_kernel_hedgehog__dense_activation_squared_relu__prompt_kernel:
 s_cmp_ge_u32 s2, 256
 s_cbranch_scc1 k_done
 s_load_dwordx8 s[64:71], s[0:1], 0
 s_load_dwordx2 s[8:9], s[0:1], 88
 s_load_dwordx8 s[72:79], s[0:1], 40
 s_load_dwordx2 s[12:13], s[0:1], 72
 s_getpc_b64 s[4:5]
 s_lshr_b32 s21, s2, 3
 s_and_b32 s20, s2, 7
 v_lshrrev_b32 v45, 6, v0
 v_and_b32 v40, 63, v0
 v_and_b32 v53, 3, v0
 v_readfirstlane_b32 s22, v45
 s_lshl_b32 s30, s21, 11
 s_add_u32 s4, s4, s30
 s_addc_u32 s5, s5, 0
 v_lshl_add_u32 v46, v45, 2, v53
 v_lshlrev_b32 v46, 7, v46
 v_mov_b32 v47, 0
 v_lshl_add_u64 v[10:11], v[46:47], 0, s[4:5]
 global_load_dword v63, v[10:11], off
 v_lshlrev_b32 v2, 4, v0
 v_lshlrev_b32 v1, 4, v40
 s_lshl_b32 s27, s22, 10
 s_lshl_b32 s86, s20, 5
 s_add_u32 s86, s86, s21
 s_mul_i32 s30, s86, 10240
 s_lshl_b32 s31, s22, 7
 s_add_u32 s30, s30, s31
 s_cmp_ge_u32 s22, 2
 s_cselect_b32 s38, 33554432, 0
 s_add_u32 s85, s30, s38
 v_lshrrev_b32 v48, 3, v40
 v_and_b32 v49, 7, v40
 v_xor_b32 v50, v48, v49
 v_mul_u32_u24 v57, 1280, v48
 v_lshl_add_u32 v57, v50, 4, v57
 s_and_b32 s32, s21, 3
 s_mul_i32 s44, s32, 3
 s_min_u32 s44, s44, 8
 s_mul_i32 s31, s20, 10
 s_add_u32 s44, s44, s31
 s_mul_i32 s31, s44, 30720
 s_cmp_ge_u32 s32, 2
 s_mov_b32 s45, 720
 s_cselect_b32 s45, 480, s45
 s_lshr_b32 s32, s21, 2
 s_mul_i32 s32, s32, 160
 s_add_u32 s31, s31, s32
 v_mov_b32 v47, 33554432
 s_mov_b32 s33, 429496730
 v_add_u32 v45, 0, v0
 v_mul_hi_u32 v46, v45, s33
 v_cmp_gt_u32 vcc, s45, v45
 v_mul_u32_u24 v46, 1120, v46
 v_lshl_add_u32 v46, v45, 4, v46
 v_cndmask_b32 v54, v47, v46, vcc
 v_add_u32 v45, 256, v0
 v_mul_hi_u32 v46, v45, s33
 v_cmp_gt_u32 vcc, s45, v45
 v_mul_u32_u24 v46, 1120, v46
 v_lshl_add_u32 v46, v45, 4, v46
 v_cndmask_b32 v55, v47, v46, vcc
 v_add_u32 v45, 512, v0
 v_mul_hi_u32 v46, v45, s33
 v_cmp_gt_u32 vcc, s45, v45
 v_mul_u32_u24 v46, 1120, v46
 v_lshl_add_u32 v46, v45, 4, v46
 v_cndmask_b32 v56, v47, v46, vcc
 s_waitcnt lgkmcnt(0)
 s_mov_b32 s16, s64
 s_mov_b32 s17, s65
 s_mov_b32 s18, 2621440
 s_mov_b32 s19, 0x20000
 s_mov_b32 s4, s66
 s_mov_b32 s5, s67
 s_mov_b32 s6, 2457600
 s_mov_b32 s7, 0x20000
 s_add_u32 m0, s27, 2048
 s_nop 0
 buffer_load_dwordx4 v57, s[16:19], s30 offen lds
 s_add_u32 m0, s27, 5632
 s_nop 0
 buffer_load_dwordx4 v57, s[16:19], s30 offen offset:512 lds
 s_add_u32 m0, s27, 9216
 s_nop 0
 buffer_load_dwordx4 v57, s[16:19], s85 offen offset:1024 lds
 s_add_u32 m0, s27, 14336
 s_nop 0
 buffer_load_dwordx4 v54, s[4:7], s31 offen lds
 s_add_u32 m0, s27, 18432
 s_nop 0
 buffer_load_dwordx4 v55, s[4:7], s31 offen lds
 s_add_u32 m0, s27, 22528
 s_nop 0
 buffer_load_dwordx4 v56, s[4:7], s31 offen lds
 s_branch kbody
.p2align 12
kbody:
 s_mov_b32 s10, 33554432
 s_mov_b32 s11, 0x20000
 s_mov_b32 s14, 2621440
 s_mov_b32 s15, 0x20000
 s_mov_b32 s16, s68
 s_mov_b32 s17, s69
 s_mov_b32 s18, 25600
 s_mov_b32 s19, 0x20000
 s_mul_i32 s30, s21, 800
 s_mov_b32 m0, 47104
 s_nop 0
 buffer_load_dwordx4 v1, s[16:19], s30 offen lds
 s_lshl_b32 s30, s2, 3
 s_add_u32 s30, s30, 13959168
 v_mov_b32 v110, s30
 s_mov_b32 s30, 13991936
 v_writelane_b32 v110, s30, 0
 buffer_load_dword v110, v110, s[8:11], 0 offen sc1
 v_lshrrev_b32 v42, 4, v40
 v_bfe_u32 v52, v40, 2, 2
 v_lshl_add_u32 v51, v42, 3, v52
 v_and_b32 v41, 15, v40
 v_lshrrev_b32 v43, 5, v40
 v_and_b32 v44, 31, v40
 v_lshlrev_b32 v22, 2, v40
 s_mov_b32 s29, 0
 v_lshlrev_b32 v45, 15, v43
 v_lshl_add_u32 v45, v44, 2, v45
 v_mov_b32 v98, 0
 s_lshl_b32 s30, s2, 7
 s_add_u32 s30, s30, 13893632
 s_cmp_eq_u32 s22, 0
 s_cselect_b32 s30, s30, 33554432
 buffer_store_dword v98, v45, s[8:11], s30 offen sc1
 v_lshlrev_b32 v56, 7, v49
 v_lshl_add_u32 v56, v50, 4, v56
 v_add_u32 v56, s27, v56
 v_lshrrev_b32 v46, 3, v0
 v_lshlrev_b32 v57, 8, v46
 v_lshl_add_u32 v57, v49, 4, v57
 v_lshrrev_b32 v45, 2, v44
 v_lshlrev_b32 v58, 7, v45
 v_lshl_add_u32 v45, v43, 2, v53
 v_lshlrev_b32 v45, 4, v45
 s_and_b32 s30, s22, 1
 s_mul_i32 s30, s30, 5120
 v_add3_u32 v58, v58, v45, s30
 s_lshr_b32 s30, s86, 1
 s_and_b32 s31, s86, 1
 s_lshl_b32 s31, s31, 7
 s_mul_i32 s52, s30, 20480
 s_add_u32 s52, s52, s31
 v_add_u32 v57, s52, v57
 s_lshl_b32 s54, s30, 10
 s_add_u32 s54, s54, s31
 s_lshl_b32 s30, s22, 8
 s_add_u32 s54, s54, s30
 s_add_u32 s54, s54, 12320768
 s_mul_i32 s34, s21, 81920
 s_add_u32 s34, s34, 14680064
 s_and_b32 s32, s21, 28
 s_add_u32 s32, s32, s22
 s_mul_i32 s30, s32, 81920
 s_add_u32 s30, s30, 14680064
 v_lshlrev_b32 v76, 10, v42
 v_lshl_add_u32 v76, v41, 4, v76
 v_add_u32 v76, s30, v76
 s_lshl_b32 s58, s32, 13
 s_lshl_b32 s30, s20, 10
 s_add_u32 s58, s58, s30
 s_and_b32 s30, s21, 3
 s_lshl_b32 s30, s30, 8
 s_add_u32 s58, s58, s30
 s_add_u32 s58, s58, 14286848
 s_add_u32 s30, s44, 0
 s_lshr_b32 s31, s30, 2
 s_lshl_b32 s31, s31, 12
 s_and_b32 s30, s30, 3
 s_lshl_b32 s30, s30, 8
 s_add_u32 s56, s30, s31
 s_add_u32 s30, s44, 1
 s_lshr_b32 s31, s30, 2
 s_lshl_b32 s31, s31, 12
 s_and_b32 s30, s30, 3
 s_lshl_b32 s30, s30, 8
 s_add_u32 s57, s30, s31
 s_add_u32 s30, s44, 2
 s_lshr_b32 s31, s30, 2
 s_lshl_b32 s31, s31, 12
 s_and_b32 s30, s30, 3
 s_lshl_b32 s30, s30, 8
 s_add_u32 s55, s30, s31
 s_cmp_eq_u32 s45, 480
 s_cselect_b32 s55, 33554432, s55
 s_mov_b32 s53, 16384
 s_mov_b32 s52, 8192
 s_cmp_ge_u32 s22, 2
 s_cselect_b32 s53, 33554432, s53
 v_mov_b32 v45, 387323156
 v_mov_b32 v46, 724183336
 v_cmp_eq_u32 vcc, 1, v42
 s_mov_b32 s62, -1
 s_mov_b32 s63, 0x0fffffff
 v_cndmask_b32 v45, v45, v46, vcc
 v_mov_b32 v46, 50462976
 v_cmp_eq_u32 vcc, 2, v42
 s_mul_i32 s31, s22, 40
 s_add_u32 s31, s31, 14336
 v_cndmask_b32 v45, v45, v46, vcc
 v_mov_b32 v46, 273432
 v_cmp_eq_u32 vcc, 3, v42
 v_lshlrev_b32 v47, 3, v53
 v_mul_u32_u24 v48, 480, v52
 v_cndmask_b32 v45, v45, v46, vcc
 v_bfe_u32 v45, v45, v47, 8
 v_lshlrev_b32 v45, 3, v45
 v_add3_u32 v59, v45, v48, s31
 v_lshlrev_b32 v60, 2, v44
 v_mov_b32 v97, 0x3f803f80
 s_cmp_ge_u32 s2, 108
 s_cbranch_scc1 st_w2
 s_mov_b32 s92, s72
 s_mov_b32 s93, s73
 s_mov_b32 s94, 2211840
 s_mov_b32 s95, 0x20000
 s_mul_i32 s46, s2, 2428
 s_lshr_b32 s46, s46, 16
 s_mul_i32 s47, s46, 27
 s_sub_u32 s47, s2, s47
 s_mul_i32 s30, s46, 552960
 s_lshl_b32 s31, s47, 7
 s_add_u32 s30, s30, s31
 v_lshrrev_b32 v45, 3, v0
 v_and_b32 v46, 7, v0
 v_mul_u32_u24 v45, 3456, v45
 v_lshl_add_u32 v45, v46, 4, v45
 v_add_u32 v104, s30, v45
 s_add_u32 s30, s30, 110592
 v_add_u32 v105, s30, v45
 s_add_u32 s30, s30, 110592
 v_add_u32 v106, s30, v45
 s_add_u32 s30, s30, 110592
 v_add_u32 v107, s30, v45
 s_add_u32 s30, s30, 110592
 v_add_u32 v108, s30, v45
 s_add_u32 s30, s30, 110592
 v_lshlrev_b32 v61, 7, v51
 v_lshl_add_u32 v61, v53, 4, v61
 s_lshr_b32 s30, s22, 1
 s_lshl_b32 s30, s30, 6
 s_and_b32 s31, s22, 1
 s_lshl_b32 s31, s31, 3
 s_add_u32 s30, s30, s31
 s_add_u32 s30, s30, 26624
 v_add_u32 v61, s30, v61
 s_lshl_b32 s31, s47, 2
 s_add_u32 s31, s31, s22
 s_mul_i32 s4, s31, 20480
 s_mul_i32 s30, s46, 5120
 s_add_u32 s4, s4, s30
 s_add_u32 s4, s4, 18350080
 s_mul_i32 s5, s46, 13824
 s_lshl_b32 s31, s31, 7
 s_add_u32 s5, s5, s31
 s_add_u32 s5, s5, 13697024
 s_branch st_j1
st_w2:
 s_cmp_ge_u32 s2, 216
 s_cselect_b32 s92, s70, s76
 s_cselect_b32 s93, s71, s77
 s_mov_b32 s94, 819200
 s_cselect_b32 s94, s94, 2211840
 s_mov_b32 s95, 0x20000
 s_mov_b32 s46, 216
 s_cselect_b32 s46, s46, 108
 s_mov_b32 s4, 17301504
 s_cselect_b32 s4, s4, 20971520
 s_cselect_b32 s5, 20, 54
 s_sub_u32 s46, s2, s46
 s_and_b32 s47, s46, 1
 s_lshr_b32 s46, s46, 1
 s_mul_i32 s30, s46, 52
 s_lshr_b32 s30, s30, 8
 s_mul_i32 s31, s30, 5
 s_sub_u32 s31, s46, s31
 s_mul_i32 s30, s30, 160
 s_mul_i32 s48, s31, 40
 s_cmp_eq_u32 s31, 4
 s_cselect_b32 s48, 16, s48
 s_cselect_b32 s49, 40, 20
 s_cselect_b32 s50, 20, 8
 s_cselect_b32 s51, 80, 4
 s_add_u32 s30, s30, s48
 s_lshl_b32 s48, s46, 5
 s_cmp_eq_u32 s5, 20
 s_cselect_b32 s30, s30, s48
 s_cselect_b32 s49, s49, 16
 s_cselect_b32 s50, s50, 8
 s_cselect_b32 s51, s51, 4
 s_mul_i32 s30, s30, 1280
 s_mul_i32 s31, s47, 640
 s_add_u32 s30, s30, s31
 s_mov_b32 s31, 107374183
 v_add_u32 v45, 0, v0
 v_mul_hi_u32 v46, v45, s31
 v_mul_u32_u24 v47, 40, v46
 v_sub_u32 v45, v45, v47
 v_and_b32 v47, 3, v46
 v_bfe_u32 v48, v46, 2, 1
 v_mad_u32_u24 v47, v48, s51, v47
 v_bfe_u32 v48, v46, 3, 1
 v_mad_u32_u24 v47, v48, s50, v47
 v_lshrrev_b32 v48, 4, v46
 v_mad_u32_u24 v47, v48, s49, v47
 v_mul_u32_u24 v47, 1280, v47
 v_lshl_add_u32 v46, v45, 4, v47
 v_add_u32 v104, s30, v46
 v_add_u32 v45, 256, v0
 v_mul_hi_u32 v46, v45, s31
 v_mul_u32_u24 v47, 40, v46
 v_sub_u32 v45, v45, v47
 v_and_b32 v47, 3, v46
 v_bfe_u32 v48, v46, 2, 1
 v_mad_u32_u24 v47, v48, s51, v47
 v_bfe_u32 v48, v46, 3, 1
 v_mad_u32_u24 v47, v48, s50, v47
 v_lshrrev_b32 v48, 4, v46
 v_mad_u32_u24 v47, v48, s49, v47
 v_mul_u32_u24 v47, 1280, v47
 v_lshl_add_u32 v46, v45, 4, v47
 v_add_u32 v105, s30, v46
 v_add_u32 v45, 512, v0
 v_mul_hi_u32 v46, v45, s31
 v_mul_u32_u24 v47, 40, v46
 v_sub_u32 v45, v45, v47
 v_and_b32 v47, 3, v46
 v_bfe_u32 v48, v46, 2, 1
 v_mad_u32_u24 v47, v48, s51, v47
 v_bfe_u32 v48, v46, 3, 1
 v_mad_u32_u24 v47, v48, s50, v47
 v_lshrrev_b32 v48, 4, v46
 v_mad_u32_u24 v47, v48, s49, v47
 v_mul_u32_u24 v47, 1280, v47
 v_lshl_add_u32 v46, v45, 4, v47
 v_add_u32 v106, s30, v46
 v_add_u32 v45, 768, v0
 v_mul_hi_u32 v46, v45, s31
 v_mul_u32_u24 v47, 40, v46
 v_sub_u32 v45, v45, v47
 v_and_b32 v47, 3, v46
 v_bfe_u32 v48, v46, 2, 1
 v_mad_u32_u24 v47, v48, s51, v47
 v_bfe_u32 v48, v46, 3, 1
 v_mad_u32_u24 v47, v48, s50, v47
 v_lshrrev_b32 v48, 4, v46
 v_mad_u32_u24 v47, v48, s49, v47
 v_mul_u32_u24 v47, 1280, v47
 v_lshl_add_u32 v46, v45, 4, v47
 v_add_u32 v107, s30, v46
 v_add_u32 v45, 1024, v0
 v_mul_hi_u32 v46, v45, s31
 v_mul_u32_u24 v47, 40, v46
 v_sub_u32 v45, v45, v47
 v_and_b32 v47, 3, v46
 v_bfe_u32 v48, v46, 2, 1
 v_mad_u32_u24 v47, v48, s51, v47
 v_bfe_u32 v48, v46, 3, 1
 v_mad_u32_u24 v47, v48, s50, v47
 v_lshrrev_b32 v48, 4, v46
 v_mad_u32_u24 v47, v48, s49, v47
 v_mul_u32_u24 v47, 1280, v47
 v_lshl_add_u32 v46, v45, 4, v47
 v_add_u32 v108, s30, v46
 v_mul_u32_u24 v61, 640, v51
 s_mul_i32 s30, s22, 160
 s_add_u32 s30, s30, 26624
 v_add_u32 v61, s30, v61
 v_lshl_add_u32 v62, v53, 3, v61
 v_lshl_add_u32 v61, v53, 4, v61
 s_lshl_b32 s30, s47, 2
 s_add_u32 s30, s30, s22
 s_mul_i32 s30, s30, s5
 s_add_u32 s30, s30, s46
 s_mul_i32 s30, s30, 5120
 s_add_u32 s4, s4, s30
 s_mov_b32 s5, 33554432
st_j1:
 v_lshlrev_b32 v8, 8, v43
 v_lshl_add_u32 v8, v41, 4, v8
 v_and_b32 v45, 1, v42
 v_lshl_add_u32 v8, v45, 3, v8
 v_lshlrev_b32 v9, 9, v43
 v_lshl_add_u32 v9, v41, 4, v9
 v_lshlrev_b32 v45, 4, v44
 v_add_u32 v45, s27, v45
 v_add_u32 v45, 2048, v45
 v_mul_u32_u24 v46, 4224, v43
 v_add_u32 v12, v45, v46
 v_add_u32 v13, v12, v46
 v_lshl_add_u32 v14, v43, 3, v45
 v_lshrrev_b32 v45, 2, v40
 v_lshlrev_b32 v45, 4, v45
 v_add_u32 v45, 2048, v45
 v_and_b32 v46, 1, v40
 v_bfe_u32 v48, v40, 1, 1
 v_lshl_add_u32 v49, v46, 3, v45
 v_cmp_eq_u32 vcc, 0, v48
 v_add_u32 v50, 16896, v49
 v_add_u32 v51, 21120, v45
 v_cndmask_b32 v16, v51, v50, vcc
 v_add_u32 v50, 25344, v49
 v_add_u32 v51, 21128, v45
 v_cndmask_b32 v17, v51, v50, vcc
 v_mul_u32_u24 v50, 4224, v48
 v_add_u32 v50, v50, v49
 s_mul_i32 s31, s22, 8448
 v_add_u32 v50, s31, v50
 v_lshl_add_u32 v51, v48, 3, v45
 v_add_u32 v51, 29568, v51
 v_cmp_gt_u32 vcc, 128, v0
 s_nop 1
 v_cndmask_b32 v15, v51, v50, vcc
 v_lshrrev_b32 v45, 4, v0
 v_add_u32 v46, 8, v43
 v_cndmask_b32 v45, v46, v45, vcc
 v_mad_u32_u24 v45, v45, 12, v41
 v_lshlrev_b32 v45, 4, v45
 v_mov_b32 v49, 33554432
 v_and_b32 v46, 0x50, v0
 v_cndmask_b32 v46, v46, 0, vcc
 v_cmp_eq_u32 vcc, 0, v46
 s_nop 1
 v_cndmask_b32 v45, v49, v45, vcc
 v_cmp_gt_u32 vcc, 12, v41
 s_nop 1
 v_cndmask_b32 v18, v49, v45, vcc
 s_lshl_b32 s31, s21, 14
 s_add_u32 s31, s31, 12582912
 v_lshlrev_b32 v45, 3, v0
 v_add_u32 v45, s31, v45
 v_cmp_gt_u32 vcc, 240, v0
 s_nop 1
 v_cndmask_b32 v19, v49, v45, vcc
 v_mul_u32_u24 v45, 2731, v0
 v_lshrrev_b32 v45, 16, v45
 v_mul_u32_u24 v46, 24, v45
 v_sub_u32 v46, v0, v46
 v_lshrrev_b32 v48, 1, v46
 v_and_b32 v49, 1, v46
 v_and_b32 v50, 3, v48
 v_lshrrev_b32 v48, 2, v48
 v_lshl_add_u32 v50, v48, 3, v50
 v_lshl_add_u32 v50, v49, 2, v50
 v_cmp_eq_u32 vcc, 17, v46
 s_nop 1
 v_cndmask_b32 v50, v50, 28, vcc
 v_cmp_eq_u32 vcc, 19, v46
 s_nop 1
 v_cndmask_b32 v50, v50, 24, vcc
 v_lshlrev_b32 v48, 1, v45
 v_subrev_u32 v48, 8, v48
 v_cmp_gt_u32 vcc, 8, v45
 s_nop 1
 v_cndmask_b32 v45, v48, v45, vcc
 v_lshrrev_b32 v48, 1, v45
 v_lshlrev_b32 v48, 9, v48
 v_lshl_add_u32 v48, v50, 4, v48
 v_and_b32 v45, 1, v45
 v_lshl_add_u32 v48, v45, 3, v48
 v_add_u32 v20, 35840, v48
 v_mul_u32_u24 v23, 0x3f80, v43
 v_lshl_add_u32 v23, v23, 16, v23
 s_waitcnt vmcnt(6)
 ds_read_b128 v[64:67], v56 offset:2048
 ds_read_b128 v[68:71], v56 offset:6144
 ds_read_b128 v[72:75], v56 offset:10240
 s_waitcnt lgkmcnt(2)
 buffer_store_dwordx4 v[64:67], v57, s[8:11], 0 offen sc1
 s_waitcnt lgkmcnt(1)
 buffer_store_dwordx4 v[68:71], v57, s[8:11], s52 offen sc1
 s_waitcnt lgkmcnt(0)
 buffer_store_dwordx4 v[72:75], v57, s[8:11], s53 offen sc1
 s_waitcnt vmcnt(6)
 s_barrier
 ds_read_b64_tr_b16 v[80:81], v59
 ds_read_b64_tr_b16 v[82:83], v59 offset:1920
 ds_read_b64_tr_b16 v[84:85], v59 offset:3840
 ds_read_b64_tr_b16 v[86:87], v59 offset:5760
 ds_read_b64_tr_b16 v[88:89], v59 offset:7680
 ds_read_b64_tr_b16 v[90:91], v59 offset:9600
 ds_read_b128 v[112:115], v58 offset:2048
 ds_read_b128 v[116:119], v58 offset:3072
 ds_read_b128 v[120:123], v58 offset:4096
 ds_read_b128 v[124:127], v58 offset:5120
 ds_read_b128 v[128:131], v58 offset:6144
 s_waitcnt lgkmcnt(10)
 v_cndmask_b32 v80, 0, v80, s[62:63]
 v_cndmask_b32 v81, 0, v81, s[62:63]
 s_waitcnt lgkmcnt(9)
 v_cndmask_b32 v82, 0, v82, s[62:63]
 v_cndmask_b32 v83, 0, v83, s[62:63]
 buffer_store_dwordx4 v[80:83], v76, s[8:11], s56 offen sc1
 s_waitcnt lgkmcnt(8)
 v_cndmask_b32 v84, 0, v84, s[62:63]
 v_cndmask_b32 v85, 0, v85, s[62:63]
 s_waitcnt lgkmcnt(7)
 v_cndmask_b32 v86, 0, v86, s[62:63]
 v_cndmask_b32 v87, 0, v87, s[62:63]
 buffer_store_dwordx4 v[84:87], v76, s[8:11], s57 offen sc1
 s_waitcnt lgkmcnt(6)
 v_cndmask_b32 v88, 0, v88, s[62:63]
 v_cndmask_b32 v89, 0, v89, s[62:63]
 s_waitcnt lgkmcnt(5)
 v_cndmask_b32 v90, 0, v90, s[62:63]
 v_cndmask_b32 v91, 0, v91, s[62:63]
 buffer_store_dwordx4 v[88:91], v76, s[8:11], s55 offen sc1
 s_waitcnt lgkmcnt(0)
 s_cmp_ge_u32 s22, 2
 s_cbranch_scc1 st_sq
 v_dot2_f32_bf16 v54, v112, v97, 0
 v_dot2_f32_bf16 v54, v113, v97, v54
 v_dot2_f32_bf16 v54, v114, v97, v54
 v_dot2_f32_bf16 v54, v115, v97, v54
 v_dot2_f32_bf16 v54, v116, v97, v54
 v_dot2_f32_bf16 v54, v117, v97, v54
 v_dot2_f32_bf16 v54, v118, v97, v54
 v_dot2_f32_bf16 v54, v119, v97, v54
 v_dot2_f32_bf16 v54, v120, v97, v54
 v_dot2_f32_bf16 v54, v121, v97, v54
 v_dot2_f32_bf16 v54, v122, v97, v54
 v_dot2_f32_bf16 v54, v123, v97, v54
 v_dot2_f32_bf16 v54, v124, v97, v54
 v_dot2_f32_bf16 v54, v125, v97, v54
 v_dot2_f32_bf16 v54, v126, v97, v54
 v_dot2_f32_bf16 v54, v127, v97, v54
 v_dot2_f32_bf16 v54, v128, v97, v54
 v_dot2_f32_bf16 v54, v129, v97, v54
 v_dot2_f32_bf16 v54, v130, v97, v54
 v_dot2_f32_bf16 v54, v131, v97, v54
 s_branch st_j3
st_sq:
 v_dot2_f32_bf16 v54, v112, v112, 0
 v_dot2_f32_bf16 v54, v113, v113, v54
 v_dot2_f32_bf16 v54, v114, v114, v54
 v_dot2_f32_bf16 v54, v115, v115, v54
 v_dot2_f32_bf16 v54, v116, v116, v54
 v_dot2_f32_bf16 v54, v117, v117, v54
 v_dot2_f32_bf16 v54, v118, v118, v54
 v_dot2_f32_bf16 v54, v119, v119, v54
 v_dot2_f32_bf16 v54, v120, v120, v54
 v_dot2_f32_bf16 v54, v121, v121, v54
 v_dot2_f32_bf16 v54, v122, v122, v54
 v_dot2_f32_bf16 v54, v123, v123, v54
 v_dot2_f32_bf16 v54, v124, v124, v54
 v_dot2_f32_bf16 v54, v125, v125, v54
 v_dot2_f32_bf16 v54, v126, v126, v54
 v_dot2_f32_bf16 v54, v127, v127, v54
 v_dot2_f32_bf16 v54, v128, v128, v54
 v_dot2_f32_bf16 v54, v129, v129, v54
 v_dot2_f32_bf16 v54, v130, v130, v54
 v_dot2_f32_bf16 v54, v131, v131, v54
st_j3:
 v_dot2_f32_bf16 v56, v80, v97, 0
 v_dot2_f32_bf16 v56, v81, v97, v56
 v_dot2_f32_bf16 v56, v82, v97, v56
 v_dot2_f32_bf16 v56, v83, v97, v56
 v_dot2_f32_bf16 v56, v84, v97, v56
 v_dot2_f32_bf16 v56, v85, v97, v56
 v_dot2_f32_bf16 v56, v86, v97, v56
 v_dot2_f32_bf16 v56, v87, v97, v56
 v_dot2_f32_bf16 v56, v88, v97, v56
 v_dot2_f32_bf16 v56, v89, v97, v56
 v_dot2_f32_bf16 v56, v90, v97, v56
 v_dot2_f32_bf16 v56, v91, v97, v56
 v_mov_b32 v55, v54
 s_nop 1
 v_permlane32_swap_b32 v54, v55
 v_add_f32 v54, v54, v55
 v_and_b32 v54, -2, v54
 buffer_store_dword v56, v22, s[8:11], s58 offen sc1
 buffer_store_dword v54, v60, s[8:11], s54 offen sc1
 s_getreg_b32 s87, hwreg(HW_REG_XCC_ID, 0, 4)
 s_waitcnt vmcnt(9)
 v_readfirstlane_b32 s3, v110
 s_nop 0
 s_mul_i32 s100, s3, 0x9e3779b1
 s_xor_b32 s101, s100, 0xa5a5a5a5
 s_add_u32 s100, s100, 1
 s_add_u32 s30, s100, s87
 v_mov_b32 v98, s30
 v_mov_b32 v99, s101
 s_lshl_b32 s30, s2, 7
 s_add_u32 s30, s30, 13893632
 s_cmp_eq_u32 s22, 0
 s_cselect_b32 s30, s30, 33554432
 v_lshlrev_b32 v45, 1, v22
 s_waitcnt vmcnt(5)
 s_barrier
 s_mov_b64 exec, 0xffff
 buffer_store_dwordx2 v[98:99], v45, s[8:11], s30 offen sc1
 s_mov_b64 exec, -1
 s_add_u32 m0, s27, 26624
 s_nop 0
 buffer_load_dwordx4 v104, s[92:95], 0 offen lds
 s_add_u32 m0, s27, 30720
 s_nop 0
 buffer_load_dwordx4 v105, s[92:95], 0 offen lds
 s_add_u32 m0, s27, 34816
 s_nop 0
 buffer_load_dwordx4 v106, s[92:95], 0 offen lds
 s_add_u32 m0, s27, 38912
 s_nop 0
 buffer_load_dwordx4 v107, s[92:95], 0 offen lds
 s_add_u32 m0, s27, 43008
 s_nop 0
 buffer_load_dwordx4 v108, s[92:95], 0 offen lds
 s_mov_b32 s16, s74
 s_mov_b32 s17, s75
 s_mov_b32 s18, 3456
 s_mov_b32 s19, 0x20000
 s_mov_b32 s96, s78
 s_mov_b32 s97, s79
 s_mov_b32 s98, 1280
 s_mov_b32 s99, 0x20000
 s_lshl_b32 s28, s22, 12
 v_add_u32 v3, s28, v1
 v_lshlrev_b32 v21, 4, v42
 s_lshr_b32 s23, s21, 3
 s_and_b32 s24, s21, 7
 s_lshr_b32 s25, s21, 4
 s_and_b32 s26, s21, 15
 s_lshr_b32 s32, s26, 2
 s_mul_i32 s33, s32, 13
 s_min_u32 s32, s32, 1
 s_add_u32 s33, s33, s32
 s_and_b32 s32, s26, 3
 s_add_u32 s85, s33, s32
 s_add_u32 s30, s85, s32
 s_add_u32 s30, s30, 6
 s_add_u32 s85, s85, 2
 s_xor_b32 s31, s32, 2
 s_lshl_b32 s33, s33, 1
 s_add_u32 s31, s31, s33
 s_and_b32 s32, s26, 10
 s_cmp_eq_u32 s32, 10
 s_cselect_b32 s31, 255, s31
 v_lshrrev_b32 v45, 2, v44
 s_lshl_b32 s32, s30, 1
 v_add_u32 v46, s32, v45
 s_lshl_b32 s32, s85, 1
 s_sub_u32 s32, s32, 4
 v_add_u32 v47, s32, v45
 v_cmp_gt_u32 vcc, 4, v45
 s_nop 1
 v_cndmask_b32 v46, v47, v46, vcc
 v_mov_b32 v47, s31
 v_cmp_gt_u32 vcc, 6, v45
 s_nop 1
 v_cndmask_b32 v46, v47, v46, vcc
 v_and_b32 v47, 3, v40
 v_lshrrev_b32 v49, 1, v46
 v_lshlrev_b32 v49, 6, v49
 v_lshl_add_u32 v49, v47, 4, v49
 v_and_b32 v50, 1, v46
 v_lshl_add_u32 v49, v50, 3, v49
 buffer_load_dwordx2 v[100:101], v49, s[16:19], 0 offen
 v_lshlrev_b32 v48, 7, v46
 v_lshl_add_u32 v48, v47, 4, v48
 v_mul_u32_u24 v49, 13824, v43
 v_add_u32 v48, v48, v49
 v_add_u32 v48, 13697024, v48
 v_mov_b32 v49, 33554432
 v_cmp_gt_u32 vcc, 108, v46
 s_nop 1
 v_cndmask_b32 v232, v49, v48, vcc
 v_lshrrev_b32 v49, 1, v45
 v_lshlrev_b32 v49, 6, v49
 v_and_b32 v50, 1, v45
 v_lshl_add_u32 v49, v50, 3, v49
 v_lshl_add_u32 v50, v47, 4, v49
 v_lshl_add_u32 v49, v47, 3, v49
 v_cmp_gt_u32 vcc, 4, v45
 s_nop 1
 v_cndmask_b32 v49, v49, v50, vcc
 s_mul_i32 s32, s24, 160
 buffer_load_dwordx2 v[102:103], v49, s[96:99], s32 offen
 s_mul_i32 s35, s30, 40960
 s_add_u32 s35, s35, 18350080
 s_mul_i32 s64, s85, 40960
 s_add_u32 s64, s64, 18350080
 s_mul_i32 s36, s31, 20480
 s_add_u32 s36, s36, 18350080
 s_lshl_b32 s32, s20, 4
 s_lshl_b32 s33, s25, 3
 s_add_u32 s32, s32, s33
 s_lshl_b32 s33, s22, 1
 s_add_u32 s32, s32, s33
 s_mul_i32 s60, s32, 20480
 s_lshl_b32 s61, s32, 10
 s_add_u32 s61, s61, 12320768
 s_mul_i32 s32, s32, 55296
 s_add_u32 s32, s32, 5242880
 s_lshl_b32 s33, s30, 10
 s_add_u32 s41, s32, s33
 s_lshl_b32 s33, s85, 10
 s_add_u32 s84, s32, s33
 s_lshr_b32 s33, s31, 1
 s_lshl_b32 s33, s33, 10
 s_add_u32 s42, s32, s33
 s_and_b32 s33, s31, 1
 s_lshl_b32 s32, s33, 9
 s_add_u32 s82, s42, s32
 s_lshl_b32 s33, s33, 3
 s_add_u32 s42, s42, s33
 s_cmp_eq_u32 s31, 255
 s_cselect_b32 s82, 33554432, s82
 s_cselect_b32 s36, 33554432, s36
 s_cselect_b32 s42, 33554432, s42
 v_and_b32 v49, 3, v40
 v_lshrrev_b32 v50, 3, v44
 v_lshl_add_u32 v49, v50, 2, v49
 v_min_u32 v49, 9, v49
 v_bfe_u32 v50, v40, 2, 1
 v_mad_u32_u24 v50, v50, 10, v49
 v_lshlrev_b32 v50, 1, v50
 v_add_u32 v50, 47104, v50
 v_mul_u32_u24 v51, 320, v43
 v_add_u32 v51, v51, v50
 ds_read_u16 v64, v51
 ds_read_u16 v65, v51 offset:40
 ds_read_u16 v66, v51 offset:80
 ds_read_u16 v67, v51 offset:120
 ds_read_u16 v68, v51 offset:160
 ds_read_u16 v69, v51 offset:200
 ds_read_u16 v70, v51 offset:240
 ds_read_u16 v71, v51 offset:280
 ds_read_u16 v72, v50 offset:640
 ds_read_u16 v73, v50 offset:680
 ds_read_u16 v74, v50 offset:720
 ds_read_u16 v75, v50 offset:760
 s_waitcnt lgkmcnt(10)
 v_lshl_or_b32 v64, v65, 16, v64
 s_waitcnt lgkmcnt(8)
 v_lshl_or_b32 v66, v67, 16, v66
 s_waitcnt lgkmcnt(6)
 v_lshl_or_b32 v68, v69, 16, v68
 s_waitcnt lgkmcnt(4)
 v_lshl_or_b32 v70, v71, 16, v70
 s_waitcnt lgkmcnt(2)
 v_lshl_or_b32 v72, v73, 16, v72
 s_waitcnt lgkmcnt(0)
 v_lshl_or_b32 v74, v75, 16, v74
 v_accvgpr_write_b32 a164, v64
 v_accvgpr_write_b32 a165, v66
 v_accvgpr_write_b32 a166, v68
 v_accvgpr_write_b32 a167, v70
 v_cmp_eq_u32 vcc, 0, v43
 v_accvgpr_write_b32 a170, 0
 v_accvgpr_write_b32 a174, 0
 v_cndmask_b32 v45, 0, v72, vcc
 v_cndmask_b32 v46, v72, 0, vcc
 v_accvgpr_write_b32 a168, v45
 v_accvgpr_write_b32 a172, v46
 v_accvgpr_write_b32 a171, 0
 v_accvgpr_write_b32 a175, 0
 v_cndmask_b32 v45, 0, v74, vcc
 v_cndmask_b32 v46, v74, 0, vcc
 v_accvgpr_write_b32 a169, v45
 v_accvgpr_write_b32 a173, v46
 v_mov_b32 v98, s100
 v_mov_b32 v99, s101
 s_lshl_b32 s30, s2, 7
 s_add_u32 s30, s30, 13926400
 s_cmp_eq_u32 s22, 0
 s_cselect_b32 s30, s30, 33554432
 v_lshlrev_b32 v45, 1, v22
 s_waitcnt vmcnt(8)
 s_barrier
 s_mov_b64 exec, 0xffff
 buffer_store_dwordx2 v[98:99], v45, s[8:11], s30 offen sc1
 s_mov_b64 exec, -1
 s_mov_b32 s65, 4096
 s_mov_b32 s66, 8192
 s_mov_b32 s67, 12288
 s_mov_b32 s68, 16384
 s_mov_b32 s69, 20480
 s_mov_b32 s70, 24576
 s_mov_b32 s71, 28672
 s_mov_b32 s72, 32768
 s_mov_b32 s73, 36864
 s_mov_b32 s74, 40960
 s_mov_b32 s75, 45056
 s_mov_b32 s76, 49152
 s_mov_b32 s77, 53248
 s_mov_b32 s78, 57344
 s_mov_b32 s79, 61440
 s_mov_b32 s80, 65536
 s_mov_b32 s81, 69632
 s_lshl_b32 s30, s20, 4
 s_lshl_b32 s31, s22, 2
 s_add_u32 s30, s30, s31
 v_and_b32 v45, 1, v42
 v_add_u32 v45, s30, v45
 v_mul_u32_u24 v46, 55296, v45
 s_mov_b32 s0, 110592
 v_lshl_add_u32 v46, v41, 4, v46
 v_lshl_add_u32 v47, v43, 8, v46
 s_mul_i32 s31, s30, 20480
 v_add_u32 v4, s31, v1
 v_add_u32 v5, 40960, v4
 s_lshl_b32 s16, s30, 10
 s_add_u32 s16, s16, 12320768
 s_mul_i32 s31, s23, 5120
 s_add_u32 s31, s31, 5277696
 s_lshl_b32 s33, s24, 9
 s_add_u32 s33, s33, s31
 v_add_u32 v6, s33, v47
 s_and_b32 s33, s24, 3
 s_lshl_b32 s33, s33, 8
 s_add_u32 s31, s31, s33
 s_lshr_b32 s33, s24, 2
 s_lshl_b32 s33, s33, 3
 s_add_u32 s31, s31, s33
 s_add_u32 s31, s31, 4096
 v_add_u32 v7, s31, v46
 v_lshl_add_u32 v7, v43, 25, v7
 v_and_b32 v46, 7, v40
 s_lshl_b32 s30, s22, 6
 s_add_u32 s30, s30, s20
 v_lshl_add_u32 v54, v46, 3, s30
 s_and_b32 s30, s21, 28
 s_add_u32 s30, s30, s22
 s_lshl_b32 s30, s30, 3
 v_add_u32 v46, s30, v46
 v_cmp_eq_u32 vcc, 0, v43
 s_nop 1
 v_cndmask_b32 v55, v46, v54, vcc
 v_lshlrev_b32 v55, 7, v55
 v_lshlrev_b32 v54, 7, v54
 v_add_u32 v55, 13926400, v55
 v_add_u32 v54, 13893632, v54
 buffer_load_dwordx2 v[98:99], v54, s[8:11], 0 offen sc1
 s_mov_b64 exec, 0
 s_cmp_eq_u32 s22, 0
 s_cbranch_scc1 pad0
 s_cmp_eq_u32 s22, 1
 s_cbranch_scc1 pad1
 s_cmp_eq_u32 s22, 2
 s_cbranch_scc1 pad2
 s_branch pad3
padret:
 s_mov_b64 exec, -1
 s_branch padchk
hspin_1:
 buffer_load_dwordx2 v[98:99], v54, s[8:11], 0 offen sc1
padchk:
 s_waitcnt vmcnt(0) lgkmcnt(0)
 v_subrev_u32 v98, s100, v98
 v_xor_b32 v99, s101, v99
 v_and_or_b32 v99, v98, -16, v99
 v_cmp_ne_u32 vcc, 0, v99
 s_cbranch_vccz hok_2
 s_add_u32 s29, s29, 1
 s_cmp_lt_u32 s29, 524288
 s_cbranch_scc1 hspin_1
hok_2:
 buffer_load_dwordx4 a[0:3], v4, s[8:11], 0 offen sc1
 buffer_load_dwordx4 a[4:7], v4, s[8:11], s69 offen sc1
 buffer_load_dwordx4 a[8:11], v5, s[8:11], 0 offen sc1
 buffer_load_dwordx4 a[12:15], v5, s[8:11], s69 offen sc1
 buffer_load_dwordx4 a[16:19], v4, s[8:11], 0 offen offset:1024 sc1
 buffer_load_dwordx4 a[20:23], v4, s[8:11], s69 offen offset:1024 sc1
 buffer_load_dwordx4 a[24:27], v5, s[8:11], 0 offen offset:1024 sc1
 buffer_load_dwordx4 a[28:31], v5, s[8:11], s69 offen offset:1024 sc1
 v_cmp_ne_u32 vcc, s87, v98
 s_nop 1
 v_mov_b32 v46, vcc_lo
 s_lshl_b32 s30, s22, 2
 v_mov_b32 v47, s30
 ds_write_b32 v47, v46 offset:1792
 buffer_load_dwordx2 v[98:99], v55, s[8:11], 0 offen sc1
 buffer_load_dwordx4 a[32:35], v4, s[8:11], 0 offen offset:2048 sc1
 buffer_load_dwordx4 a[36:39], v4, s[8:11], s69 offen offset:2048 sc1
 buffer_load_dwordx4 a[40:43], v5, s[8:11], 0 offen offset:2048 sc1
 buffer_load_dwordx4 a[44:47], v5, s[8:11], s69 offen offset:2048 sc1
 s_waitcnt lgkmcnt(0)
 s_barrier
 s_cmp_ge_u32 s2, 108
 s_cbranch_scc1 st_w2b
 ds_read_b64_tr_b16 v[234:235], v61
 ds_read_b64_tr_b16 v[236:237], v61 offset:512
 ds_read_b64_tr_b16 v[238:239], v61 offset:4096
 ds_read_b64_tr_b16 v[240:241], v61 offset:4608
 ds_read_b64_tr_b16 v[242:243], v61 offset:8192
 ds_read_b64_tr_b16 v[244:245], v61 offset:8704
 ds_read_b64_tr_b16 v[246:247], v61 offset:12288
 ds_read_b64_tr_b16 v[248:249], v61 offset:12800
 ds_read_b64_tr_b16 v[250:251], v61 offset:16384
 ds_read_b64_tr_b16 v[252:253], v61 offset:16896
 s_waitcnt lgkmcnt(9)
 v_dot2_f32_bf16 v254, v234, v97, 0
 v_dot2_f32_bf16 v254, v235, v97, v254
 s_waitcnt lgkmcnt(8)
 v_dot2_f32_bf16 v254, v236, v97, v254
 v_dot2_f32_bf16 v254, v237, v97, v254
 s_waitcnt lgkmcnt(7)
 v_dot2_f32_bf16 v254, v238, v97, v254
 v_dot2_f32_bf16 v254, v239, v97, v254
 s_waitcnt lgkmcnt(6)
 v_dot2_f32_bf16 v254, v240, v97, v254
 v_dot2_f32_bf16 v254, v241, v97, v254
 s_waitcnt lgkmcnt(5)
 v_dot2_f32_bf16 v254, v242, v97, v254
 v_dot2_f32_bf16 v254, v243, v97, v254
 s_waitcnt lgkmcnt(4)
 v_dot2_f32_bf16 v254, v244, v97, v254
 v_dot2_f32_bf16 v254, v245, v97, v254
 s_waitcnt lgkmcnt(3)
 v_dot2_f32_bf16 v254, v246, v97, v254
 v_dot2_f32_bf16 v254, v247, v97, v254
 s_waitcnt lgkmcnt(2)
 v_dot2_f32_bf16 v254, v248, v97, v254
 v_dot2_f32_bf16 v254, v249, v97, v254
 s_waitcnt lgkmcnt(1)
 v_dot2_f32_bf16 v254, v250, v97, v254
 v_dot2_f32_bf16 v254, v251, v97, v254
 s_waitcnt lgkmcnt(0)
 v_dot2_f32_bf16 v254, v252, v97, v254
 v_dot2_f32_bf16 v254, v253, v97, v254
 s_nop 2
 v_mov_b32 v46, v254
 s_nop 1
 v_permlane32_swap_b32 v254, v46
 v_add_f32 v254, v254, v46
 v_mov_b32 v46, v254
 s_nop 1
 v_permlane16_swap_b32 v254, v46
 v_add_f32 v254, v254, v46
 s_branch st_j2
st_w2b:
 ds_read_b64_tr_b16 v[234:235], v61
 ds_read_b64_tr_b16 v[236:237], v61 offset:2560
 ds_read_b64_tr_b16 v[238:239], v61 offset:8
 ds_read_b64_tr_b16 v[240:241], v61 offset:2568
 ds_read_b64_tr_b16 v[242:243], v61 offset:64
 ds_read_b64_tr_b16 v[244:245], v61 offset:2624
 ds_read_b64_tr_b16 v[246:247], v61 offset:72
 ds_read_b64_tr_b16 v[248:249], v61 offset:2632
 ds_read_b64_tr_b16 v[250:251], v62 offset:128
 ds_read_b64_tr_b16 v[252:253], v62 offset:2688
 s_waitcnt lgkmcnt(0)
st_j2:
 s_add_u32 s6, s4, 4096
 v_lshlrev_b32 v255, 2, v44
 buffer_store_dwordx4 v[234:237], v1, s[8:11], s4 offen sc1
 buffer_store_dwordx4 v[238:241], v1, s[8:11], s4 offen offset:1024 sc1
 buffer_store_dwordx4 v[242:245], v1, s[8:11], s4 offen offset:2048 sc1
 buffer_store_dwordx4 v[246:249], v1, s[8:11], s4 offen offset:3072 sc1
 buffer_store_dwordx4 v[250:253], v1, s[8:11], s6 offen sc1
 buffer_store_dword v254, v255, s[8:11], s5 offen sc1
 s_lshl_b32 s31, s21, 14
 s_lshl_b32 s32, s20, 11
 s_add_u32 s31, s31, s32
 s_add_u32 s43, s31, 12582912
 v_mov_b32 v92, -1
 v_mov_b32 v93, -1
 v_mov_b32 v94, -1
 v_mov_b32 v95, -1
 v_mov_b32 v96, 0
 v_lshrrev_b32 v45, 7, v0
 v_and_b32 v46, 0x7ff, v2
 v_lshl_add_u32 v45, v45, 19, v46
 s_lshl_b32 s31, s20, 5
 s_add_u32 s31, s31, s21
 s_lshl_b32 s31, s31, 8
 s_add_u32 s31, s31, 13631488
 s_cmp_eq_u32 s22, 0
 s_cselect_b32 s31, s31, 33554432
 buffer_store_dwordx4 v[92:95], v45, s[8:11], s43 offen sc1
 buffer_store_dword v96, v22, s[8:11], s31 offen sc1
 buffer_load_dwordx4 a[48:51], v4, s[8:11], 0 offen offset:3072 sc1
 buffer_load_dwordx4 a[52:55], v4, s[8:11], s69 offen offset:3072 sc1
 buffer_load_dwordx4 a[56:59], v5, s[8:11], 0 offen offset:3072 sc1
 buffer_load_dwordx4 a[60:63], v5, s[8:11], s69 offen offset:3072 sc1
 v_mov_b32 v47, 0
 ds_read_b128 v[76:79], v47 offset:1792
 s_waitcnt vmcnt(16)
 v_xor_b32 v98, s100, v98
 v_xor_b32 v99, s101, v99
 v_or_b32 v98, v98, v99
 v_cmp_ne_u32 vcc, 0, v98
 s_cbranch_vccnz hretry_3
hback_4:
 s_barrier
 s_waitcnt lgkmcnt(0)
 v_or3_b32 v76, v76, v77, v78
 v_or_b32 v76, v76, v79
 s_nop 0
 v_readfirstlane_b32 s87, v76
 v_lshlrev_b32 v45, 5, v44
 s_add_u32 m0, s27, 81920
 s_add_u32 s85, s34, 0
 buffer_load_dwordx4 v2, s[8:11], s85 offen sc1 lds
 v_cmp_gt_u32 vcc, 28, v44
 v_mov_b32 v46, 1280
 s_nop 0
 v_cndmask_b32 v233, v46, v45, vcc
 v_lshlrev_b32 v45, 4, v44
 v_cmp_gt_u32 vcc, 20, v44
 v_mov_b32 v46, 512
 s_nop 0
 v_cndmask_b32 v49, v46, v45, vcc
 v_and_b32 v80, 0xffff, v100
 v_lshrrev_b32 v81, 16, v100
 buffer_load_dwordx4 a[64:67], v4, s[8:11], s65 offen sc1
 v_lshlrev_b32 v84, 16, v102
 v_and_b32 v85, 0xffff0000, v102
 v_and_b32 v82, 0xffff, v101
 v_lshrrev_b32 v83, 16, v101
 v_lshlrev_b32 v86, 16, v103
 v_and_b32 v87, 0xffff0000, v103
 ds_write2_b32 v233, v80, v81 offset0:65 offset1:67
 ds_write2_b32 v233, v82, v83 offset0:69 offset1:71
 ds_write_b128 v49, v[84:87] offset:1152
 buffer_load_dwordx4 a[68:71], v4, s[8:11], s70 offen sc1
 buffer_load_dwordx4 a[72:75], v5, s[8:11], s65 offen sc1
 buffer_load_dwordx4 a[76:79], v5, s[8:11], s70 offen sc1
 s_add_u32 m0, s27, 86016
 s_add_u32 s85, s34, 4096
 buffer_load_dwordx4 v2, s[8:11], s85 offen sc1 lds
 buffer_load_dwordx4 a[80:83], v4, s[8:11], s65 offen offset:1024 sc1
 buffer_load_dwordx4 a[84:87], v4, s[8:11], s70 offen offset:1024 sc1
 buffer_load_dwordx4 a[88:91], v5, s[8:11], s65 offen offset:1024 sc1
 s_add_u32 m0, s27, 90112
 s_add_u32 s85, s34, 8192
 buffer_load_dwordx4 v2, s[8:11], s85 offen sc1 lds
 buffer_load_dwordx4 a[92:95], v5, s[8:11], s70 offen offset:1024 sc1
 buffer_load_dwordx4 a[96:99], v4, s[8:11], s65 offen offset:2048 sc1
 buffer_load_dwordx4 v[104:107], v4, s[8:11], s70 offen offset:2048 sc1
 s_add_u32 m0, s27, 94208
 s_add_u32 s85, s34, 12288
 buffer_load_dwordx4 v2, s[8:11], s85 offen sc1 lds
 buffer_load_dwordx4 v[108:111], v5, s[8:11], s65 offen offset:2048 sc1
 buffer_load_dwordx4 v[112:115], v5, s[8:11], s70 offen offset:2048 sc1
 buffer_load_dwordx4 v[116:119], v4, s[8:11], s65 offen offset:3072 sc1
 s_add_u32 m0, s27, 98304
 s_add_u32 s85, s34, 16384
 buffer_load_dwordx4 v2, s[8:11], s85 offen sc1 lds
 buffer_load_dwordx4 v[120:123], v4, s[8:11], s70 offen offset:3072 sc1
 buffer_load_dwordx4 v[124:127], v5, s[8:11], s65 offen offset:3072 sc1
 v_add_u32 v25, 81920, v1
 v_add_u32 v26, 122880, v1
 s_waitcnt vmcnt(19)
 s_barrier
 ds_read_b128 v[152:155], v25
 ds_read_b128 v[156:159], v25 offset:1024
 ds_read_b128 v[160:163], v25 offset:2048
 ds_read_b128 v[164:167], v25 offset:3072
 s_mov_b32 s92, 0xffff0000
 s_mov_b32 s93, 0
 s_mov_b32 s94, -1
 s_mov_b32 s95, 0
 s_waitcnt lgkmcnt(2)
 v_mfma_f32_16x16x32_bf16 v[40:43], v[152:155], a[0:3], 0
 s_waitcnt vmcnt(14)
 s_barrier
 ds_read_b128 v[168:171], v25 offset:4096
 s_lshl_b32 s31, s21, 13
 s_lshl_b32 s32, s22, 11
 s_add_u32 s31, s31, s32
 s_add_u32 s31, s31, 14286848
 v_and_b32 v228, 0x3c, v22
 buffer_load_dwordx4 v[236:239], v1, s[8:11], s31 offen sc1
 buffer_load_dwordx4 v[240:243], v1, s[8:11], s31 offen offset:1024 sc1
 buffer_load_dwordx4 v[128:131], v5, s[8:11], s70 offen offset:3072 sc1
 v_mfma_f32_16x16x32_bf16 v[56:59], v[152:155], a[4:7], 0
 ds_read_b128 v[172:175], v25 offset:5120
 ds_read_b128 v[176:179], v25 offset:6144
 v_mov_b32 v252, s100
 v_mov_b32 v253, s101
 s_lshl_b32 s30, s2, 3
 s_add_u32 s30, s30, 13959168
 s_cmp_eq_u32 s22, 0
 s_cselect_b32 s30, s30, 33554432
 s_mov_b64 exec, 1
 buffer_store_dwordx2 v[252:253], off, s[8:11], s30 sc1
 s_mov_b64 exec, -1
 v_mfma_f32_16x16x32_bf16 v[72:75], v[152:155], a[8:11], 0
 s_lshl_b32 s17, s20, 4
 s_lshl_b32 s18, s23, 2
 s_add_u32 s17, s17, s18
 v_mov_b32 v185, 0
 v_mfma_f32_16x16x32_bf16 v[88:91], v[152:155], a[12:15], 0
 s_mul_i32 s97, s22, 13
 s_min_u32 s18, s22, 1
 s_add_u32 s97, s97, s18
 v_mfma_f32_16x16x32_bf16 v[44:47], v[156:159], a[0:3], 0
 ds_read_b128 v[180:183], v25 offset:7168
 s_mul_i32 s98, s22, 5120
 v_mov_b32 v186, 0
 v_mfma_f32_16x16x32_bf16 v[60:63], v[156:159], a[4:7], 0
 s_add_u32 s98, s98, 5277696
 s_lshl_b32 s99, s97, 10
 s_add_u32 s99, s99, 5242880
 v_add_u32 v255, 81920, v3
 v_mfma_f32_16x16x32_bf16 v[76:79], v[156:159], a[8:11], 0
 s_add_u32 m0, s27, 102400
 s_add_u32 s85, s34, 20480
 buffer_load_dwordx4 v2, s[8:11], s85 offen sc1 lds
 s_add_u32 s18, s22, 1
 v_mfma_f32_16x16x32_bf16 v[92:95], v[156:159], a[12:15], 0
 s_waitcnt lgkmcnt(4)
 s_and_b32 s18, s18, 3
 s_add_u32 s18, s18, s17
 s_mul_i32 s52, s18, 55296
 v_mov_b32 v187, 0
 v_mfma_f32_16x16x32_bf16 v[48:51], v[160:163], a[0:3], 0
 s_waitcnt vmcnt(15)
 s_barrier
 ds_read_b128 v[152:155], v25 offset:8192
 s_add_u32 s52, s52, s98
 v_mfma_f32_16x16x32_bf16 v[64:67], v[160:163], a[4:7], 0
 s_mul_i32 s56, s18, 55296
 s_add_u32 s56, s56, s99
 s_add_u32 s18, s22, 2
 v_mov_b32 v189, 0
 v_mfma_f32_16x16x32_bf16 v[80:83], v[160:163], a[8:11], 0
 s_and_b32 s18, s18, 3
 s_add_u32 s18, s18, s17
 v_mov_b32 v190, 0
 v_mfma_f32_16x16x32_bf16 v[96:99], v[160:163], a[12:15], 0
 s_mul_i32 s53, s18, 55296
 s_add_u32 s53, s53, s98
 s_mul_i32 s57, s18, 55296
 v_mov_b32 v191, 0
 v_mfma_f32_16x16x32_bf16 v[52:55], v[164:167], a[0:3], 0
 ds_read_b128 v[156:159], v25 offset:9216
 buffer_load_dwordx4 v[208:211], v1, s[8:11], s16 offen sc1
 buffer_load_dwordx4 v[132:135], v4, s[8:11], s66 offen sc1
 v_mfma_f32_16x16x32_bf16 v[68:71], v[164:167], a[4:7], 0
 s_add_u32 s57, s57, s99
 s_add_u32 s18, s22, 3
 s_and_b32 s18, s18, 3
 v_mfma_f32_16x16x32_bf16 v[84:87], v[164:167], a[8:11], 0
 s_add_u32 s18, s18, s17
 s_mul_i32 s54, s18, 55296
 s_add_u32 s54, s54, s98
 v_mov_b32 v193, 0
 v_mfma_f32_16x16x32_bf16 v[100:103], v[164:167], a[12:15], 0
 s_waitcnt lgkmcnt(4)
 s_mul_i32 s58, s18, 55296
 s_add_u32 s58, s58, s99
 s_add_u32 s18, s22, 4
 v_mov_b32 v194, 0
 v_mfma_f32_16x16x32_bf16 v[40:43], v[168:171], a[16:19], v[40:43]
 ds_read_b128 v[160:163], v25 offset:10240
 s_and_b32 s18, s18, 3
 v_mfma_f32_16x16x32_bf16 v[56:59], v[168:171], a[20:23], v[56:59]
 s_add_u32 s18, s18, s17
 s_mul_i32 s55, s18, 55296
 s_add_u32 s55, s55, s98
 v_mov_b32 v195, 0
 v_mfma_f32_16x16x32_bf16 v[72:75], v[168:171], a[24:27], v[72:75]
 buffer_load_dwordx4 v[212:215], v1, s[8:11], s16 offen offset:1024 sc1
 buffer_load_dwordx4 v[136:139], v4, s[8:11], s71 offen sc1
 v_mfma_f32_16x16x32_bf16 v[88:91], v[168:171], a[28:31], v[88:91]
 s_mul_i32 s59, s18, 55296
 s_add_u32 s59, s59, s99
 v_mov_b32 v197, 0
 v_mfma_f32_16x16x32_bf16 v[44:47], v[172:175], a[16:19], v[44:47]
 ds_read_b128 v[164:167], v25 offset:11264
 s_mul_i32 s37, s24, 276480
 s_mul_i32 s19, s97, 5120
 v_mfma_f32_16x16x32_bf16 v[60:63], v[172:175], a[20:23], v[60:63]
 s_add_u32 s37, s37, s19
 s_add_u32 s37, s37, 20971520
 v_mov_b32 v198, 0
 v_mfma_f32_16x16x32_bf16 v[76:79], v[172:175], a[24:27], v[76:79]
 v_add_u32 v39, s37, v1
 v_mov_b32 v199, 0
 v_mfma_f32_16x16x32_bf16 v[92:95], v[172:175], a[28:31], v[92:95]
 s_waitcnt lgkmcnt(4)
 s_mul_i32 s62, s24, 102400
 s_mul_i32 s19, s22, 25600
 s_add_u32 s62, s62, s19
 v_mfma_f32_16x16x32_bf16 v[48:51], v[176:179], a[16:19], v[48:51]
 s_waitcnt vmcnt(15)
 s_barrier
 ds_read_b128 v[168:171], v25 offset:12288
 buffer_load_dwordx4 v[216:219], v1, s[8:11], s16 offen offset:2048 sc1
 buffer_load_dwordx4 v[140:143], v5, s[8:11], s66 offen sc1
 v_mfma_f32_16x16x32_bf16 v[64:67], v[176:179], a[20:23], v[64:67]
 s_add_u32 s62, s62, 17301504
 s_add_u32 s17, s17, s22
 s_mul_i32 s39, s17, 20480
 ds_read_b128 a[176:179], v255
 v_mfma_f32_16x16x32_bf16 v[80:83], v[176:179], a[24:27], v[80:83]
 s_mul_i32 s19, s24, 160
 s_add_u32 s63, s39, s19
 s_mul_i32 s19, s24, 2560
 v_mov_b32 v201, 0
 v_mfma_f32_16x16x32_bf16 v[96:99], v[176:179], a[28:31], v[96:99]
 s_add_u32 s39, s39, s19
 s_lshl_b32 s40, s17, 10
 s_lshr_b32 s19, s24, 2
 ds_read_b128 a[180:183], v255 offset:1024
 v_mfma_f32_16x16x32_bf16 v[52:55], v[180:183], a[16:19], v[52:55]
 ds_read_b128 v[172:175], v25 offset:13312
 s_lshl_b32 s19, s19, 8
 v_mfma_f32_16x16x32_bf16 v[68:71], v[180:183], a[20:23], v[68:71]
 s_add_u32 s40, s40, s19
 s_and_b32 s19, s24, 3
 s_lshl_b32 s19, s19, 2
 ds_read_b128 a[184:187], v255 offset:2048
 v_mfma_f32_16x16x32_bf16 v[84:87], v[180:183], a[24:27], v[84:87]
 buffer_load_dwordx4 v[220:223], v1, s[8:11], s16 offen offset:3072 sc1
 buffer_load_dwordx4 v[144:147], v5, s[8:11], s71 offen sc1
 v_mfma_f32_16x16x32_bf16 v[100:103], v[180:183], a[28:31], v[100:103]
 s_waitcnt lgkmcnt(7)
 s_add_u32 s40, s40, s19
 s_add_u32 s40, s40, 12320768
 s_mul_i32 s83, s22, 10240
 ds_read_b128 a[188:191], v255 offset:3072
 v_mfma_f32_16x16x32_bf16 v[40:43], v[152:155], a[32:35], v[40:43]
 ds_read_b128 v[176:179], v25 offset:14336
 s_add_u32 s83, s83, 2048
 v_mov_b32 v202, 0
 v_mfma_f32_16x16x32_bf16 v[56:59], v[152:155], a[36:39], v[56:59]
 s_mul_i32 s7, s22, 5120
 s_add_u32 s7, s7, 2048
 s_lshl_b32 s17, s20, 13
 v_mov_b32 v203, 0
 v_mfma_f32_16x16x32_bf16 v[72:75], v[152:155], a[40:43], v[72:75]
 s_add_u32 s17, s17, 13631488
 s_lshl_b32 s18, s23, 7
 v_mfma_f32_16x16x32_bf16 v[88:91], v[152:155], a[44:47], v[88:91]
 s_lshl_b32 s19, s24, 4
 s_add_u32 s18, s18, s19
 s_lshl_b32 s19, s22, 2
 v_mov_b32 v205, 0
 v_mfma_f32_16x16x32_bf16 v[44:47], v[156:159], a[32:35], v[44:47]
 s_add_u32 m0, s27, 106496
 ds_read_b128 v[180:183], v25 offset:15360
 s_add_u32 s85, s34, 24576
 buffer_load_dwordx4 v2, s[8:11], s85 offen sc1 lds
 v_mfma_f32_16x16x32_bf16 v[60:63], v[156:159], a[36:39], v[60:63]
 s_add_u32 s18, s18, s19
 s_add_u32 s44, s17, s18
 s_lshl_b32 s18, s22, 7
 v_mov_b32 v206, 0
 v_mfma_f32_16x16x32_bf16 v[76:79], v[156:159], a[40:43], v[76:79]
 s_add_u32 s45, s17, s18
 s_lshl_b32 s18, s23, 9
 s_lshl_b32 s19, s22, 7
 v_mov_b32 v207, 0
 v_mfma_f32_16x16x32_bf16 v[92:95], v[156:159], a[44:47], v[92:95]
 s_waitcnt lgkmcnt(8)
 buffer_load_dwordx4 v[148:151], v4, s[8:11], s66 offen offset:1024 sc1
 s_add_u32 s18, s18, s19
 v_mfma_f32_16x16x32_bf16 v[48:51], v[160:163], a[32:35], v[48:51]
 s_waitcnt vmcnt(17) lgkmcnt(2)
 s_barrier
 ds_read_b128 v[152:155], v25 offset:16384
 s_lshl_b32 s19, s24, 2
 v_mfma_f32_16x16x32_bf16 v[64:67], v[160:163], a[36:39], v[64:67]
 s_add_u32 s18, s18, s19
 s_add_u32 s18, s18, 512
 s_add_u32 s46, s17, s18
 v_mfma_f32_16x16x32_bf16 v[80:83], v[160:163], a[40:43], v[80:83]
 s_lshl_b32 s18, s22, 9
 s_lshl_b32 s19, s23, 7
 s_add_u32 s18, s18, s19
 v_mfma_f32_16x16x32_bf16 v[96:99], v[160:163], a[44:47], v[96:99]
 s_add_u32 s18, s18, 512
 s_add_u32 s47, s17, s18
 v_mfma_f32_16x16x32_bf16 v[52:55], v[164:167], a[32:35], v[52:55]
 ds_read_b128 v[156:159], v25 offset:17408
 s_lshr_b32 s98, s22, 1
 s_lshl_b32 s98, s98, 7
 v_mfma_f32_16x16x32_bf16 v[68:71], v[164:167], a[36:39], v[68:71]
 s_and_b32 s99, s22, 1
 s_lshl_b32 s99, s99, 2
 s_add_u32 s98, s98, s99
 v_mfma_f32_16x16x32_bf16 v[84:87], v[164:167], a[40:43], v[84:87]
 s_lshl_b32 s18, s23, 8
 s_lshl_b32 s19, s24, 3
 v_mfma_f32_16x16x32_bf16 v[100:103], v[164:167], a[44:47], v[100:103]
 s_add_u32 s18, s18, s19
 s_add_u32 s18, s18, s98
 s_add_u32 s18, s18, 2560
 v_mfma_f32_16x16x32_bf16 v[40:43], v[168:171], a[48:51], v[40:43]
 ds_read_b128 v[160:163], v25 offset:18432
 buffer_load_dwordx4 a[0:3], v4, s[8:11], s71 offen offset:1024 sc1
 v_mfma_f32_16x16x32_bf16 v[56:59], v[168:171], a[52:55], v[56:59]
 s_add_u32 s48, s17, s18
 s_lshl_b32 s18, s25, 9
 s_lshl_b32 s19, s22, 7
 v_mfma_f32_16x16x32_bf16 v[72:75], v[168:171], a[56:59], v[72:75]
 s_add_u32 s18, s18, s19
 s_add_u32 s18, s18, 2560
 s_add_u32 s49, s17, s18
 v_mfma_f32_16x16x32_bf16 v[88:91], v[168:171], a[60:63], v[88:91]
 s_lshr_b32 s18, s21, 2
 s_lshl_b32 s18, s18, 8
 s_and_b32 s19, s21, 3
 v_mfma_f32_16x16x32_bf16 v[44:47], v[172:175], a[48:51], v[44:47]
 ds_read_b128 v[164:167], v25 offset:19456
 s_lshl_b32 s19, s19, 3
 v_mfma_f32_16x16x32_bf16 v[60:63], v[172:175], a[52:55], v[60:63]
 s_add_u32 s18, s18, s19
 s_add_u32 s18, s18, s98
 s_add_u32 s18, s18, 3584
 v_mfma_f32_16x16x32_bf16 v[76:79], v[172:175], a[56:59], v[76:79]
 buffer_load_dwordx4 a[4:7], v5, s[8:11], s66 offen offset:1024 sc1
 s_add_u32 s50, s17, s18
 v_mfma_f32_16x16x32_bf16 v[92:95], v[172:175], a[60:63], v[92:95]
 s_waitcnt lgkmcnt(4)
 s_add_u32 m0, s27, 110592
 s_add_u32 s85, s34, 28672
 buffer_load_dwordx4 v2, s[8:11], s85 offen sc1 lds
 buffer_load_dwordx4 a[8:11], v5, s[8:11], s71 offen offset:1024 sc1
 v_mfma_f32_16x16x32_bf16 v[48:51], v[176:179], a[48:51], v[48:51]
 s_waitcnt vmcnt(14)
 s_barrier
 ds_read_b128 v[168:171], v25 offset:20480
 v_add_f32 v236, v236, v240
 v_mfma_f32_16x16x32_bf16 v[64:67], v[176:179], a[52:55], v[64:67]
 v_add_f32 v237, v237, v241
 s_lshl_b32 s18, s25, 10
 s_lshl_b32 s19, s22, 8
 v_mfma_f32_16x16x32_bf16 v[80:83], v[176:179], a[56:59], v[80:83]
 v_add_f32 v238, v238, v242
 v_add_f32 v239, v239, v243
 v_mfma_f32_16x16x32_bf16 v[96:99], v[176:179], a[60:63], v[96:99]
 v_mov_b32 v240, v236
 s_add_u32 s18, s18, s19
 v_mfma_f32_16x16x32_bf16 v[52:55], v[180:183], a[48:51], v[52:55]
 ds_read_b128 v[172:175], v25 offset:21504
 v_mov_b32 v241, v237
 v_mfma_f32_16x16x32_bf16 v[68:71], v[180:183], a[52:55], v[68:71]
 v_mov_b32 v242, v238
 v_mov_b32 v243, v239
 v_mfma_f32_16x16x32_bf16 v[84:87], v[180:183], a[56:59], v[84:87]
 v_permlane32_swap_b32 v236, v240
 v_mfma_f32_16x16x32_bf16 v[100:103], v[180:183], a[60:63], v[100:103]
 s_and_b32 s19, s23, 1
 s_lshl_b32 s19, s19, 7
 s_add_u32 s18, s18, s19
 s_barrier
 s_waitcnt lgkmcnt(4)
 v_mfma_f32_16x16x32_bf16 v[40:43], v[152:155], a[64:67], v[40:43]
 ds_read_b128 v[176:179], v25 offset:22528
 s_add_u32 s18, s18, 3584
 v_mfma_f32_16x16x32_bf16 v[56:59], v[152:155], a[68:71], v[56:59]
 v_permlane32_swap_b32 v237, v241
 v_mfma_f32_16x16x32_bf16 v[72:75], v[152:155], a[72:75], v[72:75]
 v_permlane32_swap_b32 v238, v242
 v_mfma_f32_16x16x32_bf16 v[88:91], v[152:155], a[76:79], v[88:91]
 v_permlane32_swap_b32 v239, v243
 v_mfma_f32_16x16x32_bf16 v[44:47], v[156:159], a[64:67], v[44:47]
 ds_read_b128 v[180:183], v25 offset:23552
 v_add_f32 v236, v236, v240
 v_mfma_f32_16x16x32_bf16 v[60:63], v[156:159], a[68:71], v[60:63]
 buffer_load_dwordx4 a[12:15], v4, s[8:11], s66 offen offset:2048 sc1
 v_add_f32 v237, v237, v241
 v_mfma_f32_16x16x32_bf16 v[76:79], v[156:159], a[72:75], v[76:79]
 v_add_f32 v238, v238, v242
 s_add_u32 s51, s17, s18
 v_mfma_f32_16x16x32_bf16 v[92:95], v[156:159], a[76:79], v[92:95]
 s_add_u32 m0, s27, 114688
 buffer_load_dwordx4 a[16:19], v4, s[8:11], s71 offen offset:2048 sc1
 s_add_u32 s85, s34, 32768
 buffer_load_dwordx4 v2, s[8:11], s85 offen sc1 lds
 buffer_load_dwordx4 a[20:23], v5, s[8:11], s66 offen offset:2048 sc1
 buffer_load_dwordx4 a[24:27], v5, s[8:11], s71 offen offset:2048 sc1
 s_waitcnt lgkmcnt(4)
 v_mfma_f32_16x16x32_bf16 v[48:51], v[160:163], a[64:67], v[48:51]
 s_waitcnt vmcnt(10)
 s_barrier
 ds_read_b128 v[152:155], v25 offset:24576
 v_add_f32 v239, v239, v243
 v_mfma_f32_16x16x32_bf16 v[64:67], v[160:163], a[68:71], v[64:67]
 v_mov_b32 v240, v236
 s_lshl_b32 s96, s21, 2
 s_add_u32 s96, s96, s22
 v_mfma_f32_16x16x32_bf16 v[80:83], v[160:163], a[72:75], v[80:83]
 v_mov_b32 v241, v237
 v_mov_b32 v242, v238
 v_mfma_f32_16x16x32_bf16 v[96:99], v[160:163], a[76:79], v[96:99]
 v_mov_b32 v243, v239
 s_lshl_b32 s96, s96, 7
 v_add_f32 v208, v208, v209
 v_mfma_f32_16x16x32_bf16 v[52:55], v[164:167], a[64:67], v[52:55]
 ds_read_b128 v[156:159], v25 offset:25600
 s_add_u32 s96, s96, 1024
 v_mfma_f32_16x16x32_bf16 v[68:71], v[164:167], a[68:71], v[68:71]
 v_permlane16_swap_b32 v236, v240
 v_mfma_f32_16x16x32_bf16 v[84:87], v[164:167], a[72:75], v[84:87]
 v_permlane16_swap_b32 v237, v241
 v_mfma_f32_16x16x32_bf16 v[100:103], v[164:167], a[76:79], v[100:103]
 s_waitcnt lgkmcnt(4)
 v_permlane16_swap_b32 v238, v242
 v_mfma_f32_16x16x32_bf16 v[40:43], v[168:171], a[80:83], v[40:43]
 ds_read_b128 v[160:163], v25 offset:26624
 v_add_u32 v38, s62, v1
 v_mfma_f32_16x16x32_bf16 v[56:59], v[168:171], a[84:87], v[56:59]
 v_permlane16_swap_b32 v239, v243
 v_mfma_f32_16x16x32_bf16 v[72:75], v[168:171], a[88:91], v[72:75]
 v_add_f32 v236, v236, v240
 v_add_f32 v237, v237, v241
 v_mfma_f32_16x16x32_bf16 v[88:91], v[168:171], a[92:95], v[88:91]
 v_add_f32 v238, v238, v242
 v_add_f32 v239, v239, v243
 v_mfma_f32_16x16x32_bf16 v[44:47], v[172:175], a[80:83], v[44:47]
 ds_read_b128 v[164:167], v25 offset:27648
 s_lshl_b32 s32, s22, 8
 v_add_f32 v212, v212, v213
 v_mfma_f32_16x16x32_bf16 v[60:63], v[172:175], a[84:87], v[60:63]
 buffer_load_dwordx4 a[28:31], v4, s[8:11], s66 offen offset:3072 sc1
 v_lshl_add_u32 v229, v228, 2, s32
 v_mfma_f32_16x16x32_bf16 v[76:79], v[172:175], a[88:91], v[76:79]
 ds_write_b128 v229, v[236:239] offset:2048
 v_mfma_f32_16x16x32_bf16 v[92:95], v[172:175], a[92:95], v[92:95]
 s_waitcnt lgkmcnt(5)
 s_add_u32 m0, s27, 118784
 s_add_u32 s85, s34, 36864
 buffer_load_dwordx4 v2, s[8:11], s85 offen sc1 lds
 buffer_load_dwordx4 a[32:35], v4, s[8:11], s71 offen offset:3072 sc1
 buffer_load_dwordx4 a[36:39], v5, s[8:11], s66 offen offset:3072 sc1
 v_mfma_f32_16x16x32_bf16 v[48:51], v[176:179], a[80:83], v[48:51]
 s_waitcnt vmcnt(10) lgkmcnt(0)
 s_barrier
 ds_read_b128 v[168:171], v25 offset:28672
 v_mfma_f32_16x16x32_bf16 v[64:67], v[176:179], a[84:87], v[64:67]
 ds_read2st64_b32 v[236:237], v22 offset0:8 offset1:9
 v_add_f32 v210, v210, v211
 v_mfma_f32_16x16x32_bf16 v[80:83], v[176:179], a[88:91], v[80:83]
 ds_read2st64_b32 v[238:239], v22 offset0:10 offset1:11
 ds_read_b128 a[192:195], v255 offset:16384
 v_mfma_f32_16x16x32_bf16 v[96:99], v[176:179], a[92:95], v[96:99]
 buffer_load_dwordx4 v[28:31], v1, s[8:11], s39 offen sc1
 v_mfma_f32_16x16x32_bf16 v[52:55], v[180:183], a[80:83], v[52:55]
 ds_read_b128 v[172:175], v25 offset:29696
 ds_read_b128 a[196:199], v255 offset:17408
 v_mfma_f32_16x16x32_bf16 v[68:71], v[180:183], a[84:87], v[68:71]
 v_add_f32 v214, v214, v215
 v_add_f32 v210, v210, v208
 v_mfma_f32_16x16x32_bf16 v[84:87], v[180:183], a[88:91], v[84:87]
 ds_read_b128 a[200:203], v255 offset:18432
 v_add_f32 v214, v214, v212
 v_mfma_f32_16x16x32_bf16 v[100:103], v[180:183], a[92:95], v[100:103]
 ds_read_b128 a[204:207], v255 offset:19456
 v_mfma_f32_16x16x32_bf16 v[40:43], v[152:155], a[96:99], v[40:43]
 ds_read_b128 v[176:179], v25 offset:30720
 v_mov_b32 v211, v210
 v_mfma_f32_16x16x32_bf16 v[56:59], v[152:155], v[104:107], v[56:59]
pad0:
 s_cbranch_execz pad4
 s_waitcnt lgkmcnt(7)
 v_add_f32 v236, v236, v237
 v_mov_b32 v215, v214
 v_mfma_f32_16x16x32_bf16 v[72:75], v[152:155], v[108:111], v[72:75]
 s_waitcnt lgkmcnt(6)
 v_add_f32 v236, v236, v238
 v_mfma_f32_16x16x32_bf16 v[88:91], v[152:155], v[112:115], v[88:91]
 v_add_f32 v236, v236, v239
 v_cvt_pk_bf16_f32 v237, v236, v236
 v_mfma_f32_16x16x32_bf16 v[44:47], v[156:159], a[96:99], v[44:47]
 ds_read_b128 v[180:183], v25 offset:31744
 v_mfma_f32_16x16x32_bf16 v[60:63], v[156:159], v[104:107], v[60:63]
 buffer_load_dwordx4 a[40:43], v5, s[8:11], s71 offen offset:3072 sc1
 v_and_b32 v237, 0xffff0000, v237
 v_mfma_f32_16x16x32_bf16 v[76:79], v[156:159], v[108:111], v[76:79]
 v_sub_f32 v237, v236, v237
 v_mfma_f32_16x16x32_bf16 v[92:95], v[156:159], v[112:115], v[92:95]
 s_add_u32 m0, s27, 122880
 s_add_u32 s85, s34, 40960
 buffer_load_dwordx4 v2, s[8:11], s85 offen sc1 lds
 buffer_load_dwordx4 a[44:47], v4, s[8:11], s67 offen sc1
 buffer_load_dwordx4 a[48:51], v4, s[8:11], s72 offen sc1
 v_mfma_f32_16x16x32_bf16 v[48:51], v[160:163], a[96:99], v[48:51]
 s_waitcnt vmcnt(11) lgkmcnt(2)
 s_barrier
 ds_read_b128 v[152:155], v25 offset:32768
 v_cvt_pk_bf16_f32 v236, v236, v237
 v_mfma_f32_16x16x32_bf16 v[64:67], v[160:163], v[104:107], v[64:67]
 v_permlane16_swap_b32 v210, v211
 v_mfma_f32_16x16x32_bf16 v[80:83], v[160:163], v[108:111], v[80:83]
 ds_write_b32 v22, v236
 v_mfma_f32_16x16x32_bf16 v[96:99], v[160:163], v[112:115], v[96:99]
 buffer_load_dwordx4 v[32:35], v1, s[8:11], s39 offen offset:1024 sc1
 v_mfma_f32_16x16x32_bf16 v[52:55], v[164:167], a[96:99], v[52:55]
 ds_read_b128 v[156:159], v25 offset:33792
 v_mfma_f32_16x16x32_bf16 v[68:71], v[164:167], v[104:107], v[68:71]
 v_permlane16_swap_b32 v214, v215
 v_mfma_f32_16x16x32_bf16 v[84:87], v[164:167], v[108:111], v[84:87]
 v_add_f32 v210, v210, v211
 v_add_f32 v214, v214, v215
 v_mfma_f32_16x16x32_bf16 v[100:103], v[164:167], v[112:115], v[100:103]
 v_mov_b32 v211, v210
 v_mov_b32 v215, v214
 v_mfma_f32_16x16x32_bf16 v[40:43], v[168:171], v[116:119], v[40:43]
 ds_read_b128 v[160:163], v25 offset:34816
 v_mfma_f32_16x16x32_bf16 v[56:59], v[168:171], v[120:123], v[56:59]
 v_permlane32_swap_b32 v210, v211
 v_mfma_f32_16x16x32_bf16 v[72:75], v[168:171], v[124:127], v[72:75]
 v_permlane32_swap_b32 v214, v215
 v_mfma_f32_16x16x32_bf16 v[88:91], v[168:171], v[128:131], v[88:91]
 v_mul_f32 v209, 0xbacccccd, v210
 v_mul_f32 v213, 0xbacccccd, v214
 v_mfma_f32_16x16x32_bf16 v[44:47], v[172:175], v[116:119], v[44:47]
 ds_read_b128 v[164:167], v25 offset:35840
 v_mfma_f32_16x16x32_bf16 v[60:63], v[172:175], v[120:123], v[60:63]
 buffer_load_dwordx4 a[52:55], v5, s[8:11], s67 offen sc1
 v_mul_f32 v210, v209, v209
 v_mfma_f32_16x16x32_bf16 v[76:79], v[172:175], v[124:127], v[76:79]
 v_mul_f32 v214, v213, v213
 v_mfma_f32_16x16x32_bf16 v[92:95], v[172:175], v[128:131], v[92:95]
 s_waitcnt lgkmcnt(5)
 s_add_u32 m0, s27, 126976
 buffer_load_dwordx4 a[56:59], v5, s[8:11], s72 offen sc1
 s_add_u32 s85, s34, 45056
 buffer_load_dwordx4 v2, s[8:11], s85 offen sc1 lds
 buffer_load_dwordx4 a[60:63], v4, s[8:11], s67 offen offset:1024 sc1
 v_mfma_f32_16x16x32_bf16 v[48:51], v[176:179], v[116:119], v[48:51]
 s_waitcnt vmcnt(12)
 s_barrier
 ds_read_b128 v[168:171], v25 offset:36864
 v_fmac_f32 v210, 0xbacccccd, v211
 v_mfma_f32_16x16x32_bf16 v[64:67], v[176:179], v[120:123], v[64:67]
 v_fmac_f32 v214, 0xbacccccd, v215
 v_mfma_f32_16x16x32_bf16 v[80:83], v[176:179], v[124:127], v[80:83]
 v_min_f32 v210, 0, v210
 v_min_f32 v214, 0, v214
 v_mfma_f32_16x16x32_bf16 v[96:99], v[176:179], v[128:131], v[96:99]
 buffer_load_dwordx2 v[36:37], v8, s[8:11], s39 offen offset:2048 sc1
 v_mfma_f32_16x16x32_bf16 v[52:55], v[180:183], v[116:119], v[52:55]
 ds_read_b128 v[172:175], v25 offset:37888
 v_sub_f32 v210, 0x3727c5ac, v210
 v_mfma_f32_16x16x32_bf16 v[68:71], v[180:183], v[120:123], v[68:71]
 v_sub_f32 v214, 0x3727c5ac, v214
 v_mfma_f32_16x16x32_bf16 v[84:87], v[180:183], v[124:127], v[84:87]
 v_rsq_f32 v208, v210
 v_mfma_f32_16x16x32_bf16 v[100:103], v[180:183], v[128:131], v[100:103]
 v_rsq_f32 v212, v214
 s_barrier
 s_waitcnt lgkmcnt(4)
 v_mfma_f32_16x16x32_bf16 v[40:43], v[152:155], v[132:135], v[40:43]
 ds_read_b128 v[176:179], v25 offset:38912
 v_mfma_f32_16x16x32_bf16 v[56:59], v[152:155], v[136:139], v[56:59]
 v_cvt_pk_bf16_f32 v210, v209, v209
 v_mfma_f32_16x16x32_bf16 v[72:75], v[152:155], v[140:143], v[72:75]
 v_cvt_pk_bf16_f32 v214, v213, v213
 v_and_b32 v210, 0xffff0000, v210
 v_mfma_f32_16x16x32_bf16 v[88:91], v[152:155], v[144:147], v[88:91]
 v_and_b32 v214, 0xffff0000, v214
 v_mfma_f32_16x16x32_bf16 v[44:47], v[156:159], v[132:135], v[44:47]
 ds_read_b128 v[180:183], v25 offset:39936
 v_cndmask_b32 v210, 0, v210, s[92:93]
 v_mfma_f32_16x16x32_bf16 v[60:63], v[156:159], v[136:139], v[60:63]
 buffer_load_dwordx4 a[64:67], v4, s[8:11], s72 offen offset:1024 sc1
 v_cndmask_b32 v214, 0, v214, s[92:93]
 v_mfma_f32_16x16x32_bf16 v[76:79], v[156:159], v[140:143], v[76:79]
 v_sub_f32 v210, v209, v210
 v_mfma_f32_16x16x32_bf16 v[92:95], v[156:159], v[144:147], v[92:95]
 s_waitcnt lgkmcnt(4)
 s_add_u32 m0, s27, 131072
 buffer_load_dwordx4 a[68:71], v5, s[8:11], s67 offen offset:1024 sc1
 s_add_u32 s85, s34, 49152
 buffer_load_dwordx4 v2, s[8:11], s85 offen sc1 lds
 buffer_load_dwordx4 a[72:75], v5, s[8:11], s72 offen offset:1024 sc1
 v_mfma_f32_16x16x32_bf16 v[48:51], v[160:163], v[132:135], v[48:51]
 s_waitcnt vmcnt(12)
 s_barrier
 ds_read_b128 v[152:155], v26
 v_mfma_f32_16x16x32_bf16 v[64:67], v[160:163], v[136:139], v[64:67]
 v_sub_f32 v214, v213, v214
 v_cndmask_b32 v210, 0, v210, s[94:95]
 v_mfma_f32_16x16x32_bf16 v[80:83], v[160:163], v[140:143], v[80:83]
 v_cndmask_b32 v214, 0, v214, s[94:95]
 v_mfma_f32_16x16x32_bf16 v[96:99], v[160:163], v[144:147], v[96:99]
 v_cvt_pk_bf16_f32 v184, v210, v210
 v_cvt_pk_bf16_f32 v188, v214, v214
 v_mfma_f32_16x16x32_bf16 v[52:55], v[164:167], v[132:135], v[52:55]
 ds_read_b128 v[156:159], v26 offset:1024
 v_mfma_f32_16x16x32_bf16 v[68:71], v[164:167], v[136:139], v[68:71]
 v_cndmask_b32 v209, 1.0, v208, s[92:93]
 v_cndmask_b32 v213, 1.0, v212, s[92:93]
 v_mfma_f32_16x16x32_bf16 v[84:87], v[164:167], v[140:143], v[84:87]
 v_add_f32 v216, v216, v217
 v_mfma_f32_16x16x32_bf16 v[100:103], v[164:167], v[144:147], v[100:103]
 s_waitcnt lgkmcnt(4)
 v_add_f32 v220, v220, v221
 v_add_f32 v218, v218, v219
 v_mfma_f32_16x16x32_bf16 v[40:43], v[168:171], v[148:151], v[40:43]
 ds_read_b128 v[160:163], v26 offset:2048
 v_mfma_f32_16x16x32_bf16 v[56:59], v[168:171], a[0:3], v[56:59]
 v_add_f32 v222, v222, v223
 v_add_f32 v218, v218, v216
 v_mfma_f32_16x16x32_bf16 v[72:75], v[168:171], a[4:7], v[72:75]
 v_add_f32 v222, v222, v220
 v_mfma_f32_16x16x32_bf16 v[88:91], v[168:171], a[8:11], v[88:91]
 v_mov_b32 v219, v218
 v_mfma_f32_16x16x32_bf16 v[44:47], v[172:175], v[148:151], v[44:47]
 ds_read_b128 v[164:167], v26 offset:3072
 v_mov_b32 v223, v222
 v_mfma_f32_16x16x32_bf16 v[60:63], v[172:175], a[0:3], v[60:63]
 buffer_load_dwordx4 a[76:79], v4, s[8:11], s67 offen offset:2048 sc1
 v_mfma_f32_16x16x32_bf16 v[76:79], v[172:175], a[4:7], v[76:79]
 v_permlane16_swap_b32 v218, v219
 v_mfma_f32_16x16x32_bf16 v[92:95], v[172:175], a[8:11], v[92:95]
 s_add_u32 m0, s27, 135168
 buffer_load_dwordx4 a[80:83], v4, s[8:11], s72 offen offset:2048 sc1
 s_add_u32 s85, s34, 53248
 buffer_load_dwordx4 v2, s[8:11], s85 offen sc1 lds
 buffer_load_dwordx4 a[84:87], v5, s[8:11], s67 offen offset:2048 sc1
 buffer_load_dwordx4 a[88:91], v5, s[8:11], s72 offen offset:2048 sc1
 s_waitcnt lgkmcnt(4)
 v_mfma_f32_16x16x32_bf16 v[48:51], v[176:179], v[148:151], v[48:51]
 s_waitcnt vmcnt(11)
 s_barrier
 ds_read_b128 v[168:171], v26 offset:4096
 v_mfma_f32_16x16x32_bf16 v[64:67], v[176:179], a[0:3], v[64:67]
 ds_read_b128 a[208:211], v255 offset:32768
 v_mfma_f32_16x16x32_bf16 v[80:83], v[176:179], a[4:7], v[80:83]
 v_permlane16_swap_b32 v222, v223
 v_mfma_f32_16x16x32_bf16 v[96:99], v[176:179], a[8:11], v[96:99]
 ds_read_b128 a[212:215], v255 offset:33792
 v_add_f32 v218, v218, v219
 v_mfma_f32_16x16x32_bf16 v[52:55], v[180:183], v[148:151], v[52:55]
 ds_read_b128 v[172:175], v26 offset:5120
 v_add_f32 v222, v222, v223
 v_mfma_f32_16x16x32_bf16 v[68:71], v[180:183], a[0:3], v[68:71]
 ds_read_b128 a[216:219], v255 offset:34816
 v_mov_b32 v219, v218
 v_mfma_f32_16x16x32_bf16 v[84:87], v[180:183], a[4:7], v[84:87]
 v_mov_b32 v223, v222
 v_mfma_f32_16x16x32_bf16 v[100:103], v[180:183], a[8:11], v[100:103]
 s_waitcnt lgkmcnt(7)
 ds_read_b128 a[220:223], v255 offset:35840
 v_mfma_f32_16x16x32_bf16 v[40:43], v[152:155], a[12:15], v[40:43]
 ds_read_b128 v[176:179], v26 offset:6144
 v_mfma_f32_16x16x32_bf16 v[56:59], v[152:155], a[16:19], v[56:59]
 v_permlane32_swap_b32 v218, v219
 v_mfma_f32_16x16x32_bf16 v[72:75], v[152:155], a[20:23], v[72:75]
 v_permlane32_swap_b32 v222, v223
 v_mfma_f32_16x16x32_bf16 v[88:91], v[152:155], a[24:27], v[88:91]
 v_mul_f32 v217, 0xbacccccd, v218
 v_mul_f32 v221, 0xbacccccd, v222
 v_mfma_f32_16x16x32_bf16 v[44:47], v[156:159], a[12:15], v[44:47]
 ds_read_b128 v[180:183], v26 offset:7168
 v_mul_f32 v218, v217, v217
 v_mfma_f32_16x16x32_bf16 v[60:63], v[156:159], a[16:19], v[60:63]
 buffer_load_dwordx4 a[92:95], v4, s[8:11], s67 offen offset:3072 sc1
 v_mfma_f32_16x16x32_bf16 v[76:79], v[156:159], a[20:23], v[76:79]
 v_mul_f32 v222, v221, v221
 v_fmac_f32 v218, 0xbacccccd, v219
 v_mfma_f32_16x16x32_bf16 v[92:95], v[156:159], a[24:27], v[92:95]
 s_waitcnt lgkmcnt(8)
 s_add_u32 m0, s27, 139264
 s_add_u32 s85, s34, 57344
 buffer_load_dwordx4 v2, s[8:11], s85 offen sc1 lds
 buffer_load_dwordx4 a[96:99], v4, s[8:11], s72 offen offset:3072 sc1
 buffer_load_dwordx4 v[104:107], v5, s[8:11], s67 offen offset:3072 sc1
 v_mfma_f32_16x16x32_bf16 v[48:51], v[160:163], a[12:15], v[48:51]
 s_waitcnt vmcnt(10) lgkmcnt(2)
 s_barrier
 ds_read_b128 v[152:155], v26 offset:8192
 v_mfma_f32_16x16x32_bf16 v[64:67], v[160:163], a[16:19], v[64:67]
 v_fmac_f32 v222, 0xbacccccd, v223
 v_min_f32 v218, 0, v218
 v_mfma_f32_16x16x32_bf16 v[80:83], v[160:163], a[20:23], v[80:83]
 v_min_f32 v222, 0, v222
 v_mfma_f32_16x16x32_bf16 v[96:99], v[160:163], a[24:27], v[96:99]
 v_sub_f32 v218, 0x3727c5ac, v218
 v_mfma_f32_16x16x32_bf16 v[52:55], v[164:167], a[12:15], v[52:55]
 ds_read_b128 v[156:159], v26 offset:9216
 v_sub_f32 v222, 0x3727c5ac, v222
 v_mfma_f32_16x16x32_bf16 v[68:71], v[164:167], a[16:19], v[68:71]
 v_rsq_f32 v216, v218
 v_mfma_f32_16x16x32_bf16 v[84:87], v[164:167], a[20:23], v[84:87]
 v_mfma_f32_16x16x32_bf16 v[100:103], v[164:167], a[24:27], v[100:103]
 v_rsq_f32 v220, v222
 v_mfma_f32_16x16x32_bf16 v[40:43], v[168:171], a[28:31], v[40:43]
 ds_read_b128 v[160:163], v26 offset:10240
 v_cvt_pk_bf16_f32 v218, v217, v217
 v_mfma_f32_16x16x32_bf16 v[56:59], v[168:171], a[32:35], v[56:59]
 v_cvt_pk_bf16_f32 v222, v221, v221
 v_mfma_f32_16x16x32_bf16 v[72:75], v[168:171], a[36:39], v[72:75]
 v_and_b32 v218, 0xffff0000, v218
 v_and_b32 v222, 0xffff0000, v222
 v_mfma_f32_16x16x32_bf16 v[88:91], v[168:171], a[40:43], v[88:91]
 v_cndmask_b32 v218, 0, v218, s[92:93]
 v_mfma_f32_16x16x32_bf16 v[44:47], v[172:175], a[28:31], v[44:47]
 ds_read_b128 v[164:167], v26 offset:11264
 v_cndmask_b32 v222, 0, v222, s[92:93]
 v_mfma_f32_16x16x32_bf16 v[60:63], v[172:175], a[32:35], v[60:63]
 buffer_load_dwordx4 v[108:111], v5, s[8:11], s72 offen offset:3072 sc1
 v_sub_f32 v218, v217, v218
 v_mfma_f32_16x16x32_bf16 v[76:79], v[172:175], a[36:39], v[76:79]
 v_sub_f32 v222, v221, v222
 v_mfma_f32_16x16x32_bf16 v[92:95], v[172:175], a[40:43], v[92:95]
 s_waitcnt lgkmcnt(4)
 s_add_u32 m0, s27, 143360
 s_add_u32 s85, s34, 61440
 buffer_load_dwordx4 v2, s[8:11], s85 offen sc1 lds
 buffer_load_dwordx4 v[112:115], v4, s[8:11], s68 offen sc1
 buffer_load_dwordx4 v[116:119], v4, s[8:11], s73 offen sc1
 v_mfma_f32_16x16x32_bf16 v[48:51], v[176:179], a[28:31], v[48:51]
 s_waitcnt vmcnt(10)
 s_barrier
 ds_read_b128 v[168:171], v26 offset:12288
 v_mfma_f32_16x16x32_bf16 v[64:67], v[176:179], a[32:35], v[64:67]
 ds_read_b32 v200, v228
 v_cndmask_b32 v218, 0, v218, s[94:95]
 v_mfma_f32_16x16x32_bf16 v[80:83], v[176:179], a[36:39], v[80:83]
 v_cndmask_b32 v222, 0, v222, s[94:95]
 v_cvt_pk_bf16_f32 v192, v218, v218
 v_mfma_f32_16x16x32_bf16 v[96:99], v[176:179], a[40:43], v[96:99]
 v_cvt_pk_bf16_f32 v196, v222, v222
 v_mfma_f32_16x16x32_bf16 v[52:55], v[180:183], a[28:31], v[52:55]
 ds_read_b128 v[172:175], v26 offset:13312
 v_cndmask_b32 v217, 1.0, v216, s[92:93]
 v_mfma_f32_16x16x32_bf16 v[68:71], v[180:183], a[32:35], v[68:71]
 v_cndmask_b32 v221, 1.0, v220, s[92:93]
 v_mfma_f32_16x16x32_bf16 v[84:87], v[180:183], a[36:39], v[84:87]
 v_mfma_f32_16x16x32_bf16 v[100:103], v[180:183], a[40:43], v[100:103]
 s_waitcnt lgkmcnt(1)
 v_mfma_f32_16x16x32_bf16 v[40:43], v[200:203], v[184:187], v[40:43]
 s_mov_b32 s93, 0xffff0000
 v_mfma_f32_16x16x32_bf16 v[56:59], v[200:203], v[188:191], v[56:59]
 v_mfma_f32_16x16x32_bf16 v[72:75], v[200:203], v[192:195], v[72:75]
 v_cndmask_b32 v225, v208, v212, s[92:93]
 v_mfma_f32_16x16x32_bf16 v[88:91], v[200:203], v[196:199], v[88:91]
 s_barrier
 v_mfma_f32_16x16x32_bf16 v[40:43], v[152:155], a[44:47], v[40:43]
 ds_read_b128 v[176:179], v26 offset:14336
 v_mfma_f32_16x16x32_bf16 v[56:59], v[152:155], a[48:51], v[56:59]
 buffer_load_dwordx4 v[120:123], v5, s[8:11], s68 offen sc1
 v_mfma_f32_16x16x32_bf16 v[72:75], v[152:155], a[52:55], v[72:75]
 v_mfma_f32_16x16x32_bf16 v[88:91], v[152:155], a[56:59], v[88:91]
 v_mul_f32 v225, 0x3fb8aa3b, v225
 v_mfma_f32_16x16x32_bf16 v[44:47], v[156:159], a[44:47], v[44:47]
 ds_read_b128 v[180:183], v26 offset:15360
 v_mfma_f32_16x16x32_bf16 v[60:63], v[156:159], a[48:51], v[60:63]
 v_mfma_f32_16x16x32_bf16 v[76:79], v[156:159], a[52:55], v[76:79]
 v_mfma_f32_16x16x32_bf16 v[92:95], v[156:159], a[56:59], v[92:95]
 s_add_u32 m0, s27, 147456
 buffer_load_dwordx4 v[124:127], v5, s[8:11], s73 offen sc1
 s_add_u32 s85, s34, 65536
 buffer_load_dwordx4 v2, s[8:11], s85 offen sc1 lds
 buffer_load_dwordx4 v[128:131], v4, s[8:11], s68 offen offset:1024 sc1
 v_mfma_f32_16x16x32_bf16 v[48:51], v[160:163], a[44:47], v[48:51]
 s_waitcnt vmcnt(10)
 s_barrier
 ds_read_b128 v[152:155], v26 offset:16384
 v_cndmask_b32 v227, v216, v220, s[92:93]
 v_mfma_f32_16x16x32_bf16 v[64:67], v[160:163], a[48:51], v[64:67]
 ds_read_b32 v204, v228 offset:64
 v_mfma_f32_16x16x32_bf16 v[80:83], v[160:163], a[52:55], v[80:83]
 v_lshrrev_b32 v254, 1, v2
 s_mov_b32 s31, 13959168
 buffer_load_dwordx2 v[252:253], v254, s[8:11], s31 offen sc1
 v_mfma_f32_16x16x32_bf16 v[96:99], v[160:163], a[56:59], v[96:99]
 v_mfma_f32_16x16x32_bf16 v[52:55], v[164:167], a[44:47], v[52:55]
 ds_read_b128 v[156:159], v26 offset:17408
 v_mfma_f32_16x16x32_bf16 v[68:71], v[164:167], a[48:51], v[68:71]
 v_mfma_f32_16x16x32_bf16 v[84:87], v[164:167], a[52:55], v[84:87]
 v_mul_f32 v227, 0x3fb8aa3b, v227
 v_mfma_f32_16x16x32_bf16 v[100:103], v[164:167], a[56:59], v[100:103]
 s_waitcnt lgkmcnt(1)
 v_mfma_f32_16x16x32_bf16 v[44:47], v[204:207], v[184:187], v[44:47]
 v_mfma_f32_16x16x32_bf16 v[60:63], v[204:207], v[188:191], v[60:63]
 v_mfma_f32_16x16x32_bf16 v[76:79], v[204:207], v[192:195], v[76:79]
 v_mfma_f32_16x16x32_bf16 v[92:95], v[204:207], v[196:199], v[92:95]
 v_mfma_f32_16x16x32_bf16 v[40:43], v[168:171], a[60:63], v[40:43]
 ds_read_b128 v[160:163], v26 offset:18432
 v_mfma_f32_16x16x32_bf16 v[56:59], v[168:171], a[64:67], v[56:59]
 buffer_load_dwordx4 v[132:135], v4, s[8:11], s73 offen offset:1024 sc1
 v_mfma_f32_16x16x32_bf16 v[72:75], v[168:171], a[68:71], v[72:75]
 v_mfma_f32_16x16x32_bf16 v[88:91], v[168:171], a[72:75], v[88:91]
 v_mfma_f32_16x16x32_bf16 v[44:47], v[172:175], a[60:63], v[44:47]
 ds_read_b128 v[164:167], v26 offset:19456
 v_mfma_f32_16x16x32_bf16 v[60:63], v[172:175], a[64:67], v[60:63]
 v_mfma_f32_16x16x32_bf16 v[76:79], v[172:175], a[68:71], v[76:79]
 v_mfma_f32_16x16x32_bf16 v[92:95], v[172:175], a[72:75], v[92:95]
 s_add_u32 m0, s27, 151552
 buffer_load_dwordx4 v[136:139], v5, s[8:11], s68 offen offset:1024 sc1
 s_add_u32 s85, s34, 69632
 buffer_load_dwordx4 v2, s[8:11], s85 offen sc1 lds
 buffer_load_dwordx4 v[140:143], v5, s[8:11], s73 offen offset:1024 sc1
 v_mfma_f32_16x16x32_bf16 v[48:51], v[176:179], a[60:63], v[48:51]
 s_waitcnt vmcnt(11)
 s_barrier
 ds_read_b128 v[168:171], v26 offset:20480
 v_mfma_f32_16x16x32_bf16 v[64:67], v[176:179], a[64:67], v[64:67]
 ds_read_b128 a[224:227], v255 offset:49152
 ds_read_b32 v200, v228 offset:128
 v_mfma_f32_16x16x32_bf16 v[80:83], v[176:179], a[68:71], v[80:83]
 v_mfma_f32_16x16x32_bf16 v[96:99], v[176:179], a[72:75], v[96:99]
 ds_read_b128 a[228:231], v255 offset:50176
 v_mfma_f32_16x16x32_bf16 v[52:55], v[180:183], a[60:63], v[52:55]
 ds_read_b128 v[172:175], v26 offset:21504
 v_mfma_f32_16x16x32_bf16 v[68:71], v[180:183], a[64:67], v[68:71]
 v_mfma_f32_16x16x32_bf16 v[84:87], v[180:183], a[68:71], v[84:87]
 ds_read_b128 a[232:235], v255 offset:51200
 v_mfma_f32_16x16x32_bf16 v[100:103], v[180:183], a[72:75], v[100:103]
 s_waitcnt lgkmcnt(3)
 v_mfma_f32_16x16x32_bf16 v[48:51], v[200:203], v[184:187], v[48:51]
 ds_read_b128 a[236:239], v255 offset:52224
 v_mfma_f32_16x16x32_bf16 v[64:67], v[200:203], v[188:191], v[64:67]
 v_mfma_f32_16x16x32_bf16 v[80:83], v[200:203], v[192:195], v[80:83]
 v_mfma_f32_16x16x32_bf16 v[96:99], v[200:203], v[196:199], v[96:99]
 v_mfma_f32_16x16x32_bf16 v[40:43], v[152:155], a[76:79], v[40:43]
 ds_read_b128 v[176:179], v26 offset:22528
 v_mfma_f32_16x16x32_bf16 v[56:59], v[152:155], a[80:83], v[56:59]
 buffer_load_dwordx4 v[144:147], v4, s[8:11], s68 offen offset:2048 sc1
 v_mfma_f32_16x16x32_bf16 v[72:75], v[152:155], a[84:87], v[72:75]
 v_mfma_f32_16x16x32_bf16 v[88:91], v[152:155], a[88:91], v[88:91]
 v_mfma_f32_16x16x32_bf16 v[44:47], v[156:159], a[76:79], v[44:47]
 ds_read_b128 v[180:183], v26 offset:23552
 v_mfma_f32_16x16x32_bf16 v[60:63], v[156:159], a[80:83], v[60:63]
 v_mfma_f32_16x16x32_bf16 v[76:79], v[156:159], a[84:87], v[76:79]
 v_mfma_f32_16x16x32_bf16 v[92:95], v[156:159], a[88:91], v[92:95]
 s_add_u32 m0, s27, 155648
 buffer_load_dwordx4 v[148:151], v4, s[8:11], s73 offen offset:2048 sc1
 s_add_u32 s85, s34, 73728
 buffer_load_dwordx4 v2, s[8:11], s85 offen sc1 lds
 buffer_load_dwordx4 a[0:3], v5, s[8:11], s68 offen offset:2048 sc1
 buffer_load_dwordx4 a[4:7], v5, s[8:11], s73 offen offset:2048 sc1
 v_mfma_f32_16x16x32_bf16 v[48:51], v[160:163], a[76:79], v[48:51]
 s_waitcnt vmcnt(11) lgkmcnt(2)
 s_barrier
 ds_read_b128 v[152:155], v26 offset:24576
 v_mfma_f32_16x16x32_bf16 v[64:67], v[160:163], a[80:83], v[64:67]
 ds_read_b32 v204, v228 offset:192
 v_mfma_f32_16x16x32_bf16 v[80:83], v[160:163], a[84:87], v[80:83]
 v_mfma_f32_16x16x32_bf16 v[96:99], v[160:163], a[88:91], v[96:99]
 v_mfma_f32_16x16x32_bf16 v[52:55], v[164:167], a[76:79], v[52:55]
 ds_read_b128 v[156:159], v26 offset:25600
 v_mfma_f32_16x16x32_bf16 v[68:71], v[164:167], a[80:83], v[68:71]
 v_mfma_f32_16x16x32_bf16 v[84:87], v[164:167], a[84:87], v[84:87]
 v_mfma_f32_16x16x32_bf16 v[100:103], v[164:167], a[88:91], v[100:103]
 s_waitcnt lgkmcnt(1)
 v_mfma_f32_16x16x32_bf16 v[52:55], v[204:207], v[184:187], v[52:55]
 v_mfma_f32_16x16x32_bf16 v[68:71], v[204:207], v[188:191], v[68:71]
 v_mfma_f32_16x16x32_bf16 v[84:87], v[204:207], v[192:195], v[84:87]
 v_mfma_f32_16x16x32_bf16 v[100:103], v[204:207], v[196:199], v[100:103]
 v_mfma_f32_16x16x32_bf16 v[40:43], v[168:171], a[92:95], v[40:43]
 ds_read_b128 v[160:163], v26 offset:26624
 v_mfma_f32_16x16x32_bf16 v[56:59], v[168:171], a[96:99], v[56:59]
 buffer_load_dwordx4 a[8:11], v4, s[8:11], s68 offen offset:3072 sc1
 v_mfma_f32_16x16x32_bf16 v[72:75], v[168:171], v[104:107], v[72:75]
 v_mfma_f32_16x16x32_bf16 v[88:91], v[168:171], v[108:111], v[88:91]
 v_mfma_f32_16x16x32_bf16 v[44:47], v[172:175], a[92:95], v[44:47]
 ds_read_b128 v[164:167], v26 offset:27648
 v_mfma_f32_16x16x32_bf16 v[60:63], v[172:175], a[96:99], v[60:63]
 v_mfma_f32_16x16x32_bf16 v[76:79], v[172:175], v[104:107], v[76:79]
 v_mfma_f32_16x16x32_bf16 v[92:95], v[172:175], v[108:111], v[92:95]
 s_add_u32 m0, s27, 159744
 s_add_u32 s85, s34, 77824
 buffer_load_dwordx4 v2, s[8:11], s85 offen sc1 lds
 buffer_load_dwordx4 a[12:15], v4, s[8:11], s73 offen offset:3072 sc1
 buffer_load_dwordx4 a[16:19], v5, s[8:11], s68 offen offset:3072 sc1
 v_mfma_f32_16x16x32_bf16 v[48:51], v[176:179], a[92:95], v[48:51]
 s_waitcnt vmcnt(10)
 s_barrier
 ds_read_b128 v[168:171], v26 offset:28672
 v_mfma_f32_16x16x32_bf16 v[64:67], v[176:179], a[96:99], v[64:67]
 v_mfma_f32_16x16x32_bf16 v[80:83], v[176:179], v[104:107], v[80:83]
 v_mfma_f32_16x16x32_bf16 v[96:99], v[176:179], v[108:111], v[96:99]
 v_mfma_f32_16x16x32_bf16 v[52:55], v[180:183], a[92:95], v[52:55]
 ds_read_b128 v[172:175], v26 offset:29696
 v_mfma_f32_16x16x32_bf16 v[68:71], v[180:183], a[96:99], v[68:71]
 v_mfma_f32_16x16x32_bf16 v[84:87], v[180:183], v[104:107], v[84:87]
 v_mfma_f32_16x16x32_bf16 v[100:103], v[180:183], v[108:111], v[100:103]
 s_barrier
 s_waitcnt lgkmcnt(4)
 v_mfma_f32_16x16x32_bf16 v[40:43], v[152:155], v[112:115], v[40:43]
 ds_read_b128 v[176:179], v26 offset:30720
 v_mfma_f32_16x16x32_bf16 v[56:59], v[152:155], v[116:119], v[56:59]
 v_mfma_f32_16x16x32_bf16 v[72:75], v[152:155], v[120:123], v[72:75]
 v_mfma_f32_16x16x32_bf16 v[88:91], v[152:155], v[124:127], v[88:91]
 buffer_load_dwordx4 a[20:23], v5, s[8:11], s73 offen offset:3072 sc1
 v_mfma_f32_16x16x32_bf16 v[44:47], v[156:159], v[112:115], v[44:47]
 ds_read_b128 v[180:183], v26 offset:31744
 v_xor_b32 v252, s100, v252
 v_xor_b32 v253, s101, v253
 v_or_b32 v252, v252, v253
 v_cmp_ne_u32 vcc, 0, v252
 s_cbranch_vccnz hretry_5
hback_6:
 s_barrier
 v_mfma_f32_16x16x32_bf16 v[60:63], v[156:159], v[116:119], v[60:63]
 buffer_load_dwordx4 v[200:203], v232, s[8:11], 0 offen sc1
 buffer_load_dwordx4 a[120:123], v38, s[8:11], 0 offen sc1
 v_mfma_f32_16x16x32_bf16 v[76:79], v[156:159], v[120:123], v[76:79]
 buffer_load_dwordx4 v[204:207], v232, s[8:11], s70 offen offset:3072 sc1
 v_mfma_f32_16x16x32_bf16 v[92:95], v[156:159], v[124:127], v[92:95]
 s_waitcnt lgkmcnt(4)
 v_mfma_f32_16x16x32_bf16 v[48:51], v[160:163], v[112:115], v[48:51]
 s_waitcnt vmcnt(10)
 s_barrier
 ds_read_b128 v[152:155], v26 offset:32768
 v_mfma_f32_16x16x32_bf16 v[64:67], v[160:163], v[116:119], v[64:67]
 v_mfma_f32_16x16x32_bf16 v[80:83], v[160:163], v[120:123], v[80:83]
 buffer_load_dwordx4 a[124:127], v38, s[8:11], 0 offen offset:1024 sc1
 v_mfma_f32_16x16x32_bf16 v[96:99], v[160:163], v[124:127], v[96:99]
 v_mfma_f32_16x16x32_bf16 v[52:55], v[164:167], v[112:115], v[52:55]
 ds_read_b128 v[156:159], v26 offset:33792
 v_mfma_f32_16x16x32_bf16 v[68:71], v[164:167], v[116:119], v[68:71]
 v_mfma_f32_16x16x32_bf16 v[84:87], v[164:167], v[120:123], v[84:87]
 v_mfma_f32_16x16x32_bf16 v[100:103], v[164:167], v[124:127], v[100:103]
 s_waitcnt lgkmcnt(4)
 v_mfma_f32_16x16x32_bf16 v[40:43], v[168:171], v[128:131], v[40:43]
 ds_read_b128 v[160:163], v26 offset:34816
 buffer_load_dwordx4 a[128:131], v38, s[8:11], 0 offen offset:2048 sc1
 v_mfma_f32_16x16x32_bf16 v[56:59], v[168:171], v[132:135], v[56:59]
 v_mfma_f32_16x16x32_bf16 v[72:75], v[168:171], v[136:139], v[72:75]
 v_mfma_f32_16x16x32_bf16 v[88:91], v[168:171], v[140:143], v[88:91]
 v_mfma_f32_16x16x32_bf16 v[44:47], v[172:175], v[128:131], v[44:47]
 ds_read_b128 v[164:167], v26 offset:35840
 v_mfma_f32_16x16x32_bf16 v[60:63], v[172:175], v[132:135], v[60:63]
 v_mfma_f32_16x16x32_bf16 v[76:79], v[172:175], v[136:139], v[76:79]
 buffer_load_dwordx4 a[132:135], v38, s[8:11], 0 offen offset:3072 sc1
 v_mfma_f32_16x16x32_bf16 v[92:95], v[172:175], v[140:143], v[92:95]
 s_waitcnt lgkmcnt(4)
 v_mfma_f32_16x16x32_bf16 v[48:51], v[176:179], v[128:131], v[48:51]
 s_waitcnt vmcnt(9)
 s_barrier
 ds_read_b128 v[168:171], v26 offset:36864
 v_mfma_f32_16x16x32_bf16 v[64:67], v[176:179], v[132:135], v[64:67]
 v_add_u32 v255, 65536, v255
 v_mfma_f32_16x16x32_bf16 v[80:83], v[176:179], v[136:139], v[80:83]
 ds_read_b128 a[240:243], v255
 v_mfma_f32_16x16x32_bf16 v[96:99], v[176:179], v[140:143], v[96:99]
 ds_read_b128 a[244:247], v255 offset:1024
 v_mfma_f32_16x16x32_bf16 v[52:55], v[180:183], v[128:131], v[52:55]
 ds_read_b128 v[172:175], v26 offset:37888
 buffer_load_dwordx4 a[136:139], v38, s[8:11], s65 offen sc1
 v_mfma_f32_16x16x32_bf16 v[68:71], v[180:183], v[132:135], v[68:71]
 v_mfma_f32_16x16x32_bf16 v[84:87], v[180:183], v[136:139], v[84:87]
 ds_read_b128 a[248:251], v255 offset:2048
 v_mfma_f32_16x16x32_bf16 v[100:103], v[180:183], v[140:143], v[100:103]
 s_waitcnt lgkmcnt(7)
 ds_read_b128 a[252:255], v255 offset:3072
 v_mfma_f32_16x16x32_bf16 v[40:43], v[152:155], v[144:147], v[40:43]
 ds_read_b128 v[176:179], v26 offset:38912
 v_mfma_f32_16x16x32_bf16 v[56:59], v[152:155], v[148:151], v[56:59]
 v_mfma_f32_16x16x32_bf16 v[72:75], v[152:155], a[0:3], v[72:75]
 buffer_load_dwordx4 a[140:143], v38, s[8:11], s65 offen offset:1024 sc1
 v_mfma_f32_16x16x32_bf16 v[88:91], v[152:155], a[4:7], v[88:91]
 v_mfma_f32_16x16x32_bf16 v[44:47], v[156:159], v[144:147], v[44:47]
 ds_read_b128 v[180:183], v26 offset:39936
 v_mfma_f32_16x16x32_bf16 v[60:63], v[156:159], v[148:151], v[60:63]
 v_mfma_f32_16x16x32_bf16 v[76:79], v[156:159], a[0:3], v[76:79]
 v_mfma_f32_16x16x32_bf16 v[92:95], v[156:159], a[4:7], v[92:95]
 s_waitcnt lgkmcnt(8)
 v_mfma_f32_16x16x32_bf16 v[48:51], v[160:163], v[144:147], v[48:51]
 buffer_load_dwordx4 a[144:147], v38, s[8:11], s65 offen offset:2048 sc1
 v_mfma_f32_16x16x32_bf16 v[64:67], v[160:163], v[148:151], v[64:67]
 v_mfma_f32_16x16x32_bf16 v[80:83], v[160:163], a[0:3], v[80:83]
 v_mfma_f32_16x16x32_bf16 v[96:99], v[160:163], a[4:7], v[96:99]
 v_mfma_f32_16x16x32_bf16 v[52:55], v[164:167], v[144:147], v[52:55]
 v_mfma_f32_16x16x32_bf16 v[68:71], v[164:167], v[148:151], v[68:71]
 v_mfma_f32_16x16x32_bf16 v[84:87], v[164:167], a[0:3], v[84:87]
 buffer_load_dwordx4 a[148:151], v38, s[8:11], s65 offen offset:3072 sc1
 v_mfma_f32_16x16x32_bf16 v[100:103], v[164:167], a[4:7], v[100:103]
 s_waitcnt lgkmcnt(4)
 v_mfma_f32_16x16x32_bf16 v[40:43], v[168:171], a[8:11], v[40:43]
 s_waitcnt vmcnt(12)
 v_mfma_f32_16x16x32_bf16 v[56:59], v[168:171], a[12:15], v[56:59]
 s_waitcnt vmcnt(11)
 v_mfma_f32_16x16x32_bf16 v[72:75], v[168:171], a[16:19], v[72:75]
 s_waitcnt vmcnt(10)
 v_mfma_f32_16x16x32_bf16 v[88:91], v[168:171], a[20:23], v[88:91]
 v_mfma_f32_16x16x32_bf16 v[44:47], v[172:175], a[8:11], v[44:47]
 buffer_load_dwordx4 a[152:155], v38, s[8:11], s66 offen sc1
 v_mfma_f32_16x16x32_bf16 v[60:63], v[172:175], a[12:15], v[60:63]
 v_mfma_f32_16x16x32_bf16 v[76:79], v[172:175], a[16:19], v[76:79]
 v_mfma_f32_16x16x32_bf16 v[92:95], v[172:175], a[20:23], v[92:95]
 s_waitcnt lgkmcnt(0)
 v_mfma_f32_16x16x32_bf16 v[48:51], v[176:179], a[8:11], v[48:51]
 v_mfma_f32_16x16x32_bf16 v[64:67], v[176:179], a[12:15], v[64:67]
 v_mfma_f32_16x16x32_bf16 v[80:83], v[176:179], a[16:19], v[80:83]
 buffer_load_dwordx4 a[156:159], v38, s[8:11], s66 offen offset:1024 sc1
 v_mfma_f32_16x16x32_bf16 v[96:99], v[176:179], a[20:23], v[96:99]
 v_mfma_f32_16x16x32_bf16 v[52:55], v[180:183], a[8:11], v[52:55]
 v_mfma_f32_16x16x32_bf16 v[68:71], v[180:183], a[12:15], v[68:71]
 v_mfma_f32_16x16x32_bf16 v[84:87], v[180:183], a[16:19], v[84:87]
 v_mfma_f32_16x16x32_bf16 v[100:103], v[180:183], a[20:23], v[100:103]
 s_add_u32 m0, s28, 81920
 v_cvt_pk_bf16_f32 v236, v40, v41
 s_add_u32 s85, s35, 0
 buffer_load_dwordx4 v3, s[8:11], s85 offen sc1 lds
 v_cvt_pk_bf16_f32 v237, v42, v43
 v_cvt_pk_bf16_f32 v238, v56, v57
 v_cvt_pk_bf16_f32 v239, v58, v59
 v_mul_f32 v52, v52, v209
 v_mul_f32 v53, v53, v209
 v_mul_f32 v54, v54, v209
 v_mul_f32 v55, v55, v209
 v_permlane16_swap_b32 v236, v238
 v_permlane16_swap_b32 v237, v239
 v_cvt_pk_bf16_f32 v248, v52, v53
 v_cvt_pk_bf16_f32 v249, v54, v55
 buffer_load_dwordx4 v3, s[8:11], s85 offen offset:1024 sc1 lds
 v_mul_f32 v68, v68, v213
 v_mul_f32 v69, v69, v213
 v_mfma_f32_32x32x16_bf16 v[184:199], a[164:167], v[236:239], 0
 v_mul_f32 v70, v70, v213
 v_mul_f32 v71, v71, v213
 v_cvt_pk_bf16_f32 v250, v68, v69
 v_cvt_pk_bf16_f32 v251, v70, v71
 v_mul_f32 v44, v44, v208
 v_mul_f32 v45, v45, v208
 v_permlane16_swap_b32 v248, v250
 v_permlane16_swap_b32 v249, v251
 buffer_load_dwordx4 v3, s[8:11], s85 offen offset:2048 sc1 lds
 v_or_b32 v250, v23, v250
 v_cvt_pk_bf16_f32 v104, v72, v73
 v_mul_f32 v46, v46, v208
 v_cvt_pk_bf16_f32 v105, v74, v75
 v_mul_f32 v47, v47, v208
 v_cvt_pk_bf16_f32 v106, v88, v89
 v_mfma_f32_32x32x16_bf16 v[184:199], a[168:171], v[248:251], v[184:199]
 v_cvt_pk_bf16_f32 v107, v90, v91
 ds_write_b64 v14, v[250:251] offset:21120
 v_mul_f32 v84, v84, v217
 v_cvt_pk_bf16_f32 v240, v44, v45
 buffer_load_dwordx4 v3, s[8:11], s85 offen offset:3072 sc1 lds
 v_mul_f32 v85, v85, v217
 v_cvt_pk_bf16_f32 v241, v46, v47
 v_mul_f32 v86, v86, v217
 v_mul_f32 v60, v60, v212
 v_mul_f32 v87, v87, v217
 v_mul_f32 v61, v61, v212
 v_permlane16_swap_b32 v104, v106
 v_mul_f32 v62, v62, v212
pad1:
 s_cbranch_execz pad5
 v_permlane16_swap_b32 v105, v107
 v_mul_f32 v63, v63, v212
 v_cvt_pk_bf16_f32 v116, v84, v85
 v_cvt_pk_bf16_f32 v242, v60, v61
 s_add_u32 m0, s28, 98304
 s_add_u32 s85, s35, 16384
 buffer_load_dwordx4 v3, s[8:11], s85 offen sc1 lds
 v_cvt_pk_bf16_f32 v117, v86, v87
 v_cvt_pk_bf16_f32 v243, v62, v63
 v_mul_f32 v100, v100, v221
 v_cvt_pk_bf16_f32 v244, v48, v49
 v_mul_f32 v101, v101, v221
 v_cvt_pk_bf16_f32 v245, v50, v51
 v_mfma_f32_32x32x16_bf16 v[136:151], a[164:167], v[104:107], 0
 v_permlane16_swap_b32 v240, v242
 v_mul_f32 v102, v102, v221
 v_permlane16_swap_b32 v241, v243
 v_mul_f32 v103, v103, v221
 buffer_load_dwordx4 v3, s[8:11], s85 offen offset:1024 sc1 lds
 v_cvt_pk_bf16_f32 v246, v64, v65
 v_cvt_pk_bf16_f32 v118, v100, v101
 v_cvt_pk_bf16_f32 v247, v66, v67
 v_cvt_pk_bf16_f32 v119, v102, v103
 ds_write_b128 v13, v[240:243] offset:16896
 v_mul_f32 v76, v76, v216
 v_permlane16_swap_b32 v244, v246
 v_mul_f32 v77, v77, v216
 v_permlane16_swap_b32 v245, v247
 v_permlane16_swap_b32 v116, v118
 v_max3_f32 v60, v184, v185, v186
 buffer_load_dwordx4 v3, s[8:11], s85 offen offset:2048 sc1 lds
 v_permlane16_swap_b32 v117, v119
 v_max3_f32 v61, -v184, -v185, -v186
 v_or_b32 v118, v23, v118
 v_max3_f32 v60, v60, v187, v188
 v_mul_f32 v78, v78, v216
 v_max3_f32 v61, v61, -v187, -v188
 v_mul_f32 v79, v79, v216
 v_max3_f32 v60, v60, v189, v190
 v_mfma_f32_32x32x16_bf16 v[136:151], a[168:171], v[116:119], v[136:151]
 v_max3_f32 v61, v61, -v189, -v190
 ds_write_b64 v14, v[118:119] offset:21632
 v_max3_f32 v60, v60, v191, v192
 buffer_load_dwordx4 v3, s[8:11], s85 offen offset:3072 sc1 lds
 v_cvt_pk_bf16_f32 v108, v76, v77
 v_max3_f32 v61, v61, -v191, -v192
 v_cvt_pk_bf16_f32 v109, v78, v79
 v_max_f32 v60, v60, v193
 v_mul_f32 v92, v92, v220
 v_max_f32 v61, v61, -v193
 v_mul_f32 v93, v93, v220
 s_nop 0
 v_permlane32_swap_b32 v60, v61
 v_mul_f32 v94, v94, v220
 v_max_f32 v62, v60, v61
 v_mul_f32 v95, v95, v220
 s_add_u32 m0, s28, 114688
 s_add_u32 s85, s35, 32768
 buffer_load_dwordx4 v3, s[8:11], s85 offen sc1 lds
 v_mul_f32 v60, -v62, v225
 v_cvt_pk_bf16_f32 v110, v92, v93
 v_mul_f32 v61, -v62, v225
 v_cvt_pk_bf16_f32 v111, v94, v95
 s_nop 0
 v_permlane32_swap_b32 v60, v61
 v_cvt_pk_bf16_f32 v112, v80, v81
 v_pk_fma_f32 v[40:41], v[224:225], v[184:185], v[60:61] op_sel:[1,0,0] op_sel_hi:[1,1,0]
 v_cvt_pk_bf16_f32 v113, v82, v83
 v_pk_fma_f32 v[50:51], v[224:225], v[184:185], v[60:61] op_sel:[1,0,1] op_sel_hi:[1,1,1] neg_lo:[1,0,0] neg_hi:[1,0,0]
 v_permlane16_swap_b32 v108, v110
 v_pk_fma_f32 v[42:43], v[224:225], v[186:187], v[60:61] op_sel:[1,0,0] op_sel_hi:[1,1,0]
 buffer_load_dwordx4 v3, s[8:11], s85 offen offset:1024 sc1 lds
 v_permlane16_swap_b32 v109, v111
 v_pk_fma_f32 v[52:53], v[224:225], v[186:187], v[60:61] op_sel:[1,0,1] op_sel_hi:[1,1,1] neg_lo:[1,0,0] neg_hi:[1,0,0]
 v_cvt_pk_bf16_f32 v114, v96, v97
 v_pk_fma_f32 v[44:45], v[224:225], v[188:189], v[60:61] op_sel:[1,0,0] op_sel_hi:[1,1,0]
 v_cvt_pk_bf16_f32 v115, v98, v99
 v_pk_fma_f32 v[54:55], v[224:225], v[188:189], v[60:61] op_sel:[1,0,1] op_sel_hi:[1,1,1] neg_lo:[1,0,0] neg_hi:[1,0,0]
 ds_write_b128 v13, v[108:111] offset:17408
 v_pk_fma_f32 v[46:47], v[224:225], v[190:191], v[60:61] op_sel:[1,0,0] op_sel_hi:[1,1,0]
 v_permlane16_swap_b32 v112, v114
 v_pk_fma_f32 v[56:57], v[224:225], v[190:191], v[60:61] op_sel:[1,0,1] op_sel_hi:[1,1,1] neg_lo:[1,0,0] neg_hi:[1,0,0]
 v_permlane16_swap_b32 v113, v115
 buffer_load_dword v0, v6, s[8:11], 0 offen sc1
 v_pk_fma_f32 v[48:49], v[224:225], v[192:193], v[60:61] op_sel:[1,0,0] op_sel_hi:[1,1,0]
 v_max3_f32 v172, v136, v137, v138
 v_pk_fma_f32 v[58:59], v[224:225], v[192:193], v[60:61] op_sel:[1,0,1] op_sel_hi:[1,1,1] neg_lo:[1,0,0] neg_hi:[1,0,0]
 v_max3_f32 v173, -v136, -v137, -v138
 v_exp_f32 v40, v40
 v_max3_f32 v172, v172, v139, v140
 v_exp_f32 v41, v41
 v_max3_f32 v173, v173, -v139, -v140
 v_exp_f32 v42, v42
 v_max3_f32 v172, v172, v141, v142
 v_exp_f32 v43, v43
 v_max3_f32 v173, v173, -v141, -v142
 buffer_load_dword v0, v7, s[8:11], 0 offen sc1
 v_exp_f32 v44, v44
 v_max3_f32 v172, v172, v143, v144
 v_exp_f32 v45, v45
 v_max3_f32 v173, v173, -v143, -v144
 v_exp_f32 v46, v46
 v_max_f32 v172, v172, v145
 v_exp_f32 v47, v47
 v_max_f32 v173, v173, -v145
 v_exp_f32 v48, v48
 s_nop 0
 v_permlane32_swap_b32 v172, v173
 v_exp_f32 v49, v49
 buffer_load_dword v0, v6, s[8:11], s0 offen sc1
 v_max_f32 v174, v172, v173
 v_exp_f32 v50, v50
 v_mul_f32 v172, -v174, v227
 v_exp_f32 v51, v51
 v_mul_f32 v173, -v174, v227
 v_exp_f32 v52, v52
 s_nop 0
 v_permlane32_swap_b32 v172, v173
 v_exp_f32 v53, v53
 v_pk_fma_f32 v[152:153], v[226:227], v[136:137], v[172:173] op_sel:[1,0,0] op_sel_hi:[1,1,0]
 v_exp_f32 v54, v54
 v_pk_fma_f32 v[162:163], v[226:227], v[136:137], v[172:173] op_sel:[1,0,1] op_sel_hi:[1,1,1] neg_lo:[1,0,0] neg_hi:[1,0,0]
 buffer_load_dword v0, v7, s[8:11], s0 offen sc1
 v_exp_f32 v55, v55
 v_pk_fma_f32 v[154:155], v[226:227], v[138:139], v[172:173] op_sel:[1,0,0] op_sel_hi:[1,1,0]
 v_exp_f32 v56, v56
 v_pk_fma_f32 v[164:165], v[226:227], v[138:139], v[172:173] op_sel:[1,0,1] op_sel_hi:[1,1,1] neg_lo:[1,0,0] neg_hi:[1,0,0]
 v_exp_f32 v57, v57
 v_pk_fma_f32 v[156:157], v[226:227], v[140:141], v[172:173] op_sel:[1,0,0] op_sel_hi:[1,1,0]
 v_exp_f32 v58, v58
 v_pk_fma_f32 v[166:167], v[226:227], v[140:141], v[172:173] op_sel:[1,0,1] op_sel_hi:[1,1,1] neg_lo:[1,0,0] neg_hi:[1,0,0]
 v_exp_f32 v59, v59
 v_pk_fma_f32 v[158:159], v[226:227], v[142:143], v[172:173] op_sel:[1,0,0] op_sel_hi:[1,1,0]
 v_pk_add_f32 v[60:61], v[40:41], v[42:43]
 v_pk_fma_f32 v[168:169], v[226:227], v[142:143], v[172:173] op_sel:[1,0,1] op_sel_hi:[1,1,1] neg_lo:[1,0,0] neg_hi:[1,0,0]
 buffer_load_dword v0, v1, s[8:11], s41 offen sc1
 v_pk_add_f32 v[62:63], v[50:51], v[52:53]
 v_pk_fma_f32 v[160:161], v[226:227], v[144:145], v[172:173] op_sel:[1,0,0] op_sel_hi:[1,1,0]
 v_pk_add_f32 v[60:61], v[60:61], v[44:45]
 v_pk_fma_f32 v[170:171], v[226:227], v[144:145], v[172:173] op_sel:[1,0,1] op_sel_hi:[1,1,1] neg_lo:[1,0,0] neg_hi:[1,0,0]
 v_pk_add_f32 v[62:63], v[62:63], v[54:55]
 v_exp_f32 v152, v152
 v_pk_add_f32 v[60:61], v[60:61], v[46:47]
 v_exp_f32 v153, v153
 v_pk_add_f32 v[62:63], v[62:63], v[56:57]
 v_exp_f32 v154, v154
 v_pk_add_f32 v[60:61], v[60:61], v[48:49]
 buffer_load_dword v0, v1, s[8:11], s41 offen offset:1024 sc1
 v_exp_f32 v155, v155
 v_pk_add_f32 v[62:63], v[62:63], v[58:59]
 v_exp_f32 v156, v156
 v_add_f32 v60, v60, v61
 v_exp_f32 v157, v157
 v_add_f32 v61, v62, v63
 v_exp_f32 v158, v158
 s_nop 0
 v_permlane32_swap_b32 v60, v61
 v_exp_f32 v159, v159
 v_add_f32 v60, v60, v61
 v_exp_f32 v160, v160
 buffer_load_dword v0, v1, s[8:11], s84 offen sc1
 v_rcp_f32 v60, v60
 v_exp_f32 v161, v161
 v_mov_b32 v61, v60
 v_exp_f32 v162, v162
 s_nop 0
 v_permlane32_swap_b32 v60, v61
 v_exp_f32 v163, v163
 v_pk_mul_f32 v[40:41], v[60:61], v[40:41] op_sel_hi:[0,1]
 v_exp_f32 v164, v164
 v_cvt_pk_bf16_f32 v236, v40, v41
 v_exp_f32 v165, v165
 v_pk_mul_f32 v[42:43], v[60:61], v[42:43] op_sel_hi:[0,1]
 v_exp_f32 v166, v166
 v_cvt_pk_bf16_f32 v237, v42, v43
 v_exp_f32 v167, v167
 v_pk_mul_f32 v[44:45], v[60:61], v[44:45] op_sel_hi:[0,1]
 v_exp_f32 v168, v168
 v_cvt_pk_bf16_f32 v238, v44, v45
 v_exp_f32 v169, v169
 v_pk_mul_f32 v[46:47], v[60:61], v[46:47] op_sel_hi:[0,1]
 v_exp_f32 v170, v170
 v_cvt_pk_bf16_f32 v239, v46, v47
 v_exp_f32 v171, v171
 ds_write_b128 v12, v[236:239]
 v_pk_add_f32 v[172:173], v[152:153], v[154:155]
 v_pk_mul_f32 v[48:49], v[60:61], v[48:49] op_sel_hi:[0,1]
 v_pk_add_f32 v[174:175], v[162:163], v[164:165]
 v_cvt_pk_bf16_f32 v240, v48, v49
 v_pk_add_f32 v[172:173], v[172:173], v[156:157]
 v_pk_mul_f32 v[50:51], v[60:61], v[50:51] op_sel:[1,0] op_sel_hi:[1,1]
 v_pk_add_f32 v[174:175], v[174:175], v[166:167]
 v_cvt_pk_bf16_f32 v241, v50, v51
 v_pk_add_f32 v[172:173], v[172:173], v[158:159]
 v_pk_mul_f32 v[52:53], v[60:61], v[52:53] op_sel:[1,0] op_sel_hi:[1,1]
 v_pk_add_f32 v[174:175], v[174:175], v[168:169]
 v_cvt_pk_bf16_f32 v242, v52, v53
 v_pk_add_f32 v[172:173], v[172:173], v[160:161]
 v_pk_mul_f32 v[54:55], v[60:61], v[54:55] op_sel:[1,0] op_sel_hi:[1,1]
 v_pk_add_f32 v[174:175], v[174:175], v[170:171]
 v_cvt_pk_bf16_f32 v243, v54, v55
 v_add_f32 v172, v172, v173
 ds_write_b128 v12, v[240:243] offset:8448
 v_add_f32 v173, v174, v175
 v_pk_mul_f32 v[56:57], v[60:61], v[56:57] op_sel:[1,0] op_sel_hi:[1,1]
 s_nop 0
 v_permlane32_swap_b32 v172, v173
 v_cvt_pk_bf16_f32 v64, v56, v57
 v_add_f32 v172, v172, v173
 v_pk_mul_f32 v[58:59], v[60:61], v[58:59] op_sel:[1,0] op_sel_hi:[1,1]
 v_rcp_f32 v172, v172
 v_cvt_pk_bf16_f32 v65, v58, v59
 v_mov_b32 v173, v172
 ds_write_b64 v14, v[64:65] offset:29568
 s_nop 0
 v_permlane32_swap_b32 v172, v173
 v_pk_mul_f32 v[152:153], v[172:173], v[152:153] op_sel_hi:[0,1]
 v_cvt_pk_bf16_f32 v104, v152, v153
 v_pk_mul_f32 v[154:155], v[172:173], v[154:155] op_sel_hi:[0,1]
 v_cvt_pk_bf16_f32 v105, v154, v155
 v_pk_mul_f32 v[156:157], v[172:173], v[156:157] op_sel_hi:[0,1]
 v_cvt_pk_bf16_f32 v106, v156, v157
 v_pk_mul_f32 v[158:159], v[172:173], v[158:159] op_sel_hi:[0,1]
 v_cvt_pk_bf16_f32 v107, v158, v159
 ds_write_b128 v12, v[104:107] offset:512
 v_pk_mul_f32 v[160:161], v[172:173], v[160:161] op_sel_hi:[0,1]
 v_cvt_pk_bf16_f32 v108, v160, v161
 v_pk_mul_f32 v[162:163], v[172:173], v[162:163] op_sel:[1,0] op_sel_hi:[1,1]
 v_cvt_pk_bf16_f32 v109, v162, v163
 v_pk_mul_f32 v[164:165], v[172:173], v[164:165] op_sel:[1,0] op_sel_hi:[1,1]
 v_cvt_pk_bf16_f32 v110, v164, v165
 v_pk_mul_f32 v[166:167], v[172:173], v[166:167] op_sel:[1,0] op_sel_hi:[1,1]
 v_cvt_pk_bf16_f32 v111, v166, v167
 ds_write_b128 v12, v[108:111] offset:8960
 v_pk_mul_f32 v[168:169], v[172:173], v[168:169] op_sel:[1,0] op_sel_hi:[1,1]
 v_cvt_pk_bf16_f32 v120, v168, v169
 v_pk_mul_f32 v[170:171], v[172:173], v[170:171] op_sel:[1,0] op_sel_hi:[1,1]
 v_cvt_pk_bf16_f32 v121, v170, v171
 ds_write_b64 v14, v[120:121] offset:30080
 v_mfma_f32_32x32x16_bf16 v[184:199], a[164:167], v[244:247], 0
 v_mfma_f32_32x32x16_bf16 v[184:199], a[172:175], v[248:251], v[184:199]
 v_mfma_f32_32x32x16_bf16 v[136:151], a[164:167], v[112:115], 0
 v_mfma_f32_32x32x16_bf16 v[136:151], a[172:175], v[116:119], v[136:151]
 s_waitcnt lgkmcnt(0)
 s_barrier
 s_lshl_b32 s4, s20, 11
 v_min_u32 v25, 1920, v18
 v_lshrrev_b32 v26, 1, v2
 s_cmp_eq_u32 s22, 3
 s_cbranch_scc1 hnokv_7
 ds_read_b64_tr_b16 v[40:41], v15
 ds_read_b64_tr_b16 v[42:43], v15 offset:256
 ds_read_b64_tr_b16 v[44:45], v16
 ds_read_b64_tr_b16 v[46:47], v16 offset:256
 ds_read_b64_tr_b16 v[48:49], v17
 ds_read_b64_tr_b16 v[50:51], v17 offset:256
 ds_read_b64_tr_b16 v[52:53], v15 offset:512
 ds_read_b64_tr_b16 v[54:55], v15 offset:768
 ds_read_b64_tr_b16 v[56:57], v16 offset:512
 ds_read_b64_tr_b16 v[58:59], v16 offset:768
 ds_read_b64_tr_b16 v[60:61], v17 offset:512
 ds_read_b64_tr_b16 v[62:63], v17 offset:768
 s_waitcnt lgkmcnt(8)
 v_mfma_f32_16x16x32_bf16 v[176:179], v[40:43], v[44:47], 0
 s_waitcnt lgkmcnt(6)
 ds_read_b64_tr_b16 v[64:65], v15 offset:1024
 ds_read_b64_tr_b16 v[66:67], v15 offset:1280
 ds_read_b64_tr_b16 v[68:69], v16 offset:1024
 v_mfma_f32_16x16x32_bf16 v[180:183], v[40:43], v[48:51], 0
 s_waitcnt lgkmcnt(5)
 ds_read_b64_tr_b16 v[70:71], v16 offset:1280
 ds_read_b64_tr_b16 v[72:73], v17 offset:1024
 ds_read_b64_tr_b16 v[74:75], v17 offset:1280
 v_mfma_f32_16x16x32_bf16 v[176:179], v[52:55], v[56:59], v[176:179]
 s_waitcnt lgkmcnt(6)
 ds_read_b64_tr_b16 v[76:77], v15 offset:1536
 ds_read_b64_tr_b16 v[78:79], v15 offset:1792
 ds_read_b64_tr_b16 v[80:81], v16 offset:1536
 v_mfma_f32_16x16x32_bf16 v[180:183], v[52:55], v[60:63], v[180:183]
 s_waitcnt lgkmcnt(5)
 ds_read_b64_tr_b16 v[82:83], v16 offset:1792
 ds_read_b64_tr_b16 v[84:85], v17 offset:1536
 ds_read_b64_tr_b16 v[86:87], v17 offset:1792
 v_mfma_f32_16x16x32_bf16 v[176:179], v[64:67], v[68:71], v[176:179]
 s_waitcnt lgkmcnt(6)
 ds_read_b64_tr_b16 v[40:41], v15 offset:2048
 ds_read_b64_tr_b16 v[42:43], v15 offset:2304
 ds_read_b64_tr_b16 v[44:45], v16 offset:2048
 v_mfma_f32_16x16x32_bf16 v[180:183], v[64:67], v[72:75], v[180:183]
 s_waitcnt lgkmcnt(5)
 ds_read_b64_tr_b16 v[46:47], v16 offset:2304
 ds_read_b64_tr_b16 v[48:49], v17 offset:2048
 ds_read_b64_tr_b16 v[50:51], v17 offset:2304
 v_mfma_f32_16x16x32_bf16 v[176:179], v[76:79], v[80:83], v[176:179]
 s_waitcnt lgkmcnt(6)
 ds_read_b64_tr_b16 v[52:53], v15 offset:2560
 ds_read_b64_tr_b16 v[54:55], v15 offset:2816
 ds_read_b64_tr_b16 v[56:57], v16 offset:2560
 v_mfma_f32_16x16x32_bf16 v[180:183], v[76:79], v[84:87], v[180:183]
 s_waitcnt lgkmcnt(5)
 ds_read_b64_tr_b16 v[58:59], v16 offset:2816
 ds_read_b64_tr_b16 v[60:61], v17 offset:2560
 ds_read_b64_tr_b16 v[62:63], v17 offset:2816
 v_mfma_f32_16x16x32_bf16 v[176:179], v[40:43], v[44:47], v[176:179]
 s_waitcnt lgkmcnt(6)
 ds_read_b64_tr_b16 v[64:65], v15 offset:3072
 ds_read_b64_tr_b16 v[66:67], v15 offset:3328
 ds_read_b64_tr_b16 v[68:69], v16 offset:3072
 v_mfma_f32_16x16x32_bf16 v[180:183], v[40:43], v[48:51], v[180:183]
 s_waitcnt lgkmcnt(5)
 ds_read_b64_tr_b16 v[70:71], v16 offset:3328
 ds_read_b64_tr_b16 v[72:73], v17 offset:3072
 ds_read_b64_tr_b16 v[74:75], v17 offset:3328
 v_mfma_f32_16x16x32_bf16 v[176:179], v[52:55], v[56:59], v[176:179]
 s_waitcnt lgkmcnt(6)
 ds_read_b64_tr_b16 v[76:77], v15 offset:3584
 ds_read_b64_tr_b16 v[78:79], v15 offset:3840
 ds_read_b64_tr_b16 v[80:81], v16 offset:3584
 v_mfma_f32_16x16x32_bf16 v[180:183], v[52:55], v[60:63], v[180:183]
 s_waitcnt lgkmcnt(5)
 ds_read_b64_tr_b16 v[82:83], v16 offset:3840
 ds_read_b64_tr_b16 v[84:85], v17 offset:3584
 ds_read_b64_tr_b16 v[86:87], v17 offset:3840
 v_mfma_f32_16x16x32_bf16 v[176:179], v[64:67], v[68:71], v[176:179]
 s_waitcnt lgkmcnt(6)
 v_mfma_f32_16x16x32_bf16 v[180:183], v[64:67], v[72:75], v[180:183]
 s_waitcnt lgkmcnt(2)
 v_mfma_f32_16x16x32_bf16 v[176:179], v[76:79], v[80:83], v[176:179]
 s_waitcnt lgkmcnt(0)
 v_mfma_f32_16x16x32_bf16 v[180:183], v[76:79], v[84:87], v[180:183]
 s_nop 5
 v_cvt_pk_bf16_f32 v84, v176, v177
 v_cvt_pk_bf16_f32 v85, v178, v179
 v_cvt_pk_bf16_f32 v86, v180, v181
 v_cvt_pk_bf16_f32 v87, v182, v183
hnokv_7:
 v_min_u32 v84, -2, v84
 v_min_u32 v85, -2, v85
 v_min_u32 v86, -2, v86
 v_min_u32 v87, -2, v87
 buffer_store_dwordx4 v[84:87], v18, s[8:11], s43 offen sc1
 ds_write_b128 v25, v[84:87] offset:39424
 s_waitcnt vmcnt(27)
 v_add_f32 v200, v200, v204
 buffer_load_dwordx4 a[160:163], v38, s[8:11], s66 offen offset:2048 sc1
 v_mov_b32 v204, v200
 v_add_f32 v201, v201, v205
 v_mov_b32 v205, v201
 buffer_load_dwordx4 a[100:103], v38, s[8:11], s66 offen offset:3072 sc1
 v_add_f32 v202, v202, v206
 v_mov_b32 v206, v202
 v_add_f32 v203, v203, v207
 v_mov_b32 v207, v203
 buffer_load_dwordx4 a[104:107], v38, s[8:11], s67 offen sc1
 v_permlane32_swap_b32 v200, v204
 v_permlane32_swap_b32 v201, v205
 v_permlane32_swap_b32 v202, v206
 buffer_load_dwordx4 a[108:111], v38, s[8:11], s67 offen offset:1024 sc1
 v_permlane32_swap_b32 v203, v207
 v_add_f32 v200, v200, v204
 v_add_f32 v201, v201, v205
 v_add_f32 v202, v202, v206
 buffer_load_dwordx4 v[104:107], v38, s[8:11], s68 offen sc1
 v_add_f32 v203, v203, v207
 v_cvt_pk_bf16_f32 v204, v200, v200
 v_and_b32 v204, 0xffff0000, v204
 buffer_load_dwordx4 v[108:111], v38, s[8:11], s68 offen offset:1024 sc1
 v_sub_f32 v204, v200, v204
 v_cvt_pk_bf16_f32 v200, v200, v204
 s_waitcnt lgkmcnt(0)
 s_barrier
 ds_read_b64 v[88:89], v26 offset:39424
 v_cvt_pk_bf16_f32 v205, v201, v201
 buffer_load_dwordx4 v[112:115], v38, s[8:11], s68 offen offset:2048 sc1
 v_and_b32 v205, 0xffff0000, v205
 v_sub_f32 v205, v201, v205
 v_cvt_pk_bf16_f32 v201, v201, v205
 v_cvt_pk_bf16_f32 v206, v202, v202
 buffer_load_dwordx4 v[116:119], v38, s[8:11], s68 offen offset:3072 sc1
 v_and_b32 v206, 0xffff0000, v206
 v_sub_f32 v206, v202, v206
 v_cvt_pk_bf16_f32 v202, v202, v206
 buffer_load_dwordx4 v[120:123], v38, s[8:11], s69 offen sc1
 v_cvt_pk_bf16_f32 v207, v203, v203
 v_and_b32 v207, 0xffff0000, v207
 v_sub_f32 v207, v203, v207
 v_cvt_pk_bf16_f32 v203, v203, v207
 buffer_load_dwordx4 v[124:127], v38, s[8:11], s69 offen offset:1024 sc1
 ds_write2_b32 v233, v200, v201 offset0:64 offset1:66
 ds_write2_b32 v233, v202, v203 offset0:68 offset1:70
 v_max3_f32 v172, v184, v185, v186
 buffer_load_dwordx4 v[128:131], v38, s[8:11], s69 offen offset:2048 sc1
 v_max3_f32 v220, v136, v137, v138
 v_max3_f32 v173, -v184, -v185, -v186
 v_max3_f32 v221, -v136, -v137, -v138
 v_max3_f32 v172, v172, v187, v188
 buffer_load_dwordx4 v[132:135], v38, s[8:11], s69 offen offset:3072 sc1
 v_max3_f32 v220, v220, v139, v140
 v_max3_f32 v173, v173, -v187, -v188
 v_max3_f32 v221, v221, -v139, -v140
 buffer_load_dwordx4 v[216:219], v38, s[8:11], s70 offen sc1
 v_max3_f32 v172, v172, v189, v190
 v_max3_f32 v220, v220, v141, v142
 v_max3_f32 v173, v173, -v189, -v190
 v_max3_f32 v221, v221, -v141, -v142
 s_add_u32 m0, s28, 49152
 s_add_u32 s85, s64, 8192
 buffer_load_dwordx4 v3, s[8:11], s85 offen sc1 lds
 v_max3_f32 v172, v172, v191, v192
 v_max3_f32 v220, v220, v143, v144
 v_max3_f32 v173, v173, -v191, -v192
 v_max3_f32 v221, v221, -v143, -v144
 v_max_f32 v172, v172, v193
 v_max_f32 v220, v220, v145
 v_max_f32 v173, v173, -v193
 v_max_f32 v221, v221, -v145
 s_nop 0
 v_permlane32_swap_b32 v172, v173
 v_permlane32_swap_b32 v220, v221
 v_max_f32 v174, v172, v173
 v_max_f32 v222, v220, v221
 v_mul_f32 v172, -v174, v225
 v_mul_f32 v220, -v222, v227
 v_mul_f32 v173, -v174, v225
 v_mul_f32 v221, -v222, v227
 s_nop 0
 v_permlane32_swap_b32 v172, v173
 v_permlane32_swap_b32 v220, v221
 v_pk_fma_f32 v[152:153], v[224:225], v[184:185], v[172:173] op_sel:[1,0,0] op_sel_hi:[1,1,0]
 v_pk_fma_f32 v[40:41], v[226:227], v[136:137], v[220:221] op_sel:[1,0,0] op_sel_hi:[1,1,0]
 v_pk_fma_f32 v[162:163], v[224:225], v[184:185], v[172:173] op_sel:[1,0,1] op_sel_hi:[1,1,1] neg_lo:[1,0,0] neg_hi:[1,0,0]
 v_pk_fma_f32 v[50:51], v[226:227], v[136:137], v[220:221] op_sel:[1,0,1] op_sel_hi:[1,1,1] neg_lo:[1,0,0] neg_hi:[1,0,0]
 v_pk_fma_f32 v[154:155], v[224:225], v[186:187], v[172:173] op_sel:[1,0,0] op_sel_hi:[1,1,0]
 v_pk_fma_f32 v[42:43], v[226:227], v[138:139], v[220:221] op_sel:[1,0,0] op_sel_hi:[1,1,0]
 v_pk_fma_f32 v[164:165], v[224:225], v[186:187], v[172:173] op_sel:[1,0,1] op_sel_hi:[1,1,1] neg_lo:[1,0,0] neg_hi:[1,0,0]
 v_pk_fma_f32 v[52:53], v[226:227], v[138:139], v[220:221] op_sel:[1,0,1] op_sel_hi:[1,1,1] neg_lo:[1,0,0] neg_hi:[1,0,0]
 v_pk_fma_f32 v[156:157], v[224:225], v[188:189], v[172:173] op_sel:[1,0,0] op_sel_hi:[1,1,0]
 v_pk_fma_f32 v[44:45], v[226:227], v[140:141], v[220:221] op_sel:[1,0,0] op_sel_hi:[1,1,0]
 v_pk_fma_f32 v[166:167], v[224:225], v[188:189], v[172:173] op_sel:[1,0,1] op_sel_hi:[1,1,1] neg_lo:[1,0,0] neg_hi:[1,0,0]
 v_pk_fma_f32 v[54:55], v[226:227], v[140:141], v[220:221] op_sel:[1,0,1] op_sel_hi:[1,1,1] neg_lo:[1,0,0] neg_hi:[1,0,0]
 v_pk_fma_f32 v[158:159], v[224:225], v[190:191], v[172:173] op_sel:[1,0,0] op_sel_hi:[1,1,0]
 v_pk_fma_f32 v[46:47], v[226:227], v[142:143], v[220:221] op_sel:[1,0,0] op_sel_hi:[1,1,0]
 v_pk_fma_f32 v[168:169], v[224:225], v[190:191], v[172:173] op_sel:[1,0,1] op_sel_hi:[1,1,1] neg_lo:[1,0,0] neg_hi:[1,0,0]
 v_pk_fma_f32 v[56:57], v[226:227], v[142:143], v[220:221] op_sel:[1,0,1] op_sel_hi:[1,1,1] neg_lo:[1,0,0] neg_hi:[1,0,0]
 v_pk_fma_f32 v[160:161], v[224:225], v[192:193], v[172:173] op_sel:[1,0,0] op_sel_hi:[1,1,0]
 v_pk_fma_f32 v[48:49], v[226:227], v[144:145], v[220:221] op_sel:[1,0,0] op_sel_hi:[1,1,0]
 v_pk_fma_f32 v[170:171], v[224:225], v[192:193], v[172:173] op_sel:[1,0,1] op_sel_hi:[1,1,1] neg_lo:[1,0,0] neg_hi:[1,0,0]
 v_pk_fma_f32 v[58:59], v[226:227], v[144:145], v[220:221] op_sel:[1,0,1] op_sel_hi:[1,1,1] neg_lo:[1,0,0] neg_hi:[1,0,0]
 v_exp_f32 v152, v152
 v_exp_f32 v40, v40
 v_exp_f32 v153, v153
 v_exp_f32 v41, v41
 v_exp_f32 v154, v154
 v_exp_f32 v42, v42
 v_exp_f32 v155, v155
 v_exp_f32 v43, v43
 v_exp_f32 v156, v156
 v_exp_f32 v44, v44
 v_exp_f32 v157, v157
 v_exp_f32 v45, v45
 v_exp_f32 v158, v158
 v_exp_f32 v46, v46
 v_exp_f32 v159, v159
 v_exp_f32 v47, v47
 s_xor_b32 s86, s4, 2048
 buffer_load_dwordx2 v[90:91], v19, s[8:11], s86 offen sc1
 s_xor_b32 s86, s4, 4096
 buffer_load_dwordx2 v[92:93], v19, s[8:11], s86 offen sc1
 s_xor_b32 s86, s4, 6144
 buffer_load_dwordx2 v[94:95], v19, s[8:11], s86 offen sc1
 s_xor_b32 s86, s4, 8192
 buffer_load_dwordx2 v[96:97], v19, s[8:11], s86 offen sc1
 s_xor_b32 s86, s4, 10240
 buffer_load_dwordx2 v[98:99], v19, s[8:11], s86 offen sc1
 s_xor_b32 s86, s4, 12288
 buffer_load_dwordx2 v[100:101], v19, s[8:11], s86 offen sc1
 s_xor_b32 s86, s4, 14336
 buffer_load_dwordx2 v[102:103], v19, s[8:11], s86 offen sc1
 v_exp_f32 v160, v160
 buffer_load_dwordx4 a[40:43], v39, s[8:11], s66 offen offset:2048 sc1
 v_exp_f32 v48, v48
 v_exp_f32 v161, v161
 v_exp_f32 v49, v49
 v_exp_f32 v162, v162
 v_exp_f32 v50, v50
 v_exp_f32 v163, v163
 v_exp_f32 v51, v51
 v_exp_f32 v164, v164
 v_exp_f32 v52, v52
 v_exp_f32 v165, v165
 v_exp_f32 v53, v53
 v_exp_f32 v166, v166
 v_exp_f32 v54, v54
 v_exp_f32 v167, v167
 v_exp_f32 v55, v55
 v_exp_f32 v168, v168
 v_exp_f32 v56, v56
 buffer_load_dwordx4 a[44:47], v39, s[8:11], s66 offen offset:3072 sc1
 v_exp_f32 v169, v169
 v_exp_f32 v57, v57
 v_exp_f32 v170, v170
 v_exp_f32 v58, v58
 v_exp_f32 v171, v171
 v_exp_f32 v59, v59
 v_pk_add_f32 v[172:173], v[152:153], v[154:155]
 v_pk_add_f32 v[220:221], v[40:41], v[42:43]
 v_pk_add_f32 v[174:175], v[162:163], v[164:165]
 v_pk_add_f32 v[222:223], v[50:51], v[52:53]
 v_pk_add_f32 v[172:173], v[172:173], v[156:157]
 v_pk_add_f32 v[220:221], v[220:221], v[44:45]
 v_pk_add_f32 v[174:175], v[174:175], v[166:167]
 v_pk_add_f32 v[222:223], v[222:223], v[54:55]
 v_pk_add_f32 v[172:173], v[172:173], v[158:159]
 v_pk_add_f32 v[220:221], v[220:221], v[46:47]
 v_pk_add_f32 v[174:175], v[174:175], v[168:169]
 buffer_load_dwordx4 a[48:51], v39, s[8:11], s67 offen sc1
 v_pk_add_f32 v[222:223], v[222:223], v[56:57]
 v_pk_add_f32 v[172:173], v[172:173], v[160:161]
 v_pk_add_f32 v[220:221], v[220:221], v[48:49]
 v_pk_add_f32 v[174:175], v[174:175], v[170:171]
 v_pk_add_f32 v[222:223], v[222:223], v[58:59]
 v_add_f32 v172, v172, v173
 v_add_f32 v220, v220, v221
 v_add_f32 v173, v174, v175
 v_add_f32 v221, v222, v223
 s_nop 0
 v_permlane32_swap_b32 v172, v173
 v_permlane32_swap_b32 v220, v221
 v_add_f32 v172, v172, v173
 v_add_f32 v220, v220, v221
 v_rcp_f32 v172, v172
 v_rcp_f32 v220, v220
 v_mov_b32 v173, v172
 v_mov_b32 v221, v220
 buffer_load_dwordx4 a[52:55], v39, s[8:11], s67 offen offset:1024 sc1
 v_permlane32_swap_b32 v172, v173
 v_permlane32_swap_b32 v220, v221
 v_pk_mul_f32 v[152:153], v[172:173], v[152:153] op_sel_hi:[0,1]
 v_pk_mul_f32 v[40:41], v[220:221], v[40:41] op_sel_hi:[0,1]
 v_cvt_pk_bf16_f32 v232, v152, v153
 v_cvt_pk_bf16_f32 v244, v40, v41
 v_pk_mul_f32 v[154:155], v[172:173], v[154:155] op_sel_hi:[0,1]
 v_pk_mul_f32 v[42:43], v[220:221], v[42:43] op_sel_hi:[0,1]
 v_cvt_pk_bf16_f32 v233, v154, v155
 v_cvt_pk_bf16_f32 v245, v42, v43
 v_pk_mul_f32 v[156:157], v[172:173], v[156:157] op_sel_hi:[0,1]
 v_pk_mul_f32 v[44:45], v[220:221], v[44:45] op_sel_hi:[0,1]
 v_cvt_pk_bf16_f32 v234, v156, v157
 v_cvt_pk_bf16_f32 v246, v44, v45
 v_pk_mul_f32 v[158:159], v[172:173], v[158:159] op_sel_hi:[0,1]
 v_pk_mul_f32 v[46:47], v[220:221], v[46:47] op_sel_hi:[0,1]
 v_cvt_pk_bf16_f32 v235, v158, v159
 buffer_load_dwordx4 a[56:59], v39, s[8:11], s67 offen offset:2048 sc1
 v_cvt_pk_bf16_f32 v247, v46, v47
 v_pk_mul_f32 v[160:161], v[172:173], v[160:161] op_sel_hi:[0,1]
 v_pk_mul_f32 v[48:49], v[220:221], v[48:49] op_sel_hi:[0,1]
 v_cvt_pk_bf16_f32 v236, v160, v161
 v_cvt_pk_bf16_f32 v248, v48, v49
 v_pk_mul_f32 v[162:163], v[172:173], v[162:163] op_sel:[1,0] op_sel_hi:[1,1]
 v_pk_mul_f32 v[50:51], v[220:221], v[50:51] op_sel:[1,0] op_sel_hi:[1,1]
 v_cvt_pk_bf16_f32 v237, v162, v163
 v_cvt_pk_bf16_f32 v249, v50, v51
 v_pk_mul_f32 v[164:165], v[172:173], v[164:165] op_sel:[1,0] op_sel_hi:[1,1]
 v_pk_mul_f32 v[52:53], v[220:221], v[52:53] op_sel:[1,0] op_sel_hi:[1,1]
 v_cvt_pk_bf16_f32 v238, v164, v165
 v_cvt_pk_bf16_f32 v250, v52, v53
 v_pk_mul_f32 v[166:167], v[172:173], v[166:167] op_sel:[1,0] op_sel_hi:[1,1]
 v_pk_mul_f32 v[54:55], v[220:221], v[54:55] op_sel:[1,0] op_sel_hi:[1,1]
 v_cvt_pk_bf16_f32 v239, v166, v167
 v_cvt_pk_bf16_f32 v251, v54, v55
 buffer_load_dwordx4 a[60:63], v39, s[8:11], s67 offen offset:3072 sc1
 v_pk_mul_f32 v[168:169], v[172:173], v[168:169] op_sel:[1,0] op_sel_hi:[1,1]
 v_pk_mul_f32 v[56:57], v[220:221], v[56:57] op_sel:[1,0] op_sel_hi:[1,1]
 v_cvt_pk_bf16_f32 v240, v168, v169
 v_cvt_pk_bf16_f32 v252, v56, v57
 v_pk_mul_f32 v[170:171], v[172:173], v[170:171] op_sel:[1,0] op_sel_hi:[1,1]
 v_pk_mul_f32 v[58:59], v[220:221], v[58:59] op_sel:[1,0] op_sel_hi:[1,1]
 v_cvt_pk_bf16_f32 v241, v170, v171
 v_cvt_pk_bf16_f32 v253, v58, v59
 v_mov_b32 v242, 0
 v_mov_b32 v254, 0
 v_mov_b32 v243, 0
 v_mov_b32 v255, 0
 v_mov_b32 v25, 0x3f80
 v_mov_b32 v26, 0x3f800000
 v_mov_b32 v74, 0
 v_mov_b32 v75, 0
hkvspin_8:
 s_waitcnt lgkmcnt(2)
 v_dot2_f32_bf16 v60, v88, v25, 0
 v_dot2_f32_bf16 v61, v88, v26, 0
 v_dot2_f32_bf16 v62, v89, v25, 0
 v_dot2_f32_bf16 v63, v89, v26, 0
 s_waitcnt vmcnt(12)
 v_max3_u32 v172, 0, v90, v91
 v_dot2_f32_bf16 v60, v90, v25, v60
 v_dot2_f32_bf16 v61, v90, v26, v61
 v_dot2_f32_bf16 v62, v91, v25, v62
 v_dot2_f32_bf16 v63, v91, v26, v63
 s_waitcnt vmcnt(11)
 v_max3_u32 v172, v172, v92, v93
 v_dot2_f32_bf16 v60, v92, v25, v60
 v_dot2_f32_bf16 v61, v92, v26, v61
 v_dot2_f32_bf16 v62, v93, v25, v62
 v_dot2_f32_bf16 v63, v93, v26, v63
 s_waitcnt vmcnt(10)
 v_max3_u32 v172, v172, v94, v95
 v_dot2_f32_bf16 v60, v94, v25, v60
 v_dot2_f32_bf16 v61, v94, v26, v61
 v_dot2_f32_bf16 v62, v95, v25, v62
 v_dot2_f32_bf16 v63, v95, v26, v63
 s_waitcnt vmcnt(9)
 v_max3_u32 v172, v172, v96, v97
 v_dot2_f32_bf16 v60, v96, v25, v60
 v_dot2_f32_bf16 v61, v96, v26, v61
 v_dot2_f32_bf16 v62, v97, v25, v62
 v_dot2_f32_bf16 v63, v97, v26, v63
 s_waitcnt vmcnt(8)
 v_max3_u32 v172, v172, v98, v99
 v_dot2_f32_bf16 v60, v98, v25, v60
 v_dot2_f32_bf16 v61, v98, v26, v61
 v_dot2_f32_bf16 v62, v99, v25, v62
 v_dot2_f32_bf16 v63, v99, v26, v63
 s_waitcnt vmcnt(7)
 v_max3_u32 v172, v172, v100, v101
pad2:
 s_cbranch_execz pad6
 v_dot2_f32_bf16 v60, v100, v25, v60
 v_dot2_f32_bf16 v61, v100, v26, v61
 v_dot2_f32_bf16 v62, v101, v25, v62
 v_dot2_f32_bf16 v63, v101, v26, v63
 s_waitcnt vmcnt(6)
 v_max3_u32 v172, v172, v102, v103
 v_cmp_eq_u32 vcc, -1, v172
 v_dot2_f32_bf16 v60, v102, v25, v60
 v_dot2_f32_bf16 v61, v102, v26, v61
 v_dot2_f32_bf16 v62, v103, v25, v62
 v_dot2_f32_bf16 v63, v103, v26, v63
 s_cbranch_vccz hkvok_9
hkvretry_10:
 s_xor_b32 s86, s4, 2048
 buffer_load_dwordx2 v[90:91], v19, s[8:11], s86 offen sc1
 s_xor_b32 s86, s4, 4096
 buffer_load_dwordx2 v[92:93], v19, s[8:11], s86 offen sc1
 s_xor_b32 s86, s4, 6144
 buffer_load_dwordx2 v[94:95], v19, s[8:11], s86 offen sc1
 s_xor_b32 s86, s4, 8192
 buffer_load_dwordx2 v[96:97], v19, s[8:11], s86 offen sc1
 s_xor_b32 s86, s4, 10240
 buffer_load_dwordx2 v[98:99], v19, s[8:11], s86 offen sc1
 s_xor_b32 s86, s4, 12288
 buffer_load_dwordx2 v[100:101], v19, s[8:11], s86 offen sc1
 s_xor_b32 s86, s4, 14336
 buffer_load_dwordx2 v[102:103], v19, s[8:11], s86 offen sc1
 s_waitcnt vmcnt(6)
 v_max3_u32 v172, 0, v90, v91
 s_waitcnt vmcnt(5)
 v_max3_u32 v172, v172, v92, v93
 s_waitcnt vmcnt(4)
 v_max3_u32 v172, v172, v94, v95
 s_waitcnt vmcnt(3)
 v_max3_u32 v172, v172, v96, v97
 s_waitcnt vmcnt(2)
 v_max3_u32 v172, v172, v98, v99
 s_waitcnt vmcnt(1)
 v_max3_u32 v172, v172, v100, v101
 s_waitcnt vmcnt(0)
 v_max3_u32 v172, v172, v102, v103
 v_cmp_eq_u32 vcc, -1, v172
 s_cbranch_vccz hkvspin_8
 s_add_u32 s29, s29, 1
 s_cmp_lt_u32 s29, 524288
 s_cbranch_scc1 hkvretry_10
hkvok_9:
 s_nop 1
 s_cmp_lg_u32 s87, 0
 s_cbranch_scc1 slow_body
 v_cvt_pk_bf16_f32 v88, v60, v61
 v_cvt_pk_bf16_f32 v89, v62, v63
 ds_write_b64 v20, v[88:89]
 buffer_load_dwordx4 v3, s[8:11], s85 offen offset:1024 sc1 lds
 buffer_load_dwordx4 v3, s[8:11], s85 offen offset:2048 sc1 lds
 buffer_load_dwordx4 v3, s[8:11], s85 offen offset:3072 sc1 lds
 buffer_load_dwordx4 a[64:67], v39, s[8:11], s68 offen sc1
 buffer_load_dwordx4 a[68:71], v39, s[8:11], s68 offen offset:1024 sc1
 s_waitcnt lgkmcnt(0)
 s_barrier
 ds_read_b128 v[64:67], v1 offset:35840
 ds_read_b128 v[68:71], v1 offset:36864
 ds_read_b64 v[72:73], v1 offset:37888
 s_waitcnt lgkmcnt(2)
 v_mfma_f32_32x32x16_bf16 v[184:199], v[64:67], v[232:235], 0
 s_waitcnt lgkmcnt(1)
 v_mfma_f32_32x32x16_bf16 v[184:199], v[68:71], v[236:239], v[184:199]
 s_waitcnt lgkmcnt(0)
 v_mfma_f32_32x32x16_bf16 v[184:199], v[72:75], v[240:243], v[184:199]
 v_mfma_f32_32x32x16_bf16 v[136:151], v[64:67], v[244:247], 0
 v_mfma_f32_32x32x16_bf16 v[136:151], v[68:71], v[248:251], v[136:151]
 v_mfma_f32_32x32x16_bf16 v[136:151], v[72:75], v[252:255], v[136:151]
 s_nop 8
 v_add_f32 v196, 0x358637bd, v196
 v_rcp_f32 v196, v196
 s_nop 0
 v_mul_f32 v184, v184, v196
 v_mul_f32 v185, v185, v196
 v_cvt_pk_bf16_f32 v40, v184, v185
 v_mul_f32 v186, v186, v196
 v_mul_f32 v187, v187, v196
 v_cvt_pk_bf16_f32 v41, v186, v187
 v_mul_f32 v188, v188, v196
 v_mul_f32 v189, v189, v196
 v_cvt_pk_bf16_f32 v42, v188, v189
 v_pk_mul_f32 v[190:191], v[190:191], v[196:197] op_sel_hi:[1,0]
 v_cvt_pk_bf16_f32 v43, v190, v191
 buffer_store_dwordx4 v[40:43], v6, s[8:11], 0 offen
 v_pk_mul_f32 v[192:193], v[192:193], v[196:197] op_sel_hi:[1,0]
 v_cvt_pk_bf16_f32 v44, v192, v193
 v_pk_mul_f32 v[194:195], v[194:195], v[196:197] op_sel_hi:[1,0]
 v_cvt_pk_bf16_f32 v45, v194, v195
 buffer_store_dwordx2 v[44:45], v7, s[8:11], 0 offen
 v_add_f32 v148, 0x358637bd, v148
 v_rcp_f32 v148, v148
 s_nop 0
 v_pk_mul_f32 v[136:137], v[136:137], v[148:149] op_sel_hi:[1,0]
 v_cvt_pk_bf16_f32 v48, v136, v137
 v_pk_mul_f32 v[138:139], v[138:139], v[148:149] op_sel_hi:[1,0]
 v_cvt_pk_bf16_f32 v49, v138, v139
 v_pk_mul_f32 v[140:141], v[140:141], v[148:149] op_sel_hi:[1,0]
 v_cvt_pk_bf16_f32 v50, v140, v141
 v_pk_mul_f32 v[142:143], v[142:143], v[148:149] op_sel_hi:[1,0]
 v_cvt_pk_bf16_f32 v51, v142, v143
 buffer_store_dwordx4 v[48:51], v6, s[8:11], s0 offen
 v_pk_mul_f32 v[144:145], v[144:145], v[148:149] op_sel_hi:[1,0]
 v_cvt_pk_bf16_f32 v52, v144, v145
 v_pk_mul_f32 v[146:147], v[146:147], v[148:149] op_sel_hi:[1,0]
 v_cvt_pk_bf16_f32 v53, v146, v147
 buffer_store_dwordx2 v[52:53], v7, s[8:11], s0 offen
 s_add_u32 m0, s28, 114688
 s_add_u32 s85, s35, 32768
 buffer_load_dwordx4 v3, s[8:11], s85 offen offset:2048 sc1 lds
 buffer_load_dwordx4 v3, s[8:11], s85 offen offset:3072 sc1 lds
 s_add_u32 m0, s28, 147456
 s_add_u32 s85, s35, 65536
 buffer_load_dwordx4 v3, s[8:11], s85 offen sc1 lds
 buffer_load_dwordx4 v3, s[8:11], s85 offen offset:1024 sc1 lds
 s_add_u32 s31, s22, 3
 s_and_b32 s31, s31, 3
 s_mul_i32 s31, s31, 5120
 s_add_u32 s31, s31, 2048
 v_add_u32 v220, s31, v22
 s_add_u32 s31, s22, 2
 s_and_b32 s31, s31, 3
 s_mul_i32 s31, s31, 5120
 s_add_u32 s31, s31, 2048
 v_add_u32 v221, s31, v22
 s_add_u32 s31, s22, 1
 s_and_b32 s31, s31, 3
 s_mul_i32 s31, s31, 5120
 s_add_u32 s31, s31, 2048
 v_add_u32 v222, s31, v22
 v_lshlrev_b32 v192, 16, v28
 v_and_b32 v193, 0xffff0000, v28
 v_lshlrev_b32 v194, 16, v29
 v_and_b32 v195, 0xffff0000, v29
 v_lshlrev_b32 v196, 16, v30
 v_and_b32 v197, 0xffff0000, v30
 v_lshlrev_b32 v198, 16, v31
 v_and_b32 v199, 0xffff0000, v31
 v_lshlrev_b32 v200, 16, v32
 v_and_b32 v201, 0xffff0000, v32
 v_lshlrev_b32 v202, 16, v33
 v_and_b32 v203, 0xffff0000, v33
 v_lshlrev_b32 v204, 16, v34
 v_and_b32 v205, 0xffff0000, v34
 v_lshlrev_b32 v206, 16, v35
 v_and_b32 v207, 0xffff0000, v35
 v_lshlrev_b32 v208, 16, v36
 v_and_b32 v209, 0xffff0000, v36
 v_lshlrev_b32 v210, 16, v37
 v_and_b32 v211, 0xffff0000, v37
 s_add_u32 s30, s52, 4096
 s_add_u32 s31, s53, 4096
 s_add_u32 s32, s54, 4096
 s_add_u32 s33, s55, 4096
 v_mov_b32 v27, 1
 s_waitcnt vmcnt(4)
 s_mov_b64 exec, 1
 buffer_store_dword v27, off, s[8:11], s46
 s_mov_b64 exec, -1
 buffer_load_dwordx4 a[112:115], v38, s[8:11], s67 offen offset:2048 sc1
 buffer_load_dwordx4 a[116:119], v38, s[8:11], s67 offen offset:3072 sc1
 s_add_u32 m0, s28, 131072
 s_add_u32 s85, s35, 49152
 buffer_load_dwordx4 v3, s[8:11], s85 offen sc1 lds
 buffer_load_dwordx4 v3, s[8:11], s85 offen offset:1024 sc1 lds
 s_add_u32 m0, s28, 147456
 s_add_u32 s85, s35, 65536
 buffer_load_dwordx4 v3, s[8:11], s85 offen offset:2048 sc1 lds
 buffer_load_dwordx4 v3, s[8:11], s85 offen offset:3072 sc1 lds
 v_and_b32 v25, 28, v22
 buffer_load_dword v26, v25, s[8:11], s47 offen sc1
fspin_1:
 buffer_load_dword v0, v25, s[8:11], s47 offen sc1
 s_waitcnt vmcnt(1)
 v_cmp_gt_u32 vcc, 1, v26
 s_cbranch_vccz fok_2
 buffer_load_dword v26, v25, s[8:11], s47 offen sc1
 s_waitcnt vmcnt(1)
 v_cmp_gt_u32 vcc, 1, v0
 s_cbranch_vccz fok_2
 s_add_u32 s29, s29, 1
 s_cmp_lt_u32 s29, 524288
 s_cbranch_scc1 fspin_1
fok_2:
 buffer_load_dwordx4 v[40:43], v1, s[8:11], s52 offen sc1
 buffer_load_dwordx4 v[44:47], v1, s[8:11], s52 offen offset:1024 sc1
 buffer_load_dwordx4 v[48:51], v1, s[8:11], s52 offen offset:2048 sc1
 buffer_load_dwordx4 v[52:55], v1, s[8:11], s52 offen offset:3072 sc1
 buffer_load_dwordx4 v[56:59], v1, s[8:11], s30 offen sc1
 buffer_load_dwordx4 v[60:63], v1, s[8:11], s53 offen sc1
 buffer_load_dwordx4 v[64:67], v1, s[8:11], s53 offen offset:1024 sc1
 buffer_load_dwordx4 v[68:71], v1, s[8:11], s53 offen offset:2048 sc1
 s_waitcnt vmcnt(7)
 v_mfma_f32_16x16x32_bf16 v[152:155], a[120:123], v[40:43], 0
 buffer_load_dwordx4 v[72:75], v1, s[8:11], s53 offen offset:3072 sc1
 v_mfma_f32_16x16x32_bf16 v[156:159], a[124:127], v[40:43], 0
 v_mfma_f32_16x16x32_bf16 v[160:163], a[128:131], v[40:43], 0
 v_mfma_f32_16x16x32_bf16 v[164:167], a[132:135], v[40:43], 0
 buffer_load_dwordx4 v[76:79], v1, s[8:11], s31 offen sc1
 v_mfma_f32_16x16x32_bf16 v[168:171], a[136:139], v[40:43], 0
 s_waitcnt vmcnt(8)
 v_mfma_f32_16x16x32_bf16 v[152:155], a[140:143], v[44:47], v[152:155]
 v_mfma_f32_16x16x32_bf16 v[156:159], a[144:147], v[44:47], v[156:159]
 buffer_load_dwordx4 v[80:83], v1, s[8:11], s54 offen sc1
 v_mfma_f32_16x16x32_bf16 v[160:163], a[148:151], v[44:47], v[160:163]
 v_mfma_f32_16x16x32_bf16 v[164:167], a[152:155], v[44:47], v[164:167]
 v_mfma_f32_16x16x32_bf16 v[168:171], a[156:159], v[44:47], v[168:171]
 s_waitcnt vmcnt(8)
 v_mfma_f32_16x16x32_bf16 v[152:155], a[160:163], v[48:51], v[152:155]
 buffer_load_dwordx4 v[84:87], v1, s[8:11], s54 offen offset:1024 sc1
 v_mfma_f32_16x16x32_bf16 v[156:159], a[100:103], v[48:51], v[156:159]
 v_mfma_f32_16x16x32_bf16 v[160:163], a[104:107], v[48:51], v[160:163]
 v_mfma_f32_16x16x32_bf16 v[164:167], a[108:111], v[48:51], v[164:167]
 buffer_load_dwordx4 v[88:91], v1, s[8:11], s54 offen offset:2048 sc1
 v_mfma_f32_16x16x32_bf16 v[168:171], a[112:115], v[48:51], v[168:171]
 s_waitcnt vmcnt(9)
 v_mfma_f32_16x16x32_bf16 v[152:155], a[116:119], v[52:55], v[152:155]
 v_mfma_f32_16x16x32_bf16 v[156:159], v[104:107], v[52:55], v[156:159]
 buffer_load_dwordx4 v[92:95], v1, s[8:11], s54 offen offset:3072 sc1
 v_mfma_f32_16x16x32_bf16 v[160:163], v[108:111], v[52:55], v[160:163]
 v_mfma_f32_16x16x32_bf16 v[164:167], v[112:115], v[52:55], v[164:167]
 v_mfma_f32_16x16x32_bf16 v[168:171], v[116:119], v[52:55], v[168:171]
 s_waitcnt vmcnt(9)
 v_mfma_f32_16x16x32_bf16 v[152:155], v[120:123], v[56:59], v[152:155]
 buffer_load_dwordx4 v[96:99], v1, s[8:11], s32 offen sc1
 v_mfma_f32_16x16x32_bf16 v[156:159], v[124:127], v[56:59], v[156:159]
 v_mfma_f32_16x16x32_bf16 v[160:163], v[128:131], v[56:59], v[160:163]
 v_mfma_f32_16x16x32_bf16 v[164:167], v[132:135], v[56:59], v[164:167]
 buffer_load_dwordx4 v[100:103], v1, s[8:11], s55 offen sc1
 v_mfma_f32_16x16x32_bf16 v[168:171], v[216:219], v[56:59], v[168:171]
 s_waitcnt vmcnt(10)
 v_mfma_f32_16x16x32_bf16 v[172:175], a[120:123], v[60:63], 0
 v_mfma_f32_16x16x32_bf16 v[176:179], a[124:127], v[60:63], 0
 buffer_load_dwordx4 v[136:139], v1, s[8:11], s55 offen offset:1024 sc1
 v_mfma_f32_16x16x32_bf16 v[180:183], a[128:131], v[60:63], 0
 s_mov_b32 m0, s7
 s_nop 0
 ds_write_addtid_b32 v152
 ds_write_addtid_b32 v153 offset:256
 v_mfma_f32_16x16x32_bf16 v[184:187], a[132:135], v[60:63], 0
 ds_write_addtid_b32 v154 offset:512
 ds_write_addtid_b32 v155 offset:768
 v_mfma_f32_16x16x32_bf16 v[188:191], a[136:139], v[60:63], 0
 s_waitcnt vmcnt(10)
 ds_write_addtid_b32 v156 offset:1024
 ds_write_addtid_b32 v157 offset:1280
 ds_write_addtid_b32 v158 offset:1536
 v_mfma_f32_16x16x32_bf16 v[172:175], a[140:143], v[64:67], v[172:175]
 buffer_load_dwordx4 v[140:143], v1, s[8:11], s55 offen offset:2048 sc1
 ds_write_addtid_b32 v159 offset:1792
 v_mfma_f32_16x16x32_bf16 v[176:179], a[144:147], v[64:67], v[176:179]
 ds_write_addtid_b32 v160 offset:2048
 ds_write_addtid_b32 v161 offset:2304
 v_mfma_f32_16x16x32_bf16 v[180:183], a[148:151], v[64:67], v[180:183]
 ds_write_addtid_b32 v162 offset:2560
 ds_write_addtid_b32 v163 offset:2816
 v_mfma_f32_16x16x32_bf16 v[184:187], a[152:155], v[64:67], v[184:187]
 buffer_load_dwordx4 v[144:147], v1, s[8:11], s55 offen offset:3072 sc1
 ds_write_addtid_b32 v164 offset:3072
 v_mfma_f32_16x16x32_bf16 v[188:191], a[156:159], v[64:67], v[188:191]
 s_waitcnt vmcnt(11)
 ds_write_addtid_b32 v165 offset:3328
 ds_write_addtid_b32 v166 offset:3584
 v_mfma_f32_16x16x32_bf16 v[172:175], a[160:163], v[68:71], v[172:175]
 ds_write_addtid_b32 v167 offset:3840
 ds_write_addtid_b32 v168 offset:4096
 ds_write_addtid_b32 v169 offset:4352
 v_mfma_f32_16x16x32_bf16 v[176:179], a[100:103], v[68:71], v[176:179]
 buffer_load_dwordx4 v[148:151], v1, s[8:11], s33 offen sc1
 ds_write_addtid_b32 v170 offset:4608
 v_mfma_f32_16x16x32_bf16 v[180:183], a[104:107], v[68:71], v[180:183]
 s_add_u32 m0, s28, 131072
 s_add_u32 s85, s35, 49152
 buffer_load_dwordx4 v3, s[8:11], s85 offen offset:2048 sc1 lds
 s_mov_b32 m0, s7
 s_nop 0
 ds_write_addtid_b32 v171 offset:4864
 v_mfma_f32_16x16x32_bf16 v[184:187], a[108:111], v[68:71], v[184:187]
 v_mfma_f32_16x16x32_bf16 v[188:191], a[112:115], v[68:71], v[188:191]
 s_waitcnt vmcnt(12)
 v_mfma_f32_16x16x32_bf16 v[172:175], a[116:119], v[72:75], v[172:175]
 v_mfma_f32_16x16x32_bf16 v[176:179], v[104:107], v[72:75], v[176:179]
 s_waitcnt lgkmcnt(0)
 s_add_u32 m0, s28, 131072
 s_nop 0
 buffer_load_dwordx4 v3, s[8:11], s85 offen offset:3072 sc1 lds
 s_barrier
 v_mfma_f32_16x16x32_bf16 v[180:183], v[108:111], v[72:75], v[180:183]
 ds_read2st64_b32 v[40:41], v220 offset0:0 offset1:1
 v_mfma_f32_16x16x32_bf16 v[184:187], v[112:115], v[72:75], v[184:187]
 ds_read2st64_b32 v[42:43], v220 offset0:2 offset1:3
 v_mfma_f32_16x16x32_bf16 v[188:191], v[116:119], v[72:75], v[188:191]
 s_waitcnt vmcnt(12)
 ds_read2st64_b32 v[44:45], v220 offset0:4 offset1:5
 v_mfma_f32_16x16x32_bf16 v[172:175], v[120:123], v[76:79], v[172:175]
 ds_read2st64_b32 v[46:47], v220 offset0:6 offset1:7
 v_mfma_f32_16x16x32_bf16 v[176:179], v[124:127], v[76:79], v[176:179]
 s_add_u32 m0, s28, 65536
 s_add_u32 s85, s64, 24576
 buffer_load_dwordx4 v3, s[8:11], s85 offen sc1 lds
 ds_read2st64_b32 v[48:49], v220 offset0:8 offset1:9
 v_mfma_f32_16x16x32_bf16 v[180:183], v[128:131], v[76:79], v[180:183]
 ds_read2st64_b32 v[50:51], v220 offset0:10 offset1:11
 v_mfma_f32_16x16x32_bf16 v[184:187], v[132:135], v[76:79], v[184:187]
 ds_read2st64_b32 v[52:53], v220 offset0:12 offset1:13
 v_mfma_f32_16x16x32_bf16 v[188:191], v[216:219], v[76:79], v[188:191]
 s_waitcnt vmcnt(12)
 ds_read2st64_b32 v[54:55], v220 offset0:14 offset1:15
 v_mfma_f32_16x16x32_bf16 v[152:155], a[120:123], v[80:83], 0
 ds_read2st64_b32 v[56:57], v220 offset0:16 offset1:17
 v_mfma_f32_16x16x32_bf16 v[156:159], a[124:127], v[80:83], 0
 buffer_load_dword v0, v1, s[8:11], s42 offen sc1
 ds_read2st64_b32 v[58:59], v220 offset0:18 offset1:19
 v_mfma_f32_16x16x32_bf16 v[160:163], a[128:131], v[80:83], 0
 s_mov_b32 m0, s7
 s_nop 0
 ds_write_addtid_b32 v172 offset:20480
 ds_write_addtid_b32 v173 offset:20736
 v_mfma_f32_16x16x32_bf16 v[164:167], a[132:135], v[80:83], 0
 ds_write_addtid_b32 v174 offset:20992
 ds_write_addtid_b32 v175 offset:21248
 v_mfma_f32_16x16x32_bf16 v[168:171], a[136:139], v[80:83], 0
 s_waitcnt vmcnt(12) lgkmcnt(13)
 ds_write_addtid_b32 v176 offset:21504
 ds_write_addtid_b32 v177 offset:21760
 v_add_f32 v192, v192, v40
 v_mfma_f32_16x16x32_bf16 v[152:155], a[140:143], v[84:87], v[152:155]
 ds_write_addtid_b32 v178 offset:22016
 ds_write_addtid_b32 v179 offset:22272
 v_mfma_f32_16x16x32_bf16 v[156:159], a[144:147], v[84:87], v[156:159]
 s_add_u32 s86, s41, 55296
 buffer_load_dword v0, v1, s[8:11], s86 offen sc1
 ds_write_addtid_b32 v180 offset:22528
 v_mfma_f32_16x16x32_bf16 v[160:163], a[148:151], v[84:87], v[160:163]
 ds_write_addtid_b32 v181 offset:22784
 ds_write_addtid_b32 v182 offset:23040
 v_add_f32 v193, v193, v41
 v_mfma_f32_16x16x32_bf16 v[164:167], a[152:155], v[84:87], v[164:167]
 ds_write_addtid_b32 v183 offset:23296
 ds_write_addtid_b32 v184 offset:23552
 v_mfma_f32_16x16x32_bf16 v[168:171], a[156:159], v[84:87], v[168:171]
 s_waitcnt vmcnt(12)
 ds_write_addtid_b32 v185 offset:23808
 ds_write_addtid_b32 v186 offset:24064
 v_mfma_f32_16x16x32_bf16 v[152:155], a[160:163], v[88:91], v[152:155]
 s_waitcnt lgkmcnt(14)
 buffer_load_dword v0, v1, s[8:11], s86 offen offset:1024 sc1
 ds_write_addtid_b32 v187 offset:24320
 v_add_f32 v194, v194, v42
 v_mfma_f32_16x16x32_bf16 v[156:159], a[100:103], v[88:91], v[156:159]
 ds_write_addtid_b32 v188 offset:24576
 ds_write_addtid_b32 v189 offset:24832
 v_mfma_f32_16x16x32_bf16 v[160:163], a[104:107], v[88:91], v[160:163]
 ds_write_addtid_b32 v190 offset:25088
 ds_write_addtid_b32 v191 offset:25344
 v_mfma_f32_16x16x32_bf16 v[164:167], a[108:111], v[88:91], v[164:167]
 v_add_f32 v195, v195, v43
 v_add_f32 v196, v196, v44
 v_add_f32 v197, v197, v45
 v_mfma_f32_16x16x32_bf16 v[168:171], a[112:115], v[88:91], v[168:171]
 s_waitcnt vmcnt(12)
 v_add_f32 v198, v198, v46
 v_add_f32 v199, v199, v47
 v_mfma_f32_16x16x32_bf16 v[152:155], a[116:119], v[92:95], v[152:155]
 s_add_u32 s86, s84, 55296
 buffer_load_dword v0, v1, s[8:11], s86 offen sc1
 v_add_f32 v200, v200, v48
 v_add_f32 v201, v201, v49
 v_mfma_f32_16x16x32_bf16 v[156:159], v[104:107], v[92:95], v[156:159]
 s_waitcnt lgkmcnt(0)
 s_barrier
 v_add_f32 v202, v202, v50
 v_add_f32 v203, v203, v51
 v_mfma_f32_16x16x32_bf16 v[160:163], v[108:111], v[92:95], v[160:163]
 ds_read2st64_b32 v[60:61], v221 offset0:80 offset1:81
 v_add_f32 v204, v204, v52
 v_mfma_f32_16x16x32_bf16 v[164:167], v[112:115], v[92:95], v[164:167]
 ds_read2st64_b32 v[62:63], v221 offset0:82 offset1:83
 v_add_f32 v205, v205, v53
 v_mfma_f32_16x16x32_bf16 v[168:171], v[116:119], v[92:95], v[168:171]
 s_waitcnt vmcnt(12)
 ds_read2st64_b32 v[64:65], v221 offset0:84 offset1:85
 v_add_f32 v206, v206, v54
 v_add_f32 v207, v207, v55
 v_mfma_f32_16x16x32_bf16 v[152:155], v[120:123], v[96:99], v[152:155]
 s_add_u32 s86, s42, 55296
 buffer_load_dword v0, v1, s[8:11], s86 offen sc1
 ds_read2st64_b32 v[66:67], v221 offset0:86 offset1:87
 v_mfma_f32_16x16x32_bf16 v[156:159], v[124:127], v[96:99], v[156:159]
 ds_read2st64_b32 v[68:69], v221 offset0:88 offset1:89
 v_add_f32 v208, v208, v56
 v_mfma_f32_16x16x32_bf16 v[160:163], v[128:131], v[96:99], v[160:163]
 ds_read2st64_b32 v[70:71], v221 offset0:90 offset1:91
 v_add_f32 v209, v209, v57
 v_add_f32 v210, v210, v58
 v_mfma_f32_16x16x32_bf16 v[164:167], v[132:135], v[96:99], v[164:167]
 ds_read2st64_b32 v[72:73], v221 offset0:92 offset1:93
 v_add_f32 v211, v211, v59
 v_mfma_f32_16x16x32_bf16 v[168:171], v[216:219], v[96:99], v[168:171]
 s_waitcnt vmcnt(12)
 ds_read2st64_b32 v[74:75], v221 offset0:94 offset1:95
 v_mfma_f32_16x16x32_bf16 v[192:195], a[120:123], v[100:103], v[192:195]
 buffer_load_dwordx4 a[72:75], v39, s[8:11], s68 offen offset:2048 sc1
 ds_read2st64_b32 v[76:77], v221 offset0:96 offset1:97
 v_mfma_f32_16x16x32_bf16 v[196:199], a[124:127], v[100:103], v[196:199]
 ds_read2st64_b32 v[78:79], v221 offset0:98 offset1:99
 v_mfma_f32_16x16x32_bf16 v[200:203], a[128:131], v[100:103], v[200:203]
 ds_write_addtid_b32 v152
 ds_write_addtid_b32 v153 offset:256
 v_mfma_f32_16x16x32_bf16 v[204:207], a[132:135], v[100:103], v[204:207]
 ds_write_addtid_b32 v154 offset:512
 ds_write_addtid_b32 v155 offset:768
 v_mfma_f32_16x16x32_bf16 v[208:211], a[136:139], v[100:103], v[208:211]
 s_waitcnt vmcnt(12)
 buffer_load_dwordx4 a[76:79], v39, s[8:11], s68 offen offset:3072 sc1
 ds_write_addtid_b32 v156 offset:1024
 v_mfma_f32_16x16x32_bf16 v[192:195], a[140:143], v[136:139], v[192:195]
 ds_write_addtid_b32 v157 offset:1280
 ds_write_addtid_b32 v158 offset:1536
 v_mfma_f32_16x16x32_bf16 v[196:199], a[144:147], v[136:139], v[196:199]
 ds_write_addtid_b32 v159 offset:1792
 ds_write_addtid_b32 v160 offset:2048
 v_mfma_f32_16x16x32_bf16 v[200:203], a[148:151], v[136:139], v[200:203]
 ds_write_addtid_b32 v161 offset:2304
 ds_write_addtid_b32 v162 offset:2560
 ds_write_addtid_b32 v163 offset:2816
 v_mfma_f32_16x16x32_bf16 v[204:207], a[152:155], v[136:139], v[204:207]
 buffer_load_dwordx4 a[80:83], v39, s[8:11], s69 offen sc1
 ds_write_addtid_b32 v164 offset:3072
 v_mfma_f32_16x16x32_bf16 v[208:211], a[156:159], v[136:139], v[208:211]
 s_waitcnt vmcnt(13)
 ds_write_addtid_b32 v165 offset:3328
 ds_write_addtid_b32 v166 offset:3584
 v_mfma_f32_16x16x32_bf16 v[192:195], a[160:163], v[140:143], v[192:195]
 ds_write_addtid_b32 v167 offset:3840
 ds_write_addtid_b32 v168 offset:4096
 v_mfma_f32_16x16x32_bf16 v[196:199], a[100:103], v[140:143], v[196:199]
 ds_write_addtid_b32 v169 offset:4352
 ds_write_addtid_b32 v170 offset:4608
 v_mfma_f32_16x16x32_bf16 v[200:203], a[104:107], v[140:143], v[200:203]
 buffer_load_dwordx4 a[84:87], v39, s[8:11], s69 offen offset:1024 sc1
 ds_write_addtid_b32 v171 offset:4864
 v_mfma_f32_16x16x32_bf16 v[204:207], a[108:111], v[140:143], v[204:207]
 v_mfma_f32_16x16x32_bf16 v[208:211], a[112:115], v[140:143], v[208:211]
 s_waitcnt vmcnt(13)
 v_mfma_f32_16x16x32_bf16 v[192:195], a[116:119], v[144:147], v[192:195]
 v_mfma_f32_16x16x32_bf16 v[196:199], v[104:107], v[144:147], v[196:199]
 s_waitcnt lgkmcnt(0)
 buffer_load_dwordx4 a[88:91], v39, s[8:11], s69 offen offset:2048 sc1
 s_barrier
 v_mfma_f32_16x16x32_bf16 v[200:203], v[108:111], v[144:147], v[200:203]
 ds_read2st64_b32 v[40:41], v222 offset0:0 offset1:1
 v_mfma_f32_16x16x32_bf16 v[204:207], v[112:115], v[144:147], v[204:207]
 ds_read2st64_b32 v[42:43], v222 offset0:2 offset1:3
 v_mfma_f32_16x16x32_bf16 v[208:211], v[116:119], v[144:147], v[208:211]
 s_waitcnt vmcnt(13)
 ds_read2st64_b32 v[44:45], v222 offset0:4 offset1:5
 v_mfma_f32_16x16x32_bf16 v[192:195], v[120:123], v[148:151], v[192:195]
 buffer_load_dwordx4 a[92:95], v39, s[8:11], s69 offen offset:3072 sc1
 ds_read2st64_b32 v[46:47], v222 offset0:6 offset1:7
 v_mfma_f32_16x16x32_bf16 v[196:199], v[124:127], v[148:151], v[196:199]
 ds_read2st64_b32 v[48:49], v222 offset0:8 offset1:9
 v_mfma_f32_16x16x32_bf16 v[200:203], v[128:131], v[148:151], v[200:203]
 ds_read2st64_b32 v[50:51], v222 offset0:10 offset1:11
 v_mfma_f32_16x16x32_bf16 v[204:207], v[132:135], v[148:151], v[204:207]
 ds_read2st64_b32 v[52:53], v222 offset0:12 offset1:13
 v_mfma_f32_16x16x32_bf16 v[208:211], v[216:219], v[148:151], v[208:211]
 ds_read2st64_b32 v[54:55], v222 offset0:14 offset1:15
 ds_read2st64_b32 v[56:57], v222 offset0:16 offset1:17
 ds_read2st64_b32 v[58:59], v222 offset0:18 offset1:19
 v_pk_add_f32 v[192:193], v[192:193], v[60:61]
 v_pk_add_f32 v[194:195], v[194:195], v[62:63]
 v_pk_add_f32 v[196:197], v[196:197], v[64:65]
 v_pk_add_f32 v[198:199], v[198:199], v[66:67]
 v_pk_add_f32 v[200:201], v[200:201], v[68:69]
 v_pk_add_f32 v[202:203], v[202:203], v[70:71]
 v_pk_add_f32 v[204:205], v[204:205], v[72:73]
 v_pk_add_f32 v[206:207], v[206:207], v[74:75]
 v_pk_add_f32 v[208:209], v[208:209], v[76:77]
 v_pk_add_f32 v[210:211], v[210:211], v[78:79]
 s_waitcnt lgkmcnt(0)
 v_pk_add_f32 v[192:193], v[192:193], v[40:41]
 v_cvt_pk_bf16_f32 v28, v192, v193
 v_pk_add_f32 v[194:195], v[194:195], v[42:43]
 v_cvt_pk_bf16_f32 v29, v194, v195
 v_pk_add_f32 v[196:197], v[196:197], v[44:45]
 v_cvt_pk_bf16_f32 v30, v196, v197
 v_pk_add_f32 v[198:199], v[198:199], v[46:47]
 v_cvt_pk_bf16_f32 v31, v198, v199
 buffer_store_dwordx4 v[28:31], v1, s[8:11], s39 offen
 v_pk_add_f32 v[200:201], v[200:201], v[48:49]
 v_cvt_pk_bf16_f32 v32, v200, v201
 v_pk_add_f32 v[202:203], v[202:203], v[50:51]
 v_cvt_pk_bf16_f32 v33, v202, v203
 v_pk_add_f32 v[204:205], v[204:205], v[52:53]
 v_cvt_pk_bf16_f32 v34, v204, v205
 v_pk_add_f32 v[206:207], v[206:207], v[54:55]
 v_cvt_pk_bf16_f32 v35, v206, v207
 buffer_store_dwordx4 v[32:35], v1, s[8:11], s39 offen offset:1024
 v_pk_add_f32 v[208:209], v[208:209], v[56:57]
 v_cvt_pk_bf16_f32 v36, v208, v209
 v_pk_add_f32 v[210:211], v[210:211], v[58:59]
 v_cvt_pk_bf16_f32 v37, v210, v211
 buffer_store_dwordx2 v[36:37], v8, s[8:11], s39 offen offset:2048
 v_mov_b32 v226, 0x3f803f80
 v_dot2_f32_bf16 v224, v28, v226, 0
 v_dot2_f32_bf16 v225, v28, v28, 0
 v_dot2_f32_bf16 v224, v29, v226, v224
 v_dot2_f32_bf16 v225, v29, v29, v225
 v_dot2_f32_bf16 v224, v30, v226, v224
 v_dot2_f32_bf16 v225, v30, v30, v225
 v_dot2_f32_bf16 v224, v31, v226, v224
 v_dot2_f32_bf16 v225, v31, v31, v225
 v_dot2_f32_bf16 v224, v32, v226, v224
 v_dot2_f32_bf16 v225, v32, v32, v225
 v_dot2_f32_bf16 v224, v33, v226, v224
 v_dot2_f32_bf16 v225, v33, v33, v225
 v_dot2_f32_bf16 v224, v34, v226, v224
 v_dot2_f32_bf16 v225, v34, v34, v225
 v_dot2_f32_bf16 v224, v35, v226, v224
 v_dot2_f32_bf16 v225, v35, v35, v225
 v_dot2_f32_bf16 v224, v36, v226, v224
 v_dot2_f32_bf16 v225, v36, v36, v225
 v_dot2_f32_bf16 v224, v37, v226, v224
 v_dot2_f32_bf16 v225, v37, v37, v225
 s_nop 2
 v_permlane32_swap_b32 v224, v225
 v_add_f32 v224, v224, v225
 v_mov_b32 v226, v224
 s_nop 1
 v_permlane16_swap_b32 v224, v226
 v_add_f32 v224, v224, v226
 v_or_b32 v224, 1, v224
 buffer_store_dword v224, v9, s[8:11], s40 offen
 s_barrier
 s_add_u32 m0, s28, 65536
 s_nop 0
 buffer_load_dwordx4 v3, s[8:11], s85 offen offset:1024 sc1 lds
 buffer_load_dwordx4 v3, s[8:11], s85 offen offset:2048 sc1 lds
 v_add_u32 v38, s60, v1
 s_add_u32 s30, s41, 55296
 s_add_u32 s31, s42, 55296
 s_add_u32 s32, s84, 55296
 v_mov_b32 v27, 1
 s_waitcnt vmcnt(3)
 s_mov_b64 exec, 1
 buffer_store_dword v27, off, s[8:11], s48
 s_mov_b64 exec, -1
 s_add_u32 m0, s27, 40960
 s_add_u32 s85, s64, 0
 buffer_load_dwordx4 v2, s[8:11], s85 offen sc1 lds
 s_add_u32 m0, s28, 20480
 s_add_u32 s85, s36, 0
 buffer_load_dwordx4 v3, s[8:11], s85 offen sc1 lds
 s_add_u32 m0, s28, 65536
 s_add_u32 s85, s64, 24576
 buffer_load_dwordx4 v3, s[8:11], s85 offen offset:3072 sc1 lds
 s_add_u32 m0, s27, 45056
 s_add_u32 s85, s64, 4096
 buffer_load_dwordx4 v2, s[8:11], s85 offen sc1 lds
 v_mov_b32 v130, 0
 v_mov_b32 v138, 0
 v_mov_b32 v131, 0
 v_mov_b32 v139, 0
 v_mov_b32 v134, 0
 v_mov_b32 v142, 0
 v_mov_b32 v135, 0
 v_mov_b32 v143, 0
 v_and_b32 v144, 60, v22
 buffer_load_dword v145, v144, s[8:11], s49 offen sc1
fspin_3:
 buffer_load_dword v0, v144, s[8:11], s49 offen sc1
 s_waitcnt vmcnt(1)
 v_cmp_gt_u32 vcc, 1, v145
 s_cbranch_vccz fok_4
 buffer_load_dword v145, v144, s[8:11], s49 offen sc1
 s_waitcnt vmcnt(1)
 v_cmp_gt_u32 vcc, 1, v0
 s_cbranch_vccz fok_4
 s_add_u32 s29, s29, 1
 s_cmp_lt_u32 s29, 524288
 s_cbranch_scc1 fspin_3
fok_4:
 buffer_load_dwordx4 v[160:163], v38, s[8:11], 0 offen sc1
 buffer_load_dwordx4 v[164:167], v38, s[8:11], s69 offen sc1
 buffer_load_dwordx4 v[168:171], v38, s[8:11], 0 offen offset:1024 sc1
 buffer_load_dwordx4 v[172:175], v38, s[8:11], s69 offen offset:1024 sc1
 buffer_load_dwordx4 v[176:179], v38, s[8:11], 0 offen offset:2048 sc1
 buffer_load_dwordx4 v[180:183], v38, s[8:11], s69 offen offset:2048 sc1
 buffer_load_dwordx4 v[184:187], v38, s[8:11], 0 offen offset:3072 sc1
 buffer_load_dwordx4 v[188:191], v38, s[8:11], s69 offen offset:3072 sc1
 buffer_load_dwordx4 v[192:195], v38, s[8:11], s65 offen sc1
pad3:
 s_cbranch_execz pad7
 buffer_load_dwordx4 v[196:199], v38, s[8:11], s70 offen sc1
 s_barrier
 v_add_u32 v25, 81920, v1
 v_add_u32 v26, 122880, v1
 ds_read_b128 v[96:99], v25
 ds_read_b128 v[100:103], v25 offset:20480
 ds_read_b128 v[104:107], v26
 ds_read_b128 v[108:111], v26 offset:20480
 ds_read_b128 v[112:115], v25 offset:1024
 ds_read_b128 v[116:119], v25 offset:21504
 v_and_b32 v27, 0xf0, v1
 v_lshrrev_b32 v27, 1, v27
 s_mov_b32 s92, 0xffff0000
 s_mov_b32 s93, 0
 s_mov_b32 s94, -1
 s_mov_b32 s95, 0
 s_waitcnt lgkmcnt(4)
 s_waitcnt vmcnt(9)
 v_mfma_f32_16x16x32_bf16 v[40:43], v[96:99], v[160:163], 0
 s_waitcnt vmcnt(8)
 ds_read_b128 v[120:123], v26 offset:1024
 buffer_load_dwordx4 v[152:155], v1, s[8:11], s61 offen sc1
 buffer_load_dwordx4 v[156:159], v1, s[8:11], s61 offen offset:1024 sc1
 buffer_load_dwordx4 v[200:203], v38, s[8:11], s65 offen offset:1024 sc1
 v_mfma_f32_16x16x32_bf16 v[44:47], v[96:99], v[164:167], 0
 v_mfma_f32_16x16x32_bf16 v[48:51], v[100:103], v[160:163], 0
 ds_read_b128 v[124:127], v26 offset:21504
 v_mfma_f32_16x16x32_bf16 v[52:55], v[100:103], v[164:167], 0
 s_waitcnt lgkmcnt(4)
 buffer_load_dwordx4 v[204:207], v38, s[8:11], s70 offen offset:1024 sc1
 v_mfma_f32_16x16x32_bf16 v[56:59], v[104:107], v[160:163], 0
 ds_read_b128 v[96:99], v25 offset:2048
 v_mfma_f32_16x16x32_bf16 v[60:63], v[104:107], v[164:167], 0
 v_mfma_f32_16x16x32_bf16 v[64:67], v[108:111], v[160:163], 0
 ds_read_b128 v[100:103], v25 offset:22528
 v_mfma_f32_16x16x32_bf16 v[68:71], v[108:111], v[164:167], 0
 s_waitcnt vmcnt(11) lgkmcnt(4)
 buffer_load_dwordx4 v[208:211], v38, s[8:11], s65 offen offset:2048 sc1
 v_mfma_f32_16x16x32_bf16 v[40:43], v[112:115], v[168:171], v[40:43]
 s_waitcnt vmcnt(11)
 ds_read_b128 v[104:107], v26 offset:2048
 v_mfma_f32_16x16x32_bf16 v[44:47], v[112:115], v[172:175], v[44:47]
 v_mfma_f32_16x16x32_bf16 v[48:51], v[116:119], v[168:171], v[48:51]
 ds_read_b128 v[108:111], v26 offset:22528
 v_mfma_f32_16x16x32_bf16 v[52:55], v[116:119], v[172:175], v[52:55]
 s_waitcnt lgkmcnt(4)
 buffer_load_dwordx4 v[212:215], v38, s[8:11], s70 offen offset:2048 sc1
 v_mfma_f32_16x16x32_bf16 v[56:59], v[120:123], v[168:171], v[56:59]
 ds_read_b128 v[112:115], v25 offset:3072
 v_mfma_f32_16x16x32_bf16 v[60:63], v[120:123], v[172:175], v[60:63]
 v_mfma_f32_16x16x32_bf16 v[64:67], v[124:127], v[168:171], v[64:67]
 ds_read_b128 v[116:119], v25 offset:23552
 buffer_load_dwordx4 v[216:219], v38, s[8:11], s65 offen offset:3072 sc1
 v_mfma_f32_16x16x32_bf16 v[68:71], v[124:127], v[172:175], v[68:71]
 s_waitcnt vmcnt(12) lgkmcnt(4)
 v_mfma_f32_16x16x32_bf16 v[40:43], v[96:99], v[176:179], v[40:43]
 s_waitcnt vmcnt(11)
 ds_read_b128 v[120:123], v26 offset:3072
 v_mfma_f32_16x16x32_bf16 v[44:47], v[96:99], v[180:183], v[44:47]
 v_mfma_f32_16x16x32_bf16 v[48:51], v[100:103], v[176:179], v[48:51]
 ds_read_b128 v[124:127], v26 offset:23552
 buffer_load_dwordx4 v[220:223], v38, s[8:11], s70 offen offset:3072 sc1
 v_mfma_f32_16x16x32_bf16 v[52:55], v[100:103], v[180:183], v[52:55]
 s_waitcnt lgkmcnt(4)
 v_mfma_f32_16x16x32_bf16 v[56:59], v[104:107], v[176:179], v[56:59]
 ds_read_b128 v[96:99], v25 offset:4096
 v_mfma_f32_16x16x32_bf16 v[60:63], v[104:107], v[180:183], v[60:63]
 v_mfma_f32_16x16x32_bf16 v[64:67], v[108:111], v[176:179], v[64:67]
 ds_read_b128 v[100:103], v25 offset:24576
 buffer_load_dwordx4 v[224:227], v38, s[8:11], s66 offen sc1
 v_mfma_f32_16x16x32_bf16 v[68:71], v[108:111], v[180:183], v[68:71]
 s_waitcnt vmcnt(12) lgkmcnt(4)
 v_mfma_f32_16x16x32_bf16 v[40:43], v[112:115], v[184:187], v[40:43]
 s_waitcnt vmcnt(11)
 ds_read_b128 v[104:107], v26 offset:4096
 v_mfma_f32_16x16x32_bf16 v[44:47], v[112:115], v[188:191], v[44:47]
 buffer_load_dwordx4 v[228:231], v38, s[8:11], s71 offen sc1
 v_mfma_f32_16x16x32_bf16 v[48:51], v[116:119], v[184:187], v[48:51]
 ds_read_b128 v[108:111], v26 offset:24576
 v_mfma_f32_16x16x32_bf16 v[52:55], v[116:119], v[188:191], v[52:55]
 s_waitcnt lgkmcnt(4)
 v_mfma_f32_16x16x32_bf16 v[56:59], v[120:123], v[184:187], v[56:59]
 ds_read_b128 v[112:115], v25 offset:5120
 v_mfma_f32_16x16x32_bf16 v[60:63], v[120:123], v[188:191], v[60:63]
 buffer_load_dwordx4 v[232:235], v38, s[8:11], s66 offen offset:1024 sc1
 v_mfma_f32_16x16x32_bf16 v[64:67], v[124:127], v[184:187], v[64:67]
 ds_read_b128 v[116:119], v25 offset:25600
 v_mfma_f32_16x16x32_bf16 v[68:71], v[124:127], v[188:191], v[68:71]
 s_waitcnt vmcnt(12) lgkmcnt(4)
 v_mfma_f32_16x16x32_bf16 v[40:43], v[96:99], v[192:195], v[40:43]
 s_waitcnt vmcnt(11)
 ds_read_b128 v[120:123], v26 offset:5120
 v_mfma_f32_16x16x32_bf16 v[44:47], v[96:99], v[196:199], v[44:47]
 buffer_load_dwordx4 v[236:239], v38, s[8:11], s71 offen offset:1024 sc1
 v_mfma_f32_16x16x32_bf16 v[48:51], v[100:103], v[192:195], v[48:51]
 ds_read_b128 v[124:127], v26 offset:25600
 v_mfma_f32_16x16x32_bf16 v[52:55], v[100:103], v[196:199], v[52:55]
 s_waitcnt lgkmcnt(4)
 v_mfma_f32_16x16x32_bf16 v[56:59], v[104:107], v[192:195], v[56:59]
 s_waitcnt vmcnt(11)
 ds_read_b128 v[96:99], v25 offset:6144
 v_and_b32 v147, v152, v153
 v_mfma_f32_16x16x32_bf16 v[60:63], v[104:107], v[196:199], v[60:63]
 buffer_load_dwordx4 v[240:243], v38, s[8:11], s66 offen offset:2048 sc1
 v_bitop3_b32 v147, v147, v154, v155 bitop3:0x80
 v_mfma_f32_16x16x32_bf16 v[64:67], v[108:111], v[192:195], v[64:67]
 ds_read_b128 v[100:103], v25 offset:26624
 v_mfma_f32_16x16x32_bf16 v[68:71], v[108:111], v[196:199], v[68:71]
 s_waitcnt vmcnt(10) lgkmcnt(4)
 v_bitop3_b32 v147, v147, v156, v157 bitop3:0x80
 v_bitop3_b32 v147, v147, v158, v159 bitop3:0x80
 v_mfma_f32_16x16x32_bf16 v[40:43], v[112:115], v[200:203], v[40:43]
 s_waitcnt vmcnt(9)
 ds_read_b128 v[104:107], v26 offset:6144
 buffer_load_dwordx4 v[244:247], v38, s[8:11], s71 offen offset:2048 sc1
 v_mfma_f32_16x16x32_bf16 v[44:47], v[112:115], v[204:207], v[44:47]
 v_and_b32 v147, 1, v147
 v_mfma_f32_16x16x32_bf16 v[48:51], v[116:119], v[200:203], v[48:51]
 ds_read_b128 v[108:111], v26 offset:26624
 v_cmp_ne_u32 vcc, 1, v147
 s_cbranch_vccnz fretry_5
fback_6:
 v_mfma_f32_16x16x32_bf16 v[52:55], v[116:119], v[204:207], v[52:55]
 s_waitcnt lgkmcnt(4)
 v_add_f32 v152, v152, v153
 v_add_f32 v156, v156, v157
 v_mfma_f32_16x16x32_bf16 v[56:59], v[120:123], v[200:203], v[56:59]
 ds_read_b128 v[112:115], v25 offset:7168
 buffer_load_dwordx4 v[248:251], v38, s[8:11], s66 offen offset:3072 sc1
 v_mfma_f32_16x16x32_bf16 v[60:63], v[120:123], v[204:207], v[60:63]
 v_add_f32 v154, v154, v155
 v_mfma_f32_16x16x32_bf16 v[64:67], v[124:127], v[200:203], v[64:67]
 ds_read_b128 v[116:119], v25 offset:27648
 v_add_f32 v158, v158, v159
 v_mfma_f32_16x16x32_bf16 v[68:71], v[124:127], v[204:207], v[68:71]
 s_waitcnt vmcnt(10) lgkmcnt(4)
 v_add_f32 v154, v154, v152
 v_add_f32 v158, v158, v156
 v_mfma_f32_16x16x32_bf16 v[40:43], v[96:99], v[208:211], v[40:43]
 s_waitcnt vmcnt(9)
 ds_read_b128 v[120:123], v26 offset:7168
 buffer_load_dwordx4 v[252:255], v38, s[8:11], s71 offen offset:3072 sc1
 v_mfma_f32_16x16x32_bf16 v[44:47], v[96:99], v[212:215], v[44:47]
 v_mov_b32 v155, v154
 v_mfma_f32_16x16x32_bf16 v[48:51], v[100:103], v[208:211], v[48:51]
 ds_read_b128 v[124:127], v26 offset:27648
 v_mov_b32 v159, v158
 v_mfma_f32_16x16x32_bf16 v[52:55], v[100:103], v[212:215], v[52:55]
 s_waitcnt lgkmcnt(4)
 buffer_load_dwordx4 a[100:103], v38, s[8:11], s67 offen sc1
 v_mfma_f32_16x16x32_bf16 v[56:59], v[104:107], v[208:211], v[56:59]
 ds_read_b128 v[96:99], v25 offset:8192
 v_mfma_f32_16x16x32_bf16 v[60:63], v[104:107], v[212:215], v[60:63]
 v_permlane16_swap_b32 v154, v155
 v_mfma_f32_16x16x32_bf16 v[64:67], v[108:111], v[208:211], v[64:67]
 ds_read_b128 v[100:103], v25 offset:28672
 v_mfma_f32_16x16x32_bf16 v[68:71], v[108:111], v[212:215], v[68:71]
 s_waitcnt vmcnt(10) lgkmcnt(4)
 buffer_load_dwordx4 a[104:107], v38, s[8:11], s72 offen sc1
 v_mfma_f32_16x16x32_bf16 v[40:43], v[112:115], v[216:219], v[40:43]
 s_waitcnt vmcnt(10)
 ds_read_b128 v[104:107], v26 offset:8192
 v_mfma_f32_16x16x32_bf16 v[44:47], v[112:115], v[220:223], v[44:47]
 v_permlane16_swap_b32 v158, v159
 v_mfma_f32_16x16x32_bf16 v[48:51], v[116:119], v[216:219], v[48:51]
 ds_read_b128 v[108:111], v26 offset:28672
 v_add_f32 v154, v154, v155
 v_mfma_f32_16x16x32_bf16 v[52:55], v[116:119], v[220:223], v[52:55]
 s_waitcnt lgkmcnt(4)
 buffer_load_dwordx4 a[108:111], v38, s[8:11], s67 offen offset:1024 sc1
 v_add_f32 v158, v158, v159
 v_mfma_f32_16x16x32_bf16 v[56:59], v[120:123], v[216:219], v[56:59]
 ds_read_b128 v[112:115], v25 offset:9216
 v_mov_b32 v155, v154
 v_mfma_f32_16x16x32_bf16 v[60:63], v[120:123], v[220:223], v[60:63]
 v_mov_b32 v159, v158
 v_mfma_f32_16x16x32_bf16 v[64:67], v[124:127], v[216:219], v[64:67]
 ds_read_b128 v[116:119], v25 offset:29696
 buffer_load_dwordx4 a[112:115], v38, s[8:11], s72 offen offset:1024 sc1
 v_mfma_f32_16x16x32_bf16 v[68:71], v[124:127], v[220:223], v[68:71]
 s_waitcnt vmcnt(11) lgkmcnt(4)
 v_permlane32_swap_b32 v154, v155
 v_mfma_f32_16x16x32_bf16 v[40:43], v[96:99], v[224:227], v[40:43]
 s_waitcnt vmcnt(10)
 ds_read_b128 v[120:123], v26 offset:9216
 v_mfma_f32_16x16x32_bf16 v[44:47], v[96:99], v[228:231], v[44:47]
 v_permlane32_swap_b32 v158, v159
 v_mfma_f32_16x16x32_bf16 v[48:51], v[100:103], v[224:227], v[48:51]
 ds_read_b128 v[124:127], v26 offset:29696
 buffer_load_dwordx4 a[116:119], v38, s[8:11], s67 offen offset:2048 sc1
 v_mfma_f32_16x16x32_bf16 v[52:55], v[100:103], v[228:231], v[52:55]
 s_waitcnt lgkmcnt(4)
 v_mul_f32 v153, 0xbacccccd, v154
 v_mul_f32 v157, 0xbacccccd, v158
 v_mfma_f32_16x16x32_bf16 v[56:59], v[104:107], v[224:227], v[56:59]
 ds_read_b128 v[96:99], v25 offset:10240
 v_mul_f32 v154, v153, v153
 v_mfma_f32_16x16x32_bf16 v[60:63], v[104:107], v[228:231], v[60:63]
 v_mul_f32 v158, v157, v157
 v_fmac_f32 v154, 0xbacccccd, v155
 v_mfma_f32_16x16x32_bf16 v[64:67], v[108:111], v[224:227], v[64:67]
 ds_read_b128 v[100:103], v25 offset:30720
 buffer_load_dwordx4 a[120:123], v38, s[8:11], s72 offen offset:2048 sc1
 v_mfma_f32_16x16x32_bf16 v[68:71], v[108:111], v[228:231], v[68:71]
 s_waitcnt vmcnt(11) lgkmcnt(4)
 v_fmac_f32 v158, 0xbacccccd, v159
 v_min_f32 v154, 0, v154
 v_mfma_f32_16x16x32_bf16 v[40:43], v[112:115], v[232:235], v[40:43]
 s_waitcnt vmcnt(10)
 ds_read_b128 v[104:107], v26 offset:10240
 v_min_f32 v158, 0, v158
 v_mfma_f32_16x16x32_bf16 v[44:47], v[112:115], v[236:239], v[44:47]
 v_sub_f32 v154, 0x3727c5ac, v154
 v_sub_f32 v158, 0x3727c5ac, v158
 v_mfma_f32_16x16x32_bf16 v[48:51], v[116:119], v[232:235], v[48:51]
 ds_read_b128 v[108:111], v26 offset:30720
 buffer_load_dwordx4 a[124:127], v38, s[8:11], s67 offen offset:3072 sc1
 v_mfma_f32_16x16x32_bf16 v[52:55], v[116:119], v[236:239], v[52:55]
 s_waitcnt lgkmcnt(4)
 v_rsq_f32 v152, v154
 v_mfma_f32_16x16x32_bf16 v[56:59], v[120:123], v[232:235], v[56:59]
 ds_read_b128 v[112:115], v25 offset:11264
 v_mfma_f32_16x16x32_bf16 v[60:63], v[120:123], v[236:239], v[60:63]
 buffer_load_dwordx4 a[128:131], v38, s[8:11], s72 offen offset:3072 sc1
 v_mfma_f32_16x16x32_bf16 v[64:67], v[124:127], v[232:235], v[64:67]
 ds_read_b128 v[116:119], v25 offset:31744
 v_mfma_f32_16x16x32_bf16 v[68:71], v[124:127], v[236:239], v[68:71]
 s_waitcnt vmcnt(11) lgkmcnt(4)
 v_rsq_f32 v156, v158
 v_mfma_f32_16x16x32_bf16 v[40:43], v[96:99], v[240:243], v[40:43]
 s_waitcnt vmcnt(10)
 ds_read_b128 v[120:123], v26 offset:11264
 v_mul_f32 v154, v154, v152
 v_mfma_f32_16x16x32_bf16 v[44:47], v[96:99], v[244:247], v[44:47]
 buffer_load_dwordx4 a[132:135], v38, s[8:11], s68 offen sc1
 v_mul_f32 v158, v158, v156
 v_mfma_f32_16x16x32_bf16 v[48:51], v[100:103], v[240:243], v[48:51]
 ds_read_b128 v[124:127], v26 offset:31744
 v_cvt_pk_bf16_f32 v144, v154, v153
 v_mfma_f32_16x16x32_bf16 v[52:55], v[100:103], v[244:247], v[52:55]
 s_waitcnt lgkmcnt(4)
 v_cvt_pk_bf16_f32 v148, v158, v157
 v_and_b32 v145, 0xffff0000, v144
 v_mfma_f32_16x16x32_bf16 v[56:59], v[104:107], v[240:243], v[56:59]
 ds_read_b128 v[96:99], v25 offset:12288
 v_and_b32 v149, 0xffff0000, v148
 v_mfma_f32_16x16x32_bf16 v[60:63], v[104:107], v[244:247], v[60:63]
 buffer_load_dwordx4 a[136:139], v38, s[8:11], s73 offen sc1
 v_lshlrev_b32 v144, 16, v144
 v_mfma_f32_16x16x32_bf16 v[64:67], v[108:111], v[240:243], v[64:67]
 ds_read_b128 v[100:103], v25 offset:32768
 v_lshlrev_b32 v148, 16, v148
 v_mfma_f32_16x16x32_bf16 v[68:71], v[108:111], v[244:247], v[68:71]
 s_waitcnt vmcnt(11) lgkmcnt(4)
 v_cndmask_b32 v145, 0, v145, s[92:93]
 v_cndmask_b32 v149, 0, v149, s[92:93]
 v_mfma_f32_16x16x32_bf16 v[40:43], v[112:115], v[248:251], v[40:43]
 s_waitcnt vmcnt(10)
 ds_read_b128 v[104:107], v26 offset:12288
 buffer_load_dwordx4 a[140:143], v38, s[8:11], s68 offen offset:1024 sc1
 v_mfma_f32_16x16x32_bf16 v[44:47], v[112:115], v[252:255], v[44:47]
 v_cndmask_b32 v144, 0, v144, s[92:93]
 v_cndmask_b32 v148, 0, v148, s[92:93]
 v_mfma_f32_16x16x32_bf16 v[48:51], v[116:119], v[248:251], v[48:51]
 ds_read_b128 v[108:111], v26 offset:32768
 v_sub_f32 v145, v153, v145
 v_mfma_f32_16x16x32_bf16 v[52:55], v[116:119], v[252:255], v[52:55]
 s_waitcnt lgkmcnt(4)
 v_sub_f32 v149, v157, v149
 v_sub_f32 v144, v154, v144
 v_mfma_f32_16x16x32_bf16 v[56:59], v[120:123], v[248:251], v[56:59]
 ds_read_b128 v[112:115], v25 offset:13312
 buffer_load_dwordx4 a[144:147], v38, s[8:11], s73 offen offset:1024 sc1
 v_mfma_f32_16x16x32_bf16 v[60:63], v[120:123], v[252:255], v[60:63]
 v_sub_f32 v148, v158, v148
 v_cndmask_b32 v145, 0, v145, s[94:95]
 v_mfma_f32_16x16x32_bf16 v[64:67], v[124:127], v[248:251], v[64:67]
 ds_read_b128 v[116:119], v25 offset:33792
 v_cndmask_b32 v149, 0, v149, s[94:95]
 v_mfma_f32_16x16x32_bf16 v[68:71], v[124:127], v[252:255], v[68:71]
 s_waitcnt vmcnt(11) lgkmcnt(4)
 v_cndmask_b32 v144, 0, v144, s[94:95]
 v_mfma_f32_16x16x32_bf16 v[40:43], v[96:99], a[100:103], v[40:43]
 s_waitcnt vmcnt(10)
 ds_read_b128 v[120:123], v26 offset:13312
 buffer_load_dwordx4 a[148:151], v38, s[8:11], s68 offen offset:2048 sc1
 v_mfma_f32_16x16x32_bf16 v[44:47], v[96:99], a[104:107], v[44:47]
 ds_read_b64 v[128:129], v27 offset:256
 v_cndmask_b32 v148, 0, v148, s[94:95]
 v_mfma_f32_16x16x32_bf16 v[48:51], v[100:103], a[100:103], v[48:51]
 ds_read_b128 v[124:127], v26 offset:33792
 v_cvt_pk_bf16_f32 v136, v145, v145
 v_mfma_f32_16x16x32_bf16 v[52:55], v[100:103], a[104:107], v[52:55]
 s_waitcnt lgkmcnt(5)
 v_cvt_pk_bf16_f32 v140, v149, v149
 v_mfma_f32_16x16x32_bf16 v[56:59], v[104:107], a[100:103], v[56:59]
 ds_read_b128 v[96:99], v25 offset:14336
 buffer_load_dwordx4 a[152:155], v38, s[8:11], s73 offen offset:2048 sc1
 v_mfma_f32_16x16x32_bf16 v[60:63], v[104:107], a[104:107], v[60:63]
 v_cvt_pk_bf16_f32 v137, v144, 0
 v_cvt_pk_bf16_f32 v141, v148, 0
 v_mfma_f32_16x16x32_bf16 v[64:67], v[108:111], a[100:103], v[64:67]
 ds_read_b128 v[100:103], v25 offset:34816
 v_mfma_f32_16x16x32_bf16 v[68:71], v[108:111], a[104:107], v[68:71]
 s_waitcnt lgkmcnt(3)
 buffer_load_dwordx4 a[156:159], v38, s[8:11], s68 offen offset:3072 sc1
 v_mfma_f32_16x16x32_bf16 v[40:43], v[128:131], v[136:139], v[40:43]
 v_mfma_f32_16x16x32_bf16 v[44:47], v[128:131], v[140:143], v[44:47]
 s_waitcnt vmcnt(12)
 v_mfma_f32_16x16x32_bf16 v[40:43], v[112:115], a[108:111], v[40:43]
 s_waitcnt vmcnt(11)
 ds_read_b128 v[104:107], v26 offset:14336
 v_mfma_f32_16x16x32_bf16 v[44:47], v[112:115], a[112:115], v[44:47]
 buffer_load_dwordx4 a[160:163], v38, s[8:11], s73 offen offset:3072 sc1
 ds_read_b64 v[132:133], v27 offset:384
 v_mfma_f32_16x16x32_bf16 v[48:51], v[116:119], a[108:111], v[48:51]
 ds_read_b128 v[108:111], v26 offset:34816
 v_mfma_f32_16x16x32_bf16 v[52:55], v[116:119], a[112:115], v[52:55]
 s_waitcnt lgkmcnt(5)
 v_mfma_f32_16x16x32_bf16 v[56:59], v[120:123], a[108:111], v[56:59]
 s_add_u32 m0, s28, 20480
 ds_read_b128 v[112:115], v25 offset:15360
 s_add_u32 s85, s36, 0
 buffer_load_dwordx4 v3, s[8:11], s85 offen offset:1024 sc1 lds
 v_mfma_f32_16x16x32_bf16 v[60:63], v[120:123], a[112:115], v[60:63]
 v_mfma_f32_16x16x32_bf16 v[64:67], v[124:127], a[108:111], v[64:67]
 ds_read_b128 v[116:119], v25 offset:35840
 v_mfma_f32_16x16x32_bf16 v[68:71], v[124:127], a[112:115], v[68:71]
 s_waitcnt lgkmcnt(3)
 v_mfma_f32_16x16x32_bf16 v[48:51], v[132:135], v[136:139], v[48:51]
 buffer_load_dwordx4 v3, s[8:11], s85 offen offset:2048 sc1 lds
 v_mfma_f32_16x16x32_bf16 v[52:55], v[132:135], v[140:143], v[52:55]
 s_waitcnt vmcnt(13)
 v_mfma_f32_16x16x32_bf16 v[40:43], v[96:99], a[116:119], v[40:43]
 s_waitcnt vmcnt(12)
 ds_read_b128 v[120:123], v26 offset:15360
 v_mfma_f32_16x16x32_bf16 v[44:47], v[96:99], a[120:123], v[44:47]
 ds_read_b64 v[128:129], v27 offset:512
 v_mfma_f32_16x16x32_bf16 v[48:51], v[100:103], a[116:119], v[48:51]
 ds_read_b128 v[124:127], v26 offset:35840
 buffer_load_dwordx4 v3, s[8:11], s85 offen offset:3072 sc1 lds
 v_mfma_f32_16x16x32_bf16 v[52:55], v[100:103], a[120:123], v[52:55]
 s_waitcnt lgkmcnt(5)
 v_mfma_f32_16x16x32_bf16 v[56:59], v[104:107], a[116:119], v[56:59]
 ds_read_b128 v[96:99], v25 offset:16384
 v_mfma_f32_16x16x32_bf16 v[60:63], v[104:107], a[120:123], v[60:63]
 v_mfma_f32_16x16x32_bf16 v[64:67], v[108:111], a[116:119], v[64:67]
 s_add_u32 m0, s27, 36864
 ds_read_b128 v[100:103], v25 offset:36864
 s_add_u32 s85, s36, 16384
 buffer_load_dwordx4 v2, s[8:11], s85 offen sc1 lds
 v_mfma_f32_16x16x32_bf16 v[68:71], v[108:111], a[120:123], v[68:71]
 s_waitcnt lgkmcnt(3)
 v_mfma_f32_16x16x32_bf16 v[56:59], v[128:131], v[136:139], v[56:59]
 v_mfma_f32_16x16x32_bf16 v[60:63], v[128:131], v[140:143], v[60:63]
 s_waitcnt vmcnt(13)
 v_mfma_f32_16x16x32_bf16 v[40:43], v[112:115], a[124:127], v[40:43]
 s_waitcnt vmcnt(12)
 ds_read_b128 v[104:107], v26 offset:16384
 buffer_load_dwordx4 a[96:99], v39, s[8:11], s70 offen sc1
 v_mfma_f32_16x16x32_bf16 v[44:47], v[112:115], a[128:131], v[44:47]
 ds_read_b64 v[132:133], v27 offset:640
 v_mfma_f32_16x16x32_bf16 v[48:51], v[116:119], a[124:127], v[48:51]
 ds_read_b128 v[108:111], v26 offset:36864
 v_mfma_f32_16x16x32_bf16 v[52:55], v[116:119], a[128:131], v[52:55]
 s_waitcnt lgkmcnt(5)
 v_mfma_f32_16x16x32_bf16 v[56:59], v[120:123], a[124:127], v[56:59]
 ds_read_b128 v[112:115], v25 offset:17408
 v_mfma_f32_16x16x32_bf16 v[60:63], v[120:123], a[128:131], v[60:63]
 buffer_load_dwordx4 a[20:23], v39, s[8:11], s65 offen offset:1024 sc1
 v_mfma_f32_16x16x32_bf16 v[64:67], v[124:127], a[124:127], v[64:67]
 ds_read_b128 v[116:119], v25 offset:37888
 v_mfma_f32_16x16x32_bf16 v[68:71], v[124:127], a[128:131], v[68:71]
 s_waitcnt lgkmcnt(3)
 v_mfma_f32_16x16x32_bf16 v[64:67], v[132:135], v[136:139], v[64:67]
 buffer_load_dwordx4 a[24:27], v39, s[8:11], s65 offen offset:2048 sc1
 v_mfma_f32_16x16x32_bf16 v[68:71], v[132:135], v[140:143], v[68:71]
 s_waitcnt vmcnt(14)
 v_mfma_f32_16x16x32_bf16 v[40:43], v[96:99], a[132:135], v[40:43]
 s_waitcnt vmcnt(13)
 ds_read_b128 v[120:123], v26 offset:17408
 v_mfma_f32_16x16x32_bf16 v[44:47], v[96:99], a[136:139], v[44:47]
 ds_read_b64 v[128:129], v27 offset:768
 v_mfma_f32_16x16x32_bf16 v[48:51], v[100:103], a[132:135], v[48:51]
 ds_read_b128 v[124:127], v26 offset:37888
 v_mfma_f32_16x16x32_bf16 v[52:55], v[100:103], a[136:139], v[52:55]
 s_waitcnt lgkmcnt(5)
 buffer_load_dwordx4 a[28:31], v39, s[8:11], s65 offen offset:3072 sc1
 v_mfma_f32_16x16x32_bf16 v[56:59], v[104:107], a[132:135], v[56:59]
 ds_read_b128 v[96:99], v25 offset:18432
 v_mfma_f32_16x16x32_bf16 v[60:63], v[104:107], a[136:139], v[60:63]
 v_mfma_f32_16x16x32_bf16 v[64:67], v[108:111], a[132:135], v[64:67]
 ds_read_b128 v[100:103], v25 offset:38912
 v_mfma_f32_16x16x32_bf16 v[68:71], v[108:111], a[136:139], v[68:71]
 s_waitcnt lgkmcnt(3)
 buffer_load_dwordx4 a[32:35], v39, s[8:11], s66 offen sc1
 v_mfma_f32_16x16x32_bf16 v[72:75], v[128:131], v[136:139], 0
 v_mfma_f32_16x16x32_bf16 v[76:79], v[128:131], v[140:143], 0
 s_waitcnt vmcnt(14)
 v_mfma_f32_16x16x32_bf16 v[40:43], v[112:115], a[140:143], v[40:43]
 s_waitcnt vmcnt(13)
 ds_read_b128 v[104:107], v26 offset:18432
 v_mfma_f32_16x16x32_bf16 v[44:47], v[112:115], a[144:147], v[44:47]
 ds_read_b64 v[132:133], v27 offset:896
 buffer_load_dwordx4 a[36:39], v39, s[8:11], s66 offen offset:1024 sc1
 v_mfma_f32_16x16x32_bf16 v[48:51], v[116:119], a[140:143], v[48:51]
 ds_read_b128 v[108:111], v26 offset:38912
 v_mfma_f32_16x16x32_bf16 v[52:55], v[116:119], a[144:147], v[52:55]
 s_waitcnt lgkmcnt(5)
 v_mfma_f32_16x16x32_bf16 v[56:59], v[120:123], a[140:143], v[56:59]
 ds_read_b128 v[112:115], v25 offset:19456
 v_mfma_f32_16x16x32_bf16 v[60:63], v[120:123], a[144:147], v[60:63]
 buffer_load_dwordx4 a[0:3], v39, s[8:11], s38 offen sc1
 v_mfma_f32_16x16x32_bf16 v[64:67], v[124:127], a[140:143], v[64:67]
 ds_read_b128 v[116:119], v25 offset:39936
 v_mfma_f32_16x16x32_bf16 v[68:71], v[124:127], a[144:147], v[68:71]
 s_waitcnt lgkmcnt(3)
 v_mfma_f32_16x16x32_bf16 v[80:83], v[132:135], v[136:139], 0
 v_mfma_f32_16x16x32_bf16 v[84:87], v[132:135], v[140:143], 0
 s_waitcnt vmcnt(14)
 buffer_load_dwordx4 a[4:7], v39, s[8:11], s38 offen offset:1024 sc1
 v_mfma_f32_16x16x32_bf16 v[40:43], v[96:99], a[148:151], v[40:43]
 s_waitcnt vmcnt(14)
 ds_read_b128 v[120:123], v26 offset:19456
 v_mfma_f32_16x16x32_bf16 v[44:47], v[96:99], a[152:155], v[44:47]
 ds_read_b64 v[128:129], v27 offset:1024
 v_mfma_f32_16x16x32_bf16 v[48:51], v[100:103], a[148:151], v[48:51]
 ds_read_b128 v[124:127], v26 offset:39936
 v_mfma_f32_16x16x32_bf16 v[52:55], v[100:103], a[152:155], v[52:55]
 s_waitcnt lgkmcnt(5)
 v_mfma_f32_16x16x32_bf16 v[56:59], v[104:107], a[148:151], v[56:59]
 s_barrier
 v_add_u32 v25, 20480, v1
 ds_read_b128 v[96:99], v25 offset:24576
 v_mfma_f32_16x16x32_bf16 v[60:63], v[104:107], a[152:155], v[60:63]
 v_mfma_f32_16x16x32_bf16 v[64:67], v[108:111], a[148:151], v[64:67]
 ds_read_b128 v[100:103], v25 offset:45056
 v_mfma_f32_16x16x32_bf16 v[68:71], v[108:111], a[152:155], v[68:71]
 s_waitcnt lgkmcnt(3)
 v_mfma_f32_16x16x32_bf16 v[88:91], v[128:131], v[136:139], 0
 v_mfma_f32_16x16x32_bf16 v[92:95], v[128:131], v[140:143], 0
 s_waitcnt vmcnt(13)
 v_mfma_f32_16x16x32_bf16 v[40:43], v[112:115], a[156:159], v[40:43]
 s_waitcnt vmcnt(12)
 ds_read_b128 v[104:107], v25 offset:25600
 v_mfma_f32_16x16x32_bf16 v[44:47], v[112:115], a[160:163], v[44:47]
 v_mfma_f32_16x16x32_bf16 v[48:51], v[116:119], a[156:159], v[48:51]
 ds_read_b128 v[108:111], v25 offset:46080
 v_mfma_f32_16x16x32_bf16 v[52:55], v[116:119], a[160:163], v[52:55]
 s_waitcnt lgkmcnt(4)
 v_mfma_f32_16x16x32_bf16 v[56:59], v[120:123], a[156:159], v[56:59]
 ds_read_b128 v[112:115], v25 offset:26624
 v_mfma_f32_16x16x32_bf16 v[60:63], v[120:123], a[160:163], v[60:63]
 v_mfma_f32_16x16x32_bf16 v[64:67], v[124:127], a[156:159], v[64:67]
 ds_read_b128 v[116:119], v25 offset:47104
 v_mfma_f32_16x16x32_bf16 v[68:71], v[124:127], a[160:163], v[68:71]
 s_waitcnt lgkmcnt(4)
 v_mfma_f32_16x16x32_bf16 v[72:75], v[96:99], v[192:195], v[72:75]
 ds_read_b128 v[120:123], v25 offset:27648
 v_mfma_f32_16x16x32_bf16 v[76:79], v[96:99], v[196:199], v[76:79]
 v_mul_f32 v40, v40, v152
 v_mul_f32 v41, v41, v152
 v_mfma_f32_16x16x32_bf16 v[80:83], v[100:103], v[192:195], v[80:83]
 ds_read_b128 v[124:127], v25 offset:48128
 v_mul_f32 v42, v42, v152
 v_mul_f32 v43, v43, v152
 v_mfma_f32_16x16x32_bf16 v[84:87], v[100:103], v[196:199], v[84:87]
 s_barrier
 v_mul_f32 v40, v40, abs(v40)
 v_mul_f32 v41, v41, abs(v41)
 s_waitcnt lgkmcnt(4)
 v_mfma_f32_16x16x32_bf16 v[72:75], v[104:107], v[200:203], v[72:75]
 ds_read_b128 v[96:99], v25 offset:28672
 v_mul_f32 v42, v42, abs(v42)
 v_mfma_f32_16x16x32_bf16 v[76:79], v[104:107], v[204:207], v[76:79]
 s_add_u32 m0, s28, 81920
 s_add_u32 s85, s37, 51200
 buffer_load_dwordx4 v1, s[8:11], s85 offen sc1 lds
 v_mul_f32 v43, v43, abs(v43)
 v_mfma_f32_16x16x32_bf16 v[80:83], v[108:111], v[200:203], v[80:83]
 ds_read_b128 v[100:103], v25 offset:49152
 v_cvt_pk_bf16_f32 v144, v40, v41
 v_cvt_pk_bf16_f32 v145, v42, v43
 v_mfma_f32_16x16x32_bf16 v[84:87], v[108:111], v[204:207], v[84:87]
 s_waitcnt lgkmcnt(4)
 v_pk_max_i16 v144, v144, 0
 v_pk_max_i16 v145, v145, 0
 v_mfma_f32_16x16x32_bf16 v[72:75], v[112:115], v[208:211], v[72:75]
 ds_read_b128 v[104:107], v25 offset:29696
 v_mul_f32 v48, v48, v152
 v_mfma_f32_16x16x32_bf16 v[76:79], v[112:115], v[212:215], v[76:79]
 buffer_load_dwordx4 v1, s[8:11], s85 offen offset:1024 sc1 lds
 v_mul_f32 v49, v49, v152
 v_mul_f32 v50, v50, v152
 v_mfma_f32_16x16x32_bf16 v[80:83], v[116:119], v[208:211], v[80:83]
 ds_read_b128 v[108:111], v25 offset:50176
 v_mul_f32 v51, v51, v152
 v_mfma_f32_16x16x32_bf16 v[84:87], v[116:119], v[212:215], v[84:87]
 s_waitcnt lgkmcnt(4)
 v_mul_f32 v48, v48, abs(v48)
 v_mul_f32 v49, v49, abs(v49)
 v_mfma_f32_16x16x32_bf16 v[72:75], v[120:123], v[216:219], v[72:75]
 ds_read_b128 v[112:115], v25 offset:30720
 v_mul_f32 v50, v50, abs(v50)
 v_mfma_f32_16x16x32_bf16 v[76:79], v[120:123], v[220:223], v[76:79]
 v_mul_f32 v51, v51, abs(v51)
 v_cvt_pk_bf16_f32 v146, v48, v49
 v_cvt_pk_bf16_f32 v147, v50, v51
 v_mfma_f32_16x16x32_bf16 v[80:83], v[124:127], v[216:219], v[80:83]
 ds_read_b128 v[116:119], v25 offset:51200
 v_pk_max_i16 v146, v146, 0
 v_mfma_f32_16x16x32_bf16 v[84:87], v[124:127], v[220:223], v[84:87]
 s_waitcnt lgkmcnt(4)
 buffer_load_dwordx4 v1, s[8:11], s85 offen offset:2048 sc1 lds
 v_pk_max_i16 v147, v147, 0
 v_mfma_f32_16x16x32_bf16 v[72:75], v[96:99], v[224:227], v[72:75]
 ds_read_b128 v[120:123], v25 offset:31744
 buffer_store_dwordx4 v[144:147], v1, s[8:11], s41 offen
 v_mfma_f32_16x16x32_bf16 v[76:79], v[96:99], v[228:231], v[76:79]
 v_mfma_f32_16x16x32_bf16 v[80:83], v[100:103], v[224:227], v[80:83]
 ds_read_b128 v[124:127], v25 offset:52224
 v_mfma_f32_16x16x32_bf16 v[84:87], v[100:103], v[228:231], v[84:87]
 s_waitcnt lgkmcnt(4)
 v_mul_f32 v44, v44, v156
 v_mul_f32 v45, v45, v156
 v_mul_f32 v46, v46, v156
 v_mfma_f32_16x16x32_bf16 v[72:75], v[104:107], v[232:235], v[72:75]
 ds_read_b128 v[96:99], v25 offset:32768
 v_mul_f32 v47, v47, v156
 v_mfma_f32_16x16x32_bf16 v[76:79], v[104:107], v[236:239], v[76:79]
 buffer_load_dwordx4 v1, s[8:11], s85 offen offset:3072 sc1 lds
 v_mul_f32 v44, v44, abs(v44)
 v_mfma_f32_16x16x32_bf16 v[80:83], v[108:111], v[232:235], v[80:83]
 ds_read_b128 v[100:103], v25 offset:53248
 v_mul_f32 v45, v45, abs(v45)
 v_mul_f32 v46, v46, abs(v46)
 v_mfma_f32_16x16x32_bf16 v[84:87], v[108:111], v[236:239], v[84:87]
 s_waitcnt lgkmcnt(4)
 v_mul_f32 v47, v47, abs(v47)
 v_cvt_pk_bf16_f32 v148, v44, v45
 v_mfma_f32_16x16x32_bf16 v[72:75], v[112:115], v[240:243], v[72:75]
 ds_read_b128 v[104:107], v25 offset:33792
 v_cvt_pk_bf16_f32 v149, v46, v47
 v_mfma_f32_16x16x32_bf16 v[76:79], v[112:115], v[244:247], v[76:79]
 s_add_u32 m0, s28, 98304
 s_add_u32 s85, s37, 55296
 buffer_load_dwordx4 v1, s[8:11], s85 offen sc1 lds
 v_pk_max_i16 v148, v148, 0
 v_pk_max_i16 v149, v149, 0
 v_mfma_f32_16x16x32_bf16 v[80:83], v[116:119], v[240:243], v[80:83]
 ds_read_b128 v[108:111], v25 offset:54272
 v_mul_f32 v52, v52, v156
 v_mfma_f32_16x16x32_bf16 v[84:87], v[116:119], v[244:247], v[84:87]
 s_waitcnt lgkmcnt(4)
 v_mul_f32 v53, v53, v156
 v_mul_f32 v54, v54, v156
 v_mfma_f32_16x16x32_bf16 v[72:75], v[120:123], v[248:251], v[72:75]
 ds_read_b128 v[112:115], v25 offset:34816
 v_mul_f32 v55, v55, v156
 v_mul_f32 v52, v52, abs(v52)
 v_mfma_f32_16x16x32_bf16 v[76:79], v[120:123], v[252:255], v[76:79]
 v_mul_f32 v53, v53, abs(v53)
 v_mul_f32 v54, v54, abs(v54)
 v_mfma_f32_16x16x32_bf16 v[80:83], v[124:127], v[248:251], v[80:83]
 ds_read_b128 v[116:119], v25 offset:55296
 v_mul_f32 v55, v55, abs(v55)
 v_mfma_f32_16x16x32_bf16 v[84:87], v[124:127], v[252:255], v[84:87]
 s_waitcnt lgkmcnt(4)
 buffer_load_dwordx4 v1, s[8:11], s85 offen offset:1024 sc1 lds
 v_cvt_pk_bf16_f32 v150, v52, v53
 v_cvt_pk_bf16_f32 v151, v54, v55
 v_mfma_f32_16x16x32_bf16 v[72:75], v[96:99], a[100:103], v[72:75]
 ds_read_b128 v[120:123], v25 offset:35840
 v_pk_max_i16 v150, v150, 0
 v_mfma_f32_16x16x32_bf16 v[76:79], v[96:99], a[104:107], v[76:79]
pad4:
 s_cbranch_execz pad8
 v_pk_max_i16 v151, v151, 0
 buffer_store_dwordx4 v[148:151], v1, s[8:11], s30 offen
 v_mfma_f32_16x16x32_bf16 v[80:83], v[100:103], a[100:103], v[80:83]
 ds_read_b128 v[124:127], v25 offset:56320
 v_mfma_f32_16x16x32_bf16 v[84:87], v[100:103], a[104:107], v[84:87]
 s_waitcnt lgkmcnt(4)
 v_mfma_f32_16x16x32_bf16 v[72:75], v[104:107], a[108:111], v[72:75]
 ds_read_b128 v[96:99], v25 offset:36864
 v_mul_f32 v56, v56, v152
 v_mfma_f32_16x16x32_bf16 v[76:79], v[104:107], a[112:115], v[76:79]
 buffer_load_dwordx4 v1, s[8:11], s85 offen offset:2048 sc1 lds
 v_mul_f32 v57, v57, v152
 v_mfma_f32_16x16x32_bf16 v[80:83], v[108:111], a[108:111], v[80:83]
 ds_read_b128 v[100:103], v25 offset:57344
 v_mul_f32 v58, v58, v152
 v_mul_f32 v59, v59, v152
 v_mfma_f32_16x16x32_bf16 v[84:87], v[108:111], a[112:115], v[84:87]
 s_waitcnt lgkmcnt(4)
 v_mul_f32 v56, v56, abs(v56)
 v_mul_f32 v57, v57, abs(v57)
 v_mfma_f32_16x16x32_bf16 v[72:75], v[112:115], a[116:119], v[72:75]
 ds_read_b128 v[104:107], v25 offset:37888
 v_mul_f32 v58, v58, abs(v58)
 v_mfma_f32_16x16x32_bf16 v[76:79], v[112:115], a[120:123], v[76:79]
 v_mul_f32 v59, v59, abs(v59)
 v_cvt_pk_bf16_f32 v144, v56, v57
 v_cvt_pk_bf16_f32 v145, v58, v59
 v_mfma_f32_16x16x32_bf16 v[80:83], v[116:119], a[116:119], v[80:83]
 ds_read_b128 v[108:111], v25 offset:58368
 v_pk_max_i16 v144, v144, 0
 v_mfma_f32_16x16x32_bf16 v[84:87], v[116:119], a[120:123], v[84:87]
 s_waitcnt lgkmcnt(4)
 buffer_load_dwordx4 v1, s[8:11], s85 offen offset:3072 sc1 lds
 v_pk_max_i16 v145, v145, 0
 v_mfma_f32_16x16x32_bf16 v[72:75], v[120:123], a[124:127], v[72:75]
 ds_read_b128 v[112:115], v25 offset:38912
 v_mul_f32 v64, v64, v152
 v_mul_f32 v65, v65, v152
 v_mfma_f32_16x16x32_bf16 v[76:79], v[120:123], a[128:131], v[76:79]
 v_mul_f32 v66, v66, v152
 v_mul_f32 v67, v67, v152
 v_mfma_f32_16x16x32_bf16 v[80:83], v[124:127], a[124:127], v[80:83]
 ds_read_b128 v[116:119], v25 offset:59392
 v_mul_f32 v64, v64, abs(v64)
 v_mfma_f32_16x16x32_bf16 v[84:87], v[124:127], a[128:131], v[84:87]
 s_waitcnt lgkmcnt(4)
 s_add_u32 m0, s28, 114688
 s_add_u32 s85, s37, 59392
 buffer_load_dwordx4 v1, s[8:11], s85 offen sc1 lds
 v_mul_f32 v65, v65, abs(v65)
 v_mul_f32 v66, v66, abs(v66)
 v_mfma_f32_16x16x32_bf16 v[72:75], v[96:99], a[132:135], v[72:75]
 ds_read_b128 v[120:123], v25 offset:39936
 v_mul_f32 v67, v67, abs(v67)
 v_mfma_f32_16x16x32_bf16 v[76:79], v[96:99], a[136:139], v[76:79]
 v_cvt_pk_bf16_f32 v146, v64, v65
 v_cvt_pk_bf16_f32 v147, v66, v67
 v_mfma_f32_16x16x32_bf16 v[80:83], v[100:103], a[132:135], v[80:83]
 ds_read_b128 v[124:127], v25 offset:60416
 v_pk_max_i16 v146, v146, 0
 v_pk_max_i16 v147, v147, 0
 v_mfma_f32_16x16x32_bf16 v[84:87], v[100:103], a[136:139], v[84:87]
 s_waitcnt lgkmcnt(4)
 buffer_store_dwordx4 v[144:147], v1, s[8:11], s41 offen offset:1024
 v_mfma_f32_16x16x32_bf16 v[72:75], v[104:107], a[140:143], v[72:75]
 s_waitcnt vmcnt(20)
 s_barrier
 ds_read_b128 v[96:99], v25 offset:20480
 v_mfma_f32_16x16x32_bf16 v[76:79], v[104:107], a[144:147], v[76:79]
 buffer_load_dwordx4 v1, s[8:11], s85 offen offset:1024 sc1 lds
 v_mfma_f32_16x16x32_bf16 v[80:83], v[108:111], a[140:143], v[80:83]
 ds_read_b128 v[100:103], v25 offset:40960
 v_mul_f32 v60, v60, v156
 v_mfma_f32_16x16x32_bf16 v[84:87], v[108:111], a[144:147], v[84:87]
 s_waitcnt lgkmcnt(4)
 v_mul_f32 v61, v61, v156
 v_mul_f32 v62, v62, v156
 v_mfma_f32_16x16x32_bf16 v[72:75], v[112:115], a[148:151], v[72:75]
 ds_read_b128 v[104:107], v25 offset:21504
 v_mul_f32 v63, v63, v156
 v_mfma_f32_16x16x32_bf16 v[76:79], v[112:115], a[152:155], v[76:79]
 v_mul_f32 v60, v60, abs(v60)
 v_mul_f32 v61, v61, abs(v61)
 v_mul_f32 v62, v62, abs(v62)
 v_mfma_f32_16x16x32_bf16 v[80:83], v[116:119], a[148:151], v[80:83]
 ds_read_b128 v[108:111], v25 offset:41984
 v_mul_f32 v63, v63, abs(v63)
 v_mfma_f32_16x16x32_bf16 v[84:87], v[116:119], a[152:155], v[84:87]
 s_waitcnt lgkmcnt(4)
 buffer_load_dwordx4 v1, s[8:11], s85 offen offset:2048 sc1 lds
 v_cvt_pk_bf16_f32 v148, v60, v61
 v_mfma_f32_16x16x32_bf16 v[72:75], v[120:123], a[156:159], v[72:75]
 ds_read_b128 v[112:115], v25 offset:22528
 v_cvt_pk_bf16_f32 v149, v62, v63
 v_mfma_f32_16x16x32_bf16 v[76:79], v[120:123], a[160:163], v[76:79]
 v_pk_max_i16 v148, v148, 0
 v_pk_max_i16 v149, v149, 0
 v_mul_f32 v68, v68, v156
 v_mfma_f32_16x16x32_bf16 v[80:83], v[124:127], a[156:159], v[80:83]
 ds_read_b128 v[116:119], v25 offset:43008
 v_mul_f32 v69, v69, v156
 v_mfma_f32_16x16x32_bf16 v[84:87], v[124:127], a[160:163], v[84:87]
 s_waitcnt lgkmcnt(4)
 buffer_load_dwordx4 v1, s[8:11], s85 offen offset:3072 sc1 lds
 v_mul_f32 v70, v70, v156
 v_mfma_f32_16x16x32_bf16 v[72:75], v[96:99], v[160:163], v[72:75]
 ds_read_b128 v[120:123], v25 offset:23552
 v_mul_f32 v71, v71, v156
 v_mul_f32 v68, v68, abs(v68)
 v_mfma_f32_16x16x32_bf16 v[76:79], v[96:99], v[164:167], v[76:79]
 v_mul_f32 v69, v69, abs(v69)
 v_mul_f32 v70, v70, abs(v70)
 v_mfma_f32_16x16x32_bf16 v[80:83], v[100:103], v[160:163], v[80:83]
 ds_read_b128 v[124:127], v25 offset:44032
 v_mul_f32 v71, v71, abs(v71)
 v_mfma_f32_16x16x32_bf16 v[84:87], v[100:103], v[164:167], v[84:87]
 s_waitcnt lgkmcnt(4)
 v_cvt_pk_bf16_f32 v150, v68, v69
 v_cvt_pk_bf16_f32 v151, v70, v71
 v_pk_max_i16 v150, v150, 0
 v_mfma_f32_16x16x32_bf16 v[72:75], v[104:107], v[168:171], v[72:75]
 ds_read_b128 v[96:99], v25
 v_pk_max_i16 v151, v151, 0
 v_mfma_f32_16x16x32_bf16 v[76:79], v[104:107], v[172:175], v[76:79]
 s_add_u32 m0, s28, 131072
 s_add_u32 s85, s37, 63488
 buffer_load_dwordx4 v1, s[8:11], s85 offen sc1 lds
 buffer_store_dwordx4 v[148:151], v1, s[8:11], s30 offen offset:1024
 v_mfma_f32_16x16x32_bf16 v[80:83], v[108:111], v[168:171], v[80:83]
 ds_read_b128 v[100:103], v25 offset:1024
 v_mfma_f32_16x16x32_bf16 v[84:87], v[108:111], v[172:175], v[84:87]
 s_waitcnt lgkmcnt(4)
 v_mfma_f32_16x16x32_bf16 v[72:75], v[112:115], v[176:179], v[72:75]
 ds_read_b128 v[104:107], v25 offset:2048
 v_mfma_f32_16x16x32_bf16 v[76:79], v[112:115], v[180:183], v[76:79]
 v_mfma_f32_16x16x32_bf16 v[80:83], v[116:119], v[176:179], v[80:83]
 ds_read_b128 v[108:111], v25 offset:3072
 v_mfma_f32_16x16x32_bf16 v[84:87], v[116:119], v[180:183], v[84:87]
 s_waitcnt lgkmcnt(4)
 buffer_load_dwordx4 a[8:11], v39, s[8:11], s38 offen offset:2048 sc1
 v_mfma_f32_16x16x32_bf16 v[72:75], v[120:123], v[184:187], v[72:75]
 ds_read_b128 v[112:115], v25 offset:4096
 v_mfma_f32_16x16x32_bf16 v[76:79], v[120:123], v[188:191], v[76:79]
 v_mfma_f32_16x16x32_bf16 v[80:83], v[124:127], v[184:187], v[80:83]
 ds_read_b128 v[116:119], v25 offset:5120
 v_mfma_f32_16x16x32_bf16 v[84:87], v[124:127], v[188:191], v[84:87]
 s_waitcnt lgkmcnt(4)
 v_mfma_f32_16x16x32_bf16 v[88:91], v[96:99], v[160:163], v[88:91]
 ds_read_b128 v[120:123], v25 offset:6144
 v_mfma_f32_16x16x32_bf16 v[92:95], v[96:99], v[164:167], v[92:95]
 buffer_load_dwordx4 v1, s[8:11], s85 offen offset:1024 sc1 lds
 v_mfma_f32_16x16x32_bf16 v[88:91], v[100:103], v[168:171], v[88:91]
 ds_read_b128 v[124:127], v25 offset:7168
 v_mfma_f32_16x16x32_bf16 v[92:95], v[100:103], v[172:175], v[92:95]
 s_waitcnt lgkmcnt(4)
 v_mul_f32 v72, v72, v152
 v_mul_f32 v73, v73, v152
 v_mfma_f32_16x16x32_bf16 v[88:91], v[104:107], v[176:179], v[88:91]
 ds_read_b128 v[96:99], v25 offset:8192
 v_mul_f32 v74, v74, v152
 v_mfma_f32_16x16x32_bf16 v[92:95], v[104:107], v[180:183], v[92:95]
 buffer_load_dwordx4 v1, s[8:11], s85 offen offset:2048 sc1 lds
 v_mul_f32 v75, v75, v152
 v_mul_f32 v72, v72, abs(v72)
 v_mfma_f32_16x16x32_bf16 v[88:91], v[108:111], v[184:187], v[88:91]
 ds_read_b128 v[100:103], v25 offset:9216
 v_mul_f32 v73, v73, abs(v73)
 v_mfma_f32_16x16x32_bf16 v[92:95], v[108:111], v[188:191], v[92:95]
 s_waitcnt lgkmcnt(4)
 v_mul_f32 v74, v74, abs(v74)
 v_mul_f32 v75, v75, abs(v75)
 v_mfma_f32_16x16x32_bf16 v[88:91], v[112:115], v[192:195], v[88:91]
 ds_read_b128 v[104:107], v25 offset:10240
 v_cvt_pk_bf16_f32 v144, v72, v73
 v_mfma_f32_16x16x32_bf16 v[92:95], v[112:115], v[196:199], v[92:95]
 buffer_load_dwordx4 v1, s[8:11], s85 offen offset:3072 sc1 lds
 v_cvt_pk_bf16_f32 v145, v74, v75
 v_pk_max_i16 v144, v144, 0
 v_mfma_f32_16x16x32_bf16 v[88:91], v[116:119], v[200:203], v[88:91]
 ds_read_b128 v[108:111], v25 offset:11264
 v_pk_max_i16 v145, v145, 0
 v_mfma_f32_16x16x32_bf16 v[92:95], v[116:119], v[204:207], v[92:95]
 s_waitcnt lgkmcnt(4)
 v_mul_f32 v80, v80, v152
 v_mul_f32 v81, v81, v152
 v_mfma_f32_16x16x32_bf16 v[88:91], v[120:123], v[208:211], v[88:91]
 ds_read_b128 v[112:115], v25 offset:12288
 v_mul_f32 v82, v82, v152
 v_mfma_f32_16x16x32_bf16 v[92:95], v[120:123], v[212:215], v[92:95]
 s_add_u32 m0, s28, 147456
 s_add_u32 s85, s37, 67584
 buffer_load_dwordx4 v1, s[8:11], s85 offen sc1 lds
 v_mul_f32 v83, v83, v152
 v_mfma_f32_16x16x32_bf16 v[88:91], v[124:127], v[216:219], v[88:91]
 ds_read_b128 v[116:119], v25 offset:13312
 v_mul_f32 v80, v80, abs(v80)
 v_mul_f32 v81, v81, abs(v81)
 v_mfma_f32_16x16x32_bf16 v[92:95], v[124:127], v[220:223], v[92:95]
 s_waitcnt lgkmcnt(4)
 v_mul_f32 v82, v82, abs(v82)
 v_mul_f32 v83, v83, abs(v83)
 v_mfma_f32_16x16x32_bf16 v[88:91], v[96:99], v[224:227], v[88:91]
 ds_read_b128 v[120:123], v25 offset:14336
 v_cvt_pk_bf16_f32 v146, v80, v81
 v_mfma_f32_16x16x32_bf16 v[92:95], v[96:99], v[228:231], v[92:95]
 buffer_load_dwordx4 v1, s[8:11], s85 offen offset:1024 sc1 lds
 v_cvt_pk_bf16_f32 v147, v82, v83
 v_mfma_f32_16x16x32_bf16 v[88:91], v[100:103], v[232:235], v[88:91]
 s_waitcnt vmcnt(6)
 ds_read_b128 v[124:127], v25 offset:15360
 v_mov_b32 v27, 1
 s_mov_b64 exec, 1
 buffer_store_dword v27, off, s[8:11], s50
 s_mov_b64 exec, -1
 v_mfma_f32_16x16x32_bf16 v[92:95], v[100:103], v[236:239], v[92:95]
 s_waitcnt lgkmcnt(4)
 v_pk_max_i16 v146, v146, 0
 v_pk_max_i16 v147, v147, 0
 v_mfma_f32_16x16x32_bf16 v[88:91], v[104:107], v[240:243], v[88:91]
 ds_read_b128 v[96:99], v25 offset:16384
 buffer_store_dwordx4 v[144:147], v1, s[8:11], s84 offen
 v_mfma_f32_16x16x32_bf16 v[92:95], v[104:107], v[244:247], v[92:95]
 buffer_load_dwordx4 v1, s[8:11], s85 offen offset:2048 sc1 lds
 v_mfma_f32_16x16x32_bf16 v[88:91], v[108:111], v[248:251], v[88:91]
 ds_read_b128 v[100:103], v25 offset:17408
 v_mfma_f32_16x16x32_bf16 v[92:95], v[108:111], v[252:255], v[92:95]
 s_waitcnt lgkmcnt(4)
 v_mul_f32 v76, v76, v156
 v_mul_f32 v77, v77, v156
 v_mfma_f32_16x16x32_bf16 v[88:91], v[112:115], a[100:103], v[88:91]
 ds_read_b128 v[104:107], v25 offset:18432
 v_mul_f32 v78, v78, v156
 v_mfma_f32_16x16x32_bf16 v[92:95], v[112:115], a[104:107], v[92:95]
 buffer_load_dwordx4 v1, s[8:11], s85 offen offset:3072 sc1 lds
 v_mul_f32 v79, v79, v156
 v_mfma_f32_16x16x32_bf16 v[88:91], v[116:119], a[108:111], v[88:91]
 ds_read_b128 v[108:111], v25 offset:19456
 v_and_b32 v254, 28, v22
 v_mfma_f32_16x16x32_bf16 v[92:95], v[116:119], a[112:115], v[92:95]
 s_waitcnt lgkmcnt(4)
 v_mul_f32 v76, v76, abs(v76)
 v_mul_f32 v77, v77, abs(v77)
 v_mfma_f32_16x16x32_bf16 v[88:91], v[120:123], a[116:119], v[88:91]
 v_mul_f32 v78, v78, abs(v78)
 v_mul_f32 v79, v79, abs(v79)
 v_cvt_pk_bf16_f32 v148, v76, v77
 v_mfma_f32_16x16x32_bf16 v[92:95], v[120:123], a[120:123], v[92:95]
 buffer_load_dwordx4 a[12:15], v39, s[8:11], s38 offen offset:3072 sc1
 v_cvt_pk_bf16_f32 v149, v78, v79
 v_mfma_f32_16x16x32_bf16 v[88:91], v[124:127], a[124:127], v[88:91]
 v_pk_max_i16 v148, v148, 0
 v_pk_max_i16 v149, v149, 0
 v_mfma_f32_16x16x32_bf16 v[92:95], v[124:127], a[128:131], v[92:95]
 s_waitcnt lgkmcnt(2)
 v_mul_f32 v84, v84, v156
 v_mul_f32 v85, v85, v156
 v_mfma_f32_16x16x32_bf16 v[88:91], v[96:99], a[132:135], v[88:91]
 buffer_load_dword v26, v254, s[8:11], s51 offen sc1
 v_mul_f32 v86, v86, v156
 v_mfma_f32_16x16x32_bf16 v[92:95], v[96:99], a[136:139], v[92:95]
 buffer_load_dword v0, v1, s[8:11], s39 offen sc1
 v_mul_f32 v87, v87, v156
 v_mul_f32 v84, v84, abs(v84)
 v_mfma_f32_16x16x32_bf16 v[88:91], v[100:103], a[140:143], v[88:91]
 v_mul_f32 v85, v85, abs(v85)
 v_mul_f32 v86, v86, abs(v86)
 v_mfma_f32_16x16x32_bf16 v[92:95], v[100:103], a[144:147], v[92:95]
 s_waitcnt lgkmcnt(0)
 v_mul_f32 v87, v87, abs(v87)
 v_cvt_pk_bf16_f32 v150, v84, v85
 v_mfma_f32_16x16x32_bf16 v[88:91], v[104:107], a[148:151], v[88:91]
 v_cvt_pk_bf16_f32 v151, v86, v87
 v_pk_max_i16 v150, v150, 0
 v_mfma_f32_16x16x32_bf16 v[92:95], v[104:107], a[152:155], v[92:95]
 buffer_load_dword v0, v1, s[8:11], s39 offen offset:1024 sc1
 v_pk_max_i16 v151, v151, 0
 v_mfma_f32_16x16x32_bf16 v[88:91], v[108:111], a[156:159], v[88:91]
 buffer_store_dwordx4 v[148:151], v1, s[8:11], s32 offen
 v_mfma_f32_16x16x32_bf16 v[92:95], v[108:111], a[160:163], v[92:95]
 v_add_u32 v244, s56, v1
 v_add_u32 v245, s57, v1
 v_add_u32 v246, s58, v1
 v_add_u32 v247, s59, v1
 s_nop 1
 v_pk_mul_f32 v[88:89], v[88:89], v[152:153] op_sel_hi:[1,0]
 v_pk_mul_f32 v[90:91], v[90:91], v[152:153] op_sel_hi:[1,0]
 v_mul_f32 v88, v88, abs(v88)
 v_mul_f32 v89, v89, abs(v89)
 v_mul_f32 v90, v90, abs(v90)
 v_mul_f32 v91, v91, abs(v91)
 v_cvt_pk_bf16_f32 v144, v88, v89
 v_cvt_pk_bf16_f32 v145, v90, v91
 v_pk_max_i16 v144, v144, 0
 v_pk_max_i16 v145, v145, 0
 buffer_store_dwordx2 v[144:145], v1, s[8:11], s42 offen
 v_pk_mul_f32 v[92:93], v[92:93], v[156:157] op_sel_hi:[1,0]
 v_pk_mul_f32 v[94:95], v[94:95], v[156:157] op_sel_hi:[1,0]
 v_mul_f32 v92, v92, abs(v92)
 v_mul_f32 v93, v93, abs(v93)
 v_mul_f32 v94, v94, abs(v94)
 v_mul_f32 v95, v95, abs(v95)
 v_cvt_pk_bf16_f32 v148, v92, v93
 v_cvt_pk_bf16_f32 v149, v94, v95
 v_pk_max_i16 v148, v148, 0
 v_pk_max_i16 v149, v149, 0
 buffer_store_dwordx2 v[148:149], v1, s[8:11], s31 offen
 s_waitcnt vmcnt(5)
 v_cmp_gt_u32 vcc, 1, v26
 s_cbranch_vccnz fretry_7
fback_8:
 buffer_load_dwordx4 v[160:163], v244, s[8:11], s66 offen offset:2048 sc1
 buffer_load_dwordx4 v[164:167], v245, s[8:11], s66 offen offset:2048 sc1
 buffer_load_dwordx4 v[168:171], v246, s[8:11], s66 offen offset:2048 sc1
 buffer_load_dwordx4 v[172:175], v247, s[8:11], s66 offen offset:2048 sc1
 v_add_u32 v252, 81920, v3
 v_add_u32 v253, 147456, v3
 v_add_u32 v248, s83, v1
 s_barrier
 s_add_u32 m0, s83, 0
 s_add_u32 s85, s37, 40960
 buffer_load_dwordx4 v1, s[8:11], s85 offen sc1 lds
 buffer_load_dwordx4 v1, s[8:11], s85 offen offset:1024 sc1 lds
 buffer_load_dwordx4 v1, s[8:11], s85 offen offset:2048 sc1 lds
 buffer_load_dwordx4 v1, s[8:11], s85 offen offset:3072 sc1 lds
 v_mov_b32 v27, 2
 s_waitcnt vmcnt(8)
 s_mov_b64 exec, 1
 buffer_store_dword v27, off, s[8:11], s50
 s_mov_b64 exec, -1
 ds_read_b128 v[224:227], v252
 ds_read_b128 v[228:231], v252 offset:1024
 ds_read_b128 v[232:235], v252 offset:2048
 ds_read_b128 v[236:239], v252 offset:3072
 ds_read_b128 v[240:243], v252 offset:16384
 s_add_u32 s31, s22, 3
 s_and_b32 s31, s31, 3
 s_mul_i32 s31, s31, 10240
 s_add_u32 s31, s31, 2048
 v_add_u32 v249, s31, v22
 s_add_u32 s31, s22, 2
 s_and_b32 s31, s31, 3
 s_mul_i32 s31, s31, 10240
 s_add_u32 s31, s31, 2048
 v_add_u32 v250, s31, v22
 s_add_u32 s31, s22, 1
 s_and_b32 s31, s31, 3
 s_mul_i32 s31, s31, 10240
 s_add_u32 s31, s31, 2048
 v_add_u32 v251, s31, v22
 ds_read_b128 v[184:187], v21 offset:1152
 buffer_load_dwordx4 v[176:179], v244, s[8:11], s66 offen offset:3072 sc1
 ds_read_b128 v[188:191], v21 offset:1216
 ds_read_b128 v[192:195], v21 offset:1280
 ds_read_b128 v[196:199], v21 offset:1344
 ds_read_b128 v[200:203], v21 offset:1408
 v_lshlrev_b32 v100, 16, v28
 v_and_b32 v101, 0xffff0000, v28
 v_lshlrev_b32 v102, 16, v29
 v_and_b32 v103, 0xffff0000, v29
 buffer_load_dwordx4 v[180:183], v245, s[8:11], s66 offen offset:3072 sc1
 v_lshlrev_b32 v104, 16, v30
 v_and_b32 v105, 0xffff0000, v30
 v_lshlrev_b32 v106, 16, v31
 v_and_b32 v107, 0xffff0000, v31
 v_lshlrev_b32 v108, 16, v32
 v_and_b32 v109, 0xffff0000, v32
 v_lshlrev_b32 v110, 16, v33
 v_and_b32 v111, 0xffff0000, v33
 v_lshlrev_b32 v112, 16, v34
 buffer_load_dwordx4 v[120:123], v246, s[8:11], s66 offen offset:3072 sc1
 v_and_b32 v113, 0xffff0000, v34
 v_lshlrev_b32 v114, 16, v35
 v_and_b32 v115, 0xffff0000, v35
 v_lshlrev_b32 v116, 16, v36
 v_and_b32 v117, 0xffff0000, v36
 v_lshlrev_b32 v118, 16, v37
 v_and_b32 v119, 0xffff0000, v37
 s_waitcnt lgkmcnt(4)
 v_pk_add_f32 v[100:101], v[100:101], v[184:185]
 v_pk_add_f32 v[102:103], v[102:103], v[186:187]
 buffer_load_dwordx4 v[124:127], v247, s[8:11], s66 offen offset:3072 sc1
 s_waitcnt lgkmcnt(3)
 v_pk_add_f32 v[104:105], v[104:105], v[188:189]
 v_pk_add_f32 v[106:107], v[106:107], v[190:191]
 s_waitcnt lgkmcnt(2)
 v_pk_add_f32 v[108:109], v[108:109], v[192:193]
 v_pk_add_f32 v[110:111], v[110:111], v[194:195]
 s_waitcnt lgkmcnt(1)
 v_pk_add_f32 v[112:113], v[112:113], v[196:197]
 v_pk_add_f32 v[114:115], v[114:115], v[198:199]
 s_waitcnt lgkmcnt(0)
 v_pk_add_f32 v[116:117], v[116:117], v[200:201]
 v_pk_add_f32 v[118:119], v[118:119], v[202:203]
 s_add_u32 m0, s83, 4096
 s_add_u32 s85, s37, 45056
 buffer_load_dwordx4 v1, s[8:11], s85 offen sc1 lds
 buffer_load_dwordx4 v1, s[8:11], s85 offen offset:1024 sc1 lds
 buffer_load_dwordx4 v1, s[8:11], s85 offen offset:2048 sc1 lds
 buffer_load_dwordx4 v1, s[8:11], s85 offen offset:3072 sc1 lds
 s_add_u32 m0, s83, 8192
 s_add_u32 s85, s37, 49152
 buffer_load_dwordx4 v1, s[8:11], s85 offen sc1 lds
 buffer_load_dwordx4 v1, s[8:11], s85 offen offset:1024 sc1 lds
 buffer_load_dwordx4 a[120:123], v39, s[8:11], s71 offen offset:2048 sc1
 buffer_load_dwordx4 a[124:127], v39, s[8:11], s71 offen offset:3072 sc1
 s_waitcnt vmcnt(20)
 v_mfma_f32_16x16x32_bf16 v[40:43], v[224:227], v[160:163], 0
 buffer_load_dwordx4 v[128:131], v244, s[8:11], s67 offen sc1
 ds_write_b128 v252, a[176:179]
 v_mfma_f32_16x16x32_bf16 v[44:47], v[228:231], v[160:163], 0
 ds_read_b128 a[176:179], v252 offset:17408
 v_mfma_f32_16x16x32_bf16 v[48:51], v[232:235], v[160:163], 0
 v_mfma_f32_16x16x32_bf16 v[52:55], v[236:239], v[160:163], 0
 ds_write_b128 v252, a[180:183] offset:1024
 v_mfma_f32_16x16x32_bf16 v[56:59], v[240:243], v[160:163], 0
 s_waitcnt vmcnt(20)
 buffer_load_dwordx4 v[132:135], v245, s[8:11], s67 offen sc1
 ds_read_b128 a[180:183], v252 offset:18432
 v_mfma_f32_16x16x32_bf16 v[60:63], v[224:227], v[164:167], 0
 v_mfma_f32_16x16x32_bf16 v[64:67], v[228:231], v[164:167], 0
 ds_write_b128 v252, a[184:187] offset:2048
 v_mfma_f32_16x16x32_bf16 v[68:71], v[232:235], v[164:167], 0
 ds_read_b128 a[184:187], v252 offset:19456
 buffer_load_dwordx4 a[128:131], v39, s[8:11], s72 offen sc1
 v_mfma_f32_16x16x32_bf16 v[72:75], v[236:239], v[164:167], 0
 v_mfma_f32_16x16x32_bf16 v[76:79], v[240:243], v[164:167], 0
 s_waitcnt vmcnt(21)
 buffer_load_dwordx4 v[136:139], v246, s[8:11], s67 offen sc1
 ds_write_b128 v252, a[188:191] offset:3072
 v_mfma_f32_16x16x32_bf16 v[80:83], v[224:227], v[168:171], 0
 ds_read_b128 a[188:191], v252 offset:32768
 v_mfma_f32_16x16x32_bf16 v[84:87], v[228:231], v[168:171], 0
 v_mfma_f32_16x16x32_bf16 v[88:91], v[232:235], v[168:171], 0
 ds_write_b128 v252, a[192:195] offset:16384
 v_mfma_f32_16x16x32_bf16 v[92:95], v[236:239], v[168:171], 0
 buffer_load_dwordx4 v[140:143], v247, s[8:11], s67 offen sc1
 ds_read_b128 a[192:195], v252 offset:33792
 v_mfma_f32_16x16x32_bf16 v[96:99], v[240:243], v[168:171], 0
 s_waitcnt vmcnt(22)
 v_mfma_f32_16x16x32_bf16 v[100:103], v[224:227], v[172:175], v[100:103]
 v_mfma_f32_16x16x32_bf16 v[104:107], v[228:231], v[172:175], v[104:107]
 buffer_load_dwordx4 a[132:135], v39, s[8:11], s72 offen offset:1024 sc1
 v_mfma_f32_16x16x32_bf16 v[108:111], v[232:235], v[172:175], v[108:111]
 v_mfma_f32_16x16x32_bf16 v[112:115], v[236:239], v[172:175], v[112:115]
 buffer_load_dwordx4 v[144:147], v244, s[8:11], s67 offen offset:1024 sc1
 v_mfma_f32_16x16x32_bf16 v[116:119], v[240:243], v[172:175], v[116:119]
 s_waitcnt vmcnt(18) lgkmcnt(8)
 v_mfma_f32_16x16x32_bf16 v[40:43], a[176:179], v[176:179], v[40:43]
 s_waitcnt lgkmcnt(6)
 ds_write_b128 v252, a[196:199] offset:17408
 v_mfma_f32_16x16x32_bf16 v[44:47], a[180:183], v[176:179], v[44:47]
 s_waitcnt lgkmcnt(5)
 ds_read_b128 a[196:199], v252 offset:34816
 v_mfma_f32_16x16x32_bf16 v[48:51], a[184:187], v[176:179], v[48:51]
 s_waitcnt lgkmcnt(4)
 buffer_load_dwordx4 v[148:151], v245, s[8:11], s67 offen offset:1024 sc1
 v_mfma_f32_16x16x32_bf16 v[52:55], a[188:191], v[176:179], v[52:55]
 s_waitcnt lgkmcnt(2)
 ds_write_b128 v252, a[200:203] offset:18432
 v_mfma_f32_16x16x32_bf16 v[56:59], a[192:195], v[176:179], v[56:59]
 s_waitcnt vmcnt(18)
 ds_read_b128 a[200:203], v252 offset:35840
 v_mfma_f32_16x16x32_bf16 v[60:63], a[176:179], v[180:183], v[60:63]
 v_mfma_f32_16x16x32_bf16 v[64:67], a[180:183], v[180:183], v[64:67]
 ds_write_b128 v252, a[204:207] offset:19456
 v_mfma_f32_16x16x32_bf16 v[68:71], a[184:187], v[180:183], v[68:71]
 buffer_load_dwordx4 v[152:155], v246, s[8:11], s67 offen offset:1024 sc1
 ds_read_b128 a[204:207], v252 offset:49152
 v_mfma_f32_16x16x32_bf16 v[72:75], a[188:191], v[180:183], v[72:75]
 s_add_u32 s86, s38, 4096
 buffer_load_dwordx4 a[16:19], v39, s[8:11], s86 offen sc1
 v_mfma_f32_16x16x32_bf16 v[76:79], a[192:195], v[180:183], v[76:79]
 s_waitcnt vmcnt(19)
 ds_write_b128 v252, a[208:211] offset:32768
 v_mfma_f32_16x16x32_bf16 v[80:83], a[176:179], v[120:123], v[80:83]
 ds_read_b128 a[208:211], v252 offset:50176
 v_mfma_f32_16x16x32_bf16 v[84:87], a[180:183], v[120:123], v[84:87]
 buffer_load_dwordx4 v[156:159], v247, s[8:11], s67 offen offset:1024 sc1
 v_mfma_f32_16x16x32_bf16 v[88:91], a[184:187], v[120:123], v[88:91]
 ds_write_b128 v252, a[212:215] offset:33792
 v_mfma_f32_16x16x32_bf16 v[92:95], a[188:191], v[120:123], v[92:95]
 ds_read_b128 a[212:215], v252 offset:51200
 v_mfma_f32_16x16x32_bf16 v[96:99], a[192:195], v[120:123], v[96:99]
 s_waitcnt vmcnt(19)
 v_mfma_f32_16x16x32_bf16 v[100:103], a[176:179], v[124:127], v[100:103]
 v_mfma_f32_16x16x32_bf16 v[104:107], a[180:183], v[124:127], v[104:107]
 buffer_load_dwordx4 v[160:163], v244, s[8:11], s66 offen sc1
 v_mfma_f32_16x16x32_bf16 v[108:111], a[184:187], v[124:127], v[108:111]
 buffer_load_dword v0, v8, s[8:11], s39 offen offset:2048 sc1
 v_mfma_f32_16x16x32_bf16 v[112:115], a[188:191], v[124:127], v[112:115]
 v_mfma_f32_16x16x32_bf16 v[116:119], a[192:195], v[124:127], v[116:119]
 s_waitcnt vmcnt(12) lgkmcnt(8)
 v_mfma_f32_16x16x32_bf16 v[40:43], a[196:199], v[128:131], v[40:43]
 s_waitcnt lgkmcnt(6)
 buffer_load_dwordx4 v[164:167], v245, s[8:11], s66 offen sc1
 ds_write_b128 v252, a[216:219] offset:34816
 v_mfma_f32_16x16x32_bf16 v[44:47], a[200:203], v[128:131], v[44:47]
 s_waitcnt lgkmcnt(5)
 ds_read_b128 a[216:219], v252 offset:52224
 v_mfma_f32_16x16x32_bf16 v[48:51], a[204:207], v[128:131], v[48:51]
 s_waitcnt lgkmcnt(4)
 v_mfma_f32_16x16x32_bf16 v[52:55], a[208:211], v[128:131], v[52:55]
 s_waitcnt lgkmcnt(2)
 ds_write_b128 v252, a[220:223] offset:35840
 v_mfma_f32_16x16x32_bf16 v[56:59], a[212:215], v[128:131], v[56:59]
 s_waitcnt vmcnt(12)
 ds_read_b128 a[220:223], v253
 v_mfma_f32_16x16x32_bf16 v[60:63], a[196:199], v[132:135], v[60:63]
 buffer_load_dword v26, v254, s[8:11], s51 offen sc1
 buffer_load_dwordx4 v[168:171], v246, s[8:11], s66 offen sc1
 v_mfma_f32_16x16x32_bf16 v[64:67], a[200:203], v[132:135], v[64:67]
 ds_write_b128 v252, a[224:227] offset:49152
 v_mfma_f32_16x16x32_bf16 v[68:71], a[204:207], v[132:135], v[68:71]
 ds_read_b128 a[224:227], v253 offset:1024
 v_mfma_f32_16x16x32_bf16 v[72:75], a[208:211], v[132:135], v[72:75]
 buffer_load_dword v0, v9, s[8:11], s40 offen sc1
 v_mfma_f32_16x16x32_bf16 v[76:79], a[212:215], v[132:135], v[76:79]
 s_waitcnt vmcnt(13)
 ds_write_b128 v252, a[228:231] offset:50176
 v_mfma_f32_16x16x32_bf16 v[80:83], a[196:199], v[136:139], v[80:83]
 buffer_load_dwordx4 v[172:175], v247, s[8:11], s66 offen sc1
 ds_read_b128 a[228:231], v253 offset:2048
 v_mfma_f32_16x16x32_bf16 v[84:87], a[200:203], v[136:139], v[84:87]
 v_mfma_f32_16x16x32_bf16 v[88:91], a[204:207], v[136:139], v[88:91]
 ds_write_b128 v252, a[232:235] offset:51200
 v_mfma_f32_16x16x32_bf16 v[92:95], a[208:211], v[136:139], v[92:95]
 ds_read_b128 a[232:235], v253 offset:3072
 v_mfma_f32_16x16x32_bf16 v[96:99], a[212:215], v[136:139], v[96:99]
 s_waitcnt vmcnt(13)
 buffer_load_dwordx4 v[176:179], v244, s[8:11], s66 offen offset:1024 sc1
 v_mfma_f32_16x16x32_bf16 v[100:103], a[196:199], v[140:143], v[100:103]
 v_mfma_f32_16x16x32_bf16 v[104:107], a[200:203], v[140:143], v[104:107]
 buffer_load_dwordx4 a[136:139], v39, s[8:11], s72 offen offset:2048 sc1
 v_mfma_f32_16x16x32_bf16 v[108:111], a[204:207], v[140:143], v[108:111]
 v_mfma_f32_16x16x32_bf16 v[112:115], a[208:211], v[140:143], v[112:115]
 v_mfma_f32_16x16x32_bf16 v[116:119], a[212:215], v[140:143], v[116:119]
 s_waitcnt vmcnt(13) lgkmcnt(8)
 buffer_load_dwordx4 v[180:183], v245, s[8:11], s66 offen offset:1024 sc1
 v_mfma_f32_16x16x32_bf16 v[40:43], a[216:219], v[144:147], v[40:43]
 s_waitcnt lgkmcnt(6)
 ds_write_b128 v252, a[236:239] offset:52224
 v_mfma_f32_16x16x32_bf16 v[44:47], a[220:223], v[144:147], v[44:47]
 s_waitcnt lgkmcnt(5)
 ds_read_b128 v[184:187], v248
 v_mfma_f32_16x16x32_bf16 v[48:51], a[224:227], v[144:147], v[48:51]
 s_waitcnt lgkmcnt(4)
 buffer_load_dwordx4 a[140:143], v39, s[8:11], s72 offen offset:3072 sc1
 v_mfma_f32_16x16x32_bf16 v[52:55], a[228:231], v[144:147], v[52:55]
 s_waitcnt lgkmcnt(2)
 buffer_load_dwordx4 v[120:123], v246, s[8:11], s66 offen offset:1024 sc1
 ds_write_b128 v253, a[240:243]
 v_mfma_f32_16x16x32_bf16 v[56:59], a[232:235], v[144:147], v[56:59]
 s_waitcnt vmcnt(15)
 ds_read_b128 v[188:191], v248 offset:1024
 v_mfma_f32_16x16x32_bf16 v[60:63], a[216:219], v[148:151], v[60:63]
 v_mfma_f32_16x16x32_bf16 v[64:67], a[220:223], v[148:151], v[64:67]
 ds_write_b128 v253, a[244:247] offset:1024
 v_mfma_f32_16x16x32_bf16 v[68:71], a[224:227], v[148:151], v[68:71]
 ds_read_b128 v[192:195], v248 offset:2048
 v_mfma_f32_16x16x32_bf16 v[72:75], a[228:231], v[148:151], v[72:75]
 buffer_load_dwordx4 v[124:127], v247, s[8:11], s66 offen offset:1024 sc1
 v_mfma_f32_16x16x32_bf16 v[76:79], a[232:235], v[148:151], v[76:79]
 s_waitcnt vmcnt(15)
 ds_write_b128 v253, a[248:251] offset:2048
 v_mfma_f32_16x16x32_bf16 v[80:83], a[216:219], v[152:155], v[80:83]
 ds_read_b128 v[196:199], v248 offset:3072
 buffer_load_dwordx4 a[144:147], v39, s[8:11], s73 offen sc1
 v_mfma_f32_16x16x32_bf16 v[84:87], a[220:223], v[152:155], v[84:87]
 v_mfma_f32_16x16x32_bf16 v[88:91], a[224:227], v[152:155], v[88:91]
 buffer_load_dwordx4 v[128:131], v244, s[8:11], s65 offen offset:2048 sc1
 ds_write_b128 v253, a[252:255] offset:3072
 v_mfma_f32_16x16x32_bf16 v[92:95], a[228:231], v[152:155], v[92:95]
 ds_read_b128 v[200:203], v248 offset:4096
 v_mfma_f32_16x16x32_bf16 v[96:99], a[232:235], v[152:155], v[96:99]
 s_waitcnt vmcnt(15)
 v_mfma_f32_16x16x32_bf16 v[100:103], a[216:219], v[156:159], v[100:103]
pad5:
 s_cbranch_execz pad9
 buffer_load_dwordx4 a[148:151], v39, s[8:11], s73 offen offset:1024 sc1
 v_mfma_f32_16x16x32_bf16 v[104:107], a[220:223], v[156:159], v[104:107]
 v_mfma_f32_16x16x32_bf16 v[108:111], a[224:227], v[156:159], v[108:111]
 buffer_load_dwordx4 v[132:135], v245, s[8:11], s65 offen offset:2048 sc1
 v_mfma_f32_16x16x32_bf16 v[112:115], a[228:231], v[156:159], v[112:115]
 v_mfma_f32_16x16x32_bf16 v[116:119], a[232:235], v[156:159], v[116:119]
 s_waitcnt vmcnt(16) lgkmcnt(8)
 buffer_load_dwordx4 a[152:155], v39, s[8:11], s73 offen offset:2048 sc1
 v_mfma_f32_16x16x32_bf16 v[40:43], v[184:187], v[160:163], v[40:43]
 s_waitcnt lgkmcnt(6)
 v_mfma_f32_16x16x32_bf16 v[44:47], v[188:191], v[160:163], v[44:47]
 s_waitcnt lgkmcnt(4)
 buffer_load_dwordx4 v[136:139], v246, s[8:11], s65 offen offset:2048 sc1
 v_mfma_f32_16x16x32_bf16 v[48:51], v[192:195], v[160:163], v[48:51]
 s_waitcnt lgkmcnt(2)
 v_mfma_f32_16x16x32_bf16 v[52:55], v[196:199], v[160:163], v[52:55]
 s_waitcnt lgkmcnt(0)
 buffer_load_dwordx4 a[156:159], v39, s[8:11], s73 offen offset:3072 sc1
 v_mfma_f32_16x16x32_bf16 v[56:59], v[200:203], v[160:163], v[56:59]
 s_waitcnt vmcnt(17)
 ds_read_b128 v[204:207], v248 offset:5120
 v_mfma_f32_16x16x32_bf16 v[60:63], v[184:187], v[164:167], v[60:63]
 v_mfma_f32_16x16x32_bf16 v[64:67], v[188:191], v[164:167], v[64:67]
 buffer_load_dwordx4 v[140:143], v247, s[8:11], s65 offen offset:2048 sc1
 ds_read_b128 v[208:211], v248 offset:6144
 v_mfma_f32_16x16x32_bf16 v[68:71], v[192:195], v[164:167], v[68:71]
 v_mfma_f32_16x16x32_bf16 v[72:75], v[196:199], v[164:167], v[72:75]
 buffer_load_dwordx4 a[100:103], v39, s[8:11], s70 offen offset:1024 sc1
 v_mfma_f32_16x16x32_bf16 v[76:79], v[200:203], v[164:167], v[76:79]
 s_waitcnt vmcnt(17)
 ds_read_b128 v[212:215], v248 offset:7168
 v_mfma_f32_16x16x32_bf16 v[80:83], v[184:187], v[168:171], v[80:83]
 buffer_load_dwordx4 v[144:147], v244, s[8:11], s65 offen offset:3072 sc1
 v_mfma_f32_16x16x32_bf16 v[84:87], v[188:191], v[168:171], v[84:87]
 ds_read_b128 v[216:219], v248 offset:8192
 v_mfma_f32_16x16x32_bf16 v[88:91], v[192:195], v[168:171], v[88:91]
 v_mfma_f32_16x16x32_bf16 v[92:95], v[196:199], v[168:171], v[92:95]
 ds_read_b128 v[220:223], v248 offset:9216
 buffer_load_dwordx4 a[104:107], v39, s[8:11], s70 offen offset:2048 sc1
 v_mfma_f32_16x16x32_bf16 v[96:99], v[200:203], v[168:171], v[96:99]
 s_waitcnt vmcnt(17)
 v_mfma_f32_16x16x32_bf16 v[100:103], v[184:187], v[172:175], v[100:103]
 buffer_load_dwordx4 v[148:151], v245, s[8:11], s65 offen offset:3072 sc1
 v_mfma_f32_16x16x32_bf16 v[104:107], v[188:191], v[172:175], v[104:107]
 v_mfma_f32_16x16x32_bf16 v[108:111], v[192:195], v[172:175], v[108:111]
 buffer_load_dwordx4 a[108:111], v39, s[8:11], s70 offen offset:3072 sc1
 v_mfma_f32_16x16x32_bf16 v[112:115], v[196:199], v[172:175], v[112:115]
 v_mfma_f32_16x16x32_bf16 v[116:119], v[200:203], v[172:175], v[116:119]
 s_waitcnt vmcnt(18) lgkmcnt(4)
 v_mfma_f32_16x16x32_bf16 v[40:43], v[204:207], v[176:179], v[40:43]
 s_waitcnt lgkmcnt(3)
 buffer_load_dwordx4 v[152:155], v246, s[8:11], s65 offen offset:3072 sc1
 v_mfma_f32_16x16x32_bf16 v[44:47], v[208:211], v[176:179], v[44:47]
 s_waitcnt lgkmcnt(2)
 v_accvgpr_write_b32 a236, v224
 buffer_load_dwordx4 a[112:115], v39, s[8:11], s71 offen sc1
 v_mfma_f32_16x16x32_bf16 v[48:51], v[212:215], v[176:179], v[48:51]
 s_waitcnt lgkmcnt(1)
 v_mfma_f32_16x16x32_bf16 v[52:55], v[216:219], v[176:179], v[52:55]
 s_waitcnt lgkmcnt(0)
 v_accvgpr_write_b32 a237, v225
 v_mfma_f32_16x16x32_bf16 v[56:59], v[220:223], v[176:179], v[56:59]
 s_waitcnt vmcnt(18)
 buffer_load_dwordx4 v[156:159], v247, s[8:11], s65 offen offset:3072 sc1
 v_mfma_f32_16x16x32_bf16 v[60:63], v[204:207], v[180:183], v[60:63]
 v_mfma_f32_16x16x32_bf16 v[64:67], v[208:211], v[180:183], v[64:67]
 v_accvgpr_write_b32 a238, v226
 buffer_load_dwordx4 a[116:119], v39, s[8:11], s71 offen offset:1024 sc1
 v_mfma_f32_16x16x32_bf16 v[68:71], v[212:215], v[180:183], v[68:71]
 v_mfma_f32_16x16x32_bf16 v[72:75], v[216:219], v[180:183], v[72:75]
 v_accvgpr_write_b32 a239, v227
 v_mfma_f32_16x16x32_bf16 v[76:79], v[220:223], v[180:183], v[76:79]
 v_cmp_gt_u32 vcc, 2, v26
 s_cbranch_vccnz fretry_9
fback_10:
 buffer_load_dwordx4 v[160:163], v244, s[8:11], 0 offen offset:2048 sc1
 s_waitcnt vmcnt(19)
 v_mfma_f32_16x16x32_bf16 v[80:83], v[204:207], v[120:123], v[80:83]
 v_mfma_f32_16x16x32_bf16 v[84:87], v[208:211], v[120:123], v[84:87]
 v_accvgpr_write_b32 a240, v228
 v_mfma_f32_16x16x32_bf16 v[88:91], v[212:215], v[120:123], v[88:91]
 v_mfma_f32_16x16x32_bf16 v[92:95], v[216:219], v[120:123], v[92:95]
 buffer_load_dwordx4 v[164:167], v244, s[8:11], 0 offen offset:3072 sc1
 v_mfma_f32_16x16x32_bf16 v[96:99], v[220:223], v[120:123], v[96:99]
 s_waitcnt vmcnt(19)
 v_accvgpr_write_b32 a241, v229
 v_mfma_f32_16x16x32_bf16 v[100:103], v[204:207], v[124:127], v[100:103]
 v_mfma_f32_16x16x32_bf16 v[104:107], v[208:211], v[124:127], v[104:107]
 v_accvgpr_write_b32 a242, v230
 v_mfma_f32_16x16x32_bf16 v[108:111], v[212:215], v[124:127], v[108:111]
 v_mfma_f32_16x16x32_bf16 v[112:115], v[216:219], v[124:127], v[112:115]
 buffer_load_dwordx4 v[168:171], v244, s[8:11], s65 offen sc1
 v_mfma_f32_16x16x32_bf16 v[116:119], v[220:223], v[124:127], v[116:119]
 s_waitcnt vmcnt(18)
 v_accvgpr_write_b32 a243, v231
 v_mfma_f32_16x16x32_bf16 v[40:43], a[120:123], v[128:131], v[40:43]
 v_mfma_f32_16x16x32_bf16 v[44:47], a[124:127], v[128:131], v[44:47]
 v_accvgpr_write_b32 a244, v232
 v_mfma_f32_16x16x32_bf16 v[48:51], a[128:131], v[128:131], v[48:51]
 buffer_load_dwordx4 v[172:175], v244, s[8:11], s65 offen offset:1024 sc1
 v_mfma_f32_16x16x32_bf16 v[52:55], a[132:135], v[128:131], v[52:55]
 v_mfma_f32_16x16x32_bf16 v[56:59], a[136:139], v[128:131], v[56:59]
 s_waitcnt vmcnt(17)
 v_accvgpr_write_b32 a245, v233
 v_mfma_f32_16x16x32_bf16 v[60:63], a[120:123], v[132:135], v[60:63]
 v_mfma_f32_16x16x32_bf16 v[64:67], a[124:127], v[132:135], v[64:67]
 v_accvgpr_write_b32 a246, v234
 v_mfma_f32_16x16x32_bf16 v[68:71], a[128:131], v[132:135], v[68:71]
 buffer_load_dwordx4 v[176:179], v244, s[8:11], 0 offen offset:1024 sc1
 v_mfma_f32_16x16x32_bf16 v[72:75], a[132:135], v[132:135], v[72:75]
 v_mfma_f32_16x16x32_bf16 v[76:79], a[136:139], v[132:135], v[76:79]
 s_waitcnt vmcnt(16)
 v_accvgpr_write_b32 a247, v235
 v_mfma_f32_16x16x32_bf16 v[80:83], a[120:123], v[136:139], v[80:83]
 v_mfma_f32_16x16x32_bf16 v[84:87], a[124:127], v[136:139], v[84:87]
 buffer_load_dwordx4 v[180:183], v244, s[8:11], s38 offen sc1
 v_mfma_f32_16x16x32_bf16 v[88:91], a[128:131], v[136:139], v[88:91]
 v_accvgpr_write_b32 a248, v236
 v_mfma_f32_16x16x32_bf16 v[92:95], a[132:135], v[136:139], v[92:95]
 v_mfma_f32_16x16x32_bf16 v[96:99], a[136:139], v[136:139], v[96:99]
 s_waitcnt vmcnt(15)
 v_accvgpr_write_b32 a249, v237
 v_mfma_f32_16x16x32_bf16 v[100:103], a[120:123], v[140:143], v[100:103]
 v_mfma_f32_16x16x32_bf16 v[104:107], a[124:127], v[140:143], v[104:107]
 buffer_load_dwordx4 v[120:123], v245, s[8:11], 0 offen offset:2048 sc1
 v_accvgpr_write_b32 a250, v238
 v_mfma_f32_16x16x32_bf16 v[108:111], a[128:131], v[140:143], v[108:111]
 v_mfma_f32_16x16x32_bf16 v[112:115], a[132:135], v[140:143], v[112:115]
 v_mfma_f32_16x16x32_bf16 v[116:119], a[136:139], v[140:143], v[116:119]
 s_waitcnt vmcnt(14)
 v_accvgpr_write_b32 a251, v239
 v_mfma_f32_16x16x32_bf16 v[40:43], a[140:143], v[144:147], v[40:43]
 buffer_load_dwordx4 v[124:127], v245, s[8:11], 0 offen offset:3072 sc1
 v_mfma_f32_16x16x32_bf16 v[44:47], a[144:147], v[144:147], v[44:47]
 v_accvgpr_write_b32 a252, v240
 v_mfma_f32_16x16x32_bf16 v[48:51], a[148:151], v[144:147], v[48:51]
 v_mfma_f32_16x16x32_bf16 v[52:55], a[152:155], v[144:147], v[52:55]
 v_mfma_f32_16x16x32_bf16 v[56:59], a[156:159], v[144:147], v[56:59]
 s_waitcnt vmcnt(13)
 v_accvgpr_write_b32 a253, v241
 v_mfma_f32_16x16x32_bf16 v[60:63], a[140:143], v[148:151], v[60:63]
 buffer_load_dwordx4 v[128:131], v245, s[8:11], s65 offen sc1
 v_mfma_f32_16x16x32_bf16 v[64:67], a[144:147], v[148:151], v[64:67]
 v_accvgpr_write_b32 a254, v242
 v_mfma_f32_16x16x32_bf16 v[68:71], a[148:151], v[148:151], v[68:71]
 v_mfma_f32_16x16x32_bf16 v[72:75], a[152:155], v[148:151], v[72:75]
 v_accvgpr_write_b32 a255, v243
 v_mfma_f32_16x16x32_bf16 v[76:79], a[156:159], v[148:151], v[76:79]
 s_waitcnt vmcnt(12)
 v_mfma_f32_16x16x32_bf16 v[80:83], a[140:143], v[152:155], v[80:83]
 buffer_load_dwordx4 v[132:135], v245, s[8:11], s65 offen offset:1024 sc1
 v_mfma_f32_16x16x32_bf16 v[84:87], a[144:147], v[152:155], v[84:87]
 v_mfma_f32_16x16x32_bf16 v[88:91], a[148:151], v[152:155], v[88:91]
 v_mfma_f32_16x16x32_bf16 v[92:95], a[152:155], v[152:155], v[92:95]
 v_mfma_f32_16x16x32_bf16 v[96:99], a[156:159], v[152:155], v[96:99]
 s_waitcnt vmcnt(11)
 buffer_load_dwordx4 v[136:139], v245, s[8:11], 0 offen offset:1024 sc1
 v_mfma_f32_16x16x32_bf16 v[100:103], a[140:143], v[156:159], v[100:103]
 v_mfma_f32_16x16x32_bf16 v[104:107], a[144:147], v[156:159], v[104:107]
 v_mfma_f32_16x16x32_bf16 v[108:111], a[148:151], v[156:159], v[108:111]
 v_mfma_f32_16x16x32_bf16 v[112:115], a[152:155], v[156:159], v[112:115]
 v_mfma_f32_16x16x32_bf16 v[116:119], a[156:159], v[156:159], v[116:119]
 s_waitcnt vmcnt(10)
 buffer_load_dwordx4 v[140:143], v245, s[8:11], s38 offen sc1
 v_mfma_f32_16x16x32_bf16 v[40:43], a[40:43], v[160:163], v[40:43]
 v_mfma_f32_16x16x32_bf16 v[44:47], a[44:47], v[160:163], v[44:47]
 v_mfma_f32_16x16x32_bf16 v[48:51], a[48:51], v[160:163], v[48:51]
 v_mfma_f32_16x16x32_bf16 v[52:55], a[52:55], v[160:163], v[52:55]
 buffer_load_dwordx4 v[144:147], v246, s[8:11], 0 offen offset:2048 sc1
 v_mfma_f32_16x16x32_bf16 v[56:59], a[56:59], v[160:163], v[56:59]
 s_waitcnt vmcnt(11)
 v_mfma_f32_16x16x32_bf16 v[40:43], a[60:63], v[164:167], v[40:43]
 v_mfma_f32_16x16x32_bf16 v[44:47], a[64:67], v[164:167], v[44:47]
 v_mfma_f32_16x16x32_bf16 v[48:51], a[68:71], v[164:167], v[48:51]
 v_mfma_f32_16x16x32_bf16 v[52:55], a[72:75], v[164:167], v[52:55]
 buffer_load_dwordx4 v[148:151], v246, s[8:11], 0 offen offset:3072 sc1
 v_mfma_f32_16x16x32_bf16 v[56:59], a[76:79], v[164:167], v[56:59]
 s_waitcnt vmcnt(11)
 v_mfma_f32_16x16x32_bf16 v[40:43], a[80:83], v[168:171], v[40:43]
 v_mfma_f32_16x16x32_bf16 v[44:47], a[84:87], v[168:171], v[44:47]
 v_mfma_f32_16x16x32_bf16 v[48:51], a[88:91], v[168:171], v[48:51]
 buffer_load_dwordx4 v[152:155], v246, s[8:11], s65 offen sc1
 v_mfma_f32_16x16x32_bf16 v[52:55], a[92:95], v[168:171], v[52:55]
 v_mfma_f32_16x16x32_bf16 v[56:59], a[96:99], v[168:171], v[56:59]
 s_waitcnt vmcnt(11)
 v_mfma_f32_16x16x32_bf16 v[40:43], a[100:103], v[172:175], v[40:43]
 v_mfma_f32_16x16x32_bf16 v[44:47], a[104:107], v[172:175], v[44:47]
 v_mfma_f32_16x16x32_bf16 v[48:51], a[108:111], v[172:175], v[48:51]
 buffer_load_dwordx4 v[156:159], v246, s[8:11], s65 offen offset:1024 sc1
 v_mfma_f32_16x16x32_bf16 v[52:55], a[112:115], v[172:175], v[52:55]
 v_mfma_f32_16x16x32_bf16 v[56:59], a[116:119], v[172:175], v[56:59]
 s_waitcnt vmcnt(11)
 v_mfma_f32_16x16x32_bf16 v[40:43], a[20:23], v[176:179], v[40:43]
 v_mfma_f32_16x16x32_bf16 v[44:47], a[24:27], v[176:179], v[44:47]
 buffer_load_dwordx4 v[160:163], v246, s[8:11], 0 offen offset:1024 sc1
 v_mfma_f32_16x16x32_bf16 v[48:51], a[28:31], v[176:179], v[48:51]
 v_mfma_f32_16x16x32_bf16 v[52:55], a[32:35], v[176:179], v[52:55]
 v_mfma_f32_16x16x32_bf16 v[56:59], a[36:39], v[176:179], v[56:59]
 s_waitcnt vmcnt(11)
 v_mfma_f32_16x16x32_bf16 v[40:43], a[0:3], v[180:183], v[40:43]
 v_mfma_f32_16x16x32_bf16 v[44:47], a[4:7], v[180:183], v[44:47]
 buffer_load_dwordx4 v[164:167], v246, s[8:11], s38 offen sc1
 v_mfma_f32_16x16x32_bf16 v[48:51], a[8:11], v[180:183], v[48:51]
 v_mfma_f32_16x16x32_bf16 v[52:55], a[12:15], v[180:183], v[52:55]
 v_mfma_f32_16x16x32_bf16 v[56:59], a[16:19], v[180:183], v[56:59]
 s_waitcnt vmcnt(11)
 v_mfma_f32_16x16x32_bf16 v[60:63], a[40:43], v[120:123], v[60:63]
 buffer_load_dwordx4 v[168:171], v247, s[8:11], 0 offen offset:2048 sc1
 v_mfma_f32_16x16x32_bf16 v[64:67], a[44:47], v[120:123], v[64:67]
 v_mfma_f32_16x16x32_bf16 v[68:71], a[48:51], v[120:123], v[68:71]
 s_mov_b32 m0, s83
 s_nop 0
 ds_write_addtid_b32 v40
 v_mfma_f32_16x16x32_bf16 v[72:75], a[52:55], v[120:123], v[72:75]
 ds_write_addtid_b32 v41 offset:256
 ds_write_addtid_b32 v42 offset:512
 v_mfma_f32_16x16x32_bf16 v[76:79], a[56:59], v[120:123], v[76:79]
 s_waitcnt vmcnt(11)
 ds_write_addtid_b32 v43 offset:768
 v_mfma_f32_16x16x32_bf16 v[60:63], a[60:63], v[124:127], v[60:63]
 buffer_load_dwordx4 v[172:175], v247, s[8:11], 0 offen offset:3072 sc1
 ds_write_addtid_b32 v44 offset:1024
 v_mfma_f32_16x16x32_bf16 v[64:67], a[64:67], v[124:127], v[64:67]
 ds_write_addtid_b32 v45 offset:1280
 v_mfma_f32_16x16x32_bf16 v[68:71], a[68:71], v[124:127], v[68:71]
 ds_write_addtid_b32 v46 offset:1536
 ds_write_addtid_b32 v47 offset:1792
 v_mfma_f32_16x16x32_bf16 v[72:75], a[72:75], v[124:127], v[72:75]
 ds_write_addtid_b32 v48 offset:2048
 v_mfma_f32_16x16x32_bf16 v[76:79], a[76:79], v[124:127], v[76:79]
 s_waitcnt vmcnt(11)
 ds_write_addtid_b32 v49 offset:2304
 v_mfma_f32_16x16x32_bf16 v[60:63], a[80:83], v[128:131], v[60:63]
 buffer_load_dwordx4 v[176:179], v247, s[8:11], s65 offen sc1
 ds_write_addtid_b32 v50 offset:2560
 v_mfma_f32_16x16x32_bf16 v[64:67], a[84:87], v[128:131], v[64:67]
 ds_write_addtid_b32 v51 offset:2816
 v_mfma_f32_16x16x32_bf16 v[68:71], a[88:91], v[128:131], v[68:71]
 ds_write_addtid_b32 v52 offset:3072
 ds_write_addtid_b32 v53 offset:3328
 v_mfma_f32_16x16x32_bf16 v[72:75], a[92:95], v[128:131], v[72:75]
 ds_write_addtid_b32 v54 offset:3584
 v_mfma_f32_16x16x32_bf16 v[76:79], a[96:99], v[128:131], v[76:79]
 s_waitcnt vmcnt(11)
 buffer_load_dwordx4 v[180:183], v247, s[8:11], s65 offen offset:1024 sc1
 ds_write_addtid_b32 v55 offset:3840
 v_mfma_f32_16x16x32_bf16 v[60:63], a[100:103], v[132:135], v[60:63]
 ds_write_addtid_b32 v56 offset:4096
 v_mfma_f32_16x16x32_bf16 v[64:67], a[104:107], v[132:135], v[64:67]
 ds_write_addtid_b32 v57 offset:4352
 ds_write_addtid_b32 v58 offset:4608
 v_mfma_f32_16x16x32_bf16 v[68:71], a[108:111], v[132:135], v[68:71]
 ds_write_addtid_b32 v59 offset:4864
 v_mfma_f32_16x16x32_bf16 v[72:75], a[112:115], v[132:135], v[72:75]
 v_mfma_f32_16x16x32_bf16 v[76:79], a[116:119], v[132:135], v[76:79]
 s_waitcnt vmcnt(11)
 buffer_load_dwordx4 v[120:123], v247, s[8:11], 0 offen offset:1024 sc1
 v_mfma_f32_16x16x32_bf16 v[60:63], a[20:23], v[136:139], v[60:63]
 v_mfma_f32_16x16x32_bf16 v[64:67], a[24:27], v[136:139], v[64:67]
 s_waitcnt lgkmcnt(0)
 s_barrier
 v_mfma_f32_16x16x32_bf16 v[68:71], a[28:31], v[136:139], v[68:71]
 ds_read2st64_b32 v[224:225], v249 offset0:0 offset1:1
 v_mfma_f32_16x16x32_bf16 v[72:75], a[32:35], v[136:139], v[72:75]
 buffer_load_dwordx4 v[124:127], v247, s[8:11], s38 offen sc1
 ds_read2st64_b32 v[226:227], v249 offset0:2 offset1:3
 v_mfma_f32_16x16x32_bf16 v[76:79], a[36:39], v[136:139], v[76:79]
 s_waitcnt vmcnt(12)
 v_add_u32 v38, s62, v1
 ds_read2st64_b32 v[228:229], v249 offset0:4 offset1:5
 v_mfma_f32_16x16x32_bf16 v[60:63], a[0:3], v[140:143], v[60:63]
 buffer_load_dwordx4 a[120:123], v38, s[8:11], 0 offen sc1
 ds_read2st64_b32 v[230:231], v249 offset0:6 offset1:7
 v_mfma_f32_16x16x32_bf16 v[64:67], a[4:7], v[140:143], v[64:67]
 ds_read2st64_b32 v[232:233], v249 offset0:8 offset1:9
 v_mfma_f32_16x16x32_bf16 v[68:71], a[8:11], v[140:143], v[68:71]
 ds_read2st64_b32 v[234:235], v249 offset0:10 offset1:11
 v_mfma_f32_16x16x32_bf16 v[72:75], a[12:15], v[140:143], v[72:75]
 ds_read2st64_b32 v[236:237], v249 offset0:12 offset1:13
 v_mfma_f32_16x16x32_bf16 v[76:79], a[16:19], v[140:143], v[76:79]
 s_waitcnt vmcnt(12)
 ds_read2st64_b32 v[238:239], v249 offset0:14 offset1:15
 v_mfma_f32_16x16x32_bf16 v[80:83], a[40:43], v[144:147], v[80:83]
 buffer_load_dwordx4 a[124:127], v38, s[8:11], 0 offen offset:1024 sc1
 ds_read2st64_b32 v[240:241], v249 offset0:16 offset1:17
 v_mfma_f32_16x16x32_bf16 v[84:87], a[44:47], v[144:147], v[84:87]
 ds_read2st64_b32 v[242:243], v249 offset0:18 offset1:19
 v_mfma_f32_16x16x32_bf16 v[88:91], a[48:51], v[144:147], v[88:91]
 ds_write_addtid_b32 v60 offset:5120
 v_mfma_f32_16x16x32_bf16 v[92:95], a[52:55], v[144:147], v[92:95]
 ds_write_addtid_b32 v61 offset:5376
 ds_write_addtid_b32 v62 offset:5632
 v_mfma_f32_16x16x32_bf16 v[96:99], a[56:59], v[144:147], v[96:99]
 s_waitcnt vmcnt(12) lgkmcnt(12)
 ds_write_addtid_b32 v63 offset:5888
 v_add_f32 v100, v100, v224
 v_mfma_f32_16x16x32_bf16 v[80:83], a[60:63], v[148:151], v[80:83]
 buffer_load_dwordx4 a[128:131], v38, s[8:11], 0 offen offset:2048 sc1
 ds_write_addtid_b32 v64 offset:6144
 v_mfma_f32_16x16x32_bf16 v[84:87], a[64:67], v[148:151], v[84:87]
 ds_write_addtid_b32 v65 offset:6400
 v_add_f32 v101, v101, v225
 v_mfma_f32_16x16x32_bf16 v[88:91], a[68:71], v[148:151], v[88:91]
 ds_write_addtid_b32 v66 offset:6656
 ds_write_addtid_b32 v67 offset:6912
 v_mfma_f32_16x16x32_bf16 v[92:95], a[72:75], v[148:151], v[92:95]
 s_waitcnt lgkmcnt(14)
 ds_write_addtid_b32 v68 offset:7168
 v_add_f32 v102, v102, v226
 v_mfma_f32_16x16x32_bf16 v[96:99], a[76:79], v[148:151], v[96:99]
 s_waitcnt vmcnt(12)
 ds_write_addtid_b32 v69 offset:7424
 v_add_f32 v103, v103, v227
 v_mfma_f32_16x16x32_bf16 v[80:83], a[80:83], v[152:155], v[80:83]
 buffer_load_dwordx4 a[132:135], v38, s[8:11], 0 offen offset:3072 sc1
 ds_write_addtid_b32 v70 offset:7680
 v_mfma_f32_16x16x32_bf16 v[84:87], a[84:87], v[152:155], v[84:87]
 ds_write_addtid_b32 v71 offset:7936
 v_add_f32 v104, v104, v228
 v_mfma_f32_16x16x32_bf16 v[88:91], a[88:91], v[152:155], v[88:91]
 ds_write_addtid_b32 v72 offset:8192
 ds_write_addtid_b32 v73 offset:8448
 v_mfma_f32_16x16x32_bf16 v[92:95], a[92:95], v[152:155], v[92:95]
 ds_write_addtid_b32 v74 offset:8704
 v_add_f32 v105, v105, v229
 v_mfma_f32_16x16x32_bf16 v[96:99], a[96:99], v[152:155], v[96:99]
 s_waitcnt vmcnt(12)
 ds_write_addtid_b32 v75 offset:8960
 ds_write_addtid_b32 v76 offset:9216
 v_mfma_f32_16x16x32_bf16 v[80:83], a[100:103], v[156:159], v[80:83]
 buffer_load_dwordx4 a[136:139], v38, s[8:11], s65 offen sc1
 v_add_f32 v106, v106, v230
 v_mfma_f32_16x16x32_bf16 v[84:87], a[104:107], v[156:159], v[84:87]
 ds_write_addtid_b32 v77 offset:9472
 ds_write_addtid_b32 v78 offset:9728
 v_mfma_f32_16x16x32_bf16 v[88:91], a[108:111], v[156:159], v[88:91]
 ds_write_addtid_b32 v79 offset:9984
 v_add_f32 v107, v107, v231
 v_mfma_f32_16x16x32_bf16 v[92:95], a[112:115], v[156:159], v[92:95]
 s_waitcnt lgkmcnt(15)
 v_add_f32 v108, v108, v232
 v_add_f32 v109, v109, v233
 v_mfma_f32_16x16x32_bf16 v[96:99], a[116:119], v[156:159], v[96:99]
 s_waitcnt vmcnt(12)
 v_add_f32 v110, v110, v234
 v_add_f32 v111, v111, v235
 v_mfma_f32_16x16x32_bf16 v[80:83], a[20:23], v[160:163], v[80:83]
 buffer_load_dwordx4 a[140:143], v38, s[8:11], s65 offen offset:1024 sc1
 v_add_f32 v112, v112, v236
 v_mfma_f32_16x16x32_bf16 v[84:87], a[24:27], v[160:163], v[84:87]
 s_waitcnt lgkmcnt(0)
 s_barrier
 v_add_f32 v113, v113, v237
 v_mfma_f32_16x16x32_bf16 v[88:91], a[28:31], v[160:163], v[88:91]
 ds_read2st64_b32 v[184:185], v250 offset0:20 offset1:21
 v_add_f32 v114, v114, v238
 v_mfma_f32_16x16x32_bf16 v[92:95], a[32:35], v[160:163], v[92:95]
 ds_read2st64_b32 v[186:187], v250 offset0:22 offset1:23
 v_add_f32 v115, v115, v239
 v_mfma_f32_16x16x32_bf16 v[96:99], a[36:39], v[160:163], v[96:99]
 s_waitcnt vmcnt(12)
 ds_read2st64_b32 v[188:189], v250 offset0:24 offset1:25
 v_add_f32 v116, v116, v240
 v_mfma_f32_16x16x32_bf16 v[80:83], a[0:3], v[164:167], v[80:83]
 buffer_load_dwordx4 a[144:147], v38, s[8:11], s65 offen offset:2048 sc1
 ds_read2st64_b32 v[190:191], v250 offset0:26 offset1:27
 v_mfma_f32_16x16x32_bf16 v[84:87], a[4:7], v[164:167], v[84:87]
 ds_read2st64_b32 v[192:193], v250 offset0:28 offset1:29
 v_add_f32 v117, v117, v241
 v_mfma_f32_16x16x32_bf16 v[88:91], a[8:11], v[164:167], v[88:91]
 ds_read2st64_b32 v[194:195], v250 offset0:30 offset1:31
 v_add_f32 v118, v118, v242
 v_mfma_f32_16x16x32_bf16 v[92:95], a[12:15], v[164:167], v[92:95]
 ds_read2st64_b32 v[196:197], v250 offset0:32 offset1:33
 v_add_f32 v119, v119, v243
 v_mfma_f32_16x16x32_bf16 v[96:99], a[16:19], v[164:167], v[96:99]
 s_waitcnt vmcnt(12)
 ds_read2st64_b32 v[198:199], v250 offset0:34 offset1:35
 v_mfma_f32_16x16x32_bf16 v[100:103], a[40:43], v[168:171], v[100:103]
 buffer_load_dwordx4 a[148:151], v38, s[8:11], s65 offen offset:3072 sc1
 ds_read2st64_b32 v[200:201], v250 offset0:36 offset1:37
 v_mfma_f32_16x16x32_bf16 v[104:107], a[44:47], v[168:171], v[104:107]
 ds_read2st64_b32 v[202:203], v250 offset0:38 offset1:39
 v_mfma_f32_16x16x32_bf16 v[108:111], a[48:51], v[168:171], v[108:111]
 ds_write_addtid_b32 v80
 v_mfma_f32_16x16x32_bf16 v[112:115], a[52:55], v[168:171], v[112:115]
 ds_write_addtid_b32 v81 offset:256
 ds_write_addtid_b32 v82 offset:512
 v_mfma_f32_16x16x32_bf16 v[116:119], a[56:59], v[168:171], v[116:119]
 s_waitcnt vmcnt(12)
 ds_write_addtid_b32 v83 offset:768
 v_mfma_f32_16x16x32_bf16 v[100:103], a[60:63], v[172:175], v[100:103]
 buffer_load_dwordx4 a[152:155], v38, s[8:11], s66 offen sc1
 ds_write_addtid_b32 v84 offset:1024
 v_mfma_f32_16x16x32_bf16 v[104:107], a[64:67], v[172:175], v[104:107]
 ds_write_addtid_b32 v85 offset:1280
 v_mfma_f32_16x16x32_bf16 v[108:111], a[68:71], v[172:175], v[108:111]
 ds_write_addtid_b32 v86 offset:1536
 v_mfma_f32_16x16x32_bf16 v[112:115], a[72:75], v[172:175], v[112:115]
 ds_write_addtid_b32 v87 offset:1792
 v_mfma_f32_16x16x32_bf16 v[116:119], a[76:79], v[172:175], v[116:119]
 s_waitcnt vmcnt(12)
 ds_write_addtid_b32 v88 offset:2048
 ds_write_addtid_b32 v89 offset:2304
 v_mfma_f32_16x16x32_bf16 v[100:103], a[80:83], v[176:179], v[100:103]
 ds_write_addtid_b32 v90 offset:2560
 v_mfma_f32_16x16x32_bf16 v[104:107], a[84:87], v[176:179], v[104:107]
 ds_write_addtid_b32 v91 offset:2816
 v_mfma_f32_16x16x32_bf16 v[108:111], a[88:91], v[176:179], v[108:111]
 ds_write_addtid_b32 v92 offset:3072
 ds_write_addtid_b32 v93 offset:3328
 v_mfma_f32_16x16x32_bf16 v[112:115], a[92:95], v[176:179], v[112:115]
 ds_write_addtid_b32 v94 offset:3584
 v_mfma_f32_16x16x32_bf16 v[116:119], a[96:99], v[176:179], v[116:119]
 s_waitcnt vmcnt(11)
 ds_write_addtid_b32 v95 offset:3840
 v_mfma_f32_16x16x32_bf16 v[100:103], a[100:103], v[180:183], v[100:103]
 ds_write_addtid_b32 v96 offset:4096
 v_mfma_f32_16x16x32_bf16 v[104:107], a[104:107], v[180:183], v[104:107]
 ds_write_addtid_b32 v97 offset:4352
 ds_write_addtid_b32 v98 offset:4608
 v_mfma_f32_16x16x32_bf16 v[108:111], a[108:111], v[180:183], v[108:111]
 ds_write_addtid_b32 v99 offset:4864
 v_mfma_f32_16x16x32_bf16 v[112:115], a[112:115], v[180:183], v[112:115]
 v_mfma_f32_16x16x32_bf16 v[116:119], a[116:119], v[180:183], v[116:119]
 s_waitcnt vmcnt(10)
 v_mfma_f32_16x16x32_bf16 v[100:103], a[20:23], v[120:123], v[100:103]
 v_mfma_f32_16x16x32_bf16 v[104:107], a[24:27], v[120:123], v[104:107]
 s_waitcnt lgkmcnt(0)
 s_barrier
 v_mfma_f32_16x16x32_bf16 v[108:111], a[28:31], v[120:123], v[108:111]
 ds_read2st64_b32 v[224:225], v251 offset0:0 offset1:1
 v_mfma_f32_16x16x32_bf16 v[112:115], a[32:35], v[120:123], v[112:115]
 ds_read2st64_b32 v[226:227], v251 offset0:2 offset1:3
 v_mfma_f32_16x16x32_bf16 v[116:119], a[36:39], v[120:123], v[116:119]
 s_waitcnt vmcnt(9)
 ds_read2st64_b32 v[228:229], v251 offset0:4 offset1:5
 v_mfma_f32_16x16x32_bf16 v[100:103], a[0:3], v[124:127], v[100:103]
 ds_read2st64_b32 v[230:231], v251 offset0:6 offset1:7
 v_mfma_f32_16x16x32_bf16 v[104:107], a[4:7], v[124:127], v[104:107]
 ds_read2st64_b32 v[232:233], v251 offset0:8 offset1:9
 v_mfma_f32_16x16x32_bf16 v[108:111], a[8:11], v[124:127], v[108:111]
 ds_read2st64_b32 v[234:235], v251 offset0:10 offset1:11
 v_mfma_f32_16x16x32_bf16 v[112:115], a[12:15], v[124:127], v[112:115]
 ds_read2st64_b32 v[236:237], v251 offset0:12 offset1:13
 v_mfma_f32_16x16x32_bf16 v[116:119], a[16:19], v[124:127], v[116:119]
 ds_read2st64_b32 v[238:239], v251 offset0:14 offset1:15
 ds_read2st64_b32 v[240:241], v251 offset0:16 offset1:17
 ds_read2st64_b32 v[242:243], v251 offset0:18 offset1:19
 v_pk_add_f32 v[100:101], v[100:101], v[184:185]
 v_pk_add_f32 v[102:103], v[102:103], v[186:187]
 v_pk_add_f32 v[104:105], v[104:105], v[188:189]
 v_pk_add_f32 v[106:107], v[106:107], v[190:191]
 v_pk_add_f32 v[108:109], v[108:109], v[192:193]
 v_pk_add_f32 v[110:111], v[110:111], v[194:195]
 v_pk_add_f32 v[112:113], v[112:113], v[196:197]
 v_pk_add_f32 v[114:115], v[114:115], v[198:199]
 v_pk_add_f32 v[116:117], v[116:117], v[200:201]
 v_pk_add_f32 v[118:119], v[118:119], v[202:203]
 s_waitcnt lgkmcnt(0)
 v_pk_add_f32 v[100:101], v[100:101], v[224:225]
 v_cvt_pk_bf16_f32 v28, v100, v101
 v_pk_add_f32 v[102:103], v[102:103], v[226:227]
 v_cvt_pk_bf16_f32 v29, v102, v103
 v_pk_add_f32 v[104:105], v[104:105], v[228:229]
 v_cvt_pk_bf16_f32 v30, v104, v105
 v_pk_add_f32 v[106:107], v[106:107], v[230:231]
 v_cvt_pk_bf16_f32 v31, v106, v107
 buffer_store_dwordx4 v[28:31], v1, s[8:11], s39 offen
 v_pk_add_f32 v[108:109], v[108:109], v[232:233]
 v_cvt_pk_bf16_f32 v32, v108, v109
 v_pk_add_f32 v[110:111], v[110:111], v[234:235]
 v_cvt_pk_bf16_f32 v33, v110, v111
 v_pk_add_f32 v[112:113], v[112:113], v[236:237]
 v_cvt_pk_bf16_f32 v34, v112, v113
 v_pk_add_f32 v[114:115], v[114:115], v[238:239]
 v_cvt_pk_bf16_f32 v35, v114, v115
 buffer_store_dwordx4 v[32:35], v1, s[8:11], s39 offen offset:1024
 v_pk_add_f32 v[116:117], v[116:117], v[240:241]
 v_cvt_pk_bf16_f32 v36, v116, v117
 v_pk_add_f32 v[118:119], v[118:119], v[242:243]
 v_cvt_pk_bf16_f32 v37, v118, v119
 buffer_store_dwordx2 v[36:37], v8, s[8:11], s39 offen offset:2048
 v_mov_b32 v254, 0x3f803f80
 v_dot2_f32_bf16 v252, v28, v254, 0
 v_dot2_f32_bf16 v253, v28, v28, 0
 v_dot2_f32_bf16 v252, v29, v254, v252
 v_dot2_f32_bf16 v253, v29, v29, v253
 v_dot2_f32_bf16 v252, v30, v254, v252
 v_dot2_f32_bf16 v253, v30, v30, v253
 v_dot2_f32_bf16 v252, v31, v254, v252
 v_dot2_f32_bf16 v253, v31, v31, v253
 v_dot2_f32_bf16 v252, v32, v254, v252
 v_dot2_f32_bf16 v253, v32, v32, v253
 v_dot2_f32_bf16 v252, v33, v254, v252
 v_dot2_f32_bf16 v253, v33, v33, v253
 v_dot2_f32_bf16 v252, v34, v254, v252
 v_dot2_f32_bf16 v253, v34, v34, v253
 v_dot2_f32_bf16 v252, v35, v254, v252
 v_dot2_f32_bf16 v253, v35, v35, v253
 v_dot2_f32_bf16 v252, v36, v254, v252
 v_dot2_f32_bf16 v253, v36, v36, v253
 v_dot2_f32_bf16 v252, v37, v254, v252
 v_dot2_f32_bf16 v253, v37, v37, v253
 s_nop 2
 v_permlane32_swap_b32 v252, v253
 v_add_f32 v252, v252, v253
 v_mov_b32 v254, v252
 s_nop 1
 v_permlane16_swap_b32 v252, v254
 v_add_f32 v252, v252, v254
 v_and_b32 v252, -2, v252
 buffer_store_dword v252, v9, s[8:11], s40 offen
 v_mov_b32 v27, 1
 s_waitcnt vmcnt(1)
 s_mov_b64 exec, 1
 buffer_store_dword v27, off, s[8:11], s44
 s_mov_b64 exec, -1
 v_and_b32 v230, 124, v22
 buffer_load_dword v231, v230, s[8:11], s45 offen sc1
fspin_11:
 buffer_load_dword v0, v230, s[8:11], s45 offen sc1
 s_waitcnt vmcnt(1)
 v_cmp_gt_u32 vcc, 1, v231
 s_cbranch_vccz fok_12
 buffer_load_dword v231, v230, s[8:11], s45 offen sc1
 s_waitcnt vmcnt(1)
 v_cmp_gt_u32 vcc, 1, v0
 s_cbranch_vccz fok_12
 s_add_u32 s29, s29, 1
 s_cmp_lt_u32 s29, 524288
 s_cbranch_scc1 fspin_11
fok_12:
 buffer_load_dwordx4 v[104:107], v4, s[8:11], 0 offen sc1
 buffer_load_dwordx4 v[108:111], v4, s[8:11], s69 offen sc1
 buffer_load_dwordx4 v[112:115], v4, s[8:11], 0 offen offset:1024 sc1
 buffer_load_dwordx4 v[116:119], v4, s[8:11], s69 offen offset:1024 sc1
 buffer_load_dwordx4 v[120:123], v4, s[8:11], 0 offen offset:2048 sc1
 buffer_load_dwordx4 v[124:127], v4, s[8:11], s69 offen offset:2048 sc1
 buffer_load_dwordx4 v[128:131], v4, s[8:11], 0 offen offset:3072 sc1
 buffer_load_dwordx4 v[132:135], v4, s[8:11], s69 offen offset:3072 sc1
 buffer_load_dwordx4 v[136:139], v4, s[8:11], s65 offen sc1
 buffer_load_dwordx4 v[140:143], v4, s[8:11], s70 offen sc1
 v_add_u32 v25, 81920, v1
 v_add_u32 v26, 122880, v1
 s_barrier
 ds_read_b128 v[152:155], v25
 ds_read_b128 v[156:159], v25 offset:1024
 ds_read_b128 v[160:163], v25 offset:2048
 ds_read_b128 v[164:167], v25 offset:3072
 s_mov_b32 s92, 0xffff0000
 s_mov_b32 s93, 0
 s_mov_b32 s94, -1
 s_mov_b32 s95, 0
 s_waitcnt lgkmcnt(2)
 s_waitcnt vmcnt(9)
 v_mfma_f32_16x16x32_bf16 v[40:43], v[152:155], v[104:107], 0
 s_waitcnt vmcnt(8)
 ds_read_b128 v[168:171], v25 offset:4096
 v_mfma_f32_16x16x32_bf16 v[56:59], v[152:155], v[108:111], 0
 ds_read_b128 v[172:175], v25 offset:5120
 ds_read_b128 v[176:179], v25 offset:6144
 buffer_load_dwordx4 v[208:211], v1, s[8:11], s16 offen sc1
 buffer_load_dwordx4 v[144:147], v4, s[8:11], s65 offen offset:1024 sc1
 v_mfma_f32_16x16x32_bf16 v[44:47], v[156:159], v[104:107], 0
 ds_read_b128 v[180:183], v25 offset:7168
 v_and_b32 v228, 0x3c, v22
 v_mfma_f32_16x16x32_bf16 v[60:63], v[156:159], v[108:111], 0
 s_waitcnt lgkmcnt(4)
 v_mov_b32 v185, 0
 v_mfma_f32_16x16x32_bf16 v[48:51], v[160:163], v[104:107], 0
pad6:
 s_cbranch_execz pad10
 ds_read_b128 v[152:155], v25 offset:8192
 v_mfma_f32_16x16x32_bf16 v[64:67], v[160:163], v[108:111], 0
 buffer_load_dwordx4 v[212:215], v1, s[8:11], s16 offen offset:1024 sc1
 buffer_load_dwordx4 v[148:151], v4, s[8:11], s70 offen offset:1024 sc1
 v_mfma_f32_16x16x32_bf16 v[52:55], v[164:167], v[104:107], 0
 ds_read_b128 v[156:159], v25 offset:9216
 v_mov_b32 v186, 0
 v_mfma_f32_16x16x32_bf16 v[68:71], v[164:167], v[108:111], 0
 s_waitcnt vmcnt(11) lgkmcnt(4)
 v_mfma_f32_16x16x32_bf16 v[40:43], v[168:171], v[112:115], v[40:43]
 s_waitcnt vmcnt(10)
 ds_read_b128 v[160:163], v25 offset:10240
 v_mov_b32 v187, 0
 v_mfma_f32_16x16x32_bf16 v[56:59], v[168:171], v[116:119], v[56:59]
 buffer_load_dwordx4 v[216:219], v1, s[8:11], s16 offen offset:2048 sc1
 buffer_load_dwordx4 v[104:107], v4, s[8:11], s65 offen offset:2048 sc1
 v_mfma_f32_16x16x32_bf16 v[44:47], v[172:175], v[112:115], v[44:47]
 ds_read_b128 v[164:167], v25 offset:11264
 v_mfma_f32_16x16x32_bf16 v[60:63], v[172:175], v[116:119], v[60:63]
 s_waitcnt lgkmcnt(4)
 v_mov_b32 v189, 0
 v_mfma_f32_16x16x32_bf16 v[48:51], v[176:179], v[112:115], v[48:51]
 ds_read_b128 v[168:171], v25 offset:12288
 v_mfma_f32_16x16x32_bf16 v[64:67], v[176:179], v[116:119], v[64:67]
 buffer_load_dwordx4 v[220:223], v1, s[8:11], s16 offen offset:3072 sc1
 buffer_load_dwordx4 v[108:111], v4, s[8:11], s70 offen offset:2048 sc1
 v_mfma_f32_16x16x32_bf16 v[52:55], v[180:183], v[112:115], v[52:55]
 ds_read_b128 v[172:175], v25 offset:13312
 v_mov_b32 v190, 0
 v_mfma_f32_16x16x32_bf16 v[68:71], v[180:183], v[116:119], v[68:71]
 s_waitcnt vmcnt(13) lgkmcnt(4)
 v_mov_b32 v191, 0
 v_mfma_f32_16x16x32_bf16 v[40:43], v[152:155], v[120:123], v[40:43]
 s_waitcnt vmcnt(12)
 ds_read_b128 v[176:179], v25 offset:14336
 v_mfma_f32_16x16x32_bf16 v[56:59], v[152:155], v[124:127], v[56:59]
 buffer_load_dwordx4 v[112:115], v4, s[8:11], s65 offen offset:3072 sc1
 v_mov_b32 v193, 0
 v_mfma_f32_16x16x32_bf16 v[44:47], v[156:159], v[120:123], v[44:47]
 ds_read_b128 v[180:183], v25 offset:15360
 v_mfma_f32_16x16x32_bf16 v[60:63], v[156:159], v[124:127], v[60:63]
 s_waitcnt lgkmcnt(4)
 v_mov_b32 v194, 0
 v_mfma_f32_16x16x32_bf16 v[48:51], v[160:163], v[120:123], v[48:51]
 ds_read_b128 v[152:155], v25 offset:16384
 v_mfma_f32_16x16x32_bf16 v[64:67], v[160:163], v[124:127], v[64:67]
 buffer_load_dwordx4 v[116:119], v4, s[8:11], s70 offen offset:3072 sc1
 v_mov_b32 v195, 0
 v_mfma_f32_16x16x32_bf16 v[52:55], v[164:167], v[120:123], v[52:55]
 ds_read_b128 v[156:159], v25 offset:17408
 v_mfma_f32_16x16x32_bf16 v[68:71], v[164:167], v[124:127], v[68:71]
 s_waitcnt vmcnt(13) lgkmcnt(4)
 v_mov_b32 v197, 0
 v_mfma_f32_16x16x32_bf16 v[40:43], v[168:171], v[128:131], v[40:43]
 s_waitcnt vmcnt(12)
 ds_read_b128 v[160:163], v25 offset:18432
 v_mfma_f32_16x16x32_bf16 v[56:59], v[168:171], v[132:135], v[56:59]
 buffer_load_dwordx4 v[120:123], v4, s[8:11], s66 offen sc1
 v_mov_b32 v198, 0
 v_mfma_f32_16x16x32_bf16 v[44:47], v[172:175], v[128:131], v[44:47]
 ds_read_b128 v[164:167], v25 offset:19456
 v_mfma_f32_16x16x32_bf16 v[60:63], v[172:175], v[132:135], v[60:63]
 s_waitcnt lgkmcnt(4)
 v_mov_b32 v199, 0
 v_mfma_f32_16x16x32_bf16 v[48:51], v[176:179], v[128:131], v[48:51]
 ds_read_b128 v[168:171], v25 offset:20480
 v_mfma_f32_16x16x32_bf16 v[64:67], v[176:179], v[132:135], v[64:67]
 buffer_load_dwordx4 v[124:127], v4, s[8:11], s71 offen sc1
 v_mov_b32 v201, 0
 v_mfma_f32_16x16x32_bf16 v[52:55], v[180:183], v[128:131], v[52:55]
 ds_read_b128 v[172:175], v25 offset:21504
 v_mfma_f32_16x16x32_bf16 v[68:71], v[180:183], v[132:135], v[68:71]
 s_waitcnt vmcnt(13) lgkmcnt(4)
 v_mov_b32 v202, 0
 v_mfma_f32_16x16x32_bf16 v[40:43], v[152:155], v[136:139], v[40:43]
 s_waitcnt vmcnt(12)
 ds_read_b128 v[176:179], v25 offset:22528
 v_mfma_f32_16x16x32_bf16 v[56:59], v[152:155], v[140:143], v[56:59]
 buffer_load_dwordx4 v[128:131], v4, s[8:11], s66 offen offset:1024 sc1
 v_mov_b32 v203, 0
 v_mfma_f32_16x16x32_bf16 v[44:47], v[156:159], v[136:139], v[44:47]
 ds_read_b128 v[180:183], v25 offset:23552
 v_mfma_f32_16x16x32_bf16 v[60:63], v[156:159], v[140:143], v[60:63]
 s_waitcnt lgkmcnt(4)
 v_mov_b32 v205, 0
 v_mfma_f32_16x16x32_bf16 v[48:51], v[160:163], v[136:139], v[48:51]
 ds_read_b128 v[152:155], v25 offset:24576
 v_mfma_f32_16x16x32_bf16 v[64:67], v[160:163], v[140:143], v[64:67]
 buffer_load_dwordx4 v[132:135], v4, s[8:11], s71 offen offset:1024 sc1
 v_mov_b32 v206, 0
 v_mfma_f32_16x16x32_bf16 v[52:55], v[164:167], v[136:139], v[52:55]
 ds_read_b128 v[156:159], v25 offset:25600
 v_mfma_f32_16x16x32_bf16 v[68:71], v[164:167], v[140:143], v[68:71]
 s_waitcnt vmcnt(12) lgkmcnt(4)
 v_mov_b32 v207, 0
 v_mfma_f32_16x16x32_bf16 v[40:43], v[168:171], v[144:147], v[40:43]
 s_waitcnt vmcnt(10)
 ds_read_b128 v[160:163], v25 offset:26624
 v_mfma_f32_16x16x32_bf16 v[56:59], v[168:171], v[148:151], v[56:59]
 buffer_load_dwordx4 v[136:139], v4, s[8:11], s66 offen offset:2048 sc1
 v_mfma_f32_16x16x32_bf16 v[44:47], v[172:175], v[144:147], v[44:47]
 ds_read_b128 v[164:167], v25 offset:27648
 v_mfma_f32_16x16x32_bf16 v[60:63], v[172:175], v[148:151], v[60:63]
 s_waitcnt lgkmcnt(4)
 v_mfma_f32_16x16x32_bf16 v[48:51], v[176:179], v[144:147], v[48:51]
 ds_read_b128 v[168:171], v25 offset:28672
 v_mfma_f32_16x16x32_bf16 v[64:67], v[176:179], v[148:151], v[64:67]
 buffer_load_dwordx4 v[140:143], v4, s[8:11], s71 offen offset:2048 sc1
 v_mfma_f32_16x16x32_bf16 v[52:55], v[180:183], v[144:147], v[52:55]
 ds_read_b128 v[172:175], v25 offset:29696
 v_mfma_f32_16x16x32_bf16 v[68:71], v[180:183], v[148:151], v[68:71]
 s_waitcnt vmcnt(10) lgkmcnt(4)
 v_mfma_f32_16x16x32_bf16 v[40:43], v[152:155], v[104:107], v[40:43]
 s_waitcnt vmcnt(8)
 ds_read_b128 v[176:179], v25 offset:30720
 v_mfma_f32_16x16x32_bf16 v[56:59], v[152:155], v[108:111], v[56:59]
 buffer_load_dwordx4 v[144:147], v4, s[8:11], s66 offen offset:3072 sc1
 v_mfma_f32_16x16x32_bf16 v[44:47], v[156:159], v[104:107], v[44:47]
 ds_read_b128 v[180:183], v25 offset:31744
 v_mfma_f32_16x16x32_bf16 v[60:63], v[156:159], v[108:111], v[60:63]
 s_waitcnt lgkmcnt(4)
 v_mfma_f32_16x16x32_bf16 v[48:51], v[160:163], v[104:107], v[48:51]
 ds_read_b128 v[152:155], v25 offset:32768
 v_mfma_f32_16x16x32_bf16 v[64:67], v[160:163], v[108:111], v[64:67]
 buffer_load_dwordx4 v[148:151], v4, s[8:11], s71 offen offset:3072 sc1
 v_mfma_f32_16x16x32_bf16 v[52:55], v[164:167], v[104:107], v[52:55]
 ds_read_b128 v[156:159], v25 offset:33792
 v_mfma_f32_16x16x32_bf16 v[68:71], v[164:167], v[108:111], v[68:71]
 s_waitcnt vmcnt(9) lgkmcnt(4)
 v_mfma_f32_16x16x32_bf16 v[40:43], v[168:171], v[112:115], v[40:43]
 s_waitcnt vmcnt(8)
 ds_read_b128 v[160:163], v25 offset:34816
 v_or_b32 v229, v208, v209
 v_mfma_f32_16x16x32_bf16 v[56:59], v[168:171], v[116:119], v[56:59]
 buffer_load_dwordx4 v[104:107], v4, s[8:11], s67 offen sc1
 v_or3_b32 v229, v229, v210, v211
 v_mfma_f32_16x16x32_bf16 v[44:47], v[172:175], v[112:115], v[44:47]
 ds_read_b128 v[164:167], v25 offset:35840
 v_or3_b32 v229, v229, v212, v213
 v_mfma_f32_16x16x32_bf16 v[60:63], v[172:175], v[116:119], v[60:63]
 s_waitcnt lgkmcnt(4)
 v_or3_b32 v229, v229, v214, v215
 v_or3_b32 v229, v229, v216, v217
 v_or3_b32 v229, v229, v218, v219
 v_mfma_f32_16x16x32_bf16 v[48:51], v[176:179], v[112:115], v[48:51]
 ds_read_b128 v[168:171], v25 offset:36864
 v_or3_b32 v229, v229, v220, v221
 v_mfma_f32_16x16x32_bf16 v[64:67], v[176:179], v[116:119], v[64:67]
 buffer_load_dwordx4 v[108:111], v4, s[8:11], s72 offen sc1
 v_or3_b32 v229, v229, v222, v223
 v_mfma_f32_16x16x32_bf16 v[52:55], v[180:183], v[112:115], v[52:55]
 ds_read_b128 v[172:175], v25 offset:37888
 v_and_b32 v229, 1, v229
 v_mfma_f32_16x16x32_bf16 v[68:71], v[180:183], v[116:119], v[68:71]
 v_cmp_ne_u32 vcc, 0, v229
 s_cbranch_vccnz fretry_13
fback_14:
 v_add_f32 v208, v208, v209
 s_waitcnt lgkmcnt(4)
 s_waitcnt vmcnt(9)
 v_mfma_f32_16x16x32_bf16 v[40:43], v[152:155], v[120:123], v[40:43]
 s_waitcnt vmcnt(8)
 ds_read_b128 v[176:179], v25 offset:38912
 v_add_f32 v212, v212, v213
 v_mfma_f32_16x16x32_bf16 v[56:59], v[152:155], v[124:127], v[56:59]
 buffer_load_dwordx4 v[112:115], v4, s[8:11], s67 offen offset:1024 sc1
 v_add_f32 v210, v210, v211
 v_mfma_f32_16x16x32_bf16 v[44:47], v[156:159], v[120:123], v[44:47]
 ds_read_b128 v[180:183], v25 offset:39936
 v_add_f32 v214, v214, v215
 v_mfma_f32_16x16x32_bf16 v[60:63], v[156:159], v[124:127], v[60:63]
 s_waitcnt lgkmcnt(4)
 v_add_f32 v210, v210, v208
 v_add_f32 v214, v214, v212
 v_mfma_f32_16x16x32_bf16 v[48:51], v[160:163], v[120:123], v[48:51]
 ds_read_b128 v[152:155], v26
 v_mov_b32 v211, v210
 v_mfma_f32_16x16x32_bf16 v[64:67], v[160:163], v[124:127], v[64:67]
 buffer_load_dwordx4 v[116:119], v4, s[8:11], s72 offen offset:1024 sc1
 v_mov_b32 v215, v214
 v_mfma_f32_16x16x32_bf16 v[52:55], v[164:167], v[120:123], v[52:55]
 ds_read_b128 v[156:159], v26 offset:1024
 v_permlane16_swap_b32 v210, v211
 v_mfma_f32_16x16x32_bf16 v[68:71], v[164:167], v[124:127], v[68:71]
 s_waitcnt vmcnt(9) lgkmcnt(4)
 v_permlane16_swap_b32 v214, v215
 v_mfma_f32_16x16x32_bf16 v[40:43], v[168:171], v[128:131], v[40:43]
 s_waitcnt vmcnt(8)
 ds_read_b128 v[160:163], v26 offset:2048
 v_add_f32 v210, v210, v211
 v_mfma_f32_16x16x32_bf16 v[56:59], v[168:171], v[132:135], v[56:59]
 buffer_load_dwordx4 v[120:123], v4, s[8:11], s67 offen offset:2048 sc1
 v_add_f32 v214, v214, v215
 v_mfma_f32_16x16x32_bf16 v[44:47], v[172:175], v[128:131], v[44:47]
 ds_read_b128 v[164:167], v26 offset:3072
 v_mov_b32 v211, v210
 v_mfma_f32_16x16x32_bf16 v[60:63], v[172:175], v[132:135], v[60:63]
 s_waitcnt lgkmcnt(4)
 v_mov_b32 v215, v214
 v_permlane32_swap_b32 v210, v211
 v_mfma_f32_16x16x32_bf16 v[48:51], v[176:179], v[128:131], v[48:51]
 ds_read_b128 v[168:171], v26 offset:4096
 v_mfma_f32_16x16x32_bf16 v[64:67], v[176:179], v[132:135], v[64:67]
 buffer_load_dwordx4 v[124:127], v4, s[8:11], s72 offen offset:2048 sc1
 v_permlane32_swap_b32 v214, v215
 v_mfma_f32_16x16x32_bf16 v[52:55], v[180:183], v[128:131], v[52:55]
 ds_read_b128 v[172:175], v26 offset:5120
 v_mul_f32 v209, 0xbacccccd, v210
 v_mfma_f32_16x16x32_bf16 v[68:71], v[180:183], v[132:135], v[68:71]
 s_waitcnt vmcnt(9) lgkmcnt(4)
 v_mul_f32 v213, 0xbacccccd, v214
 v_mul_f32 v210, v209, v209
 v_mfma_f32_16x16x32_bf16 v[40:43], v[152:155], v[136:139], v[40:43]
 s_waitcnt vmcnt(8)
 ds_read_b128 v[176:179], v26 offset:6144
 v_mul_f32 v214, v213, v213
 v_mfma_f32_16x16x32_bf16 v[56:59], v[152:155], v[140:143], v[56:59]
 buffer_load_dwordx4 v[128:131], v4, s[8:11], s67 offen offset:3072 sc1
 v_fmac_f32 v210, 0xbacccccd, v211
 v_mfma_f32_16x16x32_bf16 v[44:47], v[156:159], v[136:139], v[44:47]
 ds_read_b128 v[180:183], v26 offset:7168
 v_fmac_f32 v214, 0xbacccccd, v215
 v_mfma_f32_16x16x32_bf16 v[60:63], v[156:159], v[140:143], v[60:63]
 s_waitcnt lgkmcnt(4)
 v_min_f32 v210, 0, v210
 v_min_f32 v214, 0, v214
 v_mfma_f32_16x16x32_bf16 v[48:51], v[160:163], v[136:139], v[48:51]
 ds_read_b128 v[152:155], v26 offset:8192
 v_sub_f32 v210, 0x3727c5ac, v210
 v_sub_f32 v214, 0x3727c5ac, v214
 v_mfma_f32_16x16x32_bf16 v[64:67], v[160:163], v[140:143], v[64:67]
 buffer_load_dwordx4 v[132:135], v4, s[8:11], s72 offen offset:3072 sc1
 v_mfma_f32_16x16x32_bf16 v[52:55], v[164:167], v[136:139], v[52:55]
 ds_read_b128 v[156:159], v26 offset:9216
 v_rsq_f32 v208, v210
 v_mfma_f32_16x16x32_bf16 v[68:71], v[164:167], v[140:143], v[68:71]
 s_waitcnt vmcnt(9) lgkmcnt(4)
 v_rsq_f32 v212, v214
 v_mfma_f32_16x16x32_bf16 v[40:43], v[168:171], v[144:147], v[40:43]
 s_waitcnt vmcnt(8)
 ds_read_b128 v[160:163], v26 offset:10240
 v_cvt_pk_bf16_f32 v210, v209, v209
 v_mfma_f32_16x16x32_bf16 v[56:59], v[168:171], v[148:151], v[56:59]
 buffer_load_dwordx4 v[136:139], v4, s[8:11], s68 offen sc1
 v_cvt_pk_bf16_f32 v214, v213, v213
 v_mfma_f32_16x16x32_bf16 v[44:47], v[172:175], v[144:147], v[44:47]
 ds_read_b128 v[164:167], v26 offset:11264
 v_and_b32 v210, 0xffff0000, v210
 v_mfma_f32_16x16x32_bf16 v[60:63], v[172:175], v[148:151], v[60:63]
 s_waitcnt lgkmcnt(4)
 v_and_b32 v214, 0xffff0000, v214
 v_cndmask_b32 v210, 0, v210, s[92:93]
 v_mfma_f32_16x16x32_bf16 v[48:51], v[176:179], v[144:147], v[48:51]
 ds_read_b128 v[168:171], v26 offset:12288
 v_cndmask_b32 v214, 0, v214, s[92:93]
 v_sub_f32 v210, v209, v210
 v_mfma_f32_16x16x32_bf16 v[64:67], v[176:179], v[148:151], v[64:67]
 buffer_load_dwordx4 v[140:143], v4, s[8:11], s73 offen sc1
 v_sub_f32 v214, v213, v214
 v_mfma_f32_16x16x32_bf16 v[52:55], v[180:183], v[144:147], v[52:55]
 ds_read_b128 v[172:175], v26 offset:13312
 v_cndmask_b32 v210, 0, v210, s[94:95]
 v_mfma_f32_16x16x32_bf16 v[68:71], v[180:183], v[148:151], v[68:71]
 s_waitcnt vmcnt(9) lgkmcnt(4)
 v_cndmask_b32 v214, 0, v214, s[94:95]
 v_cvt_pk_bf16_f32 v184, v210, v210
 v_mfma_f32_16x16x32_bf16 v[40:43], v[152:155], v[104:107], v[40:43]
 s_waitcnt vmcnt(8)
 ds_read_b128 v[176:179], v26 offset:14336
 v_cvt_pk_bf16_f32 v188, v214, v214
 v_mfma_f32_16x16x32_bf16 v[56:59], v[152:155], v[108:111], v[56:59]
 buffer_load_dwordx4 v[144:147], v4, s[8:11], s68 offen offset:1024 sc1
 v_cndmask_b32 v209, 1.0, v208, s[92:93]
 v_mfma_f32_16x16x32_bf16 v[44:47], v[156:159], v[104:107], v[44:47]
 ds_read_b128 v[180:183], v26 offset:15360
 v_cndmask_b32 v213, 1.0, v212, s[92:93]
 v_mfma_f32_16x16x32_bf16 v[60:63], v[156:159], v[108:111], v[60:63]
 s_waitcnt lgkmcnt(4)
 v_add_f32 v216, v216, v217
 v_add_f32 v220, v220, v221
 v_mfma_f32_16x16x32_bf16 v[48:51], v[160:163], v[104:107], v[48:51]
 ds_read_b128 v[152:155], v26 offset:16384
 v_add_f32 v218, v218, v219
 v_add_f32 v222, v222, v223
 v_mfma_f32_16x16x32_bf16 v[64:67], v[160:163], v[108:111], v[64:67]
 buffer_load_dwordx4 v[148:151], v4, s[8:11], s73 offen offset:1024 sc1
 v_add_f32 v218, v218, v216
 v_mfma_f32_16x16x32_bf16 v[52:55], v[164:167], v[104:107], v[52:55]
 ds_read_b128 v[156:159], v26 offset:17408
 v_add_f32 v222, v222, v220
 v_mfma_f32_16x16x32_bf16 v[68:71], v[164:167], v[108:111], v[68:71]
 s_waitcnt vmcnt(9) lgkmcnt(4)
 v_mov_b32 v219, v218
 v_mov_b32 v223, v222
 v_mfma_f32_16x16x32_bf16 v[40:43], v[168:171], v[112:115], v[40:43]
 s_waitcnt vmcnt(8)
 ds_read_b128 v[160:163], v26 offset:18432
 v_permlane16_swap_b32 v218, v219
 v_mfma_f32_16x16x32_bf16 v[56:59], v[168:171], v[116:119], v[56:59]
 buffer_load_dwordx4 v[104:107], v4, s[8:11], s68 offen offset:2048 sc1
 v_mfma_f32_16x16x32_bf16 v[44:47], v[172:175], v[112:115], v[44:47]
 ds_read_b128 v[164:167], v26 offset:19456
 v_permlane16_swap_b32 v222, v223
 v_mfma_f32_16x16x32_bf16 v[60:63], v[172:175], v[116:119], v[60:63]
 s_waitcnt lgkmcnt(4)
 v_add_f32 v218, v218, v219
 v_add_f32 v222, v222, v223
 v_mfma_f32_16x16x32_bf16 v[48:51], v[176:179], v[112:115], v[48:51]
 ds_read_b128 v[168:171], v26 offset:20480
 v_mov_b32 v219, v218
 v_mfma_f32_16x16x32_bf16 v[64:67], v[176:179], v[116:119], v[64:67]
 buffer_load_dwordx4 v[108:111], v4, s[8:11], s73 offen offset:2048 sc1
 v_mov_b32 v223, v222
 v_mfma_f32_16x16x32_bf16 v[52:55], v[180:183], v[112:115], v[52:55]
 ds_read_b128 v[172:175], v26 offset:21504
 v_mfma_f32_16x16x32_bf16 v[68:71], v[180:183], v[116:119], v[68:71]
 s_waitcnt vmcnt(9) lgkmcnt(4)
 v_permlane32_swap_b32 v218, v219
 v_permlane32_swap_b32 v222, v223
 v_mfma_f32_16x16x32_bf16 v[40:43], v[152:155], v[120:123], v[40:43]
 s_waitcnt vmcnt(8)
 ds_read_b128 v[176:179], v26 offset:22528
 v_mfma_f32_16x16x32_bf16 v[56:59], v[152:155], v[124:127], v[56:59]
 buffer_load_dwordx4 v[112:115], v4, s[8:11], s68 offen offset:3072 sc1
 v_mul_f32 v217, 0xbacccccd, v218
 v_mfma_f32_16x16x32_bf16 v[44:47], v[156:159], v[120:123], v[44:47]
 ds_read_b128 v[180:183], v26 offset:23552
 v_mul_f32 v221, 0xbacccccd, v222
 v_mfma_f32_16x16x32_bf16 v[60:63], v[156:159], v[124:127], v[60:63]
 s_waitcnt lgkmcnt(4)
 v_mul_f32 v218, v217, v217
 v_mul_f32 v222, v221, v221
 v_fmac_f32 v218, 0xbacccccd, v219
 v_mfma_f32_16x16x32_bf16 v[48:51], v[160:163], v[120:123], v[48:51]
 ds_read_b128 v[152:155], v26 offset:24576
 v_fmac_f32 v222, 0xbacccccd, v223
 v_mfma_f32_16x16x32_bf16 v[64:67], v[160:163], v[124:127], v[64:67]
 buffer_load_dwordx4 v[116:119], v4, s[8:11], s73 offen offset:3072 sc1
 v_min_f32 v218, 0, v218
 v_mfma_f32_16x16x32_bf16 v[52:55], v[164:167], v[120:123], v[52:55]
 ds_read_b128 v[156:159], v26 offset:25600
 v_min_f32 v222, 0, v222
 v_mfma_f32_16x16x32_bf16 v[68:71], v[164:167], v[124:127], v[68:71]
 s_waitcnt vmcnt(9) lgkmcnt(4)
 v_sub_f32 v218, 0x3727c5ac, v218
 v_sub_f32 v222, 0x3727c5ac, v222
 v_mfma_f32_16x16x32_bf16 v[40:43], v[168:171], v[128:131], v[40:43]
 s_waitcnt vmcnt(8)
 ds_read_b128 v[160:163], v26 offset:26624
 v_rsq_f32 v216, v218
 v_mfma_f32_16x16x32_bf16 v[56:59], v[168:171], v[132:135], v[56:59]
 buffer_load_dwordx4 v[120:123], v5, s[8:11], 0 offen sc1
 v_mfma_f32_16x16x32_bf16 v[44:47], v[172:175], v[128:131], v[44:47]
 ds_read_b128 v[164:167], v26 offset:27648
 v_rsq_f32 v220, v222
 v_mfma_f32_16x16x32_bf16 v[60:63], v[172:175], v[132:135], v[60:63]
 s_waitcnt lgkmcnt(4)
 v_cvt_pk_bf16_f32 v218, v217, v217
 v_cvt_pk_bf16_f32 v222, v221, v221
 v_mfma_f32_16x16x32_bf16 v[48:51], v[176:179], v[128:131], v[48:51]
 ds_read_b128 v[168:171], v26 offset:28672
 v_and_b32 v218, 0xffff0000, v218
 v_mfma_f32_16x16x32_bf16 v[64:67], v[176:179], v[132:135], v[64:67]
 buffer_load_dwordx4 v[124:127], v5, s[8:11], s69 offen sc1
 v_and_b32 v222, 0xffff0000, v222
 v_mfma_f32_16x16x32_bf16 v[52:55], v[180:183], v[128:131], v[52:55]
 ds_read_b128 v[172:175], v26 offset:29696
 v_cndmask_b32 v218, 0, v218, s[92:93]
 v_mfma_f32_16x16x32_bf16 v[68:71], v[180:183], v[132:135], v[68:71]
 s_waitcnt vmcnt(9) lgkmcnt(4)
 v_cndmask_b32 v222, 0, v222, s[92:93]
 v_sub_f32 v218, v217, v218
 v_mfma_f32_16x16x32_bf16 v[40:43], v[152:155], v[136:139], v[40:43]
 s_waitcnt vmcnt(8)
 ds_read_b128 v[176:179], v26 offset:30720
 v_sub_f32 v222, v221, v222
 v_mfma_f32_16x16x32_bf16 v[56:59], v[152:155], v[140:143], v[56:59]
 buffer_load_dwordx4 v[128:131], v5, s[8:11], 0 offen offset:1024 sc1
 ds_read_b32 v200, v228
 v_mfma_f32_16x16x32_bf16 v[44:47], v[156:159], v[136:139], v[44:47]
 ds_read_b128 v[180:183], v26 offset:31744
 v_cndmask_b32 v218, 0, v218, s[94:95]
 v_cndmask_b32 v222, 0, v222, s[94:95]
 v_mfma_f32_16x16x32_bf16 v[60:63], v[156:159], v[140:143], v[60:63]
 s_waitcnt lgkmcnt(5)
 v_cvt_pk_bf16_f32 v192, v218, v218
 v_cvt_pk_bf16_f32 v196, v222, v222
 v_mfma_f32_16x16x32_bf16 v[48:51], v[160:163], v[136:139], v[48:51]
 ds_read_b128 v[152:155], v26 offset:32768
 v_cndmask_b32 v217, 1.0, v216, s[92:93]
 v_mfma_f32_16x16x32_bf16 v[64:67], v[160:163], v[140:143], v[64:67]
 buffer_load_dwordx4 v[132:135], v5, s[8:11], s69 offen offset:1024 sc1
 v_cndmask_b32 v221, 1.0, v220, s[92:93]
 v_mfma_f32_16x16x32_bf16 v[52:55], v[164:167], v[136:139], v[52:55]
 ds_read_b128 v[156:159], v26 offset:33792
 v_mfma_f32_16x16x32_bf16 v[68:71], v[164:167], v[140:143], v[68:71]
 s_waitcnt lgkmcnt(3)
 v_mfma_f32_16x16x32_bf16 v[40:43], v[200:203], v[184:187], v[40:43]
 s_mov_b32 s93, 0xffff0000
 v_mfma_f32_16x16x32_bf16 v[56:59], v[200:203], v[188:191], v[56:59]
 v_cndmask_b32 v225, v208, v212, s[92:93]
 v_mfma_f32_16x16x32_bf16 v[72:75], v[200:203], v[192:195], 0
 v_mfma_f32_16x16x32_bf16 v[88:91], v[200:203], v[196:199], 0
 s_waitcnt vmcnt(9)
 v_mul_f32 v225, 0x3fb8aa3b, v225
 v_mfma_f32_16x16x32_bf16 v[40:43], v[168:171], v[144:147], v[40:43]
 s_waitcnt vmcnt(8)
 ds_read_b128 v[160:163], v26 offset:34816
 v_mfma_f32_16x16x32_bf16 v[56:59], v[168:171], v[148:151], v[56:59]
 buffer_load_dwordx4 v[136:139], v5, s[8:11], 0 offen offset:2048 sc1
 ds_read_b32 v204, v228 offset:64
 v_mfma_f32_16x16x32_bf16 v[44:47], v[172:175], v[144:147], v[44:47]
 ds_read_b128 v[164:167], v26 offset:35840
 v_mfma_f32_16x16x32_bf16 v[60:63], v[172:175], v[148:151], v[60:63]
 s_waitcnt lgkmcnt(5)
 v_cndmask_b32 v227, v216, v220, s[92:93]
 v_mfma_f32_16x16x32_bf16 v[48:51], v[176:179], v[144:147], v[48:51]
 ds_read_b128 v[168:171], v26 offset:36864
 v_mfma_f32_16x16x32_bf16 v[64:67], v[176:179], v[148:151], v[64:67]
 buffer_load_dwordx4 v[140:143], v5, s[8:11], s69 offen offset:2048 sc1
 v_mfma_f32_16x16x32_bf16 v[52:55], v[180:183], v[144:147], v[52:55]
 ds_read_b128 v[172:175], v26 offset:37888
 v_mfma_f32_16x16x32_bf16 v[68:71], v[180:183], v[148:151], v[68:71]
 s_waitcnt lgkmcnt(3)
 v_mul_f32 v227, 0x3fb8aa3b, v227
 v_mfma_f32_16x16x32_bf16 v[44:47], v[204:207], v[184:187], v[44:47]
 v_mfma_f32_16x16x32_bf16 v[60:63], v[204:207], v[188:191], v[60:63]
 v_mfma_f32_16x16x32_bf16 v[76:79], v[204:207], v[192:195], 0
 v_mfma_f32_16x16x32_bf16 v[92:95], v[204:207], v[196:199], 0
 s_waitcnt vmcnt(9)
 v_mfma_f32_16x16x32_bf16 v[40:43], v[152:155], v[104:107], v[40:43]
 s_waitcnt vmcnt(8)
 ds_read_b128 v[176:179], v26 offset:38912
 v_mfma_f32_16x16x32_bf16 v[56:59], v[152:155], v[108:111], v[56:59]
 buffer_load_dwordx4 v[144:147], v5, s[8:11], 0 offen offset:3072 sc1
 ds_read_b32 v200, v228 offset:128
 v_mfma_f32_16x16x32_bf16 v[44:47], v[156:159], v[104:107], v[44:47]
 ds_read_b128 v[180:183], v26 offset:39936
 v_mfma_f32_16x16x32_bf16 v[60:63], v[156:159], v[108:111], v[60:63]
 s_waitcnt lgkmcnt(5)
 v_mfma_f32_16x16x32_bf16 v[48:51], v[160:163], v[104:107], v[48:51]
 ds_read_b128 v[152:155], v25
 v_mfma_f32_16x16x32_bf16 v[64:67], v[160:163], v[108:111], v[64:67]
 buffer_load_dwordx4 v[148:151], v5, s[8:11], s69 offen offset:3072 sc1
 v_mfma_f32_16x16x32_bf16 v[52:55], v[164:167], v[104:107], v[52:55]
 ds_read_b128 v[156:159], v25 offset:1024
 v_mfma_f32_16x16x32_bf16 v[68:71], v[164:167], v[108:111], v[68:71]
 s_waitcnt lgkmcnt(3)
 v_mfma_f32_16x16x32_bf16 v[48:51], v[200:203], v[184:187], v[48:51]
 v_mfma_f32_16x16x32_bf16 v[64:67], v[200:203], v[188:191], v[64:67]
 v_mfma_f32_16x16x32_bf16 v[80:83], v[200:203], v[192:195], 0
 v_mfma_f32_16x16x32_bf16 v[96:99], v[200:203], v[196:199], 0
 s_waitcnt vmcnt(9)
 v_mfma_f32_16x16x32_bf16 v[40:43], v[168:171], v[112:115], v[40:43]
 s_waitcnt vmcnt(8)
 ds_read_b128 v[160:163], v25 offset:2048
 v_mfma_f32_16x16x32_bf16 v[56:59], v[168:171], v[116:119], v[56:59]
 buffer_load_dwordx4 v[104:107], v5, s[8:11], s65 offen sc1
 ds_read_b32 v204, v228 offset:192
 v_mfma_f32_16x16x32_bf16 v[44:47], v[172:175], v[112:115], v[44:47]
 ds_read_b128 v[164:167], v25 offset:3072
 v_mfma_f32_16x16x32_bf16 v[60:63], v[172:175], v[116:119], v[60:63]
 s_waitcnt lgkmcnt(5)
 v_mfma_f32_16x16x32_bf16 v[48:51], v[176:179], v[112:115], v[48:51]
 ds_read_b128 v[168:171], v25 offset:4096
 v_mfma_f32_16x16x32_bf16 v[64:67], v[176:179], v[116:119], v[64:67]
 buffer_load_dwordx4 v[108:111], v5, s[8:11], s70 offen sc1
 v_mfma_f32_16x16x32_bf16 v[52:55], v[180:183], v[112:115], v[52:55]
 ds_read_b128 v[172:175], v25 offset:5120
 v_mfma_f32_16x16x32_bf16 v[68:71], v[180:183], v[116:119], v[68:71]
 s_waitcnt lgkmcnt(3)
 v_mfma_f32_16x16x32_bf16 v[52:55], v[204:207], v[184:187], v[52:55]
 v_mfma_f32_16x16x32_bf16 v[68:71], v[204:207], v[188:191], v[68:71]
 v_mfma_f32_16x16x32_bf16 v[84:87], v[204:207], v[192:195], 0
 v_mfma_f32_16x16x32_bf16 v[100:103], v[204:207], v[196:199], 0
 s_waitcnt vmcnt(9)
 v_mfma_f32_16x16x32_bf16 v[72:75], v[152:155], v[120:123], v[72:75]
 s_waitcnt vmcnt(8)
 ds_read_b128 v[176:179], v25 offset:6144
 buffer_load_dwordx4 v[112:115], v5, s[8:11], s65 offen offset:1024 sc1
 v_mfma_f32_16x16x32_bf16 v[88:91], v[152:155], v[124:127], v[88:91]
 v_mfma_f32_16x16x32_bf16 v[76:79], v[156:159], v[120:123], v[76:79]
 v_mfma_f32_16x16x32_bf16 v[92:95], v[156:159], v[124:127], v[92:95]
 s_waitcnt lgkmcnt(3)
 ds_read_b128 v[180:183], v25 offset:7168
 ds_read_b128 v[152:155], v25 offset:8192
 v_mfma_f32_16x16x32_bf16 v[80:83], v[160:163], v[120:123], v[80:83]
 v_cvt_pk_bf16_f32 v236, v40, v41
 v_cvt_pk_bf16_f32 v237, v42, v43
 v_mfma_f32_16x16x32_bf16 v[96:99], v[160:163], v[124:127], v[96:99]
 ds_read_b128 v[156:159], v25 offset:9216
 buffer_load_dwordx4 v[116:119], v5, s[8:11], s70 offen offset:1024 sc1
 v_mfma_f32_16x16x32_bf16 v[84:87], v[164:167], v[120:123], v[84:87]
 v_cvt_pk_bf16_f32 v238, v56, v57
 v_cvt_pk_bf16_f32 v239, v58, v59
 v_mfma_f32_16x16x32_bf16 v[100:103], v[164:167], v[124:127], v[100:103]
 s_waitcnt vmcnt(9) lgkmcnt(4)
 v_mul_f32 v52, v52, v209
 v_mul_f32 v53, v53, v209
 v_mfma_f32_16x16x32_bf16 v[72:75], v[168:171], v[128:131], v[72:75]
 s_waitcnt vmcnt(8)
 ds_read_b128 v[160:163], v25 offset:10240
 buffer_load_dwordx4 v[120:123], v5, s[8:11], s65 offen offset:2048 sc1
 v_mfma_f32_16x16x32_bf16 v[88:91], v[168:171], v[132:135], v[88:91]
 v_mul_f32 v54, v54, v209
 v_mul_f32 v55, v55, v209
 v_mfma_f32_16x16x32_bf16 v[76:79], v[172:175], v[128:131], v[76:79]
 v_permlane16_swap_b32 v236, v238
 v_mfma_f32_16x16x32_bf16 v[92:95], v[172:175], v[132:135], v[92:95]
 s_waitcnt lgkmcnt(3)
 ds_read_b128 v[164:167], v25 offset:11264
 ds_read_b128 v[168:171], v25 offset:12288
 v_mfma_f32_16x16x32_bf16 v[80:83], v[176:179], v[128:131], v[80:83]
 v_permlane16_swap_b32 v237, v239
 v_mfma_f32_16x16x32_bf16 v[96:99], v[176:179], v[132:135], v[96:99]
 ds_read_b128 v[172:175], v25 offset:13312
 buffer_load_dwordx4 v[124:127], v5, s[8:11], s70 offen offset:2048 sc1
 v_mfma_f32_16x16x32_bf16 v[84:87], v[180:183], v[128:131], v[84:87]
 v_cvt_pk_bf16_f32 v248, v52, v53
 v_cvt_pk_bf16_f32 v249, v54, v55
 v_mfma_f32_16x16x32_bf16 v[100:103], v[180:183], v[132:135], v[100:103]
 v_mul_f32 v68, v68, v213
 v_mul_f32 v69, v69, v213
 v_mfma_f32_32x32x16_bf16 v[184:199], a[164:167], v[236:239], 0
 s_waitcnt vmcnt(9) lgkmcnt(4)
 v_mfma_f32_16x16x32_bf16 v[72:75], v[152:155], v[136:139], v[72:75]
 s_waitcnt vmcnt(8)
 ds_read_b128 v[176:179], v25 offset:14336
 buffer_load_dwordx4 v[128:131], v5, s[8:11], s65 offen offset:3072 sc1
 v_mfma_f32_16x16x32_bf16 v[88:91], v[152:155], v[140:143], v[88:91]
 v_mul_f32 v70, v70, v213
 v_mul_f32 v71, v71, v213
 v_mfma_f32_16x16x32_bf16 v[76:79], v[156:159], v[136:139], v[76:79]
 v_cvt_pk_bf16_f32 v250, v68, v69
 v_cvt_pk_bf16_f32 v251, v70, v71
 v_mfma_f32_16x16x32_bf16 v[92:95], v[156:159], v[140:143], v[92:95]
 s_waitcnt lgkmcnt(3)
 ds_read_b128 v[180:183], v25 offset:15360
 ds_read_b128 v[152:155], v25 offset:16384
 v_mfma_f32_16x16x32_bf16 v[80:83], v[160:163], v[136:139], v[80:83]
 v_mul_f32 v44, v44, v208
 v_mul_f32 v45, v45, v208
 v_mfma_f32_16x16x32_bf16 v[96:99], v[160:163], v[140:143], v[96:99]
 ds_read_b128 v[156:159], v25 offset:17408
 buffer_load_dwordx4 v[132:135], v5, s[8:11], s70 offen offset:3072 sc1
 v_mfma_f32_16x16x32_bf16 v[84:87], v[164:167], v[136:139], v[84:87]
 v_permlane16_swap_b32 v248, v250
 v_mfma_f32_16x16x32_bf16 v[100:103], v[164:167], v[140:143], v[100:103]
 s_waitcnt vmcnt(9) lgkmcnt(4)
 v_permlane16_swap_b32 v249, v251
 v_mfma_f32_16x16x32_bf16 v[72:75], v[168:171], v[144:147], v[72:75]
 s_waitcnt vmcnt(8)
 ds_read_b128 v[160:163], v25 offset:18432
 buffer_load_dwordx4 v[136:139], v5, s[8:11], s66 offen sc1
 v_mfma_f32_16x16x32_bf16 v[88:91], v[168:171], v[148:151], v[88:91]
 v_or_b32 v250, v23, v250
 v_mul_f32 v46, v46, v208
 v_mfma_f32_16x16x32_bf16 v[76:79], v[172:175], v[144:147], v[76:79]
 v_mul_f32 v47, v47, v208
 v_mfma_f32_32x32x16_bf16 v[184:199], a[168:171], v[248:251], v[184:199]
 v_mfma_f32_16x16x32_bf16 v[92:95], v[172:175], v[148:151], v[92:95]
 s_waitcnt lgkmcnt(3)
 ds_read_b128 v[164:167], v25 offset:19456
 ds_read_b128 v[168:171], v25 offset:20480
 v_mfma_f32_16x16x32_bf16 v[80:83], v[176:179], v[144:147], v[80:83]
 ds_write_b64 v14, v[250:251] offset:21120
 v_mfma_f32_16x16x32_bf16 v[96:99], v[176:179], v[148:151], v[96:99]
 ds_read_b128 v[172:175], v25 offset:21504
 buffer_load_dwordx4 v[140:143], v5, s[8:11], s71 offen sc1
 v_mfma_f32_16x16x32_bf16 v[84:87], v[180:183], v[144:147], v[84:87]
 v_cvt_pk_bf16_f32 v240, v44, v45
 v_cvt_pk_bf16_f32 v241, v46, v47
 v_mfma_f32_16x16x32_bf16 v[100:103], v[180:183], v[148:151], v[100:103]
 s_barrier
 v_mul_f32 v60, v60, v212
 v_mul_f32 v61, v61, v212
 s_waitcnt lgkmcnt(5)
 s_waitcnt vmcnt(9)
 v_mfma_f32_16x16x32_bf16 v[72:75], v[152:155], v[104:107], v[72:75]
 s_waitcnt vmcnt(8)
 ds_read_b128 v[176:179], v25 offset:22528
 buffer_load_dwordx4 v[144:147], v5, s[8:11], s66 offen offset:1024 sc1
 v_mfma_f32_16x16x32_bf16 v[88:91], v[152:155], v[108:111], v[88:91]
 v_mul_f32 v62, v62, v212
 v_mul_f32 v63, v63, v212
 v_mfma_f32_16x16x32_bf16 v[76:79], v[156:159], v[104:107], v[76:79]
 v_cvt_pk_bf16_f32 v242, v60, v61
 v_cvt_pk_bf16_f32 v243, v62, v63
 v_mfma_f32_16x16x32_bf16 v[92:95], v[156:159], v[108:111], v[92:95]
 s_waitcnt lgkmcnt(4)
 ds_read_b128 v[180:183], v25 offset:23552
 ds_read_b128 v[152:155], v25 offset:24576
 v_mfma_f32_16x16x32_bf16 v[80:83], v[160:163], v[104:107], v[80:83]
 v_cvt_pk_bf16_f32 v244, v48, v49
 v_cvt_pk_bf16_f32 v245, v50, v51
 v_mfma_f32_16x16x32_bf16 v[96:99], v[160:163], v[108:111], v[96:99]
 ds_read_b128 v[156:159], v25 offset:25600
 buffer_load_dwordx4 v[148:151], v5, s[8:11], s71 offen offset:1024 sc1
 v_mfma_f32_16x16x32_bf16 v[84:87], v[164:167], v[104:107], v[84:87]
pad7:
 s_cbranch_execz pad11
 v_permlane16_swap_b32 v240, v242
 v_mfma_f32_16x16x32_bf16 v[100:103], v[164:167], v[108:111], v[100:103]
 s_waitcnt vmcnt(9) lgkmcnt(4)
 v_permlane16_swap_b32 v241, v243
 v_mfma_f32_16x16x32_bf16 v[72:75], v[168:171], v[112:115], v[72:75]
 s_waitcnt vmcnt(8)
 ds_read_b128 v[160:163], v25 offset:26624
 buffer_load_dwordx4 v[104:107], v5, s[8:11], s66 offen offset:2048 sc1
 v_mfma_f32_16x16x32_bf16 v[88:91], v[168:171], v[116:119], v[88:91]
 v_cvt_pk_bf16_f32 v246, v64, v65
 v_cvt_pk_bf16_f32 v247, v66, v67
 v_mfma_f32_16x16x32_bf16 v[76:79], v[172:175], v[112:115], v[76:79]
 ds_write_b128 v13, v[240:243] offset:16896
 v_mfma_f32_16x16x32_bf16 v[92:95], v[172:175], v[116:119], v[92:95]
 s_waitcnt lgkmcnt(4)
 ds_read_b128 v[164:167], v25 offset:27648
 ds_read_b128 v[168:171], v25 offset:28672
 v_mfma_f32_16x16x32_bf16 v[80:83], v[176:179], v[112:115], v[80:83]
 v_permlane16_swap_b32 v244, v246
 v_mfma_f32_16x16x32_bf16 v[96:99], v[176:179], v[116:119], v[96:99]
 ds_read_b128 v[172:175], v25 offset:29696
 buffer_load_dwordx4 v[108:111], v5, s[8:11], s71 offen offset:2048 sc1
 v_mfma_f32_16x16x32_bf16 v[84:87], v[180:183], v[112:115], v[84:87]
 v_permlane16_swap_b32 v245, v247
 v_mfma_f32_16x16x32_bf16 v[100:103], v[180:183], v[116:119], v[100:103]
 s_waitcnt vmcnt(9) lgkmcnt(5)
 v_max3_f32 v60, v184, v185, v186
 v_max3_f32 v61, -v184, -v185, -v186
 v_mfma_f32_16x16x32_bf16 v[72:75], v[152:155], v[120:123], v[72:75]
 s_waitcnt vmcnt(8)
 ds_read_b128 v[176:179], v25 offset:30720
 buffer_load_dwordx4 v[112:115], v5, s[8:11], s66 offen offset:3072 sc1
 v_mfma_f32_16x16x32_bf16 v[88:91], v[152:155], v[124:127], v[88:91]
 v_max3_f32 v60, v60, v187, v188
 v_max3_f32 v61, v61, -v187, -v188
 v_mfma_f32_16x16x32_bf16 v[76:79], v[156:159], v[120:123], v[76:79]
 v_max3_f32 v60, v60, v189, v190
 v_max3_f32 v61, v61, -v189, -v190
 v_mfma_f32_16x16x32_bf16 v[92:95], v[156:159], v[124:127], v[92:95]
 s_waitcnt lgkmcnt(3)
 ds_read_b128 v[180:183], v25 offset:31744
 ds_read_b128 v[152:155], v25 offset:32768
 v_mfma_f32_16x16x32_bf16 v[80:83], v[160:163], v[120:123], v[80:83]
 v_max3_f32 v60, v60, v191, v192
 v_max3_f32 v61, v61, -v191, -v192
 v_mfma_f32_16x16x32_bf16 v[96:99], v[160:163], v[124:127], v[96:99]
 ds_read_b128 v[156:159], v25 offset:33792
 buffer_load_dwordx4 v[116:119], v5, s[8:11], s71 offen offset:3072 sc1
 v_mfma_f32_16x16x32_bf16 v[84:87], v[164:167], v[120:123], v[84:87]
 v_max_f32 v60, v60, v193
 v_max_f32 v61, v61, -v193
 v_mfma_f32_16x16x32_bf16 v[100:103], v[164:167], v[124:127], v[100:103]
 s_waitcnt vmcnt(9) lgkmcnt(4)
 s_nop 0
 v_permlane32_swap_b32 v60, v61
 v_mfma_f32_16x16x32_bf16 v[72:75], v[168:171], v[128:131], v[72:75]
 s_waitcnt vmcnt(8)
 ds_read_b128 v[160:163], v25 offset:34816
 buffer_load_dwordx4 v[120:123], v5, s[8:11], s67 offen sc1
 v_mfma_f32_16x16x32_bf16 v[88:91], v[168:171], v[132:135], v[88:91]
 v_max_f32 v62, v60, v61
 v_mul_f32 v60, -v62, v225
 v_mfma_f32_16x16x32_bf16 v[76:79], v[172:175], v[128:131], v[76:79]
 v_mul_f32 v61, -v62, v225
 v_mfma_f32_16x16x32_bf16 v[92:95], v[172:175], v[132:135], v[92:95]
 s_waitcnt lgkmcnt(3)
 ds_read_b128 v[164:167], v25 offset:35840
 ds_read_b128 v[168:171], v25 offset:36864
 v_mfma_f32_16x16x32_bf16 v[80:83], v[176:179], v[128:131], v[80:83]
 v_permlane32_swap_b32 v60, v61
 v_mfma_f32_16x16x32_bf16 v[96:99], v[176:179], v[132:135], v[96:99]
 ds_read_b128 v[172:175], v25 offset:37888
 buffer_load_dwordx4 v[124:127], v5, s[8:11], s72 offen sc1
 v_mfma_f32_16x16x32_bf16 v[84:87], v[180:183], v[128:131], v[84:87]
 v_fma_f32 v40, v184, v225, v60
 v_fma_f32 v50, -v184, v225, v61
 v_mfma_f32_16x16x32_bf16 v[100:103], v[180:183], v[132:135], v[100:103]
 s_barrier
 v_fma_f32 v41, v185, v225, v60
 v_fma_f32 v51, -v185, v225, v61
 s_waitcnt lgkmcnt(4)
 s_waitcnt vmcnt(9)
 v_mfma_f32_16x16x32_bf16 v[72:75], v[152:155], v[136:139], v[72:75]
 s_waitcnt vmcnt(8)
 ds_read_b128 v[176:179], v25 offset:38912
 buffer_load_dwordx4 v[128:131], v5, s[8:11], s67 offen offset:1024 sc1
 v_mfma_f32_16x16x32_bf16 v[88:91], v[152:155], v[140:143], v[88:91]
 v_fma_f32 v42, v186, v225, v60
 v_fma_f32 v52, -v186, v225, v61
 v_mfma_f32_16x16x32_bf16 v[76:79], v[156:159], v[136:139], v[76:79]
 v_fma_f32 v43, v187, v225, v60
 v_fma_f32 v53, -v187, v225, v61
 v_mfma_f32_16x16x32_bf16 v[92:95], v[156:159], v[140:143], v[92:95]
 s_waitcnt lgkmcnt(3)
 ds_read_b128 v[180:183], v25 offset:39936
 ds_read_b128 v[152:155], v26
 v_mfma_f32_16x16x32_bf16 v[80:83], v[160:163], v[136:139], v[80:83]
 v_fma_f32 v44, v188, v225, v60
 v_fma_f32 v54, -v188, v225, v61
 v_mfma_f32_16x16x32_bf16 v[96:99], v[160:163], v[140:143], v[96:99]
 ds_read_b128 v[156:159], v26 offset:1024
 buffer_load_dwordx4 v[132:135], v5, s[8:11], s72 offen offset:1024 sc1
 v_mfma_f32_16x16x32_bf16 v[84:87], v[164:167], v[136:139], v[84:87]
 v_fma_f32 v45, v189, v225, v60
 v_fma_f32 v55, -v189, v225, v61
 v_mfma_f32_16x16x32_bf16 v[100:103], v[164:167], v[140:143], v[100:103]
 s_waitcnt vmcnt(9) lgkmcnt(4)
 v_fma_f32 v46, v190, v225, v60
 v_fma_f32 v56, -v190, v225, v61
 v_mfma_f32_16x16x32_bf16 v[72:75], v[168:171], v[144:147], v[72:75]
 s_waitcnt vmcnt(8)
 ds_read_b128 v[160:163], v26 offset:2048
 buffer_load_dwordx4 v[136:139], v5, s[8:11], s67 offen offset:2048 sc1
 v_mfma_f32_16x16x32_bf16 v[88:91], v[168:171], v[148:151], v[88:91]
 v_fma_f32 v47, v191, v225, v60
 v_fma_f32 v57, -v191, v225, v61
 v_mfma_f32_16x16x32_bf16 v[76:79], v[172:175], v[144:147], v[76:79]
 v_fma_f32 v48, v192, v225, v60
 v_fma_f32 v58, -v192, v225, v61
 v_mfma_f32_16x16x32_bf16 v[92:95], v[172:175], v[148:151], v[92:95]
 s_waitcnt lgkmcnt(3)
 ds_read_b128 v[164:167], v26 offset:3072
 ds_read_b128 v[168:171], v26 offset:4096
 v_mfma_f32_16x16x32_bf16 v[80:83], v[176:179], v[144:147], v[80:83]
 v_fma_f32 v49, v193, v225, v60
 v_fma_f32 v59, -v193, v225, v61
 v_mfma_f32_16x16x32_bf16 v[96:99], v[176:179], v[148:151], v[96:99]
 ds_read_b128 v[172:175], v26 offset:5120
 buffer_load_dwordx4 v[140:143], v5, s[8:11], s72 offen offset:2048 sc1
 v_mfma_f32_16x16x32_bf16 v[84:87], v[180:183], v[144:147], v[84:87]
 v_exp_f32 v40, v40
 v_mfma_f32_16x16x32_bf16 v[100:103], v[180:183], v[148:151], v[100:103]
 s_waitcnt vmcnt(9) lgkmcnt(4)
 v_exp_f32 v41, v41
 v_mfma_f32_16x16x32_bf16 v[72:75], v[152:155], v[104:107], v[72:75]
 s_waitcnt vmcnt(8)
 ds_read_b128 v[176:179], v26 offset:6144
 buffer_load_dwordx4 v[144:147], v5, s[8:11], s67 offen offset:3072 sc1
 v_mfma_f32_16x16x32_bf16 v[88:91], v[152:155], v[108:111], v[88:91]
 v_exp_f32 v42, v42
 v_mfma_f32_16x16x32_bf16 v[76:79], v[156:159], v[104:107], v[76:79]
 v_exp_f32 v43, v43
 v_mfma_f32_16x16x32_bf16 v[92:95], v[156:159], v[108:111], v[92:95]
 s_waitcnt lgkmcnt(3)
 ds_read_b128 v[180:183], v26 offset:7168
 ds_read_b128 v[152:155], v26 offset:8192
 v_mfma_f32_16x16x32_bf16 v[80:83], v[160:163], v[104:107], v[80:83]
 v_exp_f32 v44, v44
 v_mfma_f32_16x16x32_bf16 v[96:99], v[160:163], v[108:111], v[96:99]
 ds_read_b128 v[156:159], v26 offset:9216
 buffer_load_dwordx4 v[148:151], v5, s[8:11], s72 offen offset:3072 sc1
 v_mfma_f32_16x16x32_bf16 v[84:87], v[164:167], v[104:107], v[84:87]
 v_exp_f32 v45, v45
 v_mfma_f32_16x16x32_bf16 v[100:103], v[164:167], v[108:111], v[100:103]
 s_waitcnt vmcnt(9) lgkmcnt(4)
 v_exp_f32 v46, v46
 v_mfma_f32_16x16x32_bf16 v[72:75], v[168:171], v[112:115], v[72:75]
 s_waitcnt vmcnt(8)
 ds_read_b128 v[160:163], v26 offset:10240
 buffer_load_dwordx4 v[104:107], v5, s[8:11], s68 offen sc1
 v_mfma_f32_16x16x32_bf16 v[88:91], v[168:171], v[116:119], v[88:91]
 v_exp_f32 v47, v47
 v_mfma_f32_16x16x32_bf16 v[76:79], v[172:175], v[112:115], v[76:79]
 v_exp_f32 v48, v48
 v_mfma_f32_16x16x32_bf16 v[92:95], v[172:175], v[116:119], v[92:95]
 s_waitcnt lgkmcnt(3)
 ds_read_b128 v[164:167], v26 offset:11264
 ds_read_b128 v[168:171], v26 offset:12288
 v_mfma_f32_16x16x32_bf16 v[80:83], v[176:179], v[112:115], v[80:83]
 v_exp_f32 v49, v49
 v_mfma_f32_16x16x32_bf16 v[96:99], v[176:179], v[116:119], v[96:99]
 ds_read_b128 v[172:175], v26 offset:13312
 buffer_load_dwordx4 v[108:111], v5, s[8:11], s73 offen sc1
 v_mfma_f32_16x16x32_bf16 v[84:87], v[180:183], v[112:115], v[84:87]
 v_exp_f32 v50, v50
 v_mfma_f32_16x16x32_bf16 v[100:103], v[180:183], v[116:119], v[100:103]
 s_barrier
 v_exp_f32 v51, v51
 s_waitcnt lgkmcnt(4)
 s_waitcnt vmcnt(9)
 v_mfma_f32_16x16x32_bf16 v[72:75], v[152:155], v[120:123], v[72:75]
 s_waitcnt vmcnt(8)
 ds_read_b128 v[176:179], v26 offset:14336
 buffer_load_dwordx4 v[112:115], v5, s[8:11], s68 offen offset:1024 sc1
 v_mfma_f32_16x16x32_bf16 v[88:91], v[152:155], v[124:127], v[88:91]
 v_exp_f32 v52, v52
 v_mfma_f32_16x16x32_bf16 v[76:79], v[156:159], v[120:123], v[76:79]
 v_exp_f32 v53, v53
 v_mfma_f32_16x16x32_bf16 v[92:95], v[156:159], v[124:127], v[92:95]
 s_waitcnt lgkmcnt(3)
 ds_read_b128 v[180:183], v26 offset:15360
 ds_read_b128 v[152:155], v26 offset:16384
 v_mfma_f32_16x16x32_bf16 v[80:83], v[160:163], v[120:123], v[80:83]
 v_exp_f32 v54, v54
 v_mfma_f32_16x16x32_bf16 v[96:99], v[160:163], v[124:127], v[96:99]
 ds_read_b128 v[156:159], v26 offset:17408
 buffer_load_dwordx4 v[116:119], v5, s[8:11], s73 offen offset:1024 sc1
 v_mfma_f32_16x16x32_bf16 v[84:87], v[164:167], v[120:123], v[84:87]
 v_exp_f32 v55, v55
 v_mfma_f32_16x16x32_bf16 v[100:103], v[164:167], v[124:127], v[100:103]
 s_waitcnt vmcnt(9) lgkmcnt(4)
 v_exp_f32 v56, v56
 v_mfma_f32_16x16x32_bf16 v[72:75], v[168:171], v[128:131], v[72:75]
 s_waitcnt vmcnt(8)
 ds_read_b128 v[160:163], v26 offset:18432
 buffer_load_dwordx4 v[120:123], v5, s[8:11], s68 offen offset:2048 sc1
 v_mfma_f32_16x16x32_bf16 v[88:91], v[168:171], v[132:135], v[88:91]
 v_exp_f32 v57, v57
 v_mfma_f32_16x16x32_bf16 v[76:79], v[172:175], v[128:131], v[76:79]
 v_exp_f32 v58, v58
 v_mfma_f32_16x16x32_bf16 v[92:95], v[172:175], v[132:135], v[92:95]
 s_waitcnt lgkmcnt(3)
 ds_read_b128 v[164:167], v26 offset:19456
 ds_read_b128 v[168:171], v26 offset:20480
 v_mfma_f32_16x16x32_bf16 v[80:83], v[176:179], v[128:131], v[80:83]
 v_exp_f32 v59, v59
 v_mfma_f32_16x16x32_bf16 v[96:99], v[176:179], v[132:135], v[96:99]
 ds_read_b128 v[172:175], v26 offset:21504
 buffer_load_dwordx4 v[124:127], v5, s[8:11], s73 offen offset:2048 sc1
 v_mfma_f32_16x16x32_bf16 v[84:87], v[180:183], v[128:131], v[84:87]
 v_add_f32 v60, v40, v42
 v_add_f32 v61, v41, v43
 v_mfma_f32_16x16x32_bf16 v[100:103], v[180:183], v[132:135], v[100:103]
 s_waitcnt vmcnt(9) lgkmcnt(4)
 v_add_f32 v62, v50, v52
 v_add_f32 v63, v51, v53
 v_mfma_f32_16x16x32_bf16 v[72:75], v[152:155], v[136:139], v[72:75]
 s_waitcnt vmcnt(8)
 ds_read_b128 v[176:179], v26 offset:22528
 buffer_load_dwordx4 v[128:131], v5, s[8:11], s68 offen offset:3072 sc1
 v_mfma_f32_16x16x32_bf16 v[88:91], v[152:155], v[140:143], v[88:91]
 v_add_f32 v60, v60, v44
 v_add_f32 v61, v61, v45
 v_mfma_f32_16x16x32_bf16 v[76:79], v[156:159], v[136:139], v[76:79]
 v_add_f32 v62, v62, v54
 v_add_f32 v63, v63, v55
 v_mfma_f32_16x16x32_bf16 v[92:95], v[156:159], v[140:143], v[92:95]
 s_waitcnt lgkmcnt(3)
 ds_read_b128 v[180:183], v26 offset:23552
 ds_read_b128 v[152:155], v26 offset:24576
 v_mfma_f32_16x16x32_bf16 v[80:83], v[160:163], v[136:139], v[80:83]
 v_add_f32 v60, v60, v46
 v_add_f32 v61, v61, v47
 v_mfma_f32_16x16x32_bf16 v[96:99], v[160:163], v[140:143], v[96:99]
 ds_read_b128 v[156:159], v26 offset:25600
 buffer_load_dwordx4 v[132:135], v5, s[8:11], s73 offen offset:3072 sc1
 v_mfma_f32_16x16x32_bf16 v[84:87], v[164:167], v[136:139], v[84:87]
 v_add_f32 v62, v62, v56
 v_add_f32 v63, v63, v57
 v_mfma_f32_16x16x32_bf16 v[100:103], v[164:167], v[140:143], v[100:103]
 s_waitcnt vmcnt(9) lgkmcnt(4)
 v_add_f32 v60, v60, v48
 v_add_f32 v61, v61, v49
 v_mfma_f32_16x16x32_bf16 v[72:75], v[168:171], v[144:147], v[72:75]
 s_waitcnt vmcnt(8)
 ds_read_b128 v[160:163], v26 offset:26624
 v_add_f32 v62, v62, v58
 v_mfma_f32_16x16x32_bf16 v[88:91], v[168:171], v[148:151], v[88:91]
 v_add_f32 v63, v63, v59
 v_add_f32 v60, v60, v61
 v_mfma_f32_16x16x32_bf16 v[76:79], v[172:175], v[144:147], v[76:79]
 v_add_f32 v61, v62, v63
 v_mfma_f32_16x16x32_bf16 v[92:95], v[172:175], v[148:151], v[92:95]
 s_waitcnt lgkmcnt(3)
 ds_read_b128 v[164:167], v26 offset:27648
 ds_read_b128 v[168:171], v26 offset:28672
 v_mfma_f32_16x16x32_bf16 v[80:83], v[176:179], v[144:147], v[80:83]
 v_permlane32_swap_b32 v60, v61
 v_mfma_f32_16x16x32_bf16 v[96:99], v[176:179], v[148:151], v[96:99]
 ds_read_b128 v[172:175], v26 offset:29696
 v_add_f32 v60, v60, v61
 v_mfma_f32_16x16x32_bf16 v[84:87], v[180:183], v[144:147], v[84:87]
 v_rcp_f32 v60, v60
 v_mfma_f32_16x16x32_bf16 v[100:103], v[180:183], v[148:151], v[100:103]
 s_barrier
 v_mov_b32 v61, v60
 s_waitcnt lgkmcnt(4)
 s_waitcnt vmcnt(7)
 v_mfma_f32_16x16x32_bf16 v[72:75], v[152:155], v[104:107], v[72:75]
 s_waitcnt vmcnt(6)
 s_add_u32 m0, s28, 98304
 ds_read_b128 v[176:179], v26 offset:30720
 s_add_u32 s85, s35, 16384
 buffer_load_dwordx4 v3, s[8:11], s85 offen offset:1024 sc1 lds
 v_mfma_f32_16x16x32_bf16 v[88:91], v[152:155], v[108:111], v[88:91]
 v_permlane32_swap_b32 v60, v61
 v_mfma_f32_16x16x32_bf16 v[76:79], v[156:159], v[104:107], v[76:79]
 v_mul_f32 v40, v60, v40
 v_mul_f32 v41, v60, v41
 v_mfma_f32_16x16x32_bf16 v[92:95], v[156:159], v[108:111], v[92:95]
 s_waitcnt lgkmcnt(3)
 ds_read_b128 v[180:183], v26 offset:31744
 ds_read_b128 v[152:155], v26 offset:32768
 v_mfma_f32_16x16x32_bf16 v[80:83], v[160:163], v[104:107], v[80:83]
 s_add_u32 m0, s28, 81920
 s_add_u32 s85, s35, 0
 buffer_load_dwordx4 v3, s[8:11], s85 offen sc1 lds
 v_cvt_pk_bf16_f32 v236, v40, v41
 v_mfma_f32_16x16x32_bf16 v[96:99], v[160:163], v[108:111], v[96:99]
 ds_read_b128 v[156:159], v26 offset:33792
 v_mul_f32 v42, v60, v42
 v_mfma_f32_16x16x32_bf16 v[84:87], v[164:167], v[104:107], v[84:87]
 v_mul_f32 v43, v60, v43
 v_cvt_pk_bf16_f32 v237, v42, v43
 v_mfma_f32_16x16x32_bf16 v[100:103], v[164:167], v[108:111], v[100:103]
 s_waitcnt vmcnt(7) lgkmcnt(4)
 v_mul_f32 v44, v60, v44
 v_mul_f32 v45, v60, v45
 v_mfma_f32_16x16x32_bf16 v[72:75], v[168:171], v[112:115], v[72:75]
 s_waitcnt vmcnt(6)
 s_add_u32 m0, s28, 98304
 ds_read_b128 v[160:163], v26 offset:34816
 s_add_u32 s85, s35, 16384
 buffer_load_dwordx4 v3, s[8:11], s85 offen offset:2048 sc1 lds
 v_mfma_f32_16x16x32_bf16 v[88:91], v[168:171], v[116:119], v[88:91]
 v_cvt_pk_bf16_f32 v238, v44, v45
 v_mul_f32 v46, v60, v46
 v_mfma_f32_16x16x32_bf16 v[76:79], v[172:175], v[112:115], v[76:79]
 s_add_u32 m0, s28, 81920
 s_add_u32 s85, s35, 0
 buffer_load_dwordx4 v3, s[8:11], s85 offen offset:1024 sc1 lds
 v_mul_f32 v47, v60, v47
 v_mfma_f32_16x16x32_bf16 v[92:95], v[172:175], v[116:119], v[92:95]
 s_waitcnt lgkmcnt(3)
 ds_read_b128 v[164:167], v26 offset:35840
 ds_read_b128 v[168:171], v26 offset:36864
 v_mfma_f32_16x16x32_bf16 v[80:83], v[176:179], v[112:115], v[80:83]
 v_cvt_pk_bf16_f32 v239, v46, v47
 v_mfma_f32_16x16x32_bf16 v[96:99], v[176:179], v[116:119], v[96:99]
 ds_read_b128 v[172:175], v26 offset:37888
 v_mfma_f32_16x16x32_bf16 v[84:87], v[180:183], v[112:115], v[84:87]
 ds_write_b128 v12, v[236:239]
 v_mfma_f32_16x16x32_bf16 v[100:103], v[180:183], v[116:119], v[100:103]
 s_waitcnt vmcnt(7) lgkmcnt(5)
 v_mul_f32 v48, v60, v48
 v_mul_f32 v49, v60, v49
 v_mfma_f32_16x16x32_bf16 v[72:75], v[152:155], v[120:123], v[72:75]
 s_waitcnt vmcnt(6)
 s_add_u32 m0, s28, 98304
 ds_read_b128 v[176:179], v26 offset:38912
 s_add_u32 s85, s35, 16384
 buffer_load_dwordx4 v3, s[8:11], s85 offen offset:3072 sc1 lds
 v_mfma_f32_16x16x32_bf16 v[88:91], v[152:155], v[124:127], v[88:91]
 v_cvt_pk_bf16_f32 v240, v48, v49
 v_mul_f32 v50, v61, v50
 v_mfma_f32_16x16x32_bf16 v[76:79], v[156:159], v[120:123], v[76:79]
 s_add_u32 m0, s28, 81920
 s_add_u32 s85, s35, 0
 buffer_load_dwordx4 v3, s[8:11], s85 offen offset:2048 sc1 lds
 v_mul_f32 v51, v61, v51
 v_mfma_f32_16x16x32_bf16 v[92:95], v[156:159], v[124:127], v[92:95]
 s_waitcnt lgkmcnt(4)
 ds_read_b128 v[180:183], v26 offset:39936
 v_cvt_pk_bf16_f32 v241, v50, v51
 v_mfma_f32_16x16x32_bf16 v[80:83], v[160:163], v[120:123], v[80:83]
 v_mul_f32 v52, v61, v52
 v_mul_f32 v53, v61, v53
 v_mfma_f32_16x16x32_bf16 v[96:99], v[160:163], v[124:127], v[96:99]
 v_cvt_pk_bf16_f32 v242, v52, v53
 v_mul_f32 v54, v61, v54
 v_mfma_f32_16x16x32_bf16 v[84:87], v[164:167], v[120:123], v[84:87]
 v_mul_f32 v55, v61, v55
 v_cvt_pk_bf16_f32 v243, v54, v55
 v_mfma_f32_16x16x32_bf16 v[100:103], v[164:167], v[124:127], v[100:103]
 s_waitcnt vmcnt(7) lgkmcnt(3)
 buffer_load_dwordx4 v3, s[8:11], s85 offen offset:3072 sc1 lds
 v_mfma_f32_16x16x32_bf16 v[72:75], v[168:171], v[128:131], v[72:75]
 s_waitcnt vmcnt(7)
 s_add_u32 m0, s28, 114688
 s_add_u32 s85, s35, 32768
 buffer_load_dwordx4 v3, s[8:11], s85 offen sc1 lds
 v_mfma_f32_16x16x32_bf16 v[88:91], v[168:171], v[132:135], v[88:91]
 ds_write_b128 v12, v[240:243] offset:8448
 v_mfma_f32_16x16x32_bf16 v[76:79], v[172:175], v[128:131], v[76:79]
 v_mul_f32 v56, v61, v56
 v_mul_f32 v57, v61, v57
 v_mfma_f32_16x16x32_bf16 v[92:95], v[172:175], v[132:135], v[92:95]
 s_waitcnt lgkmcnt(1)
 v_cvt_pk_bf16_f32 v64, v56, v57
 v_mul_f32 v58, v61, v58
 v_mfma_f32_16x16x32_bf16 v[80:83], v[176:179], v[128:131], v[80:83]
 v_mul_f32 v59, v61, v59
 v_cvt_pk_bf16_f32 v65, v58, v59
 v_mfma_f32_16x16x32_bf16 v[96:99], v[176:179], v[132:135], v[96:99]
 s_add_u32 m0, s28, 98304
 s_add_u32 s85, s35, 16384
 buffer_load_dwordx4 v3, s[8:11], s85 offen sc1 lds
 v_mfma_f32_16x16x32_bf16 v[84:87], v[180:183], v[128:131], v[84:87]
 ds_write_b64 v14, v[64:65] offset:29568
 v_mfma_f32_16x16x32_bf16 v[100:103], v[180:183], v[132:135], v[100:103]
 v_cvt_pk_bf16_f32 v104, v72, v73
 buffer_load_dwordx4 a[100:103], v38, s[8:11], s66 offen offset:3072 sc1
 v_cvt_pk_bf16_f32 v105, v74, v75
 v_cvt_pk_bf16_f32 v106, v88, v89
 v_cvt_pk_bf16_f32 v107, v90, v91
 s_nop 0
 v_mul_f32 v84, v84, v217
 v_mul_f32 v85, v85, v217
 v_mul_f32 v86, v86, v217
 v_mul_f32 v87, v87, v217
 v_permlane16_swap_b32 v104, v106
 v_permlane16_swap_b32 v105, v107
 v_cvt_pk_bf16_f32 v116, v84, v85
 v_cvt_pk_bf16_f32 v117, v86, v87
 v_mul_f32 v100, v100, v221
 v_mul_f32 v101, v101, v221
 v_mfma_f32_32x32x16_bf16 v[136:151], a[164:167], v[104:107], 0
 v_mul_f32 v102, v102, v221
 v_mul_f32 v103, v103, v221
 v_cvt_pk_bf16_f32 v118, v100, v101
 v_cvt_pk_bf16_f32 v119, v102, v103
 v_mul_f32 v76, v76, v216
 v_mul_f32 v77, v77, v216
 v_permlane16_swap_b32 v116, v118
 v_permlane16_swap_b32 v117, v119
 v_or_b32 v118, v23, v118
 v_mul_f32 v78, v78, v216
 s_add_u32 m0, s28, 114688
 s_add_u32 s85, s35, 32768
 buffer_load_dwordx4 v3, s[8:11], s85 offen offset:1024 sc1 lds
 v_mul_f32 v79, v79, v216
 v_mfma_f32_32x32x16_bf16 v[136:151], a[168:171], v[116:119], v[136:151]
 ds_write_b64 v14, v[118:119] offset:21632
 v_cvt_pk_bf16_f32 v108, v76, v77
 v_cvt_pk_bf16_f32 v109, v78, v79
 v_mul_f32 v92, v92, v220
 v_mul_f32 v93, v93, v220
 v_mul_f32 v94, v94, v220
 v_mul_f32 v95, v95, v220
 v_cvt_pk_bf16_f32 v110, v92, v93
 v_cvt_pk_bf16_f32 v111, v94, v95
 v_cvt_pk_bf16_f32 v112, v80, v81
 v_cvt_pk_bf16_f32 v113, v82, v83
 v_permlane16_swap_b32 v108, v110
 v_permlane16_swap_b32 v109, v111
 v_cvt_pk_bf16_f32 v114, v96, v97
 v_cvt_pk_bf16_f32 v115, v98, v99
 ds_write_b128 v13, v[108:111] offset:17408
 v_permlane16_swap_b32 v112, v114
 v_permlane16_swap_b32 v113, v115
 v_max3_f32 v172, v136, v137, v138
 v_max3_f32 v173, -v136, -v137, -v138
 v_max3_f32 v172, v172, v139, v140
 v_max3_f32 v173, v173, -v139, -v140
 buffer_load_dwordx4 v3, s[8:11], s85 offen offset:2048 sc1 lds
 v_max3_f32 v172, v172, v141, v142
 v_max3_f32 v173, v173, -v141, -v142
 v_max3_f32 v172, v172, v143, v144
 v_max3_f32 v173, v173, -v143, -v144
 v_max_f32 v172, v172, v145
 v_max_f32 v173, v173, -v145
 s_nop 1
 v_permlane32_swap_b32 v172, v173
 v_max_f32 v174, v172, v173
 v_mul_f32 v172, -v174, v227
 v_mul_f32 v173, -v174, v227
 s_nop 1
 v_permlane32_swap_b32 v172, v173
 v_pk_fma_f32 v[152:153], v[226:227], v[136:137], v[172:173] op_sel:[1,0,0] op_sel_hi:[1,1,0]
 v_pk_fma_f32 v[162:163], v[226:227], v[136:137], v[172:173] op_sel:[1,0,1] op_sel_hi:[1,1,1] neg_lo:[1,0,0] neg_hi:[1,0,0]
 v_pk_fma_f32 v[154:155], v[226:227], v[138:139], v[172:173] op_sel:[1,0,0] op_sel_hi:[1,1,0]
 v_pk_fma_f32 v[164:165], v[226:227], v[138:139], v[172:173] op_sel:[1,0,1] op_sel_hi:[1,1,1] neg_lo:[1,0,0] neg_hi:[1,0,0]
 v_pk_fma_f32 v[156:157], v[226:227], v[140:141], v[172:173] op_sel:[1,0,0] op_sel_hi:[1,1,0]
 v_pk_fma_f32 v[166:167], v[226:227], v[140:141], v[172:173] op_sel:[1,0,1] op_sel_hi:[1,1,1] neg_lo:[1,0,0] neg_hi:[1,0,0]
 v_pk_fma_f32 v[158:159], v[226:227], v[142:143], v[172:173] op_sel:[1,0,0] op_sel_hi:[1,1,0]
 v_pk_fma_f32 v[168:169], v[226:227], v[142:143], v[172:173] op_sel:[1,0,1] op_sel_hi:[1,1,1] neg_lo:[1,0,0] neg_hi:[1,0,0]
 v_pk_fma_f32 v[160:161], v[226:227], v[144:145], v[172:173] op_sel:[1,0,0] op_sel_hi:[1,1,0]
 v_pk_fma_f32 v[170:171], v[226:227], v[144:145], v[172:173] op_sel:[1,0,1] op_sel_hi:[1,1,1] neg_lo:[1,0,0] neg_hi:[1,0,0]
 v_exp_f32 v152, v152
 v_exp_f32 v153, v153
 v_exp_f32 v154, v154
 buffer_load_dwordx4 v3, s[8:11], s85 offen offset:3072 sc1 lds
 v_exp_f32 v155, v155
 v_exp_f32 v156, v156
 v_exp_f32 v157, v157
 v_exp_f32 v158, v158
 v_exp_f32 v159, v159
 v_exp_f32 v160, v160
 v_exp_f32 v161, v161
 v_exp_f32 v162, v162
 v_exp_f32 v163, v163
 v_exp_f32 v164, v164
 v_exp_f32 v165, v165
 v_exp_f32 v166, v166
 v_exp_f32 v167, v167
 v_exp_f32 v168, v168
 v_exp_f32 v169, v169
 v_exp_f32 v170, v170
 v_exp_f32 v171, v171
 v_pk_add_f32 v[172:173], v[152:153], v[154:155]
 v_pk_add_f32 v[174:175], v[162:163], v[164:165]
 v_pk_add_f32 v[172:173], v[172:173], v[156:157]
 v_pk_add_f32 v[174:175], v[174:175], v[166:167]
 v_pk_add_f32 v[172:173], v[172:173], v[158:159]
 v_pk_add_f32 v[174:175], v[174:175], v[168:169]
 v_pk_add_f32 v[172:173], v[172:173], v[160:161]
 v_pk_add_f32 v[174:175], v[174:175], v[170:171]
 v_add_f32 v172, v172, v173
 v_add_f32 v173, v174, v175
 s_nop 1
 v_permlane32_swap_b32 v172, v173
 v_add_f32 v172, v172, v173
 v_rcp_f32 v172, v172
 s_nop 0
 v_mov_b32 v173, v172
 s_nop 1
 v_permlane32_swap_b32 v172, v173
 v_pk_mul_f32 v[152:153], v[172:173], v[152:153] op_sel_hi:[0,1]
 v_cvt_pk_bf16_f32 v104, v152, v153
 v_pk_mul_f32 v[154:155], v[172:173], v[154:155] op_sel_hi:[0,1]
 v_cvt_pk_bf16_f32 v105, v154, v155
 v_pk_mul_f32 v[156:157], v[172:173], v[156:157] op_sel_hi:[0,1]
 v_cvt_pk_bf16_f32 v106, v156, v157
 v_pk_mul_f32 v[158:159], v[172:173], v[158:159] op_sel_hi:[0,1]
 v_cvt_pk_bf16_f32 v107, v158, v159
 ds_write_b128 v12, v[104:107] offset:512
 v_pk_mul_f32 v[160:161], v[172:173], v[160:161] op_sel_hi:[0,1]
 v_cvt_pk_bf16_f32 v108, v160, v161
 v_pk_mul_f32 v[162:163], v[172:173], v[162:163] op_sel:[1,0] op_sel_hi:[1,1]
 v_cvt_pk_bf16_f32 v109, v162, v163
 v_pk_mul_f32 v[164:165], v[172:173], v[164:165] op_sel:[1,0] op_sel_hi:[1,1]
 v_cvt_pk_bf16_f32 v110, v164, v165
 v_pk_mul_f32 v[166:167], v[172:173], v[166:167] op_sel:[1,0] op_sel_hi:[1,1]
 v_cvt_pk_bf16_f32 v111, v166, v167
 ds_write_b128 v12, v[108:111] offset:8960
 v_pk_mul_f32 v[168:169], v[172:173], v[168:169] op_sel:[1,0] op_sel_hi:[1,1]
 v_cvt_pk_bf16_f32 v120, v168, v169
 v_pk_mul_f32 v[170:171], v[172:173], v[170:171] op_sel:[1,0] op_sel_hi:[1,1]
 v_cvt_pk_bf16_f32 v121, v170, v171
 ds_write_b64 v14, v[120:121] offset:30080
 v_mfma_f32_32x32x16_bf16 v[184:199], a[164:167], v[244:247], 0
 v_mfma_f32_32x32x16_bf16 v[184:199], a[172:175], v[248:251], v[184:199]
 v_mfma_f32_32x32x16_bf16 v[136:151], a[164:167], v[112:115], 0
 v_mfma_f32_32x32x16_bf16 v[136:151], a[172:175], v[116:119], v[136:151]
 s_waitcnt lgkmcnt(0)
 s_barrier
 s_add_u32 s43, s43, 0x80000
 v_add_u32 v19, 0x80000, v19
 v_min_u32 v25, 1920, v18
 v_lshrrev_b32 v26, 1, v2
 s_cmp_eq_u32 s22, 3
 s_cbranch_scc1 fnokv_15
 ds_read_b64_tr_b16 v[40:41], v15
 ds_read_b64_tr_b16 v[42:43], v15 offset:256
 ds_read_b64_tr_b16 v[44:45], v16
 ds_read_b64_tr_b16 v[46:47], v16 offset:256
 ds_read_b64_tr_b16 v[48:49], v17
 ds_read_b64_tr_b16 v[50:51], v17 offset:256
 ds_read_b64_tr_b16 v[52:53], v15 offset:512
 ds_read_b64_tr_b16 v[54:55], v15 offset:768
 ds_read_b64_tr_b16 v[56:57], v16 offset:512
 ds_read_b64_tr_b16 v[58:59], v16 offset:768
 ds_read_b64_tr_b16 v[60:61], v17 offset:512
 ds_read_b64_tr_b16 v[62:63], v17 offset:768
 s_waitcnt lgkmcnt(8)
 v_mfma_f32_16x16x32_bf16 v[176:179], v[40:43], v[44:47], 0
 s_waitcnt lgkmcnt(6)
 ds_read_b64_tr_b16 v[64:65], v15 offset:1024
 ds_read_b64_tr_b16 v[66:67], v15 offset:1280
 ds_read_b64_tr_b16 v[68:69], v16 offset:1024
 v_mfma_f32_16x16x32_bf16 v[180:183], v[40:43], v[48:51], 0
 s_waitcnt lgkmcnt(5)
 ds_read_b64_tr_b16 v[70:71], v16 offset:1280
 ds_read_b64_tr_b16 v[72:73], v17 offset:1024
 ds_read_b64_tr_b16 v[74:75], v17 offset:1280
 v_mfma_f32_16x16x32_bf16 v[176:179], v[52:55], v[56:59], v[176:179]
 s_waitcnt lgkmcnt(6)
 ds_read_b64_tr_b16 v[76:77], v15 offset:1536
 ds_read_b64_tr_b16 v[78:79], v15 offset:1792
 ds_read_b64_tr_b16 v[80:81], v16 offset:1536
 v_mfma_f32_16x16x32_bf16 v[180:183], v[52:55], v[60:63], v[180:183]
 s_waitcnt lgkmcnt(5)
 ds_read_b64_tr_b16 v[82:83], v16 offset:1792
 ds_read_b64_tr_b16 v[84:85], v17 offset:1536
 ds_read_b64_tr_b16 v[86:87], v17 offset:1792
 v_mfma_f32_16x16x32_bf16 v[176:179], v[64:67], v[68:71], v[176:179]
 s_waitcnt lgkmcnt(6)
 ds_read_b64_tr_b16 v[40:41], v15 offset:2048
 ds_read_b64_tr_b16 v[42:43], v15 offset:2304
 ds_read_b64_tr_b16 v[44:45], v16 offset:2048
 v_mfma_f32_16x16x32_bf16 v[180:183], v[64:67], v[72:75], v[180:183]
 s_waitcnt lgkmcnt(5)
 ds_read_b64_tr_b16 v[46:47], v16 offset:2304
 ds_read_b64_tr_b16 v[48:49], v17 offset:2048
 ds_read_b64_tr_b16 v[50:51], v17 offset:2304
 v_mfma_f32_16x16x32_bf16 v[176:179], v[76:79], v[80:83], v[176:179]
 s_waitcnt lgkmcnt(6)
 ds_read_b64_tr_b16 v[52:53], v15 offset:2560
 ds_read_b64_tr_b16 v[54:55], v15 offset:2816
 ds_read_b64_tr_b16 v[56:57], v16 offset:2560
 v_mfma_f32_16x16x32_bf16 v[180:183], v[76:79], v[84:87], v[180:183]
 s_waitcnt lgkmcnt(5)
 ds_read_b64_tr_b16 v[58:59], v16 offset:2816
 ds_read_b64_tr_b16 v[60:61], v17 offset:2560
 ds_read_b64_tr_b16 v[62:63], v17 offset:2816
 v_mfma_f32_16x16x32_bf16 v[176:179], v[40:43], v[44:47], v[176:179]
 s_waitcnt lgkmcnt(6)
 ds_read_b64_tr_b16 v[64:65], v15 offset:3072
 ds_read_b64_tr_b16 v[66:67], v15 offset:3328
 ds_read_b64_tr_b16 v[68:69], v16 offset:3072
 v_mfma_f32_16x16x32_bf16 v[180:183], v[40:43], v[48:51], v[180:183]
 s_waitcnt lgkmcnt(5)
 ds_read_b64_tr_b16 v[70:71], v16 offset:3328
 ds_read_b64_tr_b16 v[72:73], v17 offset:3072
 ds_read_b64_tr_b16 v[74:75], v17 offset:3328
 v_mfma_f32_16x16x32_bf16 v[176:179], v[52:55], v[56:59], v[176:179]
 s_waitcnt lgkmcnt(6)
 ds_read_b64_tr_b16 v[76:77], v15 offset:3584
 ds_read_b64_tr_b16 v[78:79], v15 offset:3840
 ds_read_b64_tr_b16 v[80:81], v16 offset:3584
 v_mfma_f32_16x16x32_bf16 v[180:183], v[52:55], v[60:63], v[180:183]
 s_waitcnt lgkmcnt(5)
 ds_read_b64_tr_b16 v[82:83], v16 offset:3840
 ds_read_b64_tr_b16 v[84:85], v17 offset:3584
 ds_read_b64_tr_b16 v[86:87], v17 offset:3840
 v_mfma_f32_16x16x32_bf16 v[176:179], v[64:67], v[68:71], v[176:179]
pad8:
 s_cbranch_execz pad12
 s_waitcnt lgkmcnt(6)
 v_mfma_f32_16x16x32_bf16 v[180:183], v[64:67], v[72:75], v[180:183]
 s_waitcnt lgkmcnt(2)
 v_mfma_f32_16x16x32_bf16 v[176:179], v[76:79], v[80:83], v[176:179]
 s_waitcnt lgkmcnt(0)
 v_mfma_f32_16x16x32_bf16 v[180:183], v[76:79], v[84:87], v[180:183]
 s_nop 5
 v_cvt_pk_bf16_f32 v84, v176, v177
 v_cvt_pk_bf16_f32 v85, v178, v179
 v_cvt_pk_bf16_f32 v86, v180, v181
 v_cvt_pk_bf16_f32 v87, v182, v183
fnokv_15:
 v_min_u32 v84, -2, v84
 v_min_u32 v85, -2, v85
 v_min_u32 v86, -2, v86
 v_min_u32 v87, -2, v87
 buffer_store_dwordx4 v[84:87], v18, s[8:11], s43 offen sc1
 ds_write_b128 v25, v[84:87] offset:39424
 v_max3_f32 v172, v184, v185, v186
 buffer_load_dword v0, v6, s[8:11], 0 offen sc1
 v_max3_f32 v220, v136, v137, v138
 v_max3_f32 v173, -v184, -v185, -v186
 buffer_load_dword v0, v7, s[8:11], 0 offen sc1
 v_max3_f32 v221, -v136, -v137, -v138
 v_max3_f32 v172, v172, v187, v188
 v_max3_f32 v220, v220, v139, v140
 buffer_load_dword v0, v6, s[8:11], s0 offen sc1
 v_max3_f32 v173, v173, -v187, -v188
 v_max3_f32 v221, v221, -v139, -v140
 buffer_load_dword v0, v7, s[8:11], s0 offen sc1
 v_max3_f32 v172, v172, v189, v190
 v_max3_f32 v220, v220, v141, v142
 v_max3_f32 v173, v173, -v189, -v190
 buffer_load_dwordx4 a[104:107], v38, s[8:11], s67 offen sc1
 v_max3_f32 v221, v221, -v141, -v142
 v_max3_f32 v172, v172, v191, v192
 buffer_load_dwordx4 a[108:111], v38, s[8:11], s67 offen offset:1024 sc1
 v_max3_f32 v220, v220, v143, v144
 v_max3_f32 v173, v173, -v191, -v192
 v_max3_f32 v221, v221, -v143, -v144
 buffer_load_dwordx4 a[112:115], v38, s[8:11], s67 offen offset:2048 sc1
 v_max_f32 v172, v172, v193
 v_max_f32 v220, v220, v145
 buffer_load_dwordx4 a[116:119], v38, s[8:11], s67 offen offset:3072 sc1
 v_max_f32 v173, v173, -v193
 v_max_f32 v221, v221, -v145
 s_waitcnt lgkmcnt(0)
 s_barrier
 ds_read_b64 v[88:89], v26 offset:39424
 buffer_load_dwordx4 v[104:107], v38, s[8:11], s68 offen sc1
 v_permlane32_swap_b32 v172, v173
 v_permlane32_swap_b32 v220, v221
 buffer_load_dwordx4 v[108:111], v38, s[8:11], s68 offen offset:1024 sc1
 v_max_f32 v174, v172, v173
 v_max_f32 v222, v220, v221
 v_mul_f32 v172, -v174, v225
 buffer_load_dwordx4 v[112:115], v38, s[8:11], s68 offen offset:2048 sc1
 v_mul_f32 v220, -v222, v227
 v_mul_f32 v173, -v174, v225
 buffer_load_dwordx4 v[116:119], v38, s[8:11], s68 offen offset:3072 sc1
 v_mul_f32 v221, -v222, v227
 v_permlane32_swap_b32 v172, v173
 s_nop 0
 v_permlane32_swap_b32 v220, v221
 buffer_load_dwordx4 v[120:123], v38, s[8:11], s69 offen sc1
 v_pk_fma_f32 v[152:153], v[224:225], v[184:185], v[172:173] op_sel:[1,0,0] op_sel_hi:[1,1,0]
 v_pk_fma_f32 v[40:41], v[226:227], v[136:137], v[220:221] op_sel:[1,0,0] op_sel_hi:[1,1,0]
 v_pk_fma_f32 v[162:163], v[224:225], v[184:185], v[172:173] op_sel:[1,0,1] op_sel_hi:[1,1,1] neg_lo:[1,0,0] neg_hi:[1,0,0]
 v_pk_fma_f32 v[50:51], v[226:227], v[136:137], v[220:221] op_sel:[1,0,1] op_sel_hi:[1,1,1] neg_lo:[1,0,0] neg_hi:[1,0,0]
 v_pk_fma_f32 v[154:155], v[224:225], v[186:187], v[172:173] op_sel:[1,0,0] op_sel_hi:[1,1,0]
 v_pk_fma_f32 v[42:43], v[226:227], v[138:139], v[220:221] op_sel:[1,0,0] op_sel_hi:[1,1,0]
 v_pk_fma_f32 v[164:165], v[224:225], v[186:187], v[172:173] op_sel:[1,0,1] op_sel_hi:[1,1,1] neg_lo:[1,0,0] neg_hi:[1,0,0]
 v_pk_fma_f32 v[52:53], v[226:227], v[138:139], v[220:221] op_sel:[1,0,1] op_sel_hi:[1,1,1] neg_lo:[1,0,0] neg_hi:[1,0,0]
 v_pk_fma_f32 v[156:157], v[224:225], v[188:189], v[172:173] op_sel:[1,0,0] op_sel_hi:[1,1,0]
 v_pk_fma_f32 v[44:45], v[226:227], v[140:141], v[220:221] op_sel:[1,0,0] op_sel_hi:[1,1,0]
 v_pk_fma_f32 v[166:167], v[224:225], v[188:189], v[172:173] op_sel:[1,0,1] op_sel_hi:[1,1,1] neg_lo:[1,0,0] neg_hi:[1,0,0]
 v_pk_fma_f32 v[54:55], v[226:227], v[140:141], v[220:221] op_sel:[1,0,1] op_sel_hi:[1,1,1] neg_lo:[1,0,0] neg_hi:[1,0,0]
 v_pk_fma_f32 v[158:159], v[224:225], v[190:191], v[172:173] op_sel:[1,0,0] op_sel_hi:[1,1,0]
 v_pk_fma_f32 v[46:47], v[226:227], v[142:143], v[220:221] op_sel:[1,0,0] op_sel_hi:[1,1,0]
 v_pk_fma_f32 v[168:169], v[224:225], v[190:191], v[172:173] op_sel:[1,0,1] op_sel_hi:[1,1,1] neg_lo:[1,0,0] neg_hi:[1,0,0]
 v_pk_fma_f32 v[56:57], v[226:227], v[142:143], v[220:221] op_sel:[1,0,1] op_sel_hi:[1,1,1] neg_lo:[1,0,0] neg_hi:[1,0,0]
 v_pk_fma_f32 v[160:161], v[224:225], v[192:193], v[172:173] op_sel:[1,0,0] op_sel_hi:[1,1,0]
 v_pk_fma_f32 v[48:49], v[226:227], v[144:145], v[220:221] op_sel:[1,0,0] op_sel_hi:[1,1,0]
 v_pk_fma_f32 v[170:171], v[224:225], v[192:193], v[172:173] op_sel:[1,0,1] op_sel_hi:[1,1,1] neg_lo:[1,0,0] neg_hi:[1,0,0]
 v_pk_fma_f32 v[58:59], v[226:227], v[144:145], v[220:221] op_sel:[1,0,1] op_sel_hi:[1,1,1] neg_lo:[1,0,0] neg_hi:[1,0,0]
 v_exp_f32 v152, v152
 v_exp_f32 v40, v40
 v_exp_f32 v153, v153
 v_exp_f32 v41, v41
 v_exp_f32 v154, v154
 v_exp_f32 v42, v42
 v_exp_f32 v155, v155
 v_exp_f32 v43, v43
 v_exp_f32 v156, v156
 v_exp_f32 v44, v44
 v_exp_f32 v157, v157
 v_exp_f32 v45, v45
 v_exp_f32 v158, v158
 v_exp_f32 v46, v46
 v_exp_f32 v159, v159
 v_exp_f32 v47, v47
 s_xor_b32 s86, s4, 2048
 buffer_load_dwordx2 v[90:91], v19, s[8:11], s86 offen sc1
 s_xor_b32 s86, s4, 4096
 buffer_load_dwordx2 v[92:93], v19, s[8:11], s86 offen sc1
 s_xor_b32 s86, s4, 6144
 buffer_load_dwordx2 v[94:95], v19, s[8:11], s86 offen sc1
 s_xor_b32 s86, s4, 8192
 buffer_load_dwordx2 v[96:97], v19, s[8:11], s86 offen sc1
 s_xor_b32 s86, s4, 10240
 buffer_load_dwordx2 v[98:99], v19, s[8:11], s86 offen sc1
 s_xor_b32 s86, s4, 12288
 buffer_load_dwordx2 v[100:101], v19, s[8:11], s86 offen sc1
 s_xor_b32 s86, s4, 14336
 buffer_load_dwordx2 v[102:103], v19, s[8:11], s86 offen sc1
 v_exp_f32 v160, v160
 v_exp_f32 v48, v48
 v_exp_f32 v161, v161
 v_exp_f32 v49, v49
 v_exp_f32 v162, v162
 v_exp_f32 v50, v50
 v_exp_f32 v163, v163
 v_exp_f32 v51, v51
 v_exp_f32 v164, v164
 v_exp_f32 v52, v52
 v_exp_f32 v165, v165
 v_exp_f32 v53, v53
 v_exp_f32 v166, v166
 v_exp_f32 v54, v54
 v_exp_f32 v167, v167
 v_exp_f32 v55, v55
 v_exp_f32 v168, v168
 v_exp_f32 v56, v56
 v_exp_f32 v169, v169
 v_exp_f32 v57, v57
 v_exp_f32 v170, v170
 v_exp_f32 v58, v58
 v_exp_f32 v171, v171
 v_exp_f32 v59, v59
 v_pk_add_f32 v[172:173], v[152:153], v[154:155]
 v_pk_add_f32 v[220:221], v[40:41], v[42:43]
 v_pk_add_f32 v[174:175], v[162:163], v[164:165]
 v_pk_add_f32 v[222:223], v[50:51], v[52:53]
 v_pk_add_f32 v[172:173], v[172:173], v[156:157]
 v_pk_add_f32 v[220:221], v[220:221], v[44:45]
 v_pk_add_f32 v[174:175], v[174:175], v[166:167]
 v_pk_add_f32 v[222:223], v[222:223], v[54:55]
 v_pk_add_f32 v[172:173], v[172:173], v[158:159]
 v_pk_add_f32 v[220:221], v[220:221], v[46:47]
 v_pk_add_f32 v[174:175], v[174:175], v[168:169]
 v_pk_add_f32 v[222:223], v[222:223], v[56:57]
 v_pk_add_f32 v[172:173], v[172:173], v[160:161]
 v_pk_add_f32 v[220:221], v[220:221], v[48:49]
 v_pk_add_f32 v[174:175], v[174:175], v[170:171]
 v_pk_add_f32 v[222:223], v[222:223], v[58:59]
 v_add_f32 v172, v172, v173
 v_add_f32 v220, v220, v221
 v_add_f32 v173, v174, v175
 v_add_f32 v221, v222, v223
 s_nop 0
 v_permlane32_swap_b32 v172, v173
 v_permlane32_swap_b32 v220, v221
 v_add_f32 v172, v172, v173
 v_add_f32 v220, v220, v221
 v_rcp_f32 v172, v172
 v_rcp_f32 v220, v220
 v_mov_b32 v173, v172
 v_mov_b32 v221, v220
 s_nop 0
 v_permlane32_swap_b32 v172, v173
 v_permlane32_swap_b32 v220, v221
 v_pk_mul_f32 v[152:153], v[172:173], v[152:153] op_sel_hi:[0,1]
 v_pk_mul_f32 v[40:41], v[220:221], v[40:41] op_sel_hi:[0,1]
 v_cvt_pk_bf16_f32 v232, v152, v153
 v_cvt_pk_bf16_f32 v244, v40, v41
 v_pk_mul_f32 v[154:155], v[172:173], v[154:155] op_sel_hi:[0,1]
 v_pk_mul_f32 v[42:43], v[220:221], v[42:43] op_sel_hi:[0,1]
 v_cvt_pk_bf16_f32 v233, v154, v155
 v_cvt_pk_bf16_f32 v245, v42, v43
 v_pk_mul_f32 v[156:157], v[172:173], v[156:157] op_sel_hi:[0,1]
 v_pk_mul_f32 v[44:45], v[220:221], v[44:45] op_sel_hi:[0,1]
 v_cvt_pk_bf16_f32 v234, v156, v157
 v_cvt_pk_bf16_f32 v246, v44, v45
 v_pk_mul_f32 v[158:159], v[172:173], v[158:159] op_sel_hi:[0,1]
 v_pk_mul_f32 v[46:47], v[220:221], v[46:47] op_sel_hi:[0,1]
 v_cvt_pk_bf16_f32 v235, v158, v159
 v_cvt_pk_bf16_f32 v247, v46, v47
 v_pk_mul_f32 v[160:161], v[172:173], v[160:161] op_sel_hi:[0,1]
 v_pk_mul_f32 v[48:49], v[220:221], v[48:49] op_sel_hi:[0,1]
 v_cvt_pk_bf16_f32 v236, v160, v161
 v_cvt_pk_bf16_f32 v248, v48, v49
 v_pk_mul_f32 v[162:163], v[172:173], v[162:163] op_sel:[1,0] op_sel_hi:[1,1]
 v_pk_mul_f32 v[50:51], v[220:221], v[50:51] op_sel:[1,0] op_sel_hi:[1,1]
 v_cvt_pk_bf16_f32 v237, v162, v163
 v_cvt_pk_bf16_f32 v249, v50, v51
 v_pk_mul_f32 v[164:165], v[172:173], v[164:165] op_sel:[1,0] op_sel_hi:[1,1]
 v_pk_mul_f32 v[52:53], v[220:221], v[52:53] op_sel:[1,0] op_sel_hi:[1,1]
 v_cvt_pk_bf16_f32 v238, v164, v165
 v_cvt_pk_bf16_f32 v250, v52, v53
 v_pk_mul_f32 v[166:167], v[172:173], v[166:167] op_sel:[1,0] op_sel_hi:[1,1]
 v_pk_mul_f32 v[54:55], v[220:221], v[54:55] op_sel:[1,0] op_sel_hi:[1,1]
 v_cvt_pk_bf16_f32 v239, v166, v167
 v_cvt_pk_bf16_f32 v251, v54, v55
 v_pk_mul_f32 v[168:169], v[172:173], v[168:169] op_sel:[1,0] op_sel_hi:[1,1]
 v_pk_mul_f32 v[56:57], v[220:221], v[56:57] op_sel:[1,0] op_sel_hi:[1,1]
 v_cvt_pk_bf16_f32 v240, v168, v169
 v_cvt_pk_bf16_f32 v252, v56, v57
 v_pk_mul_f32 v[170:171], v[172:173], v[170:171] op_sel:[1,0] op_sel_hi:[1,1]
 v_pk_mul_f32 v[58:59], v[220:221], v[58:59] op_sel:[1,0] op_sel_hi:[1,1]
 v_cvt_pk_bf16_f32 v241, v170, v171
 v_cvt_pk_bf16_f32 v253, v58, v59
 v_mov_b32 v242, 0
 v_mov_b32 v254, 0
 v_mov_b32 v243, 0
 v_mov_b32 v255, 0
 v_mov_b32 v25, 0x3f80
 v_mov_b32 v26, 0x3f800000
 v_mov_b32 v74, 0
 v_mov_b32 v75, 0
fkvspin_16:
 s_waitcnt lgkmcnt(0)
 v_dot2_f32_bf16 v60, v88, v25, 0
 v_dot2_f32_bf16 v61, v88, v26, 0
 v_dot2_f32_bf16 v62, v89, v25, 0
 v_dot2_f32_bf16 v63, v89, v26, 0
 s_waitcnt vmcnt(6)
 v_max3_u32 v172, 0, v90, v91
 v_dot2_f32_bf16 v60, v90, v25, v60
 v_dot2_f32_bf16 v61, v90, v26, v61
 v_dot2_f32_bf16 v62, v91, v25, v62
 v_dot2_f32_bf16 v63, v91, v26, v63
 s_waitcnt vmcnt(5)
 v_max3_u32 v172, v172, v92, v93
 v_dot2_f32_bf16 v60, v92, v25, v60
 v_dot2_f32_bf16 v61, v92, v26, v61
 v_dot2_f32_bf16 v62, v93, v25, v62
 v_dot2_f32_bf16 v63, v93, v26, v63
 s_waitcnt vmcnt(4)
 v_max3_u32 v172, v172, v94, v95
 v_dot2_f32_bf16 v60, v94, v25, v60
 v_dot2_f32_bf16 v61, v94, v26, v61
 v_dot2_f32_bf16 v62, v95, v25, v62
 v_dot2_f32_bf16 v63, v95, v26, v63
 s_waitcnt vmcnt(3)
 v_max3_u32 v172, v172, v96, v97
 v_dot2_f32_bf16 v60, v96, v25, v60
 v_dot2_f32_bf16 v61, v96, v26, v61
 v_dot2_f32_bf16 v62, v97, v25, v62
 v_dot2_f32_bf16 v63, v97, v26, v63
 s_waitcnt vmcnt(2)
 v_max3_u32 v172, v172, v98, v99
 v_dot2_f32_bf16 v60, v98, v25, v60
 v_dot2_f32_bf16 v61, v98, v26, v61
 v_dot2_f32_bf16 v62, v99, v25, v62
 v_dot2_f32_bf16 v63, v99, v26, v63
 s_waitcnt vmcnt(1)
 v_max3_u32 v172, v172, v100, v101
 v_dot2_f32_bf16 v60, v100, v25, v60
 v_dot2_f32_bf16 v61, v100, v26, v61
 v_dot2_f32_bf16 v62, v101, v25, v62
 v_dot2_f32_bf16 v63, v101, v26, v63
 s_waitcnt vmcnt(0)
 v_max3_u32 v172, v172, v102, v103
 v_cmp_eq_u32 vcc, -1, v172
 v_dot2_f32_bf16 v60, v102, v25, v60
 v_dot2_f32_bf16 v61, v102, v26, v61
 v_dot2_f32_bf16 v62, v103, v25, v62
 v_dot2_f32_bf16 v63, v103, v26, v63
 s_cbranch_vccz fkvok_17
fkvretry_18:
 s_xor_b32 s86, s4, 2048
 buffer_load_dwordx2 v[90:91], v19, s[8:11], s86 offen sc1
 s_xor_b32 s86, s4, 4096
 buffer_load_dwordx2 v[92:93], v19, s[8:11], s86 offen sc1
 s_xor_b32 s86, s4, 6144
 buffer_load_dwordx2 v[94:95], v19, s[8:11], s86 offen sc1
 s_xor_b32 s86, s4, 8192
 buffer_load_dwordx2 v[96:97], v19, s[8:11], s86 offen sc1
 s_xor_b32 s86, s4, 10240
 buffer_load_dwordx2 v[98:99], v19, s[8:11], s86 offen sc1
 s_xor_b32 s86, s4, 12288
 buffer_load_dwordx2 v[100:101], v19, s[8:11], s86 offen sc1
 s_xor_b32 s86, s4, 14336
 buffer_load_dwordx2 v[102:103], v19, s[8:11], s86 offen sc1
 s_waitcnt vmcnt(6)
 v_max3_u32 v172, 0, v90, v91
 s_waitcnt vmcnt(5)
 v_max3_u32 v172, v172, v92, v93
 s_waitcnt vmcnt(4)
 v_max3_u32 v172, v172, v94, v95
 s_waitcnt vmcnt(3)
 v_max3_u32 v172, v172, v96, v97
 s_waitcnt vmcnt(2)
 v_max3_u32 v172, v172, v98, v99
 s_waitcnt vmcnt(1)
 v_max3_u32 v172, v172, v100, v101
 s_waitcnt vmcnt(0)
 v_max3_u32 v172, v172, v102, v103
 v_cmp_eq_u32 vcc, -1, v172
 s_cbranch_vccz fkvspin_16
 s_add_u32 s29, s29, 1
 s_cmp_lt_u32 s29, 524288
 s_cbranch_scc1 fkvretry_18
fkvok_17:
 s_nop 1
 v_cvt_pk_bf16_f32 v88, v60, v61
 v_cvt_pk_bf16_f32 v89, v62, v63
 ds_write_b64 v20, v[88:89]
 buffer_load_dwordx4 a[156:159], v38, s[8:11], s66 offen offset:1024 sc1
 buffer_load_dwordx4 a[160:163], v38, s[8:11], s66 offen offset:2048 sc1
 buffer_load_dwordx4 v[124:127], v38, s[8:11], s69 offen offset:1024 sc1
 buffer_load_dwordx4 v[128:131], v38, s[8:11], s69 offen offset:2048 sc1
 s_waitcnt lgkmcnt(0)
 s_barrier
 ds_read_b128 v[64:67], v1 offset:35840
 ds_read_b128 v[68:71], v1 offset:36864
 ds_read_b64 v[72:73], v1 offset:37888
 s_waitcnt lgkmcnt(2)
 v_mfma_f32_32x32x16_bf16 v[184:199], v[64:67], v[232:235], 0
 s_waitcnt lgkmcnt(1)
 v_mfma_f32_32x32x16_bf16 v[184:199], v[68:71], v[236:239], v[184:199]
 s_waitcnt lgkmcnt(0)
 v_mfma_f32_32x32x16_bf16 v[184:199], v[72:75], v[240:243], v[184:199]
 v_mfma_f32_32x32x16_bf16 v[136:151], v[64:67], v[244:247], 0
 v_mfma_f32_32x32x16_bf16 v[136:151], v[68:71], v[248:251], v[136:151]
 v_mfma_f32_32x32x16_bf16 v[136:151], v[72:75], v[252:255], v[136:151]
 s_nop 8
 v_add_f32 v196, 0x358637bd, v196
 v_rcp_f32 v196, v196
 s_nop 0
 v_mul_f32 v184, v184, v196
 v_mul_f32 v185, v185, v196
 v_cvt_pk_bf16_f32 v40, v184, v185
 v_mul_f32 v186, v186, v196
 v_mul_f32 v187, v187, v196
 v_cvt_pk_bf16_f32 v41, v186, v187
 v_mul_f32 v188, v188, v196
 v_mul_f32 v189, v189, v196
 v_cvt_pk_bf16_f32 v42, v188, v189
 v_pk_mul_f32 v[190:191], v[190:191], v[196:197] op_sel_hi:[1,0]
 v_cvt_pk_bf16_f32 v43, v190, v191
 buffer_store_dwordx4 v[40:43], v6, s[8:11], 0 offen
 v_pk_mul_f32 v[192:193], v[192:193], v[196:197] op_sel_hi:[1,0]
 v_cvt_pk_bf16_f32 v44, v192, v193
 v_pk_mul_f32 v[194:195], v[194:195], v[196:197] op_sel_hi:[1,0]
 v_cvt_pk_bf16_f32 v45, v194, v195
 buffer_store_dwordx2 v[44:45], v7, s[8:11], 0 offen
 v_add_f32 v148, 0x358637bd, v148
 v_rcp_f32 v148, v148
 s_nop 0
 v_pk_mul_f32 v[136:137], v[136:137], v[148:149] op_sel_hi:[1,0]
 v_cvt_pk_bf16_f32 v48, v136, v137
 v_pk_mul_f32 v[138:139], v[138:139], v[148:149] op_sel_hi:[1,0]
 v_cvt_pk_bf16_f32 v49, v138, v139
 v_pk_mul_f32 v[140:141], v[140:141], v[148:149] op_sel_hi:[1,0]
 v_cvt_pk_bf16_f32 v50, v140, v141
 v_pk_mul_f32 v[142:143], v[142:143], v[148:149] op_sel_hi:[1,0]
 v_cvt_pk_bf16_f32 v51, v142, v143
 buffer_store_dwordx4 v[48:51], v6, s[8:11], s0 offen
 v_pk_mul_f32 v[144:145], v[144:145], v[148:149] op_sel_hi:[1,0]
 v_cvt_pk_bf16_f32 v52, v144, v145
 v_pk_mul_f32 v[146:147], v[146:147], v[148:149] op_sel_hi:[1,0]
 v_cvt_pk_bf16_f32 v53, v146, v147
 buffer_store_dwordx2 v[52:53], v7, s[8:11], s0 offen
 s_add_u32 m0, s28, 147456
 s_add_u32 s85, s35, 65536
 buffer_load_dwordx4 v3, s[8:11], s85 offen sc1 lds
 buffer_load_dwordx4 v3, s[8:11], s85 offen offset:1024 sc1 lds
 s_add_u32 s31, s22, 3
 s_and_b32 s31, s31, 3
 s_mul_i32 s31, s31, 5120
 s_add_u32 s31, s31, 2048
 v_add_u32 v220, s31, v22
 s_add_u32 s31, s22, 2
 s_and_b32 s31, s31, 3
 s_mul_i32 s31, s31, 5120
 s_add_u32 s31, s31, 2048
 v_add_u32 v221, s31, v22
 s_add_u32 s31, s22, 1
 s_and_b32 s31, s31, 3
 s_mul_i32 s31, s31, 5120
 s_add_u32 s31, s31, 2048
 v_add_u32 v222, s31, v22
 v_lshlrev_b32 v192, 16, v28
 v_and_b32 v193, 0xffff0000, v28
 v_lshlrev_b32 v194, 16, v29
 v_and_b32 v195, 0xffff0000, v29
 v_lshlrev_b32 v196, 16, v30
 v_and_b32 v197, 0xffff0000, v30
 v_lshlrev_b32 v198, 16, v31
 v_and_b32 v199, 0xffff0000, v31
 v_lshlrev_b32 v200, 16, v32
 v_and_b32 v201, 0xffff0000, v32
 v_lshlrev_b32 v202, 16, v33
 v_and_b32 v203, 0xffff0000, v33
 v_lshlrev_b32 v204, 16, v34
 v_and_b32 v205, 0xffff0000, v34
 v_lshlrev_b32 v206, 16, v35
 v_and_b32 v207, 0xffff0000, v35
 v_lshlrev_b32 v208, 16, v36
 v_and_b32 v209, 0xffff0000, v36
 v_lshlrev_b32 v210, 16, v37
 v_and_b32 v211, 0xffff0000, v37
 s_add_u32 s30, s52, 4096
 s_add_u32 s31, s53, 4096
 s_add_u32 s32, s54, 4096
 s_add_u32 s33, s55, 4096
 v_mov_b32 v27, 2
 s_waitcnt vmcnt(2)
 s_mov_b64 exec, 1
 buffer_store_dword v27, off, s[8:11], s46
 s_mov_b64 exec, -1
 buffer_load_dwordx4 v[132:135], v38, s[8:11], s69 offen offset:3072 sc1
 buffer_load_dwordx4 v[216:219], v38, s[8:11], s70 offen sc1
 v_and_b32 v25, 28, v22
 buffer_load_dword v26, v25, s[8:11], s47 offen sc1
fspin_19:
 buffer_load_dword v0, v25, s[8:11], s47 offen sc1
 s_waitcnt vmcnt(1)
 v_cmp_gt_u32 vcc, 2, v26
 s_cbranch_vccz fok_20
 buffer_load_dword v26, v25, s[8:11], s47 offen sc1
 s_waitcnt vmcnt(1)
 v_cmp_gt_u32 vcc, 2, v0
 s_cbranch_vccz fok_20
 s_add_u32 s29, s29, 1
 s_cmp_lt_u32 s29, 524288
 s_cbranch_scc1 fspin_19
fok_20:
 buffer_load_dwordx4 v[40:43], v1, s[8:11], s52 offen sc1
 buffer_load_dwordx4 v[44:47], v1, s[8:11], s52 offen offset:1024 sc1
 buffer_load_dwordx4 v[48:51], v1, s[8:11], s52 offen offset:2048 sc1
 buffer_load_dwordx4 v[52:55], v1, s[8:11], s52 offen offset:3072 sc1
 s_waitcnt vmcnt(3)
 v_mfma_f32_16x16x32_bf16 v[152:155], a[120:123], v[40:43], 0
 buffer_load_dwordx4 v[56:59], v1, s[8:11], s30 offen sc1
 v_mfma_f32_16x16x32_bf16 v[156:159], a[124:127], v[40:43], 0
 v_mfma_f32_16x16x32_bf16 v[160:163], a[128:131], v[40:43], 0
 v_mfma_f32_16x16x32_bf16 v[164:167], a[132:135], v[40:43], 0
 v_mfma_f32_16x16x32_bf16 v[168:171], a[136:139], v[40:43], 0
 s_waitcnt vmcnt(3)
 buffer_load_dwordx4 v[60:63], v1, s[8:11], s53 offen sc1
 v_mfma_f32_16x16x32_bf16 v[152:155], a[140:143], v[44:47], v[152:155]
 v_mfma_f32_16x16x32_bf16 v[156:159], a[144:147], v[44:47], v[156:159]
 v_mfma_f32_16x16x32_bf16 v[160:163], a[148:151], v[44:47], v[160:163]
 v_mfma_f32_16x16x32_bf16 v[164:167], a[152:155], v[44:47], v[164:167]
 buffer_load_dwordx4 v[64:67], v1, s[8:11], s53 offen offset:1024 sc1
 v_mfma_f32_16x16x32_bf16 v[168:171], a[156:159], v[44:47], v[168:171]
 s_waitcnt vmcnt(4)
 v_mfma_f32_16x16x32_bf16 v[152:155], a[160:163], v[48:51], v[152:155]
 v_mfma_f32_16x16x32_bf16 v[156:159], a[100:103], v[48:51], v[156:159]
 v_mfma_f32_16x16x32_bf16 v[160:163], a[104:107], v[48:51], v[160:163]
 buffer_load_dwordx4 v[68:71], v1, s[8:11], s53 offen offset:2048 sc1
 v_mfma_f32_16x16x32_bf16 v[164:167], a[108:111], v[48:51], v[164:167]
 v_mfma_f32_16x16x32_bf16 v[168:171], a[112:115], v[48:51], v[168:171]
 s_waitcnt vmcnt(4)
 v_mfma_f32_16x16x32_bf16 v[152:155], a[116:119], v[52:55], v[152:155]
 v_mfma_f32_16x16x32_bf16 v[156:159], v[104:107], v[52:55], v[156:159]
 buffer_load_dwordx4 v[72:75], v1, s[8:11], s53 offen offset:3072 sc1
 v_mfma_f32_16x16x32_bf16 v[160:163], v[108:111], v[52:55], v[160:163]
 v_mfma_f32_16x16x32_bf16 v[164:167], v[112:115], v[52:55], v[164:167]
 v_mfma_f32_16x16x32_bf16 v[168:171], v[116:119], v[52:55], v[168:171]
 s_waitcnt vmcnt(4)
 v_mfma_f32_16x16x32_bf16 v[152:155], v[120:123], v[56:59], v[152:155]
 buffer_load_dwordx4 v[76:79], v1, s[8:11], s31 offen sc1
 v_mfma_f32_16x16x32_bf16 v[156:159], v[124:127], v[56:59], v[156:159]
 v_mfma_f32_16x16x32_bf16 v[160:163], v[128:131], v[56:59], v[160:163]
 v_mfma_f32_16x16x32_bf16 v[164:167], v[132:135], v[56:59], v[164:167]
 v_mfma_f32_16x16x32_bf16 v[168:171], v[216:219], v[56:59], v[168:171]
 s_waitcnt vmcnt(4)
 buffer_load_dwordx4 v[80:83], v1, s[8:11], s54 offen sc1
 v_mfma_f32_16x16x32_bf16 v[172:175], a[120:123], v[60:63], 0
 v_mfma_f32_16x16x32_bf16 v[176:179], a[124:127], v[60:63], 0
 v_mfma_f32_16x16x32_bf16 v[180:183], a[128:131], v[60:63], 0
 s_mov_b32 m0, s7
 s_nop 0
 ds_write_addtid_b32 v152
 ds_write_addtid_b32 v153 offset:256
 v_mfma_f32_16x16x32_bf16 v[184:187], a[132:135], v[60:63], 0
 buffer_load_dwordx4 v[84:87], v1, s[8:11], s54 offen offset:1024 sc1
 ds_write_addtid_b32 v154 offset:512
 v_mfma_f32_16x16x32_bf16 v[188:191], a[136:139], v[60:63], 0
 s_waitcnt vmcnt(5)
 ds_write_addtid_b32 v155 offset:768
 ds_write_addtid_b32 v156 offset:1024
 v_mfma_f32_16x16x32_bf16 v[172:175], a[140:143], v[64:67], v[172:175]
 ds_write_addtid_b32 v157 offset:1280
 ds_write_addtid_b32 v158 offset:1536
 v_mfma_f32_16x16x32_bf16 v[176:179], a[144:147], v[64:67], v[176:179]
 ds_write_addtid_b32 v159 offset:1792
 ds_write_addtid_b32 v160 offset:2048
 v_mfma_f32_16x16x32_bf16 v[180:183], a[148:151], v[64:67], v[180:183]
 buffer_load_dwordx4 v[88:91], v1, s[8:11], s54 offen offset:2048 sc1
 ds_write_addtid_b32 v161 offset:2304
 ds_write_addtid_b32 v162 offset:2560
 v_mfma_f32_16x16x32_bf16 v[184:187], a[152:155], v[64:67], v[184:187]
 ds_write_addtid_b32 v163 offset:2816
 ds_write_addtid_b32 v164 offset:3072
 v_mfma_f32_16x16x32_bf16 v[188:191], a[156:159], v[64:67], v[188:191]
 s_waitcnt vmcnt(5)
 ds_write_addtid_b32 v165 offset:3328
 ds_write_addtid_b32 v166 offset:3584
 v_mfma_f32_16x16x32_bf16 v[172:175], a[160:163], v[68:71], v[172:175]
 ds_write_addtid_b32 v167 offset:3840
 ds_write_addtid_b32 v168 offset:4096
 v_mfma_f32_16x16x32_bf16 v[176:179], a[100:103], v[68:71], v[176:179]
 buffer_load_dwordx4 v[92:95], v1, s[8:11], s54 offen offset:3072 sc1
 ds_write_addtid_b32 v169 offset:4352
 v_mfma_f32_16x16x32_bf16 v[180:183], a[104:107], v[68:71], v[180:183]
 ds_write_addtid_b32 v170 offset:4608
 ds_write_addtid_b32 v171 offset:4864
 v_mfma_f32_16x16x32_bf16 v[184:187], a[108:111], v[68:71], v[184:187]
 v_mfma_f32_16x16x32_bf16 v[188:191], a[112:115], v[68:71], v[188:191]
 s_waitcnt vmcnt(5)
 v_mfma_f32_16x16x32_bf16 v[172:175], a[116:119], v[72:75], v[172:175]
 buffer_load_dwordx4 v[96:99], v1, s[8:11], s32 offen sc1
 v_mfma_f32_16x16x32_bf16 v[176:179], v[104:107], v[72:75], v[176:179]
 s_waitcnt lgkmcnt(0)
 s_barrier
 v_mfma_f32_16x16x32_bf16 v[180:183], v[108:111], v[72:75], v[180:183]
 ds_read2st64_b32 v[40:41], v220 offset0:0 offset1:1
 v_mfma_f32_16x16x32_bf16 v[184:187], v[112:115], v[72:75], v[184:187]
 ds_read2st64_b32 v[42:43], v220 offset0:2 offset1:3
 v_mfma_f32_16x16x32_bf16 v[188:191], v[116:119], v[72:75], v[188:191]
 s_waitcnt vmcnt(5)
 buffer_load_dwordx4 v[100:103], v1, s[8:11], s55 offen sc1
 ds_read2st64_b32 v[44:45], v220 offset0:4 offset1:5
 v_mfma_f32_16x16x32_bf16 v[172:175], v[120:123], v[76:79], v[172:175]
 ds_read2st64_b32 v[46:47], v220 offset0:6 offset1:7
 v_mfma_f32_16x16x32_bf16 v[176:179], v[124:127], v[76:79], v[176:179]
 ds_read2st64_b32 v[48:49], v220 offset0:8 offset1:9
 v_mfma_f32_16x16x32_bf16 v[180:183], v[128:131], v[76:79], v[180:183]
 ds_read2st64_b32 v[50:51], v220 offset0:10 offset1:11
 v_mfma_f32_16x16x32_bf16 v[184:187], v[132:135], v[76:79], v[184:187]
 buffer_load_dwordx4 v[136:139], v1, s[8:11], s55 offen offset:1024 sc1
 ds_read2st64_b32 v[52:53], v220 offset0:12 offset1:13
 v_mfma_f32_16x16x32_bf16 v[188:191], v[216:219], v[76:79], v[188:191]
 s_waitcnt vmcnt(6)
 ds_read2st64_b32 v[54:55], v220 offset0:14 offset1:15
 v_mfma_f32_16x16x32_bf16 v[152:155], a[120:123], v[80:83], 0
 ds_read2st64_b32 v[56:57], v220 offset0:16 offset1:17
 v_mfma_f32_16x16x32_bf16 v[156:159], a[124:127], v[80:83], 0
 ds_read2st64_b32 v[58:59], v220 offset0:18 offset1:19
 v_mfma_f32_16x16x32_bf16 v[160:163], a[128:131], v[80:83], 0
 buffer_load_dwordx4 v[140:143], v1, s[8:11], s55 offen offset:2048 sc1
 ds_write_addtid_b32 v172 offset:20480
 v_mfma_f32_16x16x32_bf16 v[164:167], a[132:135], v[80:83], 0
 ds_write_addtid_b32 v173 offset:20736
 ds_write_addtid_b32 v174 offset:20992
 v_mfma_f32_16x16x32_bf16 v[168:171], a[136:139], v[80:83], 0
 s_waitcnt vmcnt(6) lgkmcnt(12)
 ds_write_addtid_b32 v175 offset:21248
 ds_write_addtid_b32 v176 offset:21504
 ds_write_addtid_b32 v177 offset:21760
 v_add_f32 v192, v192, v40
 v_mfma_f32_16x16x32_bf16 v[152:155], a[140:143], v[84:87], v[152:155]
 ds_write_addtid_b32 v178 offset:22016
 ds_write_addtid_b32 v179 offset:22272
 v_mfma_f32_16x16x32_bf16 v[156:159], a[144:147], v[84:87], v[156:159]
 buffer_load_dwordx4 v[144:147], v1, s[8:11], s55 offen offset:3072 sc1
 ds_write_addtid_b32 v180 offset:22528
 v_add_f32 v193, v193, v41
 v_mfma_f32_16x16x32_bf16 v[160:163], a[148:151], v[84:87], v[160:163]
 ds_write_addtid_b32 v181 offset:22784
 ds_write_addtid_b32 v182 offset:23040
 v_mfma_f32_16x16x32_bf16 v[164:167], a[152:155], v[84:87], v[164:167]
 ds_write_addtid_b32 v183 offset:23296
 ds_write_addtid_b32 v184 offset:23552
 v_mfma_f32_16x16x32_bf16 v[168:171], a[156:159], v[84:87], v[168:171]
 s_waitcnt vmcnt(6) lgkmcnt(13)
 ds_write_addtid_b32 v185 offset:23808
 ds_write_addtid_b32 v186 offset:24064
 v_add_f32 v194, v194, v42
 v_mfma_f32_16x16x32_bf16 v[152:155], a[160:163], v[88:91], v[152:155]
 buffer_load_dwordx4 v[148:151], v1, s[8:11], s33 offen sc1
 ds_write_addtid_b32 v187 offset:24320
 ds_write_addtid_b32 v188 offset:24576
 v_mfma_f32_16x16x32_bf16 v[156:159], a[100:103], v[88:91], v[156:159]
 s_add_u32 m0, s28, 131072
 s_add_u32 s85, s35, 49152
 buffer_load_dwordx4 v3, s[8:11], s85 offen sc1 lds
 s_mov_b32 m0, s7
 s_nop 0
 ds_write_addtid_b32 v189 offset:24832
 v_add_f32 v195, v195, v43
 v_mfma_f32_16x16x32_bf16 v[160:163], a[104:107], v[88:91], v[160:163]
 ds_write_addtid_b32 v190 offset:25088
 ds_write_addtid_b32 v191 offset:25344
 v_mfma_f32_16x16x32_bf16 v[164:167], a[108:111], v[88:91], v[164:167]
 v_add_f32 v196, v196, v44
 v_add_f32 v197, v197, v45
 v_mfma_f32_16x16x32_bf16 v[168:171], a[112:115], v[88:91], v[168:171]
 s_waitcnt vmcnt(7)
 s_add_u32 m0, s28, 131072
 s_nop 0
 buffer_load_dwordx4 v3, s[8:11], s85 offen offset:1024 sc1 lds
 v_add_f32 v198, v198, v46
 v_add_f32 v199, v199, v47
 v_mfma_f32_16x16x32_bf16 v[152:155], a[116:119], v[92:95], v[152:155]
 v_add_f32 v200, v200, v48
 v_add_f32 v201, v201, v49
 v_mfma_f32_16x16x32_bf16 v[156:159], v[104:107], v[92:95], v[156:159]
 s_waitcnt lgkmcnt(0)
 s_barrier
 v_add_f32 v202, v202, v50
 v_add_f32 v203, v203, v51
 v_mfma_f32_16x16x32_bf16 v[160:163], v[108:111], v[92:95], v[160:163]
pad9:
 s_cbranch_execz pad13
 ds_read2st64_b32 v[60:61], v221 offset0:80 offset1:81
 v_add_f32 v204, v204, v52
 v_add_f32 v205, v205, v53
 v_mfma_f32_16x16x32_bf16 v[164:167], v[112:115], v[92:95], v[164:167]
 buffer_load_dwordx4 v3, s[8:11], s85 offen offset:2048 sc1 lds
 ds_read2st64_b32 v[62:63], v221 offset0:82 offset1:83
 v_mfma_f32_16x16x32_bf16 v[168:171], v[116:119], v[92:95], v[168:171]
 s_waitcnt vmcnt(8)
 ds_read2st64_b32 v[64:65], v221 offset0:84 offset1:85
 v_add_f32 v206, v206, v54
 v_mfma_f32_16x16x32_bf16 v[152:155], v[120:123], v[96:99], v[152:155]
 ds_read2st64_b32 v[66:67], v221 offset0:86 offset1:87
 v_add_f32 v207, v207, v55
 v_add_f32 v208, v208, v56
 v_mfma_f32_16x16x32_bf16 v[156:159], v[124:127], v[96:99], v[156:159]
 buffer_load_dwordx4 v3, s[8:11], s85 offen offset:3072 sc1 lds
 ds_read2st64_b32 v[68:69], v221 offset0:88 offset1:89
 v_mfma_f32_16x16x32_bf16 v[160:163], v[128:131], v[96:99], v[160:163]
 ds_read2st64_b32 v[70:71], v221 offset0:90 offset1:91
 v_add_f32 v209, v209, v57
 v_add_f32 v210, v210, v58
 v_mfma_f32_16x16x32_bf16 v[164:167], v[132:135], v[96:99], v[164:167]
 ds_read2st64_b32 v[72:73], v221 offset0:92 offset1:93
 v_add_f32 v211, v211, v59
 v_mfma_f32_16x16x32_bf16 v[168:171], v[216:219], v[96:99], v[168:171]
 s_waitcnt vmcnt(8)
 ds_read2st64_b32 v[74:75], v221 offset0:94 offset1:95
 v_mfma_f32_16x16x32_bf16 v[192:195], a[120:123], v[100:103], v[192:195]
 s_add_u32 m0, s28, 147456
 s_add_u32 s85, s35, 65536
 buffer_load_dwordx4 v3, s[8:11], s85 offen offset:2048 sc1 lds
 ds_read2st64_b32 v[76:77], v221 offset0:96 offset1:97
 v_mfma_f32_16x16x32_bf16 v[196:199], a[124:127], v[100:103], v[196:199]
 ds_read2st64_b32 v[78:79], v221 offset0:98 offset1:99
 v_mfma_f32_16x16x32_bf16 v[200:203], a[128:131], v[100:103], v[200:203]
 s_mov_b32 m0, s7
 s_nop 0
 ds_write_addtid_b32 v152
 ds_write_addtid_b32 v153 offset:256
 v_mfma_f32_16x16x32_bf16 v[204:207], a[132:135], v[100:103], v[204:207]
 ds_write_addtid_b32 v154 offset:512
 ds_write_addtid_b32 v155 offset:768
 v_mfma_f32_16x16x32_bf16 v[208:211], a[136:139], v[100:103], v[208:211]
 s_waitcnt vmcnt(8)
 ds_write_addtid_b32 v156 offset:1024
 ds_write_addtid_b32 v157 offset:1280
 v_mfma_f32_16x16x32_bf16 v[192:195], a[140:143], v[136:139], v[192:195]
 ds_write_addtid_b32 v158 offset:1536
 ds_write_addtid_b32 v159 offset:1792
 v_mfma_f32_16x16x32_bf16 v[196:199], a[144:147], v[136:139], v[196:199]
 ds_write_addtid_b32 v160 offset:2048
 ds_write_addtid_b32 v161 offset:2304
 v_mfma_f32_16x16x32_bf16 v[200:203], a[148:151], v[136:139], v[200:203]
 ds_write_addtid_b32 v162 offset:2560
 v_mfma_f32_16x16x32_bf16 v[204:207], a[152:155], v[136:139], v[204:207]
 ds_write_addtid_b32 v163 offset:2816
 ds_write_addtid_b32 v164 offset:3072
 v_mfma_f32_16x16x32_bf16 v[208:211], a[156:159], v[136:139], v[208:211]
 s_waitcnt vmcnt(7)
 ds_write_addtid_b32 v165 offset:3328
 ds_write_addtid_b32 v166 offset:3584
 v_mfma_f32_16x16x32_bf16 v[192:195], a[160:163], v[140:143], v[192:195]
 ds_write_addtid_b32 v167 offset:3840
 ds_write_addtid_b32 v168 offset:4096
 v_mfma_f32_16x16x32_bf16 v[196:199], a[100:103], v[140:143], v[196:199]
 ds_write_addtid_b32 v169 offset:4352
 ds_write_addtid_b32 v170 offset:4608
 v_mfma_f32_16x16x32_bf16 v[200:203], a[104:107], v[140:143], v[200:203]
 s_add_u32 m0, s28, 147456
 s_nop 0
 buffer_load_dwordx4 v3, s[8:11], s85 offen offset:3072 sc1 lds
 s_mov_b32 m0, s7
 s_nop 0
 ds_write_addtid_b32 v171 offset:4864
 v_mfma_f32_16x16x32_bf16 v[204:207], a[108:111], v[140:143], v[204:207]
 v_mfma_f32_16x16x32_bf16 v[208:211], a[112:115], v[140:143], v[208:211]
 s_waitcnt vmcnt(7)
 v_mfma_f32_16x16x32_bf16 v[192:195], a[116:119], v[144:147], v[192:195]
 v_mfma_f32_16x16x32_bf16 v[196:199], v[104:107], v[144:147], v[196:199]
 s_waitcnt lgkmcnt(0)
 s_barrier
 v_mfma_f32_16x16x32_bf16 v[200:203], v[108:111], v[144:147], v[200:203]
 ds_read2st64_b32 v[40:41], v222 offset0:0 offset1:1
 v_mfma_f32_16x16x32_bf16 v[204:207], v[112:115], v[144:147], v[204:207]
 ds_read2st64_b32 v[42:43], v222 offset0:2 offset1:3
 v_mfma_f32_16x16x32_bf16 v[208:211], v[116:119], v[144:147], v[208:211]
 s_waitcnt vmcnt(6)
 ds_read2st64_b32 v[44:45], v222 offset0:4 offset1:5
 v_mfma_f32_16x16x32_bf16 v[192:195], v[120:123], v[148:151], v[192:195]
 ds_read2st64_b32 v[46:47], v222 offset0:6 offset1:7
 v_mfma_f32_16x16x32_bf16 v[196:199], v[124:127], v[148:151], v[196:199]
 ds_read2st64_b32 v[48:49], v222 offset0:8 offset1:9
 v_mfma_f32_16x16x32_bf16 v[200:203], v[128:131], v[148:151], v[200:203]
 ds_read2st64_b32 v[50:51], v222 offset0:10 offset1:11
 v_mfma_f32_16x16x32_bf16 v[204:207], v[132:135], v[148:151], v[204:207]
 ds_read2st64_b32 v[52:53], v222 offset0:12 offset1:13
 v_mfma_f32_16x16x32_bf16 v[208:211], v[216:219], v[148:151], v[208:211]
 ds_read2st64_b32 v[54:55], v222 offset0:14 offset1:15
 ds_read2st64_b32 v[56:57], v222 offset0:16 offset1:17
 ds_read2st64_b32 v[58:59], v222 offset0:18 offset1:19
 v_pk_add_f32 v[192:193], v[192:193], v[60:61]
 v_pk_add_f32 v[194:195], v[194:195], v[62:63]
 v_pk_add_f32 v[196:197], v[196:197], v[64:65]
 v_pk_add_f32 v[198:199], v[198:199], v[66:67]
 v_pk_add_f32 v[200:201], v[200:201], v[68:69]
 v_pk_add_f32 v[202:203], v[202:203], v[70:71]
 v_pk_add_f32 v[204:205], v[204:205], v[72:73]
 v_pk_add_f32 v[206:207], v[206:207], v[74:75]
 v_pk_add_f32 v[208:209], v[208:209], v[76:77]
 v_pk_add_f32 v[210:211], v[210:211], v[78:79]
 s_waitcnt lgkmcnt(0)
 v_pk_add_f32 v[192:193], v[192:193], v[40:41]
 v_cvt_pk_bf16_f32 v28, v192, v193
 v_pk_add_f32 v[194:195], v[194:195], v[42:43]
 v_cvt_pk_bf16_f32 v29, v194, v195
 v_pk_add_f32 v[196:197], v[196:197], v[44:45]
 v_cvt_pk_bf16_f32 v30, v196, v197
 v_pk_add_f32 v[198:199], v[198:199], v[46:47]
 v_cvt_pk_bf16_f32 v31, v198, v199
 buffer_store_dwordx4 v[28:31], v1, s[8:11], s39 offen
 v_pk_add_f32 v[200:201], v[200:201], v[48:49]
 v_cvt_pk_bf16_f32 v32, v200, v201
 v_pk_add_f32 v[202:203], v[202:203], v[50:51]
 v_cvt_pk_bf16_f32 v33, v202, v203
 v_pk_add_f32 v[204:205], v[204:205], v[52:53]
 v_cvt_pk_bf16_f32 v34, v204, v205
 v_pk_add_f32 v[206:207], v[206:207], v[54:55]
 v_cvt_pk_bf16_f32 v35, v206, v207
 buffer_store_dwordx4 v[32:35], v1, s[8:11], s39 offen offset:1024
 v_pk_add_f32 v[208:209], v[208:209], v[56:57]
 v_cvt_pk_bf16_f32 v36, v208, v209
 v_pk_add_f32 v[210:211], v[210:211], v[58:59]
 v_cvt_pk_bf16_f32 v37, v210, v211
 buffer_store_dwordx2 v[36:37], v8, s[8:11], s39 offen offset:2048
 v_mov_b32 v226, 0x3f803f80
 v_dot2_f32_bf16 v224, v28, v226, 0
 v_dot2_f32_bf16 v225, v28, v28, 0
 v_dot2_f32_bf16 v224, v29, v226, v224
 v_dot2_f32_bf16 v225, v29, v29, v225
 v_dot2_f32_bf16 v224, v30, v226, v224
 v_dot2_f32_bf16 v225, v30, v30, v225
 v_dot2_f32_bf16 v224, v31, v226, v224
 v_dot2_f32_bf16 v225, v31, v31, v225
 v_dot2_f32_bf16 v224, v32, v226, v224
 v_dot2_f32_bf16 v225, v32, v32, v225
 v_dot2_f32_bf16 v224, v33, v226, v224
 v_dot2_f32_bf16 v225, v33, v33, v225
 v_dot2_f32_bf16 v224, v34, v226, v224
 v_dot2_f32_bf16 v225, v34, v34, v225
 v_dot2_f32_bf16 v224, v35, v226, v224
 v_dot2_f32_bf16 v225, v35, v35, v225
 v_dot2_f32_bf16 v224, v36, v226, v224
 v_dot2_f32_bf16 v225, v36, v36, v225
 v_dot2_f32_bf16 v224, v37, v226, v224
 v_dot2_f32_bf16 v225, v37, v37, v225
 s_nop 2
 v_permlane32_swap_b32 v224, v225
 v_add_f32 v224, v224, v225
 v_mov_b32 v226, v224
 s_nop 1
 v_permlane16_swap_b32 v224, v226
 v_add_f32 v224, v224, v226
 v_or_b32 v224, 1, v224
 buffer_store_dword v224, v9, s[8:11], s40 offen
 s_barrier
 v_add_u32 v38, s60, v1
 s_add_u32 s30, s41, 55296
 s_add_u32 s31, s42, 55296
 s_add_u32 s32, s84, 55296
 v_mov_b32 v27, 2
 s_waitcnt vmcnt(1)
 s_mov_b64 exec, 1
 buffer_store_dword v27, off, s[8:11], s48
 s_mov_b64 exec, -1
 v_mov_b32 v130, 0
 v_mov_b32 v138, 0
 v_mov_b32 v131, 0
 v_mov_b32 v139, 0
 v_mov_b32 v134, 0
 v_mov_b32 v142, 0
 v_mov_b32 v135, 0
 v_mov_b32 v143, 0
 v_and_b32 v144, 60, v22
 buffer_load_dword v145, v144, s[8:11], s49 offen sc1
fspin_21:
 buffer_load_dword v0, v144, s[8:11], s49 offen sc1
 s_waitcnt vmcnt(1)
 v_cmp_gt_u32 vcc, 2, v145
 s_cbranch_vccz fok_22
 buffer_load_dword v145, v144, s[8:11], s49 offen sc1
 s_waitcnt vmcnt(1)
 v_cmp_gt_u32 vcc, 2, v0
 s_cbranch_vccz fok_22
 s_add_u32 s29, s29, 1
 s_cmp_lt_u32 s29, 524288
 s_cbranch_scc1 fspin_21
fok_22:
 buffer_load_dwordx4 v[160:163], v38, s[8:11], 0 offen sc1
 buffer_load_dwordx4 v[164:167], v38, s[8:11], s69 offen sc1
 buffer_load_dwordx4 v[168:171], v38, s[8:11], 0 offen offset:1024 sc1
 buffer_load_dwordx4 v[172:175], v38, s[8:11], s69 offen offset:1024 sc1
 buffer_load_dwordx4 v[176:179], v38, s[8:11], 0 offen offset:2048 sc1
 buffer_load_dwordx4 v[180:183], v38, s[8:11], s69 offen offset:2048 sc1
 buffer_load_dwordx4 v[184:187], v38, s[8:11], 0 offen offset:3072 sc1
 buffer_load_dwordx4 v[188:191], v38, s[8:11], s69 offen offset:3072 sc1
 s_barrier
 v_add_u32 v25, 81920, v1
 v_add_u32 v26, 122880, v1
 ds_read_b128 v[96:99], v25
 ds_read_b128 v[100:103], v25 offset:20480
 ds_read_b128 v[104:107], v26
 ds_read_b128 v[108:111], v26 offset:20480
 ds_read_b128 v[112:115], v25 offset:1024
 ds_read_b128 v[116:119], v25 offset:21504
 v_and_b32 v27, 0xf0, v1
 v_lshrrev_b32 v27, 1, v27
 s_mov_b32 s92, 0xffff0000
 s_mov_b32 s93, 0
 s_mov_b32 s94, -1
 s_mov_b32 s95, 0
 s_waitcnt lgkmcnt(4)
 s_waitcnt vmcnt(7)
 v_mfma_f32_16x16x32_bf16 v[40:43], v[96:99], v[160:163], 0
 s_waitcnt vmcnt(6)
 ds_read_b128 v[120:123], v26 offset:1024
 buffer_load_dwordx4 v[192:195], v38, s[8:11], s65 offen sc1
 v_mfma_f32_16x16x32_bf16 v[44:47], v[96:99], v[164:167], 0
 v_mfma_f32_16x16x32_bf16 v[48:51], v[100:103], v[160:163], 0
 ds_read_b128 v[124:127], v26 offset:21504
 v_mfma_f32_16x16x32_bf16 v[52:55], v[100:103], v[164:167], 0
 s_waitcnt lgkmcnt(4)
 buffer_load_dwordx4 v[196:199], v38, s[8:11], s70 offen sc1
 v_mfma_f32_16x16x32_bf16 v[56:59], v[104:107], v[160:163], 0
 ds_read_b128 v[96:99], v25 offset:2048
 v_mfma_f32_16x16x32_bf16 v[60:63], v[104:107], v[164:167], 0
 v_mfma_f32_16x16x32_bf16 v[64:67], v[108:111], v[160:163], 0
 ds_read_b128 v[100:103], v25 offset:22528
 v_mfma_f32_16x16x32_bf16 v[68:71], v[108:111], v[164:167], 0
 s_waitcnt vmcnt(7) lgkmcnt(4)
 buffer_load_dwordx4 v[152:155], v1, s[8:11], s61 offen sc1
 buffer_load_dwordx4 v[156:159], v1, s[8:11], s61 offen offset:1024 sc1
 buffer_load_dwordx4 v[200:203], v38, s[8:11], s65 offen offset:1024 sc1
 v_mfma_f32_16x16x32_bf16 v[40:43], v[112:115], v[168:171], v[40:43]
 s_waitcnt vmcnt(9)
 ds_read_b128 v[104:107], v26 offset:2048
 v_mfma_f32_16x16x32_bf16 v[44:47], v[112:115], v[172:175], v[44:47]
 v_mfma_f32_16x16x32_bf16 v[48:51], v[116:119], v[168:171], v[48:51]
 ds_read_b128 v[108:111], v26 offset:22528
 v_mfma_f32_16x16x32_bf16 v[52:55], v[116:119], v[172:175], v[52:55]
 s_waitcnt lgkmcnt(4)
 buffer_load_dwordx4 v[204:207], v38, s[8:11], s70 offen offset:1024 sc1
 v_mfma_f32_16x16x32_bf16 v[56:59], v[120:123], v[168:171], v[56:59]
 ds_read_b128 v[112:115], v25 offset:3072
 v_mfma_f32_16x16x32_bf16 v[60:63], v[120:123], v[172:175], v[60:63]
 v_mfma_f32_16x16x32_bf16 v[64:67], v[124:127], v[168:171], v[64:67]
 ds_read_b128 v[116:119], v25 offset:23552
 buffer_load_dwordx4 v[208:211], v38, s[8:11], s65 offen offset:2048 sc1
 v_mfma_f32_16x16x32_bf16 v[68:71], v[124:127], v[172:175], v[68:71]
 s_waitcnt vmcnt(10) lgkmcnt(4)
 v_mfma_f32_16x16x32_bf16 v[40:43], v[96:99], v[176:179], v[40:43]
 s_waitcnt vmcnt(9)
 ds_read_b128 v[120:123], v26 offset:3072
 v_mfma_f32_16x16x32_bf16 v[44:47], v[96:99], v[180:183], v[44:47]
 v_mfma_f32_16x16x32_bf16 v[48:51], v[100:103], v[176:179], v[48:51]
 ds_read_b128 v[124:127], v26 offset:23552
 buffer_load_dwordx4 v[212:215], v38, s[8:11], s70 offen offset:2048 sc1
 v_mfma_f32_16x16x32_bf16 v[52:55], v[100:103], v[180:183], v[52:55]
 s_waitcnt lgkmcnt(4)
 v_mfma_f32_16x16x32_bf16 v[56:59], v[104:107], v[176:179], v[56:59]
 ds_read_b128 v[96:99], v25 offset:4096
 v_mfma_f32_16x16x32_bf16 v[60:63], v[104:107], v[180:183], v[60:63]
 v_mfma_f32_16x16x32_bf16 v[64:67], v[108:111], v[176:179], v[64:67]
 ds_read_b128 v[100:103], v25 offset:24576
 buffer_load_dwordx4 v[216:219], v38, s[8:11], s65 offen offset:3072 sc1
 v_mfma_f32_16x16x32_bf16 v[68:71], v[108:111], v[180:183], v[68:71]
 s_waitcnt vmcnt(10) lgkmcnt(4)
 v_mfma_f32_16x16x32_bf16 v[40:43], v[112:115], v[184:187], v[40:43]
 s_waitcnt vmcnt(9)
 ds_read_b128 v[104:107], v26 offset:4096
 v_mfma_f32_16x16x32_bf16 v[44:47], v[112:115], v[188:191], v[44:47]
 buffer_load_dwordx4 v[220:223], v38, s[8:11], s70 offen offset:3072 sc1
 v_mfma_f32_16x16x32_bf16 v[48:51], v[116:119], v[184:187], v[48:51]
 ds_read_b128 v[108:111], v26 offset:24576
 v_mfma_f32_16x16x32_bf16 v[52:55], v[116:119], v[188:191], v[52:55]
 s_waitcnt lgkmcnt(4)
 v_mfma_f32_16x16x32_bf16 v[56:59], v[120:123], v[184:187], v[56:59]
 ds_read_b128 v[112:115], v25 offset:5120
 v_mfma_f32_16x16x32_bf16 v[60:63], v[120:123], v[188:191], v[60:63]
 buffer_load_dwordx4 v[224:227], v38, s[8:11], s66 offen sc1
 v_mfma_f32_16x16x32_bf16 v[64:67], v[124:127], v[184:187], v[64:67]
 ds_read_b128 v[116:119], v25 offset:25600
 v_mfma_f32_16x16x32_bf16 v[68:71], v[124:127], v[188:191], v[68:71]
 s_waitcnt vmcnt(10) lgkmcnt(4)
 v_mfma_f32_16x16x32_bf16 v[40:43], v[96:99], v[192:195], v[40:43]
 s_waitcnt vmcnt(9)
 ds_read_b128 v[120:123], v26 offset:5120
 v_mfma_f32_16x16x32_bf16 v[44:47], v[96:99], v[196:199], v[44:47]
 buffer_load_dwordx4 v[228:231], v38, s[8:11], s71 offen sc1
 v_mfma_f32_16x16x32_bf16 v[48:51], v[100:103], v[192:195], v[48:51]
 ds_read_b128 v[124:127], v26 offset:25600
 v_mfma_f32_16x16x32_bf16 v[52:55], v[100:103], v[196:199], v[52:55]
 s_waitcnt lgkmcnt(4)
 v_mfma_f32_16x16x32_bf16 v[56:59], v[104:107], v[192:195], v[56:59]
 s_waitcnt vmcnt(9)
 ds_read_b128 v[96:99], v25 offset:6144
 v_and_b32 v147, v152, v153
 v_mfma_f32_16x16x32_bf16 v[60:63], v[104:107], v[196:199], v[60:63]
 buffer_load_dwordx4 v[232:235], v38, s[8:11], s66 offen offset:1024 sc1
 v_bitop3_b32 v147, v147, v154, v155 bitop3:0x80
 v_mfma_f32_16x16x32_bf16 v[64:67], v[108:111], v[192:195], v[64:67]
 ds_read_b128 v[100:103], v25 offset:26624
 v_mfma_f32_16x16x32_bf16 v[68:71], v[108:111], v[196:199], v[68:71]
 s_waitcnt vmcnt(8) lgkmcnt(4)
 v_bitop3_b32 v147, v147, v156, v157 bitop3:0x80
 v_bitop3_b32 v147, v147, v158, v159 bitop3:0x80
 v_mfma_f32_16x16x32_bf16 v[40:43], v[112:115], v[200:203], v[40:43]
 s_waitcnt vmcnt(7)
 ds_read_b128 v[104:107], v26 offset:6144
 buffer_load_dwordx4 v[236:239], v38, s[8:11], s71 offen offset:1024 sc1
 v_mfma_f32_16x16x32_bf16 v[44:47], v[112:115], v[204:207], v[44:47]
 v_and_b32 v147, 1, v147
 v_mfma_f32_16x16x32_bf16 v[48:51], v[116:119], v[200:203], v[48:51]
 ds_read_b128 v[108:111], v26 offset:26624
 v_cmp_ne_u32 vcc, 1, v147
 s_cbranch_vccnz fretry_23
fback_24:
 v_mfma_f32_16x16x32_bf16 v[52:55], v[116:119], v[204:207], v[52:55]
 s_waitcnt lgkmcnt(4)
 v_add_f32 v152, v152, v153
 v_add_f32 v156, v156, v157
 v_mfma_f32_16x16x32_bf16 v[56:59], v[120:123], v[200:203], v[56:59]
 ds_read_b128 v[112:115], v25 offset:7168
 buffer_load_dwordx4 v[240:243], v38, s[8:11], s66 offen offset:2048 sc1
 v_mfma_f32_16x16x32_bf16 v[60:63], v[120:123], v[204:207], v[60:63]
 v_add_f32 v154, v154, v155
 v_mfma_f32_16x16x32_bf16 v[64:67], v[124:127], v[200:203], v[64:67]
 ds_read_b128 v[116:119], v25 offset:27648
 v_add_f32 v158, v158, v159
 v_mfma_f32_16x16x32_bf16 v[68:71], v[124:127], v[204:207], v[68:71]
 s_waitcnt vmcnt(8) lgkmcnt(4)
 v_add_f32 v154, v154, v152
 v_add_f32 v158, v158, v156
 v_mfma_f32_16x16x32_bf16 v[40:43], v[96:99], v[208:211], v[40:43]
 s_waitcnt vmcnt(7)
 ds_read_b128 v[120:123], v26 offset:7168
 buffer_load_dwordx4 v[244:247], v38, s[8:11], s71 offen offset:2048 sc1
 v_mfma_f32_16x16x32_bf16 v[44:47], v[96:99], v[212:215], v[44:47]
 v_mov_b32 v155, v154
 v_mfma_f32_16x16x32_bf16 v[48:51], v[100:103], v[208:211], v[48:51]
 ds_read_b128 v[124:127], v26 offset:27648
 v_mov_b32 v159, v158
 v_mfma_f32_16x16x32_bf16 v[52:55], v[100:103], v[212:215], v[52:55]
 s_waitcnt lgkmcnt(4)
 buffer_load_dwordx4 v[248:251], v38, s[8:11], s66 offen offset:3072 sc1
 v_mfma_f32_16x16x32_bf16 v[56:59], v[104:107], v[208:211], v[56:59]
 ds_read_b128 v[96:99], v25 offset:8192
 v_mfma_f32_16x16x32_bf16 v[60:63], v[104:107], v[212:215], v[60:63]
 v_permlane16_swap_b32 v154, v155
 v_mfma_f32_16x16x32_bf16 v[64:67], v[108:111], v[208:211], v[64:67]
 ds_read_b128 v[100:103], v25 offset:28672
 v_mfma_f32_16x16x32_bf16 v[68:71], v[108:111], v[212:215], v[68:71]
 s_waitcnt vmcnt(8) lgkmcnt(4)
 buffer_load_dwordx4 v[252:255], v38, s[8:11], s71 offen offset:3072 sc1
 v_mfma_f32_16x16x32_bf16 v[40:43], v[112:115], v[216:219], v[40:43]
 s_waitcnt vmcnt(8)
 ds_read_b128 v[104:107], v26 offset:8192
 v_mfma_f32_16x16x32_bf16 v[44:47], v[112:115], v[220:223], v[44:47]
 v_permlane16_swap_b32 v158, v159
 v_mfma_f32_16x16x32_bf16 v[48:51], v[116:119], v[216:219], v[48:51]
 ds_read_b128 v[108:111], v26 offset:28672
 v_add_f32 v154, v154, v155
 v_mfma_f32_16x16x32_bf16 v[52:55], v[116:119], v[220:223], v[52:55]
 s_waitcnt lgkmcnt(4)
 buffer_load_dwordx4 a[100:103], v38, s[8:11], s67 offen sc1
 v_add_f32 v158, v158, v159
 v_mfma_f32_16x16x32_bf16 v[56:59], v[120:123], v[216:219], v[56:59]
 ds_read_b128 v[112:115], v25 offset:9216
 v_mov_b32 v155, v154
 v_mfma_f32_16x16x32_bf16 v[60:63], v[120:123], v[220:223], v[60:63]
 v_mov_b32 v159, v158
 v_mfma_f32_16x16x32_bf16 v[64:67], v[124:127], v[216:219], v[64:67]
 ds_read_b128 v[116:119], v25 offset:29696
 buffer_load_dwordx4 a[104:107], v38, s[8:11], s72 offen sc1
 v_mfma_f32_16x16x32_bf16 v[68:71], v[124:127], v[220:223], v[68:71]
 s_waitcnt vmcnt(9) lgkmcnt(4)
 v_permlane32_swap_b32 v154, v155
 v_mfma_f32_16x16x32_bf16 v[40:43], v[96:99], v[224:227], v[40:43]
 s_waitcnt vmcnt(8)
 ds_read_b128 v[120:123], v26 offset:9216
 v_mfma_f32_16x16x32_bf16 v[44:47], v[96:99], v[228:231], v[44:47]
 v_permlane32_swap_b32 v158, v159
 v_mfma_f32_16x16x32_bf16 v[48:51], v[100:103], v[224:227], v[48:51]
 ds_read_b128 v[124:127], v26 offset:29696
 buffer_load_dwordx4 a[108:111], v38, s[8:11], s67 offen offset:1024 sc1
 v_mfma_f32_16x16x32_bf16 v[52:55], v[100:103], v[228:231], v[52:55]
 s_waitcnt lgkmcnt(4)
 v_mul_f32 v153, 0xbacccccd, v154
 v_mul_f32 v157, 0xbacccccd, v158
 v_mfma_f32_16x16x32_bf16 v[56:59], v[104:107], v[224:227], v[56:59]
 ds_read_b128 v[96:99], v25 offset:10240
 v_mul_f32 v154, v153, v153
 v_mfma_f32_16x16x32_bf16 v[60:63], v[104:107], v[228:231], v[60:63]
 v_mul_f32 v158, v157, v157
 v_fmac_f32 v154, 0xbacccccd, v155
 v_mfma_f32_16x16x32_bf16 v[64:67], v[108:111], v[224:227], v[64:67]
 ds_read_b128 v[100:103], v25 offset:30720
 buffer_load_dwordx4 a[112:115], v38, s[8:11], s72 offen offset:1024 sc1
 v_mfma_f32_16x16x32_bf16 v[68:71], v[108:111], v[228:231], v[68:71]
 s_waitcnt vmcnt(9) lgkmcnt(4)
 v_fmac_f32 v158, 0xbacccccd, v159
 v_min_f32 v154, 0, v154
 v_mfma_f32_16x16x32_bf16 v[40:43], v[112:115], v[232:235], v[40:43]
 s_waitcnt vmcnt(8)
 ds_read_b128 v[104:107], v26 offset:10240
 v_min_f32 v158, 0, v158
 v_mfma_f32_16x16x32_bf16 v[44:47], v[112:115], v[236:239], v[44:47]
 v_sub_f32 v154, 0x3727c5ac, v154
 v_sub_f32 v158, 0x3727c5ac, v158
 v_mfma_f32_16x16x32_bf16 v[48:51], v[116:119], v[232:235], v[48:51]
 ds_read_b128 v[108:111], v26 offset:30720
 buffer_load_dwordx4 a[116:119], v38, s[8:11], s67 offen offset:2048 sc1
 v_mfma_f32_16x16x32_bf16 v[52:55], v[116:119], v[236:239], v[52:55]
 s_waitcnt lgkmcnt(4)
 v_rsq_f32 v152, v154
 v_mfma_f32_16x16x32_bf16 v[56:59], v[120:123], v[232:235], v[56:59]
 ds_read_b128 v[112:115], v25 offset:11264
 v_mfma_f32_16x16x32_bf16 v[60:63], v[120:123], v[236:239], v[60:63]
 buffer_load_dwordx4 a[120:123], v38, s[8:11], s72 offen offset:2048 sc1
 v_mfma_f32_16x16x32_bf16 v[64:67], v[124:127], v[232:235], v[64:67]
 ds_read_b128 v[116:119], v25 offset:31744
 v_mfma_f32_16x16x32_bf16 v[68:71], v[124:127], v[236:239], v[68:71]
 s_waitcnt vmcnt(9) lgkmcnt(4)
 v_rsq_f32 v156, v158
 v_mfma_f32_16x16x32_bf16 v[40:43], v[96:99], v[240:243], v[40:43]
 s_waitcnt vmcnt(8)
 ds_read_b128 v[120:123], v26 offset:11264
 v_mul_f32 v154, v154, v152
 v_mfma_f32_16x16x32_bf16 v[44:47], v[96:99], v[244:247], v[44:47]
 buffer_load_dwordx4 a[124:127], v38, s[8:11], s67 offen offset:3072 sc1
 v_mul_f32 v158, v158, v156
 v_mfma_f32_16x16x32_bf16 v[48:51], v[100:103], v[240:243], v[48:51]
 ds_read_b128 v[124:127], v26 offset:31744
 v_cvt_pk_bf16_f32 v144, v154, v153
 v_mfma_f32_16x16x32_bf16 v[52:55], v[100:103], v[244:247], v[52:55]
 s_waitcnt lgkmcnt(4)
 v_cvt_pk_bf16_f32 v148, v158, v157
 v_and_b32 v145, 0xffff0000, v144
 v_mfma_f32_16x16x32_bf16 v[56:59], v[104:107], v[240:243], v[56:59]
 ds_read_b128 v[96:99], v25 offset:12288
 v_and_b32 v149, 0xffff0000, v148
 v_mfma_f32_16x16x32_bf16 v[60:63], v[104:107], v[244:247], v[60:63]
 buffer_load_dwordx4 a[128:131], v38, s[8:11], s72 offen offset:3072 sc1
 v_lshlrev_b32 v144, 16, v144
 v_mfma_f32_16x16x32_bf16 v[64:67], v[108:111], v[240:243], v[64:67]
 ds_read_b128 v[100:103], v25 offset:32768
 v_lshlrev_b32 v148, 16, v148
 v_mfma_f32_16x16x32_bf16 v[68:71], v[108:111], v[244:247], v[68:71]
 s_waitcnt vmcnt(9) lgkmcnt(4)
 v_cndmask_b32 v145, 0, v145, s[92:93]
 v_cndmask_b32 v149, 0, v149, s[92:93]
 v_mfma_f32_16x16x32_bf16 v[40:43], v[112:115], v[248:251], v[40:43]
 s_waitcnt vmcnt(8)
 ds_read_b128 v[104:107], v26 offset:12288
 buffer_load_dwordx4 a[132:135], v38, s[8:11], s68 offen sc1
 v_mfma_f32_16x16x32_bf16 v[44:47], v[112:115], v[252:255], v[44:47]
 v_cndmask_b32 v144, 0, v144, s[92:93]
 v_cndmask_b32 v148, 0, v148, s[92:93]
 v_mfma_f32_16x16x32_bf16 v[48:51], v[116:119], v[248:251], v[48:51]
 ds_read_b128 v[108:111], v26 offset:32768
 v_sub_f32 v145, v153, v145
 v_mfma_f32_16x16x32_bf16 v[52:55], v[116:119], v[252:255], v[52:55]
 s_waitcnt lgkmcnt(4)
 v_sub_f32 v149, v157, v149
 v_sub_f32 v144, v154, v144
 v_mfma_f32_16x16x32_bf16 v[56:59], v[120:123], v[248:251], v[56:59]
 ds_read_b128 v[112:115], v25 offset:13312
 buffer_load_dwordx4 a[136:139], v38, s[8:11], s73 offen sc1
 v_mfma_f32_16x16x32_bf16 v[60:63], v[120:123], v[252:255], v[60:63]
 v_sub_f32 v148, v158, v148
 v_cndmask_b32 v145, 0, v145, s[94:95]
 v_mfma_f32_16x16x32_bf16 v[64:67], v[124:127], v[248:251], v[64:67]
 ds_read_b128 v[116:119], v25 offset:33792
 v_cndmask_b32 v149, 0, v149, s[94:95]
 v_mfma_f32_16x16x32_bf16 v[68:71], v[124:127], v[252:255], v[68:71]
 s_waitcnt vmcnt(9) lgkmcnt(4)
 v_cndmask_b32 v144, 0, v144, s[94:95]
 v_mfma_f32_16x16x32_bf16 v[40:43], v[96:99], a[100:103], v[40:43]
 s_waitcnt vmcnt(8)
 ds_read_b128 v[120:123], v26 offset:13312
 buffer_load_dwordx4 a[140:143], v38, s[8:11], s68 offen offset:1024 sc1
 v_mfma_f32_16x16x32_bf16 v[44:47], v[96:99], a[104:107], v[44:47]
 ds_read_b64 v[128:129], v27 offset:256
 v_cndmask_b32 v148, 0, v148, s[94:95]
 v_mfma_f32_16x16x32_bf16 v[48:51], v[100:103], a[100:103], v[48:51]
 ds_read_b128 v[124:127], v26 offset:33792
 v_cvt_pk_bf16_f32 v136, v145, v145
 v_mfma_f32_16x16x32_bf16 v[52:55], v[100:103], a[104:107], v[52:55]
 s_waitcnt lgkmcnt(5)
 v_cvt_pk_bf16_f32 v140, v149, v149
 v_mfma_f32_16x16x32_bf16 v[56:59], v[104:107], a[100:103], v[56:59]
 ds_read_b128 v[96:99], v25 offset:14336
 buffer_load_dwordx4 a[144:147], v38, s[8:11], s73 offen offset:1024 sc1
 v_mfma_f32_16x16x32_bf16 v[60:63], v[104:107], a[104:107], v[60:63]
 v_cvt_pk_bf16_f32 v137, v144, 0
 v_cvt_pk_bf16_f32 v141, v148, 0
 v_mfma_f32_16x16x32_bf16 v[64:67], v[108:111], a[100:103], v[64:67]
 ds_read_b128 v[100:103], v25 offset:34816
 v_mfma_f32_16x16x32_bf16 v[68:71], v[108:111], a[104:107], v[68:71]
 s_waitcnt lgkmcnt(3)
 buffer_load_dwordx4 a[148:151], v38, s[8:11], s68 offen offset:2048 sc1
 v_mfma_f32_16x16x32_bf16 v[40:43], v[128:131], v[136:139], v[40:43]
 v_mfma_f32_16x16x32_bf16 v[44:47], v[128:131], v[140:143], v[44:47]
 s_waitcnt vmcnt(10)
 v_mfma_f32_16x16x32_bf16 v[40:43], v[112:115], a[108:111], v[40:43]
 s_waitcnt vmcnt(9)
 ds_read_b128 v[104:107], v26 offset:14336
 v_mfma_f32_16x16x32_bf16 v[44:47], v[112:115], a[112:115], v[44:47]
 buffer_load_dwordx4 a[152:155], v38, s[8:11], s73 offen offset:2048 sc1
 ds_read_b64 v[132:133], v27 offset:384
 v_mfma_f32_16x16x32_bf16 v[48:51], v[116:119], a[108:111], v[48:51]
 ds_read_b128 v[108:111], v26 offset:34816
 v_mfma_f32_16x16x32_bf16 v[52:55], v[116:119], a[112:115], v[52:55]
 s_waitcnt lgkmcnt(5)
 v_mfma_f32_16x16x32_bf16 v[56:59], v[120:123], a[108:111], v[56:59]
 ds_read_b128 v[112:115], v25 offset:15360
 v_mfma_f32_16x16x32_bf16 v[60:63], v[120:123], a[112:115], v[60:63]
 buffer_load_dwordx4 a[156:159], v38, s[8:11], s68 offen offset:3072 sc1
 v_mfma_f32_16x16x32_bf16 v[64:67], v[124:127], a[108:111], v[64:67]
 ds_read_b128 v[116:119], v25 offset:35840
 v_mfma_f32_16x16x32_bf16 v[68:71], v[124:127], a[112:115], v[68:71]
 s_waitcnt lgkmcnt(3)
 v_mfma_f32_16x16x32_bf16 v[48:51], v[132:135], v[136:139], v[48:51]
 buffer_load_dwordx4 a[160:163], v38, s[8:11], s73 offen offset:3072 sc1
 v_mfma_f32_16x16x32_bf16 v[52:55], v[132:135], v[140:143], v[52:55]
 s_waitcnt vmcnt(11)
 v_mfma_f32_16x16x32_bf16 v[40:43], v[96:99], a[116:119], v[40:43]
 s_waitcnt vmcnt(10)
 ds_read_b128 v[120:123], v26 offset:15360
 v_mfma_f32_16x16x32_bf16 v[44:47], v[96:99], a[120:123], v[44:47]
 ds_read_b64 v[128:129], v27 offset:512
 v_mfma_f32_16x16x32_bf16 v[48:51], v[100:103], a[116:119], v[48:51]
 ds_read_b128 v[124:127], v26 offset:35840
 v_mfma_f32_16x16x32_bf16 v[52:55], v[100:103], a[120:123], v[52:55]
 s_waitcnt lgkmcnt(5)
 s_add_u32 m0, s27, 40960
 s_add_u32 s85, s64, 0
 buffer_load_dwordx4 v2, s[8:11], s85 offen sc1 lds
 v_mfma_f32_16x16x32_bf16 v[56:59], v[104:107], a[116:119], v[56:59]
 ds_read_b128 v[96:99], v25 offset:16384
 v_mfma_f32_16x16x32_bf16 v[60:63], v[104:107], a[120:123], v[60:63]
 v_mfma_f32_16x16x32_bf16 v[64:67], v[108:111], a[116:119], v[64:67]
 ds_read_b128 v[100:103], v25 offset:36864
 v_mfma_f32_16x16x32_bf16 v[68:71], v[108:111], a[120:123], v[68:71]
 s_waitcnt lgkmcnt(3)
 v_mfma_f32_16x16x32_bf16 v[56:59], v[128:131], v[136:139], v[56:59]
 v_mfma_f32_16x16x32_bf16 v[60:63], v[128:131], v[140:143], v[60:63]
 s_waitcnt vmcnt(10)
 s_add_u32 m0, s28, 20480
 s_add_u32 s85, s36, 0
 buffer_load_dwordx4 v3, s[8:11], s85 offen sc1 lds
 v_mfma_f32_16x16x32_bf16 v[40:43], v[112:115], a[124:127], v[40:43]
 s_waitcnt vmcnt(10)
 ds_read_b128 v[104:107], v26 offset:16384
 v_mfma_f32_16x16x32_bf16 v[44:47], v[112:115], a[128:131], v[44:47]
 ds_read_b64 v[132:133], v27 offset:640
 v_mfma_f32_16x16x32_bf16 v[48:51], v[116:119], a[124:127], v[48:51]
 ds_read_b128 v[108:111], v26 offset:36864
 v_mfma_f32_16x16x32_bf16 v[52:55], v[116:119], a[128:131], v[52:55]
 s_waitcnt lgkmcnt(5)
 v_mfma_f32_16x16x32_bf16 v[56:59], v[120:123], a[124:127], v[56:59]
 ds_read_b128 v[112:115], v25 offset:17408
 v_mfma_f32_16x16x32_bf16 v[60:63], v[120:123], a[128:131], v[60:63]
 v_mfma_f32_16x16x32_bf16 v[64:67], v[124:127], a[124:127], v[64:67]
 ds_read_b128 v[116:119], v25 offset:37888
 v_mfma_f32_16x16x32_bf16 v[68:71], v[124:127], a[128:131], v[68:71]
 s_waitcnt lgkmcnt(3)
 buffer_load_dwordx4 v3, s[8:11], s85 offen offset:1024 sc1 lds
 v_mfma_f32_16x16x32_bf16 v[64:67], v[132:135], v[136:139], v[64:67]
 v_mfma_f32_16x16x32_bf16 v[68:71], v[132:135], v[140:143], v[68:71]
 s_waitcnt vmcnt(10)
 v_mfma_f32_16x16x32_bf16 v[40:43], v[96:99], a[132:135], v[40:43]
 s_waitcnt vmcnt(9)
 ds_read_b128 v[120:123], v26 offset:17408
 v_mfma_f32_16x16x32_bf16 v[44:47], v[96:99], a[136:139], v[44:47]
 ds_read_b64 v[128:129], v27 offset:768
 v_mfma_f32_16x16x32_bf16 v[48:51], v[100:103], a[132:135], v[48:51]
 ds_read_b128 v[124:127], v26 offset:37888
 v_mfma_f32_16x16x32_bf16 v[52:55], v[100:103], a[136:139], v[52:55]
 s_waitcnt lgkmcnt(5)
 v_mfma_f32_16x16x32_bf16 v[56:59], v[104:107], a[132:135], v[56:59]
pad10:
 s_cbranch_execz pad14
 ds_read_b128 v[96:99], v25 offset:18432
 buffer_load_dwordx4 v3, s[8:11], s85 offen offset:2048 sc1 lds
 v_mfma_f32_16x16x32_bf16 v[60:63], v[104:107], a[136:139], v[60:63]
 v_mfma_f32_16x16x32_bf16 v[64:67], v[108:111], a[132:135], v[64:67]
 ds_read_b128 v[100:103], v25 offset:38912
 v_mfma_f32_16x16x32_bf16 v[68:71], v[108:111], a[136:139], v[68:71]
 s_waitcnt lgkmcnt(3)
 v_mfma_f32_16x16x32_bf16 v[72:75], v[128:131], v[136:139], 0
 v_mfma_f32_16x16x32_bf16 v[76:79], v[128:131], v[140:143], 0
 s_waitcnt vmcnt(9)
 v_mfma_f32_16x16x32_bf16 v[40:43], v[112:115], a[140:143], v[40:43]
 s_waitcnt vmcnt(8)
 ds_read_b128 v[104:107], v26 offset:18432
 v_mfma_f32_16x16x32_bf16 v[44:47], v[112:115], a[144:147], v[44:47]
 ds_read_b64 v[132:133], v27 offset:896
 buffer_load_dwordx4 v3, s[8:11], s85 offen offset:3072 sc1 lds
 v_mfma_f32_16x16x32_bf16 v[48:51], v[116:119], a[140:143], v[48:51]
 ds_read_b128 v[108:111], v26 offset:38912
 v_mfma_f32_16x16x32_bf16 v[52:55], v[116:119], a[144:147], v[52:55]
 s_waitcnt lgkmcnt(5)
 v_mfma_f32_16x16x32_bf16 v[56:59], v[120:123], a[140:143], v[56:59]
 ds_read_b128 v[112:115], v25 offset:19456
 v_mfma_f32_16x16x32_bf16 v[60:63], v[120:123], a[144:147], v[60:63]
 v_mfma_f32_16x16x32_bf16 v[64:67], v[124:127], a[140:143], v[64:67]
 ds_read_b128 v[116:119], v25 offset:39936
 v_mfma_f32_16x16x32_bf16 v[68:71], v[124:127], a[144:147], v[68:71]
 s_waitcnt lgkmcnt(3)
 v_mfma_f32_16x16x32_bf16 v[80:83], v[132:135], v[136:139], 0
 s_add_u32 m0, s27, 36864
 s_add_u32 s85, s36, 16384
 buffer_load_dwordx4 v2, s[8:11], s85 offen sc1 lds
 v_mfma_f32_16x16x32_bf16 v[84:87], v[132:135], v[140:143], 0
 s_waitcnt vmcnt(9)
 v_mfma_f32_16x16x32_bf16 v[40:43], v[96:99], a[148:151], v[40:43]
 s_waitcnt vmcnt(8)
 ds_read_b128 v[120:123], v26 offset:19456
 v_mfma_f32_16x16x32_bf16 v[44:47], v[96:99], a[152:155], v[44:47]
 ds_read_b64 v[128:129], v27 offset:1024
 v_mfma_f32_16x16x32_bf16 v[48:51], v[100:103], a[148:151], v[48:51]
 ds_read_b128 v[124:127], v26 offset:39936
 v_mfma_f32_16x16x32_bf16 v[52:55], v[100:103], a[152:155], v[52:55]
 s_waitcnt lgkmcnt(5)
 v_mfma_f32_16x16x32_bf16 v[56:59], v[104:107], a[148:151], v[56:59]
 s_barrier
 v_add_u32 v25, 20480, v1
 ds_read_b128 v[96:99], v25 offset:24576
 v_mfma_f32_16x16x32_bf16 v[60:63], v[104:107], a[152:155], v[60:63]
 v_mfma_f32_16x16x32_bf16 v[64:67], v[108:111], a[148:151], v[64:67]
 ds_read_b128 v[100:103], v25 offset:45056
 v_mfma_f32_16x16x32_bf16 v[68:71], v[108:111], a[152:155], v[68:71]
 s_waitcnt lgkmcnt(3)
 v_mfma_f32_16x16x32_bf16 v[88:91], v[128:131], v[136:139], 0
 v_mfma_f32_16x16x32_bf16 v[92:95], v[128:131], v[140:143], 0
 s_waitcnt vmcnt(7)
 v_mfma_f32_16x16x32_bf16 v[40:43], v[112:115], a[156:159], v[40:43]
 s_waitcnt vmcnt(6)
 ds_read_b128 v[104:107], v25 offset:25600
 v_mfma_f32_16x16x32_bf16 v[44:47], v[112:115], a[160:163], v[44:47]
 v_mfma_f32_16x16x32_bf16 v[48:51], v[116:119], a[156:159], v[48:51]
 ds_read_b128 v[108:111], v25 offset:46080
 v_mfma_f32_16x16x32_bf16 v[52:55], v[116:119], a[160:163], v[52:55]
 s_waitcnt lgkmcnt(4)
 v_mfma_f32_16x16x32_bf16 v[56:59], v[120:123], a[156:159], v[56:59]
 ds_read_b128 v[112:115], v25 offset:26624
 v_mfma_f32_16x16x32_bf16 v[60:63], v[120:123], a[160:163], v[60:63]
 v_mfma_f32_16x16x32_bf16 v[64:67], v[124:127], a[156:159], v[64:67]
 ds_read_b128 v[116:119], v25 offset:47104
 v_mfma_f32_16x16x32_bf16 v[68:71], v[124:127], a[160:163], v[68:71]
 s_waitcnt lgkmcnt(4)
 v_mfma_f32_16x16x32_bf16 v[72:75], v[96:99], v[192:195], v[72:75]
 ds_read_b128 v[120:123], v25 offset:27648
 v_mfma_f32_16x16x32_bf16 v[76:79], v[96:99], v[196:199], v[76:79]
 v_mul_f32 v40, v40, v152
 v_mul_f32 v41, v41, v152
 v_mfma_f32_16x16x32_bf16 v[80:83], v[100:103], v[192:195], v[80:83]
 ds_read_b128 v[124:127], v25 offset:48128
 v_mul_f32 v42, v42, v152
 v_mul_f32 v43, v43, v152
 v_mfma_f32_16x16x32_bf16 v[84:87], v[100:103], v[196:199], v[84:87]
 s_barrier
 v_mul_f32 v40, v40, abs(v40)
 v_mul_f32 v41, v41, abs(v41)
 s_waitcnt lgkmcnt(4)
 v_mfma_f32_16x16x32_bf16 v[72:75], v[104:107], v[200:203], v[72:75]
 ds_read_b128 v[96:99], v25 offset:28672
 v_mul_f32 v42, v42, abs(v42)
 v_mfma_f32_16x16x32_bf16 v[76:79], v[104:107], v[204:207], v[76:79]
 s_add_u32 m0, s28, 81920
 s_add_u32 s85, s37, 30720
 buffer_load_dwordx4 v1, s[8:11], s85 offen sc1 lds
 v_mul_f32 v43, v43, abs(v43)
 v_cvt_pk_bf16_f32 v144, v40, v41
 v_mfma_f32_16x16x32_bf16 v[80:83], v[108:111], v[200:203], v[80:83]
 ds_read_b128 v[100:103], v25 offset:49152
 v_cvt_pk_bf16_f32 v145, v42, v43
 v_mfma_f32_16x16x32_bf16 v[84:87], v[108:111], v[204:207], v[84:87]
 s_waitcnt lgkmcnt(4)
 v_pk_max_i16 v144, v144, 0
 v_pk_max_i16 v145, v145, 0
 v_mul_f32 v48, v48, v152
 v_mfma_f32_16x16x32_bf16 v[72:75], v[112:115], v[208:211], v[72:75]
 ds_read_b128 v[104:107], v25 offset:29696
 v_mul_f32 v49, v49, v152
 v_mfma_f32_16x16x32_bf16 v[76:79], v[112:115], v[212:215], v[76:79]
 buffer_load_dwordx4 v1, s[8:11], s85 offen offset:1024 sc1 lds
 v_mul_f32 v50, v50, v152
 v_mul_f32 v51, v51, v152
 v_mfma_f32_16x16x32_bf16 v[80:83], v[116:119], v[208:211], v[80:83]
 ds_read_b128 v[108:111], v25 offset:50176
 v_mul_f32 v48, v48, abs(v48)
 v_mfma_f32_16x16x32_bf16 v[84:87], v[116:119], v[212:215], v[84:87]
 s_waitcnt lgkmcnt(4)
 v_mul_f32 v49, v49, abs(v49)
 v_mul_f32 v50, v50, abs(v50)
 v_mul_f32 v51, v51, abs(v51)
 v_mfma_f32_16x16x32_bf16 v[72:75], v[120:123], v[216:219], v[72:75]
 ds_read_b128 v[112:115], v25 offset:30720
 v_cvt_pk_bf16_f32 v146, v48, v49
 v_mfma_f32_16x16x32_bf16 v[76:79], v[120:123], v[220:223], v[76:79]
 v_cvt_pk_bf16_f32 v147, v50, v51
 v_pk_max_i16 v146, v146, 0
 v_pk_max_i16 v147, v147, 0
 v_mfma_f32_16x16x32_bf16 v[80:83], v[124:127], v[216:219], v[80:83]
 ds_read_b128 v[116:119], v25 offset:51200
 buffer_store_dwordx4 v[144:147], v1, s[8:11], s41 offen
 v_mfma_f32_16x16x32_bf16 v[84:87], v[124:127], v[220:223], v[84:87]
 s_waitcnt lgkmcnt(4)
 buffer_load_dwordx4 v1, s[8:11], s85 offen offset:2048 sc1 lds
 v_mfma_f32_16x16x32_bf16 v[72:75], v[96:99], v[224:227], v[72:75]
 ds_read_b128 v[120:123], v25 offset:31744
 v_mfma_f32_16x16x32_bf16 v[76:79], v[96:99], v[228:231], v[76:79]
 v_mul_f32 v44, v44, v156
 v_mfma_f32_16x16x32_bf16 v[80:83], v[100:103], v[224:227], v[80:83]
 ds_read_b128 v[124:127], v25 offset:52224
 v_mul_f32 v45, v45, v156
 v_mul_f32 v46, v46, v156
 v_mfma_f32_16x16x32_bf16 v[84:87], v[100:103], v[228:231], v[84:87]
 s_waitcnt lgkmcnt(4)
 v_mul_f32 v47, v47, v156
 v_mul_f32 v44, v44, abs(v44)
 v_mfma_f32_16x16x32_bf16 v[72:75], v[104:107], v[232:235], v[72:75]
 ds_read_b128 v[96:99], v25 offset:32768
 v_mul_f32 v45, v45, abs(v45)
 v_mul_f32 v46, v46, abs(v46)
 v_mfma_f32_16x16x32_bf16 v[76:79], v[104:107], v[236:239], v[76:79]
 buffer_load_dwordx4 v1, s[8:11], s85 offen offset:3072 sc1 lds
 v_mul_f32 v47, v47, abs(v47)
 v_mfma_f32_16x16x32_bf16 v[80:83], v[108:111], v[232:235], v[80:83]
 ds_read_b128 v[100:103], v25 offset:53248
 v_cvt_pk_bf16_f32 v148, v44, v45
 v_cvt_pk_bf16_f32 v149, v46, v47
 v_mfma_f32_16x16x32_bf16 v[84:87], v[108:111], v[236:239], v[84:87]
 s_waitcnt lgkmcnt(4)
 v_pk_max_i16 v148, v148, 0
 v_pk_max_i16 v149, v149, 0
 v_mfma_f32_16x16x32_bf16 v[72:75], v[112:115], v[240:243], v[72:75]
 ds_read_b128 v[104:107], v25 offset:33792
 v_mul_f32 v52, v52, v156
 v_mul_f32 v53, v53, v156
 v_mfma_f32_16x16x32_bf16 v[76:79], v[112:115], v[244:247], v[76:79]
 v_mul_f32 v54, v54, v156
 v_mul_f32 v55, v55, v156
 v_mfma_f32_16x16x32_bf16 v[80:83], v[116:119], v[240:243], v[80:83]
 ds_read_b128 v[108:111], v25 offset:54272
 v_mul_f32 v52, v52, abs(v52)
 v_mul_f32 v53, v53, abs(v53)
 v_mfma_f32_16x16x32_bf16 v[84:87], v[116:119], v[244:247], v[84:87]
 s_waitcnt lgkmcnt(4)
 s_add_u32 m0, s28, 98304
 s_add_u32 s85, s37, 34816
 buffer_load_dwordx4 v1, s[8:11], s85 offen sc1 lds
 v_mul_f32 v54, v54, abs(v54)
 v_mfma_f32_16x16x32_bf16 v[72:75], v[120:123], v[248:251], v[72:75]
 ds_read_b128 v[112:115], v25 offset:34816
 v_mul_f32 v55, v55, abs(v55)
 v_mfma_f32_16x16x32_bf16 v[76:79], v[120:123], v[252:255], v[76:79]
 v_cvt_pk_bf16_f32 v150, v52, v53
 v_cvt_pk_bf16_f32 v151, v54, v55
 v_pk_max_i16 v150, v150, 0
 v_mfma_f32_16x16x32_bf16 v[80:83], v[124:127], v[248:251], v[80:83]
 ds_read_b128 v[116:119], v25 offset:55296
 v_pk_max_i16 v151, v151, 0
 v_mfma_f32_16x16x32_bf16 v[84:87], v[124:127], v[252:255], v[84:87]
 s_waitcnt lgkmcnt(4)
 buffer_store_dwordx4 v[148:151], v1, s[8:11], s30 offen
 v_mfma_f32_16x16x32_bf16 v[72:75], v[96:99], a[100:103], v[72:75]
 ds_read_b128 v[120:123], v25 offset:35840
 v_mfma_f32_16x16x32_bf16 v[76:79], v[96:99], a[104:107], v[76:79]
 buffer_load_dwordx4 v1, s[8:11], s85 offen offset:1024 sc1 lds
 v_mul_f32 v56, v56, v152
 v_mfma_f32_16x16x32_bf16 v[80:83], v[100:103], a[100:103], v[80:83]
 ds_read_b128 v[124:127], v25 offset:56320
 v_mul_f32 v57, v57, v152
 v_mfma_f32_16x16x32_bf16 v[84:87], v[100:103], a[104:107], v[84:87]
 s_waitcnt lgkmcnt(4)
 v_mul_f32 v58, v58, v152
 v_mul_f32 v59, v59, v152
 v_mul_f32 v56, v56, abs(v56)
 v_mfma_f32_16x16x32_bf16 v[72:75], v[104:107], a[108:111], v[72:75]
 ds_read_b128 v[96:99], v25 offset:36864
 v_mul_f32 v57, v57, abs(v57)
 v_mfma_f32_16x16x32_bf16 v[76:79], v[104:107], a[112:115], v[76:79]
 v_mul_f32 v58, v58, abs(v58)
 v_mul_f32 v59, v59, abs(v59)
 v_cvt_pk_bf16_f32 v144, v56, v57
 v_mfma_f32_16x16x32_bf16 v[80:83], v[108:111], a[108:111], v[80:83]
 ds_read_b128 v[100:103], v25 offset:57344
 v_cvt_pk_bf16_f32 v145, v58, v59
 v_mfma_f32_16x16x32_bf16 v[84:87], v[108:111], a[112:115], v[84:87]
 s_waitcnt lgkmcnt(4)
 buffer_load_dwordx4 v1, s[8:11], s85 offen offset:2048 sc1 lds
 v_pk_max_i16 v144, v144, 0
 v_mfma_f32_16x16x32_bf16 v[72:75], v[112:115], a[116:119], v[72:75]
 ds_read_b128 v[104:107], v25 offset:37888
 v_pk_max_i16 v145, v145, 0
 v_mul_f32 v64, v64, v152
 v_mfma_f32_16x16x32_bf16 v[76:79], v[112:115], a[120:123], v[76:79]
 v_mul_f32 v65, v65, v152
 v_mul_f32 v66, v66, v152
 v_mfma_f32_16x16x32_bf16 v[80:83], v[116:119], a[116:119], v[80:83]
 ds_read_b128 v[108:111], v25 offset:58368
 v_mul_f32 v67, v67, v152
 v_mul_f32 v64, v64, abs(v64)
 v_mfma_f32_16x16x32_bf16 v[84:87], v[116:119], a[120:123], v[84:87]
 s_waitcnt lgkmcnt(4)
 v_mul_f32 v65, v65, abs(v65)
 v_mul_f32 v66, v66, abs(v66)
 v_mfma_f32_16x16x32_bf16 v[72:75], v[120:123], a[124:127], v[72:75]
 ds_read_b128 v[112:115], v25 offset:38912
 v_mul_f32 v67, v67, abs(v67)
 v_cvt_pk_bf16_f32 v146, v64, v65
 v_mfma_f32_16x16x32_bf16 v[76:79], v[120:123], a[128:131], v[76:79]
 buffer_load_dwordx4 v1, s[8:11], s85 offen offset:3072 sc1 lds
 v_cvt_pk_bf16_f32 v147, v66, v67
 v_mfma_f32_16x16x32_bf16 v[80:83], v[124:127], a[124:127], v[80:83]
 ds_read_b128 v[116:119], v25 offset:59392
 v_pk_max_i16 v146, v146, 0
 v_pk_max_i16 v147, v147, 0
 v_mfma_f32_16x16x32_bf16 v[84:87], v[124:127], a[128:131], v[84:87]
 s_waitcnt lgkmcnt(4)
 buffer_store_dwordx4 v[144:147], v1, s[8:11], s41 offen offset:1024
 v_mfma_f32_16x16x32_bf16 v[72:75], v[96:99], a[132:135], v[72:75]
 ds_read_b128 v[120:123], v25 offset:39936
 v_mfma_f32_16x16x32_bf16 v[76:79], v[96:99], a[136:139], v[76:79]
 v_mul_f32 v60, v60, v156
 v_mfma_f32_16x16x32_bf16 v[80:83], v[100:103], a[132:135], v[80:83]
 ds_read_b128 v[124:127], v25 offset:60416
 v_mul_f32 v61, v61, v156
 v_mfma_f32_16x16x32_bf16 v[84:87], v[100:103], a[136:139], v[84:87]
 s_waitcnt lgkmcnt(4)
 s_add_u32 m0, s28, 114688
 s_add_u32 s85, s37, 38912
 buffer_load_dwordx4 v1, s[8:11], s85 offen sc1 lds
 v_mul_f32 v62, v62, v156
 v_mul_f32 v63, v63, v156
 v_mfma_f32_16x16x32_bf16 v[72:75], v[104:107], a[140:143], v[72:75]
 s_waitcnt vmcnt(12)
 s_barrier
 ds_read_b128 v[96:99], v25 offset:20480
 v_mul_f32 v60, v60, abs(v60)
 v_mfma_f32_16x16x32_bf16 v[76:79], v[104:107], a[144:147], v[76:79]
 v_mul_f32 v61, v61, abs(v61)
 v_mul_f32 v62, v62, abs(v62)
 v_mul_f32 v63, v63, abs(v63)
 v_mfma_f32_16x16x32_bf16 v[80:83], v[108:111], a[140:143], v[80:83]
 ds_read_b128 v[100:103], v25 offset:40960
 v_cvt_pk_bf16_f32 v148, v60, v61
 v_mfma_f32_16x16x32_bf16 v[84:87], v[108:111], a[144:147], v[84:87]
 s_waitcnt lgkmcnt(4)
 v_cvt_pk_bf16_f32 v149, v62, v63
 v_pk_max_i16 v148, v148, 0
 v_mfma_f32_16x16x32_bf16 v[72:75], v[112:115], a[148:151], v[72:75]
 ds_read_b128 v[104:107], v25 offset:21504
 v_pk_max_i16 v149, v149, 0
 v_mul_f32 v68, v68, v156
 v_mfma_f32_16x16x32_bf16 v[76:79], v[112:115], a[152:155], v[76:79]
 buffer_load_dwordx4 v1, s[8:11], s85 offen offset:1024 sc1 lds
 v_mul_f32 v69, v69, v156
 v_mfma_f32_16x16x32_bf16 v[80:83], v[116:119], a[148:151], v[80:83]
 ds_read_b128 v[108:111], v25 offset:41984
 v_mul_f32 v70, v70, v156
 v_mul_f32 v71, v71, v156
 v_mfma_f32_16x16x32_bf16 v[84:87], v[116:119], a[152:155], v[84:87]
 s_waitcnt lgkmcnt(4)
 v_mul_f32 v68, v68, abs(v68)
 v_mul_f32 v69, v69, abs(v69)
 v_mfma_f32_16x16x32_bf16 v[72:75], v[120:123], a[156:159], v[72:75]
 ds_read_b128 v[112:115], v25 offset:22528
 v_mul_f32 v70, v70, abs(v70)
 v_mul_f32 v71, v71, abs(v71)
 v_mfma_f32_16x16x32_bf16 v[76:79], v[120:123], a[160:163], v[76:79]
 v_cvt_pk_bf16_f32 v150, v68, v69
 v_cvt_pk_bf16_f32 v151, v70, v71
 v_mfma_f32_16x16x32_bf16 v[80:83], v[124:127], a[156:159], v[80:83]
 ds_read_b128 v[116:119], v25 offset:43008
 v_pk_max_i16 v150, v150, 0
 v_pk_max_i16 v151, v151, 0
 v_mfma_f32_16x16x32_bf16 v[84:87], v[124:127], a[160:163], v[84:87]
 s_waitcnt lgkmcnt(4)
 buffer_load_dwordx4 v1, s[8:11], s85 offen offset:2048 sc1 lds
 buffer_store_dwordx4 v[148:151], v1, s[8:11], s30 offen offset:1024
 v_mfma_f32_16x16x32_bf16 v[72:75], v[96:99], v[160:163], v[72:75]
 ds_read_b128 v[120:123], v25 offset:23552
 v_mfma_f32_16x16x32_bf16 v[76:79], v[96:99], v[164:167], v[76:79]
 v_mfma_f32_16x16x32_bf16 v[80:83], v[100:103], v[160:163], v[80:83]
 ds_read_b128 v[124:127], v25 offset:44032
 v_mfma_f32_16x16x32_bf16 v[84:87], v[100:103], v[164:167], v[84:87]
 s_waitcnt lgkmcnt(4)
 v_mfma_f32_16x16x32_bf16 v[72:75], v[104:107], v[168:171], v[72:75]
 ds_read_b128 v[96:99], v25
 v_mfma_f32_16x16x32_bf16 v[76:79], v[104:107], v[172:175], v[76:79]
 buffer_load_dwordx4 v1, s[8:11], s85 offen offset:3072 sc1 lds
 v_mfma_f32_16x16x32_bf16 v[80:83], v[108:111], v[168:171], v[80:83]
 ds_read_b128 v[100:103], v25 offset:1024
 v_mfma_f32_16x16x32_bf16 v[84:87], v[108:111], v[172:175], v[84:87]
 s_waitcnt lgkmcnt(4)
 v_mfma_f32_16x16x32_bf16 v[72:75], v[112:115], v[176:179], v[72:75]
 ds_read_b128 v[104:107], v25 offset:2048
 v_mfma_f32_16x16x32_bf16 v[76:79], v[112:115], v[180:183], v[76:79]
 v_mfma_f32_16x16x32_bf16 v[80:83], v[116:119], v[176:179], v[80:83]
 ds_read_b128 v[108:111], v25 offset:3072
 v_mfma_f32_16x16x32_bf16 v[84:87], v[116:119], v[180:183], v[84:87]
 s_waitcnt lgkmcnt(4)
 s_add_u32 m0, s28, 131072
 s_add_u32 s85, s37, 43008
 buffer_load_dwordx4 v1, s[8:11], s85 offen sc1 lds
 v_mfma_f32_16x16x32_bf16 v[72:75], v[120:123], v[184:187], v[72:75]
 ds_read_b128 v[112:115], v25 offset:4096
 v_mfma_f32_16x16x32_bf16 v[76:79], v[120:123], v[188:191], v[76:79]
 v_mfma_f32_16x16x32_bf16 v[80:83], v[124:127], v[184:187], v[80:83]
 ds_read_b128 v[116:119], v25 offset:5120
 v_mfma_f32_16x16x32_bf16 v[84:87], v[124:127], v[188:191], v[84:87]
 s_waitcnt lgkmcnt(4)
 v_mfma_f32_16x16x32_bf16 v[88:91], v[96:99], v[160:163], v[88:91]
 ds_read_b128 v[120:123], v25 offset:6144
 v_mfma_f32_16x16x32_bf16 v[92:95], v[96:99], v[164:167], v[92:95]
 buffer_load_dwordx4 v1, s[8:11], s85 offen offset:1024 sc1 lds
 v_mfma_f32_16x16x32_bf16 v[88:91], v[100:103], v[168:171], v[88:91]
 ds_read_b128 v[124:127], v25 offset:7168
 v_mfma_f32_16x16x32_bf16 v[92:95], v[100:103], v[172:175], v[92:95]
 s_waitcnt lgkmcnt(4)
 v_mul_f32 v72, v72, v152
 v_mul_f32 v73, v73, v152
 v_mfma_f32_16x16x32_bf16 v[88:91], v[104:107], v[176:179], v[88:91]
 ds_read_b128 v[96:99], v25 offset:8192
 v_mul_f32 v74, v74, v152
 v_mfma_f32_16x16x32_bf16 v[92:95], v[104:107], v[180:183], v[92:95]
 buffer_load_dwordx4 v1, s[8:11], s85 offen offset:2048 sc1 lds
 v_mul_f32 v75, v75, v152
 v_mfma_f32_16x16x32_bf16 v[88:91], v[108:111], v[184:187], v[88:91]
 ds_read_b128 v[100:103], v25 offset:9216
 v_mul_f32 v72, v72, abs(v72)
 v_mul_f32 v73, v73, abs(v73)
 v_mfma_f32_16x16x32_bf16 v[92:95], v[108:111], v[188:191], v[92:95]
 s_waitcnt lgkmcnt(4)
 v_mul_f32 v74, v74, abs(v74)
 v_mul_f32 v75, v75, abs(v75)
 v_mfma_f32_16x16x32_bf16 v[88:91], v[112:115], v[192:195], v[88:91]
 ds_read_b128 v[104:107], v25 offset:10240
 v_cvt_pk_bf16_f32 v144, v72, v73
 v_mfma_f32_16x16x32_bf16 v[92:95], v[112:115], v[196:199], v[92:95]
 v_cvt_pk_bf16_f32 v145, v74, v75
 v_pk_max_i16 v144, v144, 0
 v_mfma_f32_16x16x32_bf16 v[88:91], v[116:119], v[200:203], v[88:91]
 ds_read_b128 v[108:111], v25 offset:11264
 v_pk_max_i16 v145, v145, 0
 v_mfma_f32_16x16x32_bf16 v[92:95], v[116:119], v[204:207], v[92:95]
 s_waitcnt lgkmcnt(4)
 buffer_load_dwordx4 v1, s[8:11], s85 offen offset:3072 sc1 lds
 v_mul_f32 v80, v80, v152
 v_mfma_f32_16x16x32_bf16 v[88:91], v[120:123], v[208:211], v[88:91]
 ds_read_b128 v[112:115], v25 offset:12288
 v_mul_f32 v81, v81, v152
 v_mfma_f32_16x16x32_bf16 v[92:95], v[120:123], v[212:215], v[92:95]
 v_mul_f32 v82, v82, v152
 v_mul_f32 v83, v83, v152
 v_mfma_f32_16x16x32_bf16 v[88:91], v[124:127], v[216:219], v[88:91]
 s_waitcnt vmcnt(5)
 ds_read_b128 v[116:119], v25 offset:13312
 v_mov_b32 v27, 3
 s_mov_b64 exec, 1
 buffer_store_dword v27, off, s[8:11], s50
 s_mov_b64 exec, -1
 v_mul_f32 v80, v80, abs(v80)
 v_mfma_f32_16x16x32_bf16 v[92:95], v[124:127], v[220:223], v[92:95]
 s_waitcnt lgkmcnt(4)
 v_mul_f32 v81, v81, abs(v81)
 v_mul_f32 v82, v82, abs(v82)
 v_mfma_f32_16x16x32_bf16 v[88:91], v[96:99], v[224:227], v[88:91]
 ds_read_b128 v[120:123], v25 offset:14336
 v_mul_f32 v83, v83, abs(v83)
 v_mfma_f32_16x16x32_bf16 v[92:95], v[96:99], v[228:231], v[92:95]
 s_add_u32 m0, s28, 147456
 s_add_u32 s85, s37, 47104
 buffer_load_dwordx4 v1, s[8:11], s85 offen sc1 lds
 v_cvt_pk_bf16_f32 v146, v80, v81
 v_mfma_f32_16x16x32_bf16 v[88:91], v[100:103], v[232:235], v[88:91]
 ds_read_b128 v[124:127], v25 offset:15360
 v_cvt_pk_bf16_f32 v147, v82, v83
 v_mfma_f32_16x16x32_bf16 v[92:95], v[100:103], v[236:239], v[92:95]
 s_waitcnt lgkmcnt(4)
 v_pk_max_i16 v146, v146, 0
 v_pk_max_i16 v147, v147, 0
 v_mfma_f32_16x16x32_bf16 v[88:91], v[104:107], v[240:243], v[88:91]
 ds_read_b128 v[96:99], v25 offset:16384
 buffer_store_dwordx4 v[144:147], v1, s[8:11], s84 offen
 v_mfma_f32_16x16x32_bf16 v[92:95], v[104:107], v[244:247], v[92:95]
 v_mfma_f32_16x16x32_bf16 v[88:91], v[108:111], v[248:251], v[88:91]
 ds_read_b128 v[100:103], v25 offset:17408
 v_mfma_f32_16x16x32_bf16 v[92:95], v[108:111], v[252:255], v[92:95]
 s_waitcnt lgkmcnt(4)
 buffer_load_dwordx4 v1, s[8:11], s85 offen offset:1024 sc1 lds
 v_mul_f32 v76, v76, v156
 v_mfma_f32_16x16x32_bf16 v[88:91], v[112:115], a[100:103], v[88:91]
 ds_read_b128 v[104:107], v25 offset:18432
 v_mul_f32 v77, v77, v156
 v_mfma_f32_16x16x32_bf16 v[92:95], v[112:115], a[104:107], v[92:95]
 v_mul_f32 v78, v78, v156
 v_mul_f32 v79, v79, v156
 v_mfma_f32_16x16x32_bf16 v[88:91], v[116:119], a[108:111], v[88:91]
 ds_read_b128 v[108:111], v25 offset:19456
 v_and_b32 v254, 28, v22
 v_mfma_f32_16x16x32_bf16 v[92:95], v[116:119], a[112:115], v[92:95]
 s_waitcnt lgkmcnt(4)
 v_mul_f32 v76, v76, abs(v76)
 v_mul_f32 v77, v77, abs(v77)
 v_mfma_f32_16x16x32_bf16 v[88:91], v[120:123], a[116:119], v[88:91]
 v_mul_f32 v78, v78, abs(v78)
 v_mul_f32 v79, v79, abs(v79)
 v_cvt_pk_bf16_f32 v148, v76, v77
 v_mfma_f32_16x16x32_bf16 v[92:95], v[120:123], a[120:123], v[92:95]
 buffer_load_dwordx4 v1, s[8:11], s85 offen offset:2048 sc1 lds
 buffer_load_dword v26, v254, s[8:11], s51 offen sc1
 v_mfma_f32_16x16x32_bf16 v[88:91], v[124:127], a[124:127], v[88:91]
 v_cvt_pk_bf16_f32 v149, v78, v79
 v_pk_max_i16 v148, v148, 0
 v_mfma_f32_16x16x32_bf16 v[92:95], v[124:127], a[128:131], v[92:95]
 s_waitcnt lgkmcnt(2)
 v_pk_max_i16 v149, v149, 0
 v_mul_f32 v84, v84, v156
 v_mfma_f32_16x16x32_bf16 v[88:91], v[96:99], a[132:135], v[88:91]
 v_mul_f32 v85, v85, v156
 v_mul_f32 v86, v86, v156
 v_mfma_f32_16x16x32_bf16 v[92:95], v[96:99], a[136:139], v[92:95]
 v_mul_f32 v87, v87, v156
 v_mul_f32 v84, v84, abs(v84)
 v_mfma_f32_16x16x32_bf16 v[88:91], v[100:103], a[140:143], v[88:91]
 v_mul_f32 v85, v85, abs(v85)
 v_mul_f32 v86, v86, abs(v86)
 v_mfma_f32_16x16x32_bf16 v[92:95], v[100:103], a[144:147], v[92:95]
 s_waitcnt lgkmcnt(0)
 buffer_load_dwordx4 v1, s[8:11], s85 offen offset:3072 sc1 lds
 v_mul_f32 v87, v87, abs(v87)
 v_mfma_f32_16x16x32_bf16 v[88:91], v[104:107], a[148:151], v[88:91]
 v_cvt_pk_bf16_f32 v150, v84, v85
 v_cvt_pk_bf16_f32 v151, v86, v87
 v_pk_max_i16 v150, v150, 0
 v_mfma_f32_16x16x32_bf16 v[92:95], v[104:107], a[152:155], v[92:95]
 v_pk_max_i16 v151, v151, 0
 v_mfma_f32_16x16x32_bf16 v[88:91], v[108:111], a[156:159], v[88:91]
 buffer_store_dwordx4 v[148:151], v1, s[8:11], s32 offen
 v_mfma_f32_16x16x32_bf16 v[92:95], v[108:111], a[160:163], v[92:95]
 v_add_u32 v244, s56, v1
 v_add_u32 v245, s57, v1
 v_add_u32 v246, s58, v1
 v_add_u32 v247, s59, v1
 s_nop 1
 v_pk_mul_f32 v[88:89], v[88:89], v[152:153] op_sel_hi:[1,0]
 v_pk_mul_f32 v[90:91], v[90:91], v[152:153] op_sel_hi:[1,0]
 v_mul_f32 v88, v88, abs(v88)
 v_mul_f32 v89, v89, abs(v89)
 v_mul_f32 v90, v90, abs(v90)
 v_mul_f32 v91, v91, abs(v91)
 v_cvt_pk_bf16_f32 v144, v88, v89
 v_cvt_pk_bf16_f32 v145, v90, v91
 v_pk_max_i16 v144, v144, 0
 v_pk_max_i16 v145, v145, 0
 buffer_store_dwordx2 v[144:145], v1, s[8:11], s42 offen
 v_pk_mul_f32 v[92:93], v[92:93], v[156:157] op_sel_hi:[1,0]
 v_pk_mul_f32 v[94:95], v[94:95], v[156:157] op_sel_hi:[1,0]
 v_mul_f32 v92, v92, abs(v92)
 v_mul_f32 v93, v93, abs(v93)
 v_mul_f32 v94, v94, abs(v94)
 v_mul_f32 v95, v95, abs(v95)
 v_cvt_pk_bf16_f32 v148, v92, v93
 v_cvt_pk_bf16_f32 v149, v94, v95
 v_pk_max_i16 v148, v148, 0
 v_pk_max_i16 v149, v149, 0
 buffer_store_dwordx2 v[148:149], v1, s[8:11], s31 offen
 s_waitcnt vmcnt(4)
 v_cmp_gt_u32 vcc, 3, v26
 s_cbranch_vccnz fretry_25
fback_26:
 buffer_load_dwordx4 v[160:163], v244, s[8:11], s66 offen offset:2048 sc1
 buffer_load_dwordx4 v[164:167], v245, s[8:11], s66 offen offset:2048 sc1
 buffer_load_dwordx4 v[168:171], v246, s[8:11], s66 offen offset:2048 sc1
 buffer_load_dwordx4 v[172:175], v247, s[8:11], s66 offen offset:2048 sc1
 v_add_u32 v252, 81920, v3
 v_add_u32 v253, 147456, v3
 v_add_u32 v248, s83, v1
 s_barrier
 buffer_load_dwordx4 a[100:103], v39, s[8:11], s70 offen offset:1024 sc1
 buffer_load_dwordx4 a[104:107], v39, s[8:11], s70 offen offset:2048 sc1
 v_mov_b32 v27, 4
 s_waitcnt vmcnt(6)
 s_mov_b64 exec, 1
 buffer_store_dword v27, off, s[8:11], s50
 s_mov_b64 exec, -1
 s_add_u32 s31, s22, 3
 s_and_b32 s31, s31, 3
 s_mul_i32 s31, s31, 10240
 s_add_u32 s31, s31, 2048
 v_add_u32 v249, s31, v22
 s_add_u32 s31, s22, 2
 s_and_b32 s31, s31, 3
 s_mul_i32 s31, s31, 10240
 s_add_u32 s31, s31, 2048
 v_add_u32 v250, s31, v22
 s_add_u32 s31, s22, 1
 s_and_b32 s31, s31, 3
 s_mul_i32 s31, s31, 10240
 s_add_u32 s31, s31, 2048
 v_add_u32 v251, s31, v22
 ds_read_b128 v[184:187], v21 offset:1152
 buffer_load_dwordx4 v[176:179], v244, s[8:11], s66 offen offset:3072 sc1
 ds_read_b128 v[188:191], v21 offset:1216
 ds_read_b128 v[192:195], v21 offset:1280
 ds_read_b128 v[196:199], v21 offset:1344
 ds_read_b128 v[200:203], v21 offset:1408
 v_lshlrev_b32 v100, 16, v28
 v_and_b32 v101, 0xffff0000, v28
 v_lshlrev_b32 v102, 16, v29
 v_and_b32 v103, 0xffff0000, v29
 buffer_load_dwordx4 v[180:183], v245, s[8:11], s66 offen offset:3072 sc1
 v_lshlrev_b32 v104, 16, v30
 v_and_b32 v105, 0xffff0000, v30
 v_lshlrev_b32 v106, 16, v31
 v_and_b32 v107, 0xffff0000, v31
 v_lshlrev_b32 v108, 16, v32
 v_and_b32 v109, 0xffff0000, v32
 v_lshlrev_b32 v110, 16, v33
 v_and_b32 v111, 0xffff0000, v33
 v_lshlrev_b32 v112, 16, v34
 buffer_load_dwordx4 v[120:123], v246, s[8:11], s66 offen offset:3072 sc1
 v_and_b32 v113, 0xffff0000, v34
 v_lshlrev_b32 v114, 16, v35
 v_and_b32 v115, 0xffff0000, v35
 v_lshlrev_b32 v116, 16, v36
 v_and_b32 v117, 0xffff0000, v36
 v_lshlrev_b32 v118, 16, v37
 v_and_b32 v119, 0xffff0000, v37
 s_waitcnt lgkmcnt(4)
 v_pk_add_f32 v[100:101], v[100:101], v[184:185]
 v_pk_add_f32 v[102:103], v[102:103], v[186:187]
 buffer_load_dwordx4 v[124:127], v247, s[8:11], s66 offen offset:3072 sc1
 s_waitcnt lgkmcnt(3)
 v_pk_add_f32 v[104:105], v[104:105], v[188:189]
 v_pk_add_f32 v[106:107], v[106:107], v[190:191]
 s_waitcnt lgkmcnt(2)
 v_pk_add_f32 v[108:109], v[108:109], v[192:193]
 v_pk_add_f32 v[110:111], v[110:111], v[194:195]
 s_waitcnt lgkmcnt(1)
 v_pk_add_f32 v[112:113], v[112:113], v[196:197]
 v_pk_add_f32 v[114:115], v[114:115], v[198:199]
 s_waitcnt lgkmcnt(0)
 v_pk_add_f32 v[116:117], v[116:117], v[200:201]
 v_pk_add_f32 v[118:119], v[118:119], v[202:203]
 s_waitcnt vmcnt(10)
 v_mfma_f32_16x16x32_bf16 v[40:43], a[236:239], v[160:163], 0
 buffer_load_dwordx4 v[128:131], v244, s[8:11], s67 offen sc1
 v_mfma_f32_16x16x32_bf16 v[44:47], a[240:243], v[160:163], 0
 v_mfma_f32_16x16x32_bf16 v[48:51], a[244:247], v[160:163], 0
 v_mfma_f32_16x16x32_bf16 v[52:55], a[248:251], v[160:163], 0
 v_mfma_f32_16x16x32_bf16 v[56:59], a[252:255], v[160:163], 0
 s_waitcnt vmcnt(10)
 buffer_load_dwordx4 v[132:135], v245, s[8:11], s67 offen sc1
 v_mfma_f32_16x16x32_bf16 v[60:63], a[236:239], v[164:167], 0
 v_mfma_f32_16x16x32_bf16 v[64:67], a[240:243], v[164:167], 0
 v_mfma_f32_16x16x32_bf16 v[68:71], a[244:247], v[164:167], 0
 v_mfma_f32_16x16x32_bf16 v[72:75], a[248:251], v[164:167], 0
 v_mfma_f32_16x16x32_bf16 v[76:79], a[252:255], v[164:167], 0
 s_waitcnt vmcnt(10)
 buffer_load_dwordx4 v[136:139], v246, s[8:11], s67 offen sc1
 v_mfma_f32_16x16x32_bf16 v[80:83], a[236:239], v[168:171], 0
pad11:
 s_cbranch_execz padret
 v_mfma_f32_16x16x32_bf16 v[84:87], a[240:243], v[168:171], 0
 v_mfma_f32_16x16x32_bf16 v[88:91], a[244:247], v[168:171], 0
 v_mfma_f32_16x16x32_bf16 v[92:95], a[248:251], v[168:171], 0
 buffer_load_dwordx4 v[140:143], v247, s[8:11], s67 offen sc1
 v_mfma_f32_16x16x32_bf16 v[96:99], a[252:255], v[168:171], 0
 s_waitcnt vmcnt(11)
 v_mfma_f32_16x16x32_bf16 v[100:103], a[236:239], v[172:175], v[100:103]
 v_mfma_f32_16x16x32_bf16 v[104:107], a[240:243], v[172:175], v[104:107]
 v_mfma_f32_16x16x32_bf16 v[108:111], a[244:247], v[172:175], v[108:111]
 v_mfma_f32_16x16x32_bf16 v[112:115], a[248:251], v[172:175], v[112:115]
 buffer_load_dwordx4 v[144:147], v244, s[8:11], s67 offen offset:1024 sc1
 v_mfma_f32_16x16x32_bf16 v[116:119], a[252:255], v[172:175], v[116:119]
 s_waitcnt vmcnt(8)
 v_mfma_f32_16x16x32_bf16 v[40:43], a[176:179], v[176:179], v[40:43]
 v_mfma_f32_16x16x32_bf16 v[44:47], a[180:183], v[176:179], v[44:47]
 v_mfma_f32_16x16x32_bf16 v[48:51], a[184:187], v[176:179], v[48:51]
 buffer_load_dwordx4 v[148:151], v245, s[8:11], s67 offen offset:1024 sc1
 v_mfma_f32_16x16x32_bf16 v[52:55], a[188:191], v[176:179], v[52:55]
 v_mfma_f32_16x16x32_bf16 v[56:59], a[192:195], v[176:179], v[56:59]
 s_waitcnt vmcnt(8)
 v_mfma_f32_16x16x32_bf16 v[60:63], a[176:179], v[180:183], v[60:63]
 v_mfma_f32_16x16x32_bf16 v[64:67], a[180:183], v[180:183], v[64:67]
 v_mfma_f32_16x16x32_bf16 v[68:71], a[184:187], v[180:183], v[68:71]
 buffer_load_dwordx4 v[152:155], v246, s[8:11], s67 offen offset:1024 sc1
 v_mfma_f32_16x16x32_bf16 v[72:75], a[188:191], v[180:183], v[72:75]
 v_mfma_f32_16x16x32_bf16 v[76:79], a[192:195], v[180:183], v[76:79]
 s_waitcnt vmcnt(8)
 v_mfma_f32_16x16x32_bf16 v[80:83], a[176:179], v[120:123], v[80:83]
 v_mfma_f32_16x16x32_bf16 v[84:87], a[180:183], v[120:123], v[84:87]
 buffer_load_dwordx4 v[156:159], v247, s[8:11], s67 offen offset:1024 sc1
 v_mfma_f32_16x16x32_bf16 v[88:91], a[184:187], v[120:123], v[88:91]
 v_mfma_f32_16x16x32_bf16 v[92:95], a[188:191], v[120:123], v[92:95]
 v_mfma_f32_16x16x32_bf16 v[96:99], a[192:195], v[120:123], v[96:99]
 s_waitcnt vmcnt(8)
 v_mfma_f32_16x16x32_bf16 v[100:103], a[176:179], v[124:127], v[100:103]
 v_mfma_f32_16x16x32_bf16 v[104:107], a[180:183], v[124:127], v[104:107]
 buffer_load_dwordx4 v[160:163], v244, s[8:11], s65 offen offset:2048 sc1
 v_mfma_f32_16x16x32_bf16 v[108:111], a[184:187], v[124:127], v[108:111]
 v_mfma_f32_16x16x32_bf16 v[112:115], a[188:191], v[124:127], v[112:115]
 v_mfma_f32_16x16x32_bf16 v[116:119], a[192:195], v[124:127], v[116:119]
 s_waitcnt vmcnt(8)
 v_mfma_f32_16x16x32_bf16 v[40:43], a[196:199], v[128:131], v[40:43]
 buffer_load_dwordx4 v[164:167], v245, s[8:11], s65 offen offset:2048 sc1
 v_mfma_f32_16x16x32_bf16 v[44:47], a[200:203], v[128:131], v[44:47]
 v_mfma_f32_16x16x32_bf16 v[48:51], a[204:207], v[128:131], v[48:51]
 v_mfma_f32_16x16x32_bf16 v[52:55], a[208:211], v[128:131], v[52:55]
 v_mfma_f32_16x16x32_bf16 v[56:59], a[212:215], v[128:131], v[56:59]
 s_waitcnt vmcnt(8)
 buffer_load_dwordx4 a[108:111], v39, s[8:11], s70 offen offset:3072 sc1
 v_mfma_f32_16x16x32_bf16 v[60:63], a[196:199], v[132:135], v[60:63]
 buffer_load_dword v26, v254, s[8:11], s51 offen sc1
 buffer_load_dwordx4 v[168:171], v246, s[8:11], s65 offen offset:2048 sc1
 v_mfma_f32_16x16x32_bf16 v[64:67], a[200:203], v[132:135], v[64:67]
 v_mfma_f32_16x16x32_bf16 v[68:71], a[204:207], v[132:135], v[68:71]
 v_mfma_f32_16x16x32_bf16 v[72:75], a[208:211], v[132:135], v[72:75]
 v_mfma_f32_16x16x32_bf16 v[76:79], a[212:215], v[132:135], v[76:79]
 s_waitcnt vmcnt(10)
 v_mfma_f32_16x16x32_bf16 v[80:83], a[196:199], v[136:139], v[80:83]
 buffer_load_dwordx4 v[172:175], v247, s[8:11], s65 offen offset:2048 sc1
 v_mfma_f32_16x16x32_bf16 v[84:87], a[200:203], v[136:139], v[84:87]
 v_mfma_f32_16x16x32_bf16 v[88:91], a[204:207], v[136:139], v[88:91]
 v_mfma_f32_16x16x32_bf16 v[92:95], a[208:211], v[136:139], v[92:95]
 v_mfma_f32_16x16x32_bf16 v[96:99], a[212:215], v[136:139], v[96:99]
 s_waitcnt vmcnt(10)
 buffer_load_dwordx4 v[176:179], v244, s[8:11], s65 offen offset:3072 sc1
 v_mfma_f32_16x16x32_bf16 v[100:103], a[196:199], v[140:143], v[100:103]
 v_mfma_f32_16x16x32_bf16 v[104:107], a[200:203], v[140:143], v[104:107]
 v_mfma_f32_16x16x32_bf16 v[108:111], a[204:207], v[140:143], v[108:111]
 v_mfma_f32_16x16x32_bf16 v[112:115], a[208:211], v[140:143], v[112:115]
 v_mfma_f32_16x16x32_bf16 v[116:119], a[212:215], v[140:143], v[116:119]
 s_waitcnt vmcnt(10)
 buffer_load_dwordx4 v[180:183], v245, s[8:11], s65 offen offset:3072 sc1
 v_mfma_f32_16x16x32_bf16 v[40:43], a[216:219], v[144:147], v[40:43]
 v_mfma_f32_16x16x32_bf16 v[44:47], a[220:223], v[144:147], v[44:47]
 v_mfma_f32_16x16x32_bf16 v[48:51], a[224:227], v[144:147], v[48:51]
 buffer_load_dwordx4 a[112:115], v39, s[8:11], s71 offen sc1
 v_mfma_f32_16x16x32_bf16 v[52:55], a[228:231], v[144:147], v[52:55]
 buffer_load_dwordx4 v[120:123], v246, s[8:11], s65 offen offset:3072 sc1
 v_mfma_f32_16x16x32_bf16 v[56:59], a[232:235], v[144:147], v[56:59]
 s_waitcnt vmcnt(12)
 ds_read_b128 v[184:187], v252
 v_mfma_f32_16x16x32_bf16 v[60:63], a[216:219], v[148:151], v[60:63]
 v_mfma_f32_16x16x32_bf16 v[64:67], a[220:223], v[148:151], v[64:67]
 ds_read_b128 v[188:191], v252 offset:1024
 v_mfma_f32_16x16x32_bf16 v[68:71], a[224:227], v[148:151], v[68:71]
 v_mfma_f32_16x16x32_bf16 v[72:75], a[228:231], v[148:151], v[72:75]
 buffer_load_dwordx4 v[124:127], v247, s[8:11], s65 offen offset:3072 sc1
 v_mfma_f32_16x16x32_bf16 v[76:79], a[232:235], v[148:151], v[76:79]
 s_waitcnt vmcnt(12)
 ds_read_b128 v[192:195], v252 offset:2048
 v_mfma_f32_16x16x32_bf16 v[80:83], a[216:219], v[152:155], v[80:83]
 v_mfma_f32_16x16x32_bf16 v[84:87], a[220:223], v[152:155], v[84:87]
 ds_read_b128 v[196:199], v252 offset:3072
 v_mfma_f32_16x16x32_bf16 v[88:91], a[224:227], v[152:155], v[88:91]
 buffer_load_dwordx4 v[128:131], v244, s[8:11], s66 offen sc1
 v_mfma_f32_16x16x32_bf16 v[92:95], a[228:231], v[152:155], v[92:95]
 ds_read_b128 v[200:203], v252 offset:16384
 v_mfma_f32_16x16x32_bf16 v[96:99], a[232:235], v[152:155], v[96:99]
 s_waitcnt vmcnt(12)
 v_mfma_f32_16x16x32_bf16 v[100:103], a[216:219], v[156:159], v[100:103]
 v_mfma_f32_16x16x32_bf16 v[104:107], a[220:223], v[156:159], v[104:107]
 v_mfma_f32_16x16x32_bf16 v[108:111], a[224:227], v[156:159], v[108:111]
 buffer_load_dwordx4 v[132:135], v245, s[8:11], s66 offen sc1
 v_mfma_f32_16x16x32_bf16 v[112:115], a[228:231], v[156:159], v[112:115]
 v_mfma_f32_16x16x32_bf16 v[116:119], a[232:235], v[156:159], v[116:119]
 s_waitcnt vmcnt(12) lgkmcnt(4)
 v_mfma_f32_16x16x32_bf16 v[40:43], v[184:187], v[160:163], v[40:43]
 s_waitcnt lgkmcnt(3)
 v_mfma_f32_16x16x32_bf16 v[44:47], v[188:191], v[160:163], v[44:47]
 s_waitcnt lgkmcnt(2)
 buffer_load_dwordx4 v[136:139], v246, s[8:11], s66 offen sc1
 v_mfma_f32_16x16x32_bf16 v[48:51], v[192:195], v[160:163], v[48:51]
 s_waitcnt lgkmcnt(1)
 v_mfma_f32_16x16x32_bf16 v[52:55], v[196:199], v[160:163], v[52:55]
 s_waitcnt lgkmcnt(0)
 buffer_load_dwordx4 a[116:119], v39, s[8:11], s71 offen offset:1024 sc1
 v_mfma_f32_16x16x32_bf16 v[56:59], v[200:203], v[160:163], v[56:59]
 s_waitcnt vmcnt(13)
 ds_read_b128 v[204:207], v252 offset:17408
 v_mfma_f32_16x16x32_bf16 v[60:63], v[184:187], v[164:167], v[60:63]
 v_mfma_f32_16x16x32_bf16 v[64:67], v[188:191], v[164:167], v[64:67]
 buffer_load_dwordx4 v[140:143], v247, s[8:11], s66 offen sc1
 ds_read_b128 v[208:211], v252 offset:18432
 v_mfma_f32_16x16x32_bf16 v[68:71], v[192:195], v[164:167], v[68:71]
 v_mfma_f32_16x16x32_bf16 v[72:75], v[196:199], v[164:167], v[72:75]
 v_mfma_f32_16x16x32_bf16 v[76:79], v[200:203], v[164:167], v[76:79]
 s_waitcnt vmcnt(11)
 ds_read_b128 v[212:215], v252 offset:19456
 v_mfma_f32_16x16x32_bf16 v[80:83], v[184:187], v[168:171], v[80:83]
 buffer_load_dwordx4 v[144:147], v244, s[8:11], s66 offen offset:1024 sc1
 v_mfma_f32_16x16x32_bf16 v[84:87], v[188:191], v[168:171], v[84:87]
 ds_read_b128 v[216:219], v252 offset:32768
 v_mfma_f32_16x16x32_bf16 v[88:91], v[192:195], v[168:171], v[88:91]
 v_mfma_f32_16x16x32_bf16 v[92:95], v[196:199], v[168:171], v[92:95]
 ds_read_b128 v[220:223], v252 offset:33792
 v_mfma_f32_16x16x32_bf16 v[96:99], v[200:203], v[168:171], v[96:99]
 s_waitcnt vmcnt(11)
 v_mfma_f32_16x16x32_bf16 v[100:103], v[184:187], v[172:175], v[100:103]
 buffer_load_dwordx4 v[148:151], v245, s[8:11], s66 offen offset:1024 sc1
 v_mfma_f32_16x16x32_bf16 v[104:107], v[188:191], v[172:175], v[104:107]
 v_mfma_f32_16x16x32_bf16 v[108:111], v[192:195], v[172:175], v[108:111]
 v_mfma_f32_16x16x32_bf16 v[112:115], v[196:199], v[172:175], v[112:115]
 v_mfma_f32_16x16x32_bf16 v[116:119], v[200:203], v[172:175], v[116:119]
 s_waitcnt vmcnt(11) lgkmcnt(4)
 v_mfma_f32_16x16x32_bf16 v[40:43], v[204:207], v[176:179], v[40:43]
 s_waitcnt lgkmcnt(3)
 buffer_load_dwordx4 v[152:155], v246, s[8:11], s66 offen offset:1024 sc1
 v_mfma_f32_16x16x32_bf16 v[44:47], v[208:211], v[176:179], v[44:47]
 s_waitcnt lgkmcnt(2)
 v_mfma_f32_16x16x32_bf16 v[48:51], v[212:215], v[176:179], v[48:51]
 s_waitcnt lgkmcnt(1)
 v_mfma_f32_16x16x32_bf16 v[52:55], v[216:219], v[176:179], v[52:55]
 s_waitcnt lgkmcnt(0)
 v_mfma_f32_16x16x32_bf16 v[56:59], v[220:223], v[176:179], v[56:59]
 s_waitcnt vmcnt(11)
 buffer_load_dwordx4 v[156:159], v247, s[8:11], s66 offen offset:1024 sc1
 ds_read_b128 v[184:187], v252 offset:34816
 v_mfma_f32_16x16x32_bf16 v[60:63], v[204:207], v[180:183], v[60:63]
 v_mfma_f32_16x16x32_bf16 v[64:67], v[208:211], v[180:183], v[64:67]
 ds_read_b128 v[188:191], v252 offset:35840
 v_mfma_f32_16x16x32_bf16 v[68:71], v[212:215], v[180:183], v[68:71]
 v_mfma_f32_16x16x32_bf16 v[72:75], v[216:219], v[180:183], v[72:75]
 ds_read_b128 v[192:195], v252 offset:49152
 v_mfma_f32_16x16x32_bf16 v[76:79], v[220:223], v[180:183], v[76:79]
 v_cmp_gt_u32 vcc, 4, v26
 s_cbranch_vccnz fretry_27
fback_28:
 buffer_load_dwordx4 v[160:163], v244, s[8:11], 0 offen offset:2048 sc1
 s_waitcnt vmcnt(11)
 v_mfma_f32_16x16x32_bf16 v[80:83], v[204:207], v[120:123], v[80:83]
 v_mfma_f32_16x16x32_bf16 v[84:87], v[208:211], v[120:123], v[84:87]
 ds_read_b128 v[196:199], v252 offset:50176
 v_mfma_f32_16x16x32_bf16 v[88:91], v[212:215], v[120:123], v[88:91]
 v_mfma_f32_16x16x32_bf16 v[92:95], v[216:219], v[120:123], v[92:95]
 buffer_load_dwordx4 v[164:167], v244, s[8:11], 0 offen offset:3072 sc1
 v_mfma_f32_16x16x32_bf16 v[96:99], v[220:223], v[120:123], v[96:99]
 s_waitcnt vmcnt(11)
 ds_read_b128 v[200:203], v252 offset:51200
 v_mfma_f32_16x16x32_bf16 v[100:103], v[204:207], v[124:127], v[100:103]
 v_mfma_f32_16x16x32_bf16 v[104:107], v[208:211], v[124:127], v[104:107]
 v_mfma_f32_16x16x32_bf16 v[108:111], v[212:215], v[124:127], v[108:111]
 v_mfma_f32_16x16x32_bf16 v[112:115], v[216:219], v[124:127], v[112:115]
 buffer_load_dwordx4 v[168:171], v244, s[8:11], s65 offen sc1
 v_mfma_f32_16x16x32_bf16 v[116:119], v[220:223], v[124:127], v[116:119]
 s_waitcnt vmcnt(11) lgkmcnt(4)
 v_mfma_f32_16x16x32_bf16 v[40:43], v[184:187], v[128:131], v[40:43]
 s_waitcnt lgkmcnt(3)
 v_mfma_f32_16x16x32_bf16 v[44:47], v[188:191], v[128:131], v[44:47]
 s_waitcnt lgkmcnt(2)
 v_mfma_f32_16x16x32_bf16 v[48:51], v[192:195], v[128:131], v[48:51]
 s_waitcnt lgkmcnt(1)
 buffer_load_dwordx4 v[172:175], v244, s[8:11], s65 offen offset:1024 sc1
 v_mfma_f32_16x16x32_bf16 v[52:55], v[196:199], v[128:131], v[52:55]
 s_waitcnt lgkmcnt(0)
 v_mfma_f32_16x16x32_bf16 v[56:59], v[200:203], v[128:131], v[56:59]
 s_waitcnt vmcnt(11)
 ds_read_b128 v[204:207], v252 offset:52224
 v_mfma_f32_16x16x32_bf16 v[60:63], v[184:187], v[132:135], v[60:63]
 v_mfma_f32_16x16x32_bf16 v[64:67], v[188:191], v[132:135], v[64:67]
 ds_read_b128 v[208:211], v253
 v_mfma_f32_16x16x32_bf16 v[68:71], v[192:195], v[132:135], v[68:71]
 buffer_load_dwordx4 v[176:179], v244, s[8:11], 0 offen offset:1024 sc1
 v_mfma_f32_16x16x32_bf16 v[72:75], v[196:199], v[132:135], v[72:75]
 v_mfma_f32_16x16x32_bf16 v[76:79], v[200:203], v[132:135], v[76:79]
 s_waitcnt vmcnt(11)
 ds_read_b128 v[212:215], v253 offset:1024
 v_mfma_f32_16x16x32_bf16 v[80:83], v[184:187], v[136:139], v[80:83]
 v_mfma_f32_16x16x32_bf16 v[84:87], v[188:191], v[136:139], v[84:87]
 buffer_load_dwordx4 v[180:183], v244, s[8:11], s38 offen sc1
 ds_read_b128 v[216:219], v253 offset:2048
 v_mfma_f32_16x16x32_bf16 v[88:91], v[192:195], v[136:139], v[88:91]
 v_mfma_f32_16x16x32_bf16 v[92:95], v[196:199], v[136:139], v[92:95]
 ds_read_b128 v[220:223], v253 offset:3072
 v_mfma_f32_16x16x32_bf16 v[96:99], v[200:203], v[136:139], v[96:99]
 s_waitcnt vmcnt(10)
 v_mfma_f32_16x16x32_bf16 v[100:103], v[184:187], v[140:143], v[100:103]
 v_mfma_f32_16x16x32_bf16 v[104:107], v[188:191], v[140:143], v[104:107]
 buffer_load_dwordx4 v[120:123], v245, s[8:11], 0 offen offset:2048 sc1
 v_mfma_f32_16x16x32_bf16 v[108:111], v[192:195], v[140:143], v[108:111]
 v_mfma_f32_16x16x32_bf16 v[112:115], v[196:199], v[140:143], v[112:115]
 v_mfma_f32_16x16x32_bf16 v[116:119], v[200:203], v[140:143], v[116:119]
 s_waitcnt vmcnt(10) lgkmcnt(4)
 v_mfma_f32_16x16x32_bf16 v[40:43], v[204:207], v[144:147], v[40:43]
 s_waitcnt lgkmcnt(3)
 buffer_load_dwordx4 v[124:127], v245, s[8:11], 0 offen offset:3072 sc1
 v_mfma_f32_16x16x32_bf16 v[44:47], v[208:211], v[144:147], v[44:47]
 s_waitcnt lgkmcnt(2)
 v_mfma_f32_16x16x32_bf16 v[48:51], v[212:215], v[144:147], v[48:51]
 s_waitcnt lgkmcnt(1)
 v_mfma_f32_16x16x32_bf16 v[52:55], v[216:219], v[144:147], v[52:55]
 s_waitcnt lgkmcnt(0)
 v_mfma_f32_16x16x32_bf16 v[56:59], v[220:223], v[144:147], v[56:59]
 s_waitcnt vmcnt(10)
 v_mfma_f32_16x16x32_bf16 v[60:63], v[204:207], v[148:151], v[60:63]
 buffer_load_dwordx4 v[128:131], v245, s[8:11], s65 offen sc1
 v_mfma_f32_16x16x32_bf16 v[64:67], v[208:211], v[148:151], v[64:67]
 v_mfma_f32_16x16x32_bf16 v[68:71], v[212:215], v[148:151], v[68:71]
 v_mfma_f32_16x16x32_bf16 v[72:75], v[216:219], v[148:151], v[72:75]
 v_mfma_f32_16x16x32_bf16 v[76:79], v[220:223], v[148:151], v[76:79]
 s_waitcnt vmcnt(10)
 v_mfma_f32_16x16x32_bf16 v[80:83], v[204:207], v[152:155], v[80:83]
 buffer_load_dwordx4 v[132:135], v245, s[8:11], s65 offen offset:1024 sc1
 v_mfma_f32_16x16x32_bf16 v[84:87], v[208:211], v[152:155], v[84:87]
 v_mfma_f32_16x16x32_bf16 v[88:91], v[212:215], v[152:155], v[88:91]
 v_mfma_f32_16x16x32_bf16 v[92:95], v[216:219], v[152:155], v[92:95]
 v_mfma_f32_16x16x32_bf16 v[96:99], v[220:223], v[152:155], v[96:99]
 s_waitcnt vmcnt(10)
 buffer_load_dwordx4 v[136:139], v245, s[8:11], 0 offen offset:1024 sc1
 v_mfma_f32_16x16x32_bf16 v[100:103], v[204:207], v[156:159], v[100:103]
 v_mfma_f32_16x16x32_bf16 v[104:107], v[208:211], v[156:159], v[104:107]
 v_mfma_f32_16x16x32_bf16 v[108:111], v[212:215], v[156:159], v[108:111]
 v_mfma_f32_16x16x32_bf16 v[112:115], v[216:219], v[156:159], v[112:115]
 v_mfma_f32_16x16x32_bf16 v[116:119], v[220:223], v[156:159], v[116:119]
 s_waitcnt vmcnt(10)
 buffer_load_dwordx4 v[140:143], v245, s[8:11], s38 offen sc1
 v_mfma_f32_16x16x32_bf16 v[40:43], a[40:43], v[160:163], v[40:43]
 v_mfma_f32_16x16x32_bf16 v[44:47], a[44:47], v[160:163], v[44:47]
 v_mfma_f32_16x16x32_bf16 v[48:51], a[48:51], v[160:163], v[48:51]
 v_mfma_f32_16x16x32_bf16 v[52:55], a[52:55], v[160:163], v[52:55]
 buffer_load_dwordx4 v[144:147], v246, s[8:11], 0 offen offset:2048 sc1
 v_mfma_f32_16x16x32_bf16 v[56:59], a[56:59], v[160:163], v[56:59]
 s_waitcnt vmcnt(11)
 v_mfma_f32_16x16x32_bf16 v[40:43], a[60:63], v[164:167], v[40:43]
 v_mfma_f32_16x16x32_bf16 v[44:47], a[64:67], v[164:167], v[44:47]
 v_lshrrev_b32 v254, 4, v22
 v_mfma_f32_16x16x32_bf16 v[48:51], a[68:71], v[164:167], v[48:51]
 v_mfma_f32_16x16x32_bf16 v[52:55], a[72:75], v[164:167], v[52:55]
 buffer_load_dwordx4 v[148:151], v246, s[8:11], 0 offen offset:3072 sc1
 v_mfma_f32_16x16x32_bf16 v[56:59], a[76:79], v[164:167], v[56:59]
 s_waitcnt vmcnt(11)
 v_mul_u32_u24 v252, 1280, v254
 v_mfma_f32_16x16x32_bf16 v[40:43], a[80:83], v[168:171], v[40:43]
 v_mfma_f32_16x16x32_bf16 v[44:47], a[84:87], v[168:171], v[44:47]
 v_and_b32 v25, 12, v22
 v_mfma_f32_16x16x32_bf16 v[48:51], a[88:91], v[168:171], v[48:51]
 buffer_load_dwordx4 v[152:155], v246, s[8:11], s65 offen sc1
 v_mfma_f32_16x16x32_bf16 v[52:55], a[92:95], v[168:171], v[52:55]
 v_mfma_f32_16x16x32_bf16 v[56:59], a[96:99], v[168:171], v[56:59]
 s_waitcnt vmcnt(11)
 v_mfma_f32_16x16x32_bf16 v[40:43], a[100:103], v[172:175], v[40:43]
 v_lshl_add_u32 v253, v25, 2, v252
 v_mfma_f32_16x16x32_bf16 v[44:47], a[104:107], v[172:175], v[44:47]
 v_mfma_f32_16x16x32_bf16 v[48:51], a[108:111], v[172:175], v[48:51]
 buffer_load_dwordx4 v[156:159], v246, s[8:11], s65 offen offset:1024 sc1
 v_mfma_f32_16x16x32_bf16 v[52:55], a[112:115], v[172:175], v[52:55]
 v_lshl_add_u32 v252, v25, 1, v252
 v_mfma_f32_16x16x32_bf16 v[56:59], a[116:119], v[172:175], v[56:59]
 s_waitcnt vmcnt(11)
 v_mfma_f32_16x16x32_bf16 v[40:43], a[20:23], v[176:179], v[40:43]
 v_lshlrev_b32 v254, 2, v254
 v_mfma_f32_16x16x32_bf16 v[44:47], a[24:27], v[176:179], v[44:47]
 buffer_load_dwordx4 v[160:163], v246, s[8:11], 0 offen offset:1024 sc1
 v_mfma_f32_16x16x32_bf16 v[48:51], a[28:31], v[176:179], v[48:51]
 v_mfma_f32_16x16x32_bf16 v[52:55], a[32:35], v[176:179], v[52:55]
 v_lshl_add_u32 v254, v25, 4, v254
 v_mfma_f32_16x16x32_bf16 v[56:59], a[36:39], v[176:179], v[56:59]
 s_waitcnt vmcnt(11)
 v_mfma_f32_16x16x32_bf16 v[40:43], a[0:3], v[180:183], v[40:43]
 v_mfma_f32_16x16x32_bf16 v[44:47], a[4:7], v[180:183], v[44:47]
 buffer_load_dwordx4 v[164:167], v246, s[8:11], s38 offen sc1
 v_mfma_f32_16x16x32_bf16 v[48:51], a[8:11], v[180:183], v[48:51]
 v_mfma_f32_16x16x32_bf16 v[52:55], a[12:15], v[180:183], v[52:55]
 v_mfma_f32_16x16x32_bf16 v[56:59], a[16:19], v[180:183], v[56:59]
 s_waitcnt vmcnt(11)
 v_mfma_f32_16x16x32_bf16 v[60:63], a[40:43], v[120:123], v[60:63]
 buffer_load_dwordx4 v[168:171], v247, s[8:11], 0 offen offset:2048 sc1
 v_mfma_f32_16x16x32_bf16 v[64:67], a[44:47], v[120:123], v[64:67]
 v_mfma_f32_16x16x32_bf16 v[68:71], a[48:51], v[120:123], v[68:71]
 s_mov_b32 m0, s83
 s_nop 0
 ds_write_addtid_b32 v40
 v_mfma_f32_16x16x32_bf16 v[72:75], a[52:55], v[120:123], v[72:75]
 ds_write_addtid_b32 v41 offset:256
 ds_write_addtid_b32 v42 offset:512
 v_mfma_f32_16x16x32_bf16 v[76:79], a[56:59], v[120:123], v[76:79]
 s_waitcnt vmcnt(11)
 ds_write_addtid_b32 v43 offset:768
 v_mfma_f32_16x16x32_bf16 v[60:63], a[60:63], v[124:127], v[60:63]
 buffer_load_dwordx4 v[172:175], v247, s[8:11], 0 offen offset:3072 sc1
 ds_write_addtid_b32 v44 offset:1024
 v_mfma_f32_16x16x32_bf16 v[64:67], a[64:67], v[124:127], v[64:67]
 ds_write_addtid_b32 v45 offset:1280
 v_mfma_f32_16x16x32_bf16 v[68:71], a[68:71], v[124:127], v[68:71]
 ds_write_addtid_b32 v46 offset:1536
 ds_write_addtid_b32 v47 offset:1792
 v_mfma_f32_16x16x32_bf16 v[72:75], a[72:75], v[124:127], v[72:75]
 ds_write_addtid_b32 v48 offset:2048
 v_mfma_f32_16x16x32_bf16 v[76:79], a[76:79], v[124:127], v[76:79]
 s_waitcnt vmcnt(11)
 ds_write_addtid_b32 v49 offset:2304
 v_mfma_f32_16x16x32_bf16 v[60:63], a[80:83], v[128:131], v[60:63]
 buffer_load_dwordx4 v[176:179], v247, s[8:11], s65 offen sc1
 ds_write_addtid_b32 v50 offset:2560
 v_mfma_f32_16x16x32_bf16 v[64:67], a[84:87], v[128:131], v[64:67]
 ds_write_addtid_b32 v51 offset:2816
 v_mfma_f32_16x16x32_bf16 v[68:71], a[88:91], v[128:131], v[68:71]
 ds_write_addtid_b32 v52 offset:3072
 ds_write_addtid_b32 v53 offset:3328
 v_mfma_f32_16x16x32_bf16 v[72:75], a[92:95], v[128:131], v[72:75]
 ds_write_addtid_b32 v54 offset:3584
 v_mfma_f32_16x16x32_bf16 v[76:79], a[96:99], v[128:131], v[76:79]
 s_waitcnt vmcnt(11)
 buffer_load_dwordx4 v[180:183], v247, s[8:11], s65 offen offset:1024 sc1
 ds_write_addtid_b32 v55 offset:3840
 v_mfma_f32_16x16x32_bf16 v[60:63], a[100:103], v[132:135], v[60:63]
 ds_write_addtid_b32 v56 offset:4096
 v_mfma_f32_16x16x32_bf16 v[64:67], a[104:107], v[132:135], v[64:67]
 ds_write_addtid_b32 v57 offset:4352
 ds_write_addtid_b32 v58 offset:4608
 v_mfma_f32_16x16x32_bf16 v[68:71], a[108:111], v[132:135], v[68:71]
 ds_write_addtid_b32 v59 offset:4864
 v_mfma_f32_16x16x32_bf16 v[72:75], a[112:115], v[132:135], v[72:75]
 v_mfma_f32_16x16x32_bf16 v[76:79], a[116:119], v[132:135], v[76:79]
 s_waitcnt vmcnt(11)
 buffer_load_dwordx4 v[120:123], v247, s[8:11], 0 offen offset:1024 sc1
 v_mfma_f32_16x16x32_bf16 v[60:63], a[20:23], v[136:139], v[60:63]
 v_mfma_f32_16x16x32_bf16 v[64:67], a[24:27], v[136:139], v[64:67]
 s_waitcnt lgkmcnt(0)
 s_barrier
 v_mfma_f32_16x16x32_bf16 v[68:71], a[28:31], v[136:139], v[68:71]
 ds_read2st64_b32 v[224:225], v249 offset0:0 offset1:1
 v_mfma_f32_16x16x32_bf16 v[72:75], a[32:35], v[136:139], v[72:75]
 buffer_load_dwordx4 v[124:127], v247, s[8:11], s38 offen sc1
 ds_read2st64_b32 v[226:227], v249 offset0:2 offset1:3
 v_mfma_f32_16x16x32_bf16 v[76:79], a[36:39], v[136:139], v[76:79]
 s_waitcnt vmcnt(12)
 ds_read2st64_b32 v[228:229], v249 offset0:4 offset1:5
 v_mfma_f32_16x16x32_bf16 v[60:63], a[0:3], v[140:143], v[60:63]
 ds_read2st64_b32 v[230:231], v249 offset0:6 offset1:7
 v_mfma_f32_16x16x32_bf16 v[64:67], a[4:7], v[140:143], v[64:67]
 ds_read2st64_b32 v[232:233], v249 offset0:8 offset1:9
 v_mfma_f32_16x16x32_bf16 v[68:71], a[8:11], v[140:143], v[68:71]
 ds_read2st64_b32 v[234:235], v249 offset0:10 offset1:11
 v_mfma_f32_16x16x32_bf16 v[72:75], a[12:15], v[140:143], v[72:75]
 ds_read2st64_b32 v[236:237], v249 offset0:12 offset1:13
 v_mfma_f32_16x16x32_bf16 v[76:79], a[16:19], v[140:143], v[76:79]
 s_waitcnt vmcnt(11)
 ds_read2st64_b32 v[238:239], v249 offset0:14 offset1:15
 v_mfma_f32_16x16x32_bf16 v[80:83], a[40:43], v[144:147], v[80:83]
 ds_read2st64_b32 v[240:241], v249 offset0:16 offset1:17
 v_mfma_f32_16x16x32_bf16 v[84:87], a[44:47], v[144:147], v[84:87]
 ds_read2st64_b32 v[242:243], v249 offset0:18 offset1:19
 v_mfma_f32_16x16x32_bf16 v[88:91], a[48:51], v[144:147], v[88:91]
 ds_write_addtid_b32 v60 offset:5120
 v_mfma_f32_16x16x32_bf16 v[92:95], a[52:55], v[144:147], v[92:95]
 ds_write_addtid_b32 v61 offset:5376
 ds_write_addtid_b32 v62 offset:5632
 v_mfma_f32_16x16x32_bf16 v[96:99], a[56:59], v[144:147], v[96:99]
 s_waitcnt vmcnt(10) lgkmcnt(12)
 ds_write_addtid_b32 v63 offset:5888
 v_add_f32 v100, v100, v224
 v_mfma_f32_16x16x32_bf16 v[80:83], a[60:63], v[148:151], v[80:83]
 ds_write_addtid_b32 v64 offset:6144
 v_add_f32 v101, v101, v225
 v_mfma_f32_16x16x32_bf16 v[84:87], a[64:67], v[148:151], v[84:87]
pad12:
 s_cbranch_execz padret
 ds_write_addtid_b32 v65 offset:6400
 ds_write_addtid_b32 v66 offset:6656
 v_mfma_f32_16x16x32_bf16 v[88:91], a[68:71], v[148:151], v[88:91]
 s_waitcnt lgkmcnt(14)
 ds_write_addtid_b32 v67 offset:6912
 v_add_f32 v102, v102, v226
 v_mfma_f32_16x16x32_bf16 v[92:95], a[72:75], v[148:151], v[92:95]
 s_lshl_b32 s30, s21, 2
 s_add_u32 s30, s30, s22
 s_mov_b32 s32, 33554432
 s_and_b32 s30, s30, 127
 s_cbranch_scc0 fwb_29
 buffer_store_dword v27, off, s[8:11], s32
fwbj_30:
 v_mfma_f32_16x16x32_bf16 v[96:99], a[76:79], v[148:151], v[96:99]
 s_waitcnt vmcnt(10)
 ds_write_addtid_b32 v68 offset:7168
 v_mfma_f32_16x16x32_bf16 v[80:83], a[80:83], v[152:155], v[80:83]
 ds_write_addtid_b32 v69 offset:7424
 ds_write_addtid_b32 v70 offset:7680
 v_mfma_f32_16x16x32_bf16 v[84:87], a[84:87], v[152:155], v[84:87]
 ds_write_addtid_b32 v71 offset:7936
 v_add_f32 v103, v103, v227
 v_mfma_f32_16x16x32_bf16 v[88:91], a[88:91], v[152:155], v[88:91]
 ds_write_addtid_b32 v72 offset:8192
 v_add_f32 v104, v104, v228
 v_mfma_f32_16x16x32_bf16 v[92:95], a[92:95], v[152:155], v[92:95]
 ds_write_addtid_b32 v73 offset:8448
 ds_write_addtid_b32 v74 offset:8704
 v_mfma_f32_16x16x32_bf16 v[96:99], a[96:99], v[152:155], v[96:99]
 s_waitcnt vmcnt(9)
 ds_write_addtid_b32 v75 offset:8960
 v_add_f32 v105, v105, v229
 v_mfma_f32_16x16x32_bf16 v[80:83], a[100:103], v[156:159], v[80:83]
 s_waitcnt lgkmcnt(14)
 ds_write_addtid_b32 v76 offset:9216
 v_add_f32 v106, v106, v230
 v_mfma_f32_16x16x32_bf16 v[84:87], a[104:107], v[156:159], v[84:87]
 ds_write_addtid_b32 v77 offset:9472
 ds_write_addtid_b32 v78 offset:9728
 v_mfma_f32_16x16x32_bf16 v[88:91], a[108:111], v[156:159], v[88:91]
 ds_write_addtid_b32 v79 offset:9984
 v_add_f32 v107, v107, v231
 v_mfma_f32_16x16x32_bf16 v[92:95], a[112:115], v[156:159], v[92:95]
 v_add_f32 v108, v108, v232
 v_mfma_f32_16x16x32_bf16 v[96:99], a[116:119], v[156:159], v[96:99]
 s_waitcnt vmcnt(8)
 v_add_f32 v109, v109, v233
 v_add_f32 v110, v110, v234
 v_mfma_f32_16x16x32_bf16 v[80:83], a[20:23], v[160:163], v[80:83]
 v_add_f32 v111, v111, v235
 v_add_f32 v112, v112, v236
 v_mfma_f32_16x16x32_bf16 v[84:87], a[24:27], v[160:163], v[84:87]
 s_waitcnt lgkmcnt(0)
 s_barrier
 v_add_f32 v113, v113, v237
 v_mfma_f32_16x16x32_bf16 v[88:91], a[28:31], v[160:163], v[88:91]
 ds_read2st64_b32 v[184:185], v250 offset0:20 offset1:21
 v_add_f32 v114, v114, v238
 v_mfma_f32_16x16x32_bf16 v[92:95], a[32:35], v[160:163], v[92:95]
 ds_read2st64_b32 v[186:187], v250 offset0:22 offset1:23
 v_add_f32 v115, v115, v239
 v_mfma_f32_16x16x32_bf16 v[96:99], a[36:39], v[160:163], v[96:99]
 s_waitcnt vmcnt(7)
 ds_read2st64_b32 v[188:189], v250 offset0:24 offset1:25
 v_add_f32 v116, v116, v240
 v_mfma_f32_16x16x32_bf16 v[80:83], a[0:3], v[164:167], v[80:83]
 ds_read2st64_b32 v[190:191], v250 offset0:26 offset1:27
 v_mfma_f32_16x16x32_bf16 v[84:87], a[4:7], v[164:167], v[84:87]
 ds_read2st64_b32 v[192:193], v250 offset0:28 offset1:29
 v_add_f32 v117, v117, v241
 v_mfma_f32_16x16x32_bf16 v[88:91], a[8:11], v[164:167], v[88:91]
 ds_read2st64_b32 v[194:195], v250 offset0:30 offset1:31
 v_add_f32 v118, v118, v242
 v_mfma_f32_16x16x32_bf16 v[92:95], a[12:15], v[164:167], v[92:95]
 ds_read2st64_b32 v[196:197], v250 offset0:32 offset1:33
 v_add_f32 v119, v119, v243
 v_mfma_f32_16x16x32_bf16 v[96:99], a[16:19], v[164:167], v[96:99]
 s_waitcnt vmcnt(6)
 ds_read2st64_b32 v[198:199], v250 offset0:34 offset1:35
 v_mfma_f32_16x16x32_bf16 v[100:103], a[40:43], v[168:171], v[100:103]
 ds_read2st64_b32 v[200:201], v250 offset0:36 offset1:37
 v_mfma_f32_16x16x32_bf16 v[104:107], a[44:47], v[168:171], v[104:107]
 ds_read2st64_b32 v[202:203], v250 offset0:38 offset1:39
 v_mfma_f32_16x16x32_bf16 v[108:111], a[48:51], v[168:171], v[108:111]
 ds_write_addtid_b32 v80
 v_mfma_f32_16x16x32_bf16 v[112:115], a[52:55], v[168:171], v[112:115]
 ds_write_addtid_b32 v81 offset:256
 v_mfma_f32_16x16x32_bf16 v[116:119], a[56:59], v[168:171], v[116:119]
 s_waitcnt vmcnt(5)
 ds_write_addtid_b32 v82 offset:512
 ds_write_addtid_b32 v83 offset:768
 v_mfma_f32_16x16x32_bf16 v[100:103], a[60:63], v[172:175], v[100:103]
 ds_write_addtid_b32 v84 offset:1024
 v_mfma_f32_16x16x32_bf16 v[104:107], a[64:67], v[172:175], v[104:107]
 ds_write_addtid_b32 v85 offset:1280
 v_mfma_f32_16x16x32_bf16 v[108:111], a[68:71], v[172:175], v[108:111]
 ds_write_addtid_b32 v86 offset:1536
 v_mfma_f32_16x16x32_bf16 v[112:115], a[72:75], v[172:175], v[112:115]
 ds_write_addtid_b32 v87 offset:1792
 ds_write_addtid_b32 v88 offset:2048
 v_mfma_f32_16x16x32_bf16 v[116:119], a[76:79], v[172:175], v[116:119]
 s_waitcnt vmcnt(4)
 ds_write_addtid_b32 v89 offset:2304
 v_mfma_f32_16x16x32_bf16 v[100:103], a[80:83], v[176:179], v[100:103]
 ds_write_addtid_b32 v90 offset:2560
 v_mfma_f32_16x16x32_bf16 v[104:107], a[84:87], v[176:179], v[104:107]
 ds_write_addtid_b32 v91 offset:2816
 v_mfma_f32_16x16x32_bf16 v[108:111], a[88:91], v[176:179], v[108:111]
 ds_write_addtid_b32 v92 offset:3072
 ds_write_addtid_b32 v93 offset:3328
 v_mfma_f32_16x16x32_bf16 v[112:115], a[92:95], v[176:179], v[112:115]
 ds_write_addtid_b32 v94 offset:3584
 v_mfma_f32_16x16x32_bf16 v[116:119], a[96:99], v[176:179], v[116:119]
 s_waitcnt vmcnt(3)
 ds_write_addtid_b32 v95 offset:3840
 v_mfma_f32_16x16x32_bf16 v[100:103], a[100:103], v[180:183], v[100:103]
 ds_write_addtid_b32 v96 offset:4096
 v_mfma_f32_16x16x32_bf16 v[104:107], a[104:107], v[180:183], v[104:107]
 ds_write_addtid_b32 v97 offset:4352
 ds_write_addtid_b32 v98 offset:4608
 v_mfma_f32_16x16x32_bf16 v[108:111], a[108:111], v[180:183], v[108:111]
 ds_write_addtid_b32 v99 offset:4864
 v_mfma_f32_16x16x32_bf16 v[112:115], a[112:115], v[180:183], v[112:115]
 v_mfma_f32_16x16x32_bf16 v[116:119], a[116:119], v[180:183], v[116:119]
 s_waitcnt vmcnt(2)
 v_mfma_f32_16x16x32_bf16 v[100:103], a[20:23], v[120:123], v[100:103]
pad13:
 s_cbranch_execz padret
 v_mfma_f32_16x16x32_bf16 v[104:107], a[24:27], v[120:123], v[104:107]
 s_waitcnt lgkmcnt(0)
 s_barrier
 v_mfma_f32_16x16x32_bf16 v[108:111], a[28:31], v[120:123], v[108:111]
 ds_read2st64_b32 v[224:225], v251 offset0:0 offset1:1
 v_mfma_f32_16x16x32_bf16 v[112:115], a[32:35], v[120:123], v[112:115]
 ds_read2st64_b32 v[226:227], v251 offset0:2 offset1:3
 v_mfma_f32_16x16x32_bf16 v[116:119], a[36:39], v[120:123], v[116:119]
 s_waitcnt vmcnt(1)
 ds_read2st64_b32 v[228:229], v251 offset0:4 offset1:5
 v_mfma_f32_16x16x32_bf16 v[100:103], a[0:3], v[124:127], v[100:103]
 ds_read2st64_b32 v[230:231], v251 offset0:6 offset1:7
 v_mfma_f32_16x16x32_bf16 v[104:107], a[4:7], v[124:127], v[104:107]
 ds_read2st64_b32 v[232:233], v251 offset0:8 offset1:9
 v_mfma_f32_16x16x32_bf16 v[108:111], a[8:11], v[124:127], v[108:111]
 ds_read2st64_b32 v[234:235], v251 offset0:10 offset1:11
 v_mfma_f32_16x16x32_bf16 v[112:115], a[12:15], v[124:127], v[112:115]
 ds_read2st64_b32 v[236:237], v251 offset0:12 offset1:13
 v_mfma_f32_16x16x32_bf16 v[116:119], a[16:19], v[124:127], v[116:119]
 ds_read2st64_b32 v[238:239], v251 offset0:14 offset1:15
 ds_read2st64_b32 v[240:241], v251 offset0:16 offset1:17
 ds_read2st64_b32 v[242:243], v251 offset0:18 offset1:19
 v_pk_add_f32 v[100:101], v[100:101], v[184:185]
 v_pk_add_f32 v[102:103], v[102:103], v[186:187]
 v_pk_add_f32 v[104:105], v[104:105], v[188:189]
 v_pk_add_f32 v[106:107], v[106:107], v[190:191]
 v_pk_add_f32 v[108:109], v[108:109], v[192:193]
 v_pk_add_f32 v[110:111], v[110:111], v[194:195]
 v_pk_add_f32 v[112:113], v[112:113], v[196:197]
 v_pk_add_f32 v[114:115], v[114:115], v[198:199]
 v_pk_add_f32 v[116:117], v[116:117], v[200:201]
 v_pk_add_f32 v[118:119], v[118:119], v[202:203]
 s_waitcnt lgkmcnt(0)
 v_pk_add_f32 v[100:101], v[100:101], v[224:225]
 v_cvt_pk_bf16_f32 v28, v100, v101
 ds_bpermute_b32 v28, v254, v28
 v_pk_add_f32 v[102:103], v[102:103], v[226:227]
 v_cvt_pk_bf16_f32 v29, v102, v103
 ds_bpermute_b32 v29, v254, v29
 v_pk_add_f32 v[104:105], v[104:105], v[228:229]
 v_cvt_pk_bf16_f32 v30, v104, v105
 ds_bpermute_b32 v30, v254, v30
 v_pk_add_f32 v[106:107], v[106:107], v[230:231]
 v_cvt_pk_bf16_f32 v31, v106, v107
 ds_bpermute_b32 v31, v254, v31
 v_pk_add_f32 v[108:109], v[108:109], v[232:233]
 v_cvt_pk_bf16_f32 v32, v108, v109
 ds_bpermute_b32 v32, v254, v32
pad14:
 s_cbranch_execz padret
 v_pk_add_f32 v[110:111], v[110:111], v[234:235]
 v_cvt_pk_bf16_f32 v33, v110, v111
 ds_bpermute_b32 v33, v254, v33
 v_pk_add_f32 v[112:113], v[112:113], v[236:237]
 v_cvt_pk_bf16_f32 v34, v112, v113
 ds_bpermute_b32 v34, v254, v34
 v_pk_add_f32 v[114:115], v[114:115], v[238:239]
 v_cvt_pk_bf16_f32 v35, v114, v115
 ds_bpermute_b32 v35, v254, v35
 v_pk_add_f32 v[116:117], v[116:117], v[240:241]
 v_cvt_pk_bf16_f32 v36, v116, v117
 ds_bpermute_b32 v36, v254, v36
 v_pk_add_f32 v[118:119], v[118:119], v[242:243]
 v_cvt_pk_bf16_f32 v37, v118, v119
 ds_bpermute_b32 v37, v254, v37
 s_waitcnt lgkmcnt(6)
 buffer_store_dwordx4 v[28:31], v253, s[12:15], s63 offen
 s_waitcnt lgkmcnt(2)
 buffer_store_dwordx4 v[32:35], v253, s[12:15], s63 offen offset:64
 s_waitcnt lgkmcnt(0)
 buffer_store_dwordx2 v[36:37], v252, s[12:15], s63 offen offset:128
 s_add_u32 s3, s3, 1
 v_mov_b32 v27, s3
 s_or_b32 s31, s2, s22
 s_mov_b32 s30, 13991936
 s_cselect_b32 s30, 33554432, s30
 s_mov_b64 exec, 1
 buffer_store_dword v27, off, s[8:11], s30 sc1
 s_endpgm
fwb_29:
 buffer_wbl2 sc1
 s_branch fwbj_30
hretry_3:
 buffer_load_dwordx2 v[98:99], v55, s[8:11], 0 offen sc1
 s_waitcnt vmcnt(0)
 v_xor_b32 v98, s100, v98
 v_xor_b32 v99, s101, v99
 v_or_b32 v98, v98, v99
 v_cmp_ne_u32 vcc, 0, v98
 s_cbranch_vccz hback_4
 s_add_u32 s29, s29, 1
 s_cmp_lt_u32 s29, 524288
 s_cbranch_scc1 hretry_3
 s_branch hback_4
hretry_5:
 buffer_load_dwordx2 v[252:253], v254, s[8:11], s31 offen sc1
 s_waitcnt vmcnt(0)
 v_xor_b32 v252, s100, v252
 v_xor_b32 v253, s101, v253
 v_or_b32 v252, v252, v253
 v_cmp_ne_u32 vcc, 0, v252
 s_cbranch_vccz hback_6
 s_add_u32 s29, s29, 1
 s_cmp_lt_u32 s29, 524288
 s_cbranch_scc1 hretry_5
 s_branch hback_6
fretry_5:
 buffer_load_dwordx4 v[152:155], v1, s[8:11], s61 offen sc1
 buffer_load_dwordx4 v[156:159], v1, s[8:11], s61 offen offset:1024 sc1
 s_waitcnt vmcnt(0)
 v_and_b32 v147, v152, v153
 v_bitop3_b32 v147, v147, v154, v155 bitop3:0x80
 v_bitop3_b32 v147, v147, v156, v157 bitop3:0x80
 v_bitop3_b32 v147, v147, v158, v159 bitop3:0x80
 v_and_b32 v147, 1, v147
 v_cmp_ne_u32 vcc, 1, v147
 s_cbranch_vccz fback_6
 s_add_u32 s29, s29, 1
 s_cmp_lt_u32 s29, 524288
 s_cbranch_scc1 fretry_5
 s_branch fback_6
fretry_7:
 buffer_load_dword v26, v254, s[8:11], s51 offen sc1
 s_waitcnt vmcnt(0)
 v_cmp_gt_u32 vcc, 1, v26
 s_cbranch_vccz fback_8
 s_add_u32 s29, s29, 1
 s_cmp_lt_u32 s29, 524288
 s_cbranch_scc1 fretry_7
 s_branch fback_8
fretry_9:
 buffer_load_dword v26, v254, s[8:11], s51 offen sc1
 s_waitcnt vmcnt(0)
 v_cmp_gt_u32 vcc, 2, v26
 s_cbranch_vccz fback_10
 s_add_u32 s29, s29, 1
 s_cmp_lt_u32 s29, 524288
 s_cbranch_scc1 fretry_9
 s_branch fback_10
fretry_13:
 buffer_load_dwordx4 v[208:211], v1, s[8:11], s16 offen sc1
 buffer_load_dwordx4 v[212:215], v1, s[8:11], s16 offen offset:1024 sc1
 buffer_load_dwordx4 v[216:219], v1, s[8:11], s16 offen offset:2048 sc1
 buffer_load_dwordx4 v[220:223], v1, s[8:11], s16 offen offset:3072 sc1
 s_waitcnt vmcnt(0)
 v_or_b32 v229, v208, v209
 v_or3_b32 v229, v229, v210, v211
 v_or3_b32 v229, v229, v212, v213
 v_or3_b32 v229, v229, v214, v215
 v_or3_b32 v229, v229, v216, v217
 v_or3_b32 v229, v229, v218, v219
 v_or3_b32 v229, v229, v220, v221
 v_or3_b32 v229, v229, v222, v223
 v_and_b32 v229, 1, v229
 v_cmp_ne_u32 vcc, 0, v229
 s_cbranch_vccz fback_14
 s_add_u32 s29, s29, 1
 s_cmp_lt_u32 s29, 524288
 s_cbranch_scc1 fretry_13
 s_branch fback_14
fretry_23:
 buffer_load_dwordx4 v[152:155], v1, s[8:11], s61 offen sc1
 buffer_load_dwordx4 v[156:159], v1, s[8:11], s61 offen offset:1024 sc1
 s_waitcnt vmcnt(0)
 v_and_b32 v147, v152, v153
 v_bitop3_b32 v147, v147, v154, v155 bitop3:0x80
 v_bitop3_b32 v147, v147, v156, v157 bitop3:0x80
 v_bitop3_b32 v147, v147, v158, v159 bitop3:0x80
 v_and_b32 v147, 1, v147
 v_cmp_ne_u32 vcc, 1, v147
 s_cbranch_vccz fback_24
 s_add_u32 s29, s29, 1
 s_cmp_lt_u32 s29, 524288
 s_cbranch_scc1 fretry_23
 s_branch fback_24
fretry_25:
 buffer_load_dword v26, v254, s[8:11], s51 offen sc1
 s_waitcnt vmcnt(0)
 v_cmp_gt_u32 vcc, 3, v26
 s_cbranch_vccz fback_26
 s_add_u32 s29, s29, 1
 s_cmp_lt_u32 s29, 524288
 s_cbranch_scc1 fretry_25
 s_branch fback_26
fretry_27:
 buffer_load_dword v26, v254, s[8:11], s51 offen sc1
 s_waitcnt vmcnt(0)
 v_cmp_gt_u32 vcc, 4, v26
 s_cbranch_vccz fback_28
 s_add_u32 s29, s29, 1
 s_cmp_lt_u32 s29, 524288
 s_cbranch_scc1 fretry_27
 s_branch fback_28
slow_body:
 v_cvt_pk_bf16_f32 v88, v60, v61
 v_cvt_pk_bf16_f32 v89, v62, v63
 ds_write_b64 v20, v[88:89]
 buffer_load_dwordx4 v3, s[8:11], s85 offen offset:1024 sc1 lds
 buffer_load_dwordx4 v3, s[8:11], s85 offen offset:2048 sc1 lds
 buffer_load_dwordx4 v3, s[8:11], s85 offen offset:3072 sc1 lds
 buffer_load_dwordx4 a[64:67], v39, s[8:11], s68 offen sc1
 buffer_load_dwordx4 a[68:71], v39, s[8:11], s68 offen offset:1024 sc1
 s_waitcnt lgkmcnt(0)
 s_barrier
 ds_read_b128 v[64:67], v1 offset:35840
 ds_read_b128 v[68:71], v1 offset:36864
 ds_read_b64 v[72:73], v1 offset:37888
 s_waitcnt lgkmcnt(2)
 v_mfma_f32_32x32x16_bf16 v[184:199], v[64:67], v[232:235], 0
 s_waitcnt lgkmcnt(1)
 v_mfma_f32_32x32x16_bf16 v[184:199], v[68:71], v[236:239], v[184:199]
 s_waitcnt lgkmcnt(0)
 v_mfma_f32_32x32x16_bf16 v[184:199], v[72:75], v[240:243], v[184:199]
 v_mfma_f32_32x32x16_bf16 v[136:151], v[64:67], v[244:247], 0
 v_mfma_f32_32x32x16_bf16 v[136:151], v[68:71], v[248:251], v[136:151]
 v_mfma_f32_32x32x16_bf16 v[136:151], v[72:75], v[252:255], v[136:151]
 s_nop 8
 v_add_f32 v196, 0x358637bd, v196
 v_rcp_f32 v196, v196
 s_nop 0
 v_mul_f32 v184, v184, v196
 v_mul_f32 v185, v185, v196
 v_cvt_pk_bf16_f32 v40, v184, v185
 v_mul_f32 v186, v186, v196
 v_mul_f32 v187, v187, v196
 v_cvt_pk_bf16_f32 v41, v186, v187
 v_mul_f32 v188, v188, v196
 v_mul_f32 v189, v189, v196
 v_cvt_pk_bf16_f32 v42, v188, v189
 v_pk_mul_f32 v[190:191], v[190:191], v[196:197] op_sel_hi:[1,0]
 v_cvt_pk_bf16_f32 v43, v190, v191
 buffer_store_dwordx4 v[40:43], v6, s[8:11], 0 offen sc1
 v_pk_mul_f32 v[192:193], v[192:193], v[196:197] op_sel_hi:[1,0]
 v_cvt_pk_bf16_f32 v44, v192, v193
 v_pk_mul_f32 v[194:195], v[194:195], v[196:197] op_sel_hi:[1,0]
 v_cvt_pk_bf16_f32 v45, v194, v195
 buffer_store_dwordx2 v[44:45], v7, s[8:11], 0 offen sc1
 v_add_f32 v148, 0x358637bd, v148
 v_rcp_f32 v148, v148
 s_nop 0
 v_pk_mul_f32 v[136:137], v[136:137], v[148:149] op_sel_hi:[1,0]
 v_cvt_pk_bf16_f32 v48, v136, v137
 v_pk_mul_f32 v[138:139], v[138:139], v[148:149] op_sel_hi:[1,0]
 v_cvt_pk_bf16_f32 v49, v138, v139
 v_pk_mul_f32 v[140:141], v[140:141], v[148:149] op_sel_hi:[1,0]
 v_cvt_pk_bf16_f32 v50, v140, v141
 v_pk_mul_f32 v[142:143], v[142:143], v[148:149] op_sel_hi:[1,0]
 v_cvt_pk_bf16_f32 v51, v142, v143
 buffer_store_dwordx4 v[48:51], v6, s[8:11], s0 offen sc1
 v_pk_mul_f32 v[144:145], v[144:145], v[148:149] op_sel_hi:[1,0]
 v_cvt_pk_bf16_f32 v52, v144, v145
 v_pk_mul_f32 v[146:147], v[146:147], v[148:149] op_sel_hi:[1,0]
 v_cvt_pk_bf16_f32 v53, v146, v147
 buffer_store_dwordx2 v[52:53], v7, s[8:11], s0 offen sc1
 s_add_u32 m0, s28, 114688
 s_add_u32 s85, s35, 32768
 buffer_load_dwordx4 v3, s[8:11], s85 offen offset:2048 sc1 lds
 buffer_load_dwordx4 v3, s[8:11], s85 offen offset:3072 sc1 lds
 s_add_u32 m0, s28, 147456
 s_add_u32 s85, s35, 65536
 buffer_load_dwordx4 v3, s[8:11], s85 offen sc1 lds
 buffer_load_dwordx4 v3, s[8:11], s85 offen offset:1024 sc1 lds
 s_add_u32 s31, s22, 3
 s_and_b32 s31, s31, 3
 s_mul_i32 s31, s31, 5120
 s_add_u32 s31, s31, 2048
 v_add_u32 v220, s31, v22
 s_add_u32 s31, s22, 2
 s_and_b32 s31, s31, 3
 s_mul_i32 s31, s31, 5120
 s_add_u32 s31, s31, 2048
 v_add_u32 v221, s31, v22
 s_add_u32 s31, s22, 1
 s_and_b32 s31, s31, 3
 s_mul_i32 s31, s31, 5120
 s_add_u32 s31, s31, 2048
 v_add_u32 v222, s31, v22
 v_lshlrev_b32 v192, 16, v28
 v_and_b32 v193, 0xffff0000, v28
 v_lshlrev_b32 v194, 16, v29
 v_and_b32 v195, 0xffff0000, v29
 v_lshlrev_b32 v196, 16, v30
 v_and_b32 v197, 0xffff0000, v30
 v_lshlrev_b32 v198, 16, v31
 v_and_b32 v199, 0xffff0000, v31
 v_lshlrev_b32 v200, 16, v32
 v_and_b32 v201, 0xffff0000, v32
 v_lshlrev_b32 v202, 16, v33
 v_and_b32 v203, 0xffff0000, v33
 v_lshlrev_b32 v204, 16, v34
 v_and_b32 v205, 0xffff0000, v34
 v_lshlrev_b32 v206, 16, v35
 v_and_b32 v207, 0xffff0000, v35
 v_lshlrev_b32 v208, 16, v36
 v_and_b32 v209, 0xffff0000, v36
 v_lshlrev_b32 v210, 16, v37
 v_and_b32 v211, 0xffff0000, v37
 s_add_u32 s30, s52, 4096
 s_add_u32 s31, s53, 4096
 s_add_u32 s32, s54, 4096
 s_add_u32 s33, s55, 4096
 v_mov_b32 v27, 1
 s_waitcnt vmcnt(4)
 s_mov_b64 exec, 1
 buffer_store_dword v27, off, s[8:11], s46 sc1
 s_mov_b64 exec, -1
 buffer_load_dwordx4 a[112:115], v38, s[8:11], s67 offen offset:2048 sc1
 buffer_load_dwordx4 a[116:119], v38, s[8:11], s67 offen offset:3072 sc1
 s_add_u32 m0, s28, 131072
 s_add_u32 s85, s35, 49152
 buffer_load_dwordx4 v3, s[8:11], s85 offen sc1 lds
 buffer_load_dwordx4 v3, s[8:11], s85 offen offset:1024 sc1 lds
 s_add_u32 m0, s28, 147456
 s_add_u32 s85, s35, 65536
 buffer_load_dwordx4 v3, s[8:11], s85 offen offset:2048 sc1 lds
 buffer_load_dwordx4 v3, s[8:11], s85 offen offset:3072 sc1 lds
 v_and_b32 v25, 28, v22
 buffer_load_dword v26, v25, s[8:11], s47 offen sc1
sspin_1:
 buffer_load_dword v0, v25, s[8:11], s47 offen sc1
 s_waitcnt vmcnt(1)
 v_cmp_gt_u32 vcc, 1, v26
 s_cbranch_vccz sok_2
 buffer_load_dword v26, v25, s[8:11], s47 offen sc1
 s_waitcnt vmcnt(1)
 v_cmp_gt_u32 vcc, 1, v0
 s_cbranch_vccz sok_2
 s_add_u32 s29, s29, 1
 s_cmp_lt_u32 s29, 524288
 s_cbranch_scc1 sspin_1
sok_2:
 buffer_load_dwordx4 v[40:43], v1, s[8:11], s52 offen sc1
 buffer_load_dwordx4 v[44:47], v1, s[8:11], s52 offen offset:1024 sc1
 buffer_load_dwordx4 v[48:51], v1, s[8:11], s52 offen offset:2048 sc1
 buffer_load_dwordx4 v[52:55], v1, s[8:11], s52 offen offset:3072 sc1
 buffer_load_dwordx4 v[56:59], v1, s[8:11], s30 offen sc1
 buffer_load_dwordx4 v[60:63], v1, s[8:11], s53 offen sc1
 buffer_load_dwordx4 v[64:67], v1, s[8:11], s53 offen offset:1024 sc1
 buffer_load_dwordx4 v[68:71], v1, s[8:11], s53 offen offset:2048 sc1
 s_waitcnt vmcnt(7)
 v_mfma_f32_16x16x32_bf16 v[152:155], a[120:123], v[40:43], 0
 buffer_load_dwordx4 v[72:75], v1, s[8:11], s53 offen offset:3072 sc1
 v_mfma_f32_16x16x32_bf16 v[156:159], a[124:127], v[40:43], 0
 v_mfma_f32_16x16x32_bf16 v[160:163], a[128:131], v[40:43], 0
 v_mfma_f32_16x16x32_bf16 v[164:167], a[132:135], v[40:43], 0
 buffer_load_dwordx4 v[76:79], v1, s[8:11], s31 offen sc1
 v_mfma_f32_16x16x32_bf16 v[168:171], a[136:139], v[40:43], 0
 s_waitcnt vmcnt(8)
 v_mfma_f32_16x16x32_bf16 v[152:155], a[140:143], v[44:47], v[152:155]
 v_mfma_f32_16x16x32_bf16 v[156:159], a[144:147], v[44:47], v[156:159]
 buffer_load_dwordx4 v[80:83], v1, s[8:11], s54 offen sc1
 v_mfma_f32_16x16x32_bf16 v[160:163], a[148:151], v[44:47], v[160:163]
 v_mfma_f32_16x16x32_bf16 v[164:167], a[152:155], v[44:47], v[164:167]
 v_mfma_f32_16x16x32_bf16 v[168:171], a[156:159], v[44:47], v[168:171]
 s_waitcnt vmcnt(8)
 v_mfma_f32_16x16x32_bf16 v[152:155], a[160:163], v[48:51], v[152:155]
 buffer_load_dwordx4 v[84:87], v1, s[8:11], s54 offen offset:1024 sc1
 v_mfma_f32_16x16x32_bf16 v[156:159], a[100:103], v[48:51], v[156:159]
 v_mfma_f32_16x16x32_bf16 v[160:163], a[104:107], v[48:51], v[160:163]
 v_mfma_f32_16x16x32_bf16 v[164:167], a[108:111], v[48:51], v[164:167]
 buffer_load_dwordx4 v[88:91], v1, s[8:11], s54 offen offset:2048 sc1
 v_mfma_f32_16x16x32_bf16 v[168:171], a[112:115], v[48:51], v[168:171]
 s_waitcnt vmcnt(9)
 v_mfma_f32_16x16x32_bf16 v[152:155], a[116:119], v[52:55], v[152:155]
 v_mfma_f32_16x16x32_bf16 v[156:159], v[104:107], v[52:55], v[156:159]
 buffer_load_dwordx4 v[92:95], v1, s[8:11], s54 offen offset:3072 sc1
 v_mfma_f32_16x16x32_bf16 v[160:163], v[108:111], v[52:55], v[160:163]
 v_mfma_f32_16x16x32_bf16 v[164:167], v[112:115], v[52:55], v[164:167]
 v_mfma_f32_16x16x32_bf16 v[168:171], v[116:119], v[52:55], v[168:171]
 s_waitcnt vmcnt(9)
 v_mfma_f32_16x16x32_bf16 v[152:155], v[120:123], v[56:59], v[152:155]
 buffer_load_dwordx4 v[96:99], v1, s[8:11], s32 offen sc1
 v_mfma_f32_16x16x32_bf16 v[156:159], v[124:127], v[56:59], v[156:159]
 v_mfma_f32_16x16x32_bf16 v[160:163], v[128:131], v[56:59], v[160:163]
 v_mfma_f32_16x16x32_bf16 v[164:167], v[132:135], v[56:59], v[164:167]
 buffer_load_dwordx4 v[100:103], v1, s[8:11], s55 offen sc1
 v_mfma_f32_16x16x32_bf16 v[168:171], v[216:219], v[56:59], v[168:171]
 s_waitcnt vmcnt(10)
 v_mfma_f32_16x16x32_bf16 v[172:175], a[120:123], v[60:63], 0
 v_mfma_f32_16x16x32_bf16 v[176:179], a[124:127], v[60:63], 0
 buffer_load_dwordx4 v[136:139], v1, s[8:11], s55 offen offset:1024 sc1
 v_mfma_f32_16x16x32_bf16 v[180:183], a[128:131], v[60:63], 0
 s_mov_b32 m0, s7
 s_nop 0
 ds_write_addtid_b32 v152
 ds_write_addtid_b32 v153 offset:256
 v_mfma_f32_16x16x32_bf16 v[184:187], a[132:135], v[60:63], 0
 ds_write_addtid_b32 v154 offset:512
 ds_write_addtid_b32 v155 offset:768
 v_mfma_f32_16x16x32_bf16 v[188:191], a[136:139], v[60:63], 0
 s_waitcnt vmcnt(10)
 ds_write_addtid_b32 v156 offset:1024
 ds_write_addtid_b32 v157 offset:1280
 ds_write_addtid_b32 v158 offset:1536
 v_mfma_f32_16x16x32_bf16 v[172:175], a[140:143], v[64:67], v[172:175]
 buffer_load_dwordx4 v[140:143], v1, s[8:11], s55 offen offset:2048 sc1
 ds_write_addtid_b32 v159 offset:1792
 v_mfma_f32_16x16x32_bf16 v[176:179], a[144:147], v[64:67], v[176:179]
 ds_write_addtid_b32 v160 offset:2048
 ds_write_addtid_b32 v161 offset:2304
 v_mfma_f32_16x16x32_bf16 v[180:183], a[148:151], v[64:67], v[180:183]
 ds_write_addtid_b32 v162 offset:2560
 ds_write_addtid_b32 v163 offset:2816
 v_mfma_f32_16x16x32_bf16 v[184:187], a[152:155], v[64:67], v[184:187]
 buffer_load_dwordx4 v[144:147], v1, s[8:11], s55 offen offset:3072 sc1
 ds_write_addtid_b32 v164 offset:3072
 v_mfma_f32_16x16x32_bf16 v[188:191], a[156:159], v[64:67], v[188:191]
 s_waitcnt vmcnt(11)
 ds_write_addtid_b32 v165 offset:3328
 ds_write_addtid_b32 v166 offset:3584
 v_mfma_f32_16x16x32_bf16 v[172:175], a[160:163], v[68:71], v[172:175]
 ds_write_addtid_b32 v167 offset:3840
 ds_write_addtid_b32 v168 offset:4096
 ds_write_addtid_b32 v169 offset:4352
 v_mfma_f32_16x16x32_bf16 v[176:179], a[100:103], v[68:71], v[176:179]
 buffer_load_dwordx4 v[148:151], v1, s[8:11], s33 offen sc1
 ds_write_addtid_b32 v170 offset:4608
 v_mfma_f32_16x16x32_bf16 v[180:183], a[104:107], v[68:71], v[180:183]
 s_add_u32 m0, s28, 131072
 s_add_u32 s85, s35, 49152
 buffer_load_dwordx4 v3, s[8:11], s85 offen offset:2048 sc1 lds
 s_mov_b32 m0, s7
 s_nop 0
 ds_write_addtid_b32 v171 offset:4864
 v_mfma_f32_16x16x32_bf16 v[184:187], a[108:111], v[68:71], v[184:187]
 v_mfma_f32_16x16x32_bf16 v[188:191], a[112:115], v[68:71], v[188:191]
 s_waitcnt vmcnt(12)
 v_mfma_f32_16x16x32_bf16 v[172:175], a[116:119], v[72:75], v[172:175]
 v_mfma_f32_16x16x32_bf16 v[176:179], v[104:107], v[72:75], v[176:179]
 s_waitcnt lgkmcnt(0)
 s_add_u32 m0, s28, 131072
 s_nop 0
 buffer_load_dwordx4 v3, s[8:11], s85 offen offset:3072 sc1 lds
 s_barrier
 v_mfma_f32_16x16x32_bf16 v[180:183], v[108:111], v[72:75], v[180:183]
 ds_read2st64_b32 v[40:41], v220 offset0:0 offset1:1
 v_mfma_f32_16x16x32_bf16 v[184:187], v[112:115], v[72:75], v[184:187]
 ds_read2st64_b32 v[42:43], v220 offset0:2 offset1:3
 v_mfma_f32_16x16x32_bf16 v[188:191], v[116:119], v[72:75], v[188:191]
 s_waitcnt vmcnt(12)
 ds_read2st64_b32 v[44:45], v220 offset0:4 offset1:5
 v_mfma_f32_16x16x32_bf16 v[172:175], v[120:123], v[76:79], v[172:175]
 ds_read2st64_b32 v[46:47], v220 offset0:6 offset1:7
 v_mfma_f32_16x16x32_bf16 v[176:179], v[124:127], v[76:79], v[176:179]
 s_add_u32 m0, s28, 65536
 s_add_u32 s85, s64, 24576
 buffer_load_dwordx4 v3, s[8:11], s85 offen sc1 lds
 ds_read2st64_b32 v[48:49], v220 offset0:8 offset1:9
 v_mfma_f32_16x16x32_bf16 v[180:183], v[128:131], v[76:79], v[180:183]
 ds_read2st64_b32 v[50:51], v220 offset0:10 offset1:11
 v_mfma_f32_16x16x32_bf16 v[184:187], v[132:135], v[76:79], v[184:187]
 ds_read2st64_b32 v[52:53], v220 offset0:12 offset1:13
 v_mfma_f32_16x16x32_bf16 v[188:191], v[216:219], v[76:79], v[188:191]
 s_waitcnt vmcnt(12)
 ds_read2st64_b32 v[54:55], v220 offset0:14 offset1:15
 v_mfma_f32_16x16x32_bf16 v[152:155], a[120:123], v[80:83], 0
 ds_read2st64_b32 v[56:57], v220 offset0:16 offset1:17
 v_mfma_f32_16x16x32_bf16 v[156:159], a[124:127], v[80:83], 0
 buffer_load_dword v0, v1, s[8:11], s42 offen sc1
 ds_read2st64_b32 v[58:59], v220 offset0:18 offset1:19
 v_mfma_f32_16x16x32_bf16 v[160:163], a[128:131], v[80:83], 0
 s_mov_b32 m0, s7
 s_nop 0
 ds_write_addtid_b32 v172 offset:20480
 ds_write_addtid_b32 v173 offset:20736
 v_mfma_f32_16x16x32_bf16 v[164:167], a[132:135], v[80:83], 0
 ds_write_addtid_b32 v174 offset:20992
 ds_write_addtid_b32 v175 offset:21248
 v_mfma_f32_16x16x32_bf16 v[168:171], a[136:139], v[80:83], 0
 s_waitcnt vmcnt(12) lgkmcnt(13)
 ds_write_addtid_b32 v176 offset:21504
 ds_write_addtid_b32 v177 offset:21760
 v_add_f32 v192, v192, v40
 v_mfma_f32_16x16x32_bf16 v[152:155], a[140:143], v[84:87], v[152:155]
 ds_write_addtid_b32 v178 offset:22016
 ds_write_addtid_b32 v179 offset:22272
 v_mfma_f32_16x16x32_bf16 v[156:159], a[144:147], v[84:87], v[156:159]
 s_add_u32 s86, s41, 55296
 buffer_load_dword v0, v1, s[8:11], s86 offen sc1
 ds_write_addtid_b32 v180 offset:22528
 v_mfma_f32_16x16x32_bf16 v[160:163], a[148:151], v[84:87], v[160:163]
 ds_write_addtid_b32 v181 offset:22784
 ds_write_addtid_b32 v182 offset:23040
 v_add_f32 v193, v193, v41
 v_mfma_f32_16x16x32_bf16 v[164:167], a[152:155], v[84:87], v[164:167]
 ds_write_addtid_b32 v183 offset:23296
 ds_write_addtid_b32 v184 offset:23552
 v_mfma_f32_16x16x32_bf16 v[168:171], a[156:159], v[84:87], v[168:171]
 s_waitcnt vmcnt(12)
 ds_write_addtid_b32 v185 offset:23808
 ds_write_addtid_b32 v186 offset:24064
 v_mfma_f32_16x16x32_bf16 v[152:155], a[160:163], v[88:91], v[152:155]
 s_waitcnt lgkmcnt(14)
 buffer_load_dword v0, v1, s[8:11], s86 offen offset:1024 sc1
 ds_write_addtid_b32 v187 offset:24320
 v_add_f32 v194, v194, v42
 v_mfma_f32_16x16x32_bf16 v[156:159], a[100:103], v[88:91], v[156:159]
 ds_write_addtid_b32 v188 offset:24576
 ds_write_addtid_b32 v189 offset:24832
 v_mfma_f32_16x16x32_bf16 v[160:163], a[104:107], v[88:91], v[160:163]
 ds_write_addtid_b32 v190 offset:25088
 ds_write_addtid_b32 v191 offset:25344
 v_mfma_f32_16x16x32_bf16 v[164:167], a[108:111], v[88:91], v[164:167]
 v_add_f32 v195, v195, v43
 v_add_f32 v196, v196, v44
 v_add_f32 v197, v197, v45
 v_mfma_f32_16x16x32_bf16 v[168:171], a[112:115], v[88:91], v[168:171]
 s_waitcnt vmcnt(12)
 v_add_f32 v198, v198, v46
 v_add_f32 v199, v199, v47
 v_mfma_f32_16x16x32_bf16 v[152:155], a[116:119], v[92:95], v[152:155]
 s_add_u32 s86, s84, 55296
 buffer_load_dword v0, v1, s[8:11], s86 offen sc1
 v_add_f32 v200, v200, v48
 v_add_f32 v201, v201, v49
 v_mfma_f32_16x16x32_bf16 v[156:159], v[104:107], v[92:95], v[156:159]
 s_waitcnt lgkmcnt(0)
 s_barrier
 v_add_f32 v202, v202, v50
 v_add_f32 v203, v203, v51
 v_mfma_f32_16x16x32_bf16 v[160:163], v[108:111], v[92:95], v[160:163]
 ds_read2st64_b32 v[60:61], v221 offset0:80 offset1:81
 v_add_f32 v204, v204, v52
 v_mfma_f32_16x16x32_bf16 v[164:167], v[112:115], v[92:95], v[164:167]
 ds_read2st64_b32 v[62:63], v221 offset0:82 offset1:83
 v_add_f32 v205, v205, v53
 v_mfma_f32_16x16x32_bf16 v[168:171], v[116:119], v[92:95], v[168:171]
 s_waitcnt vmcnt(12)
 ds_read2st64_b32 v[64:65], v221 offset0:84 offset1:85
 v_add_f32 v206, v206, v54
 v_add_f32 v207, v207, v55
 v_mfma_f32_16x16x32_bf16 v[152:155], v[120:123], v[96:99], v[152:155]
 s_add_u32 s86, s42, 55296
 buffer_load_dword v0, v1, s[8:11], s86 offen sc1
 ds_read2st64_b32 v[66:67], v221 offset0:86 offset1:87
 v_mfma_f32_16x16x32_bf16 v[156:159], v[124:127], v[96:99], v[156:159]
 ds_read2st64_b32 v[68:69], v221 offset0:88 offset1:89
 v_add_f32 v208, v208, v56
 v_mfma_f32_16x16x32_bf16 v[160:163], v[128:131], v[96:99], v[160:163]
 ds_read2st64_b32 v[70:71], v221 offset0:90 offset1:91
 v_add_f32 v209, v209, v57
 v_add_f32 v210, v210, v58
 v_mfma_f32_16x16x32_bf16 v[164:167], v[132:135], v[96:99], v[164:167]
 ds_read2st64_b32 v[72:73], v221 offset0:92 offset1:93
 v_add_f32 v211, v211, v59
 v_mfma_f32_16x16x32_bf16 v[168:171], v[216:219], v[96:99], v[168:171]
 s_waitcnt vmcnt(12)
 ds_read2st64_b32 v[74:75], v221 offset0:94 offset1:95
 v_mfma_f32_16x16x32_bf16 v[192:195], a[120:123], v[100:103], v[192:195]
 buffer_load_dwordx4 a[72:75], v39, s[8:11], s68 offen offset:2048 sc1
 ds_read2st64_b32 v[76:77], v221 offset0:96 offset1:97
 v_mfma_f32_16x16x32_bf16 v[196:199], a[124:127], v[100:103], v[196:199]
 ds_read2st64_b32 v[78:79], v221 offset0:98 offset1:99
 v_mfma_f32_16x16x32_bf16 v[200:203], a[128:131], v[100:103], v[200:203]
 ds_write_addtid_b32 v152
 ds_write_addtid_b32 v153 offset:256
 v_mfma_f32_16x16x32_bf16 v[204:207], a[132:135], v[100:103], v[204:207]
 ds_write_addtid_b32 v154 offset:512
 ds_write_addtid_b32 v155 offset:768
 v_mfma_f32_16x16x32_bf16 v[208:211], a[136:139], v[100:103], v[208:211]
 s_waitcnt vmcnt(12)
 buffer_load_dwordx4 a[76:79], v39, s[8:11], s68 offen offset:3072 sc1
 ds_write_addtid_b32 v156 offset:1024
 v_mfma_f32_16x16x32_bf16 v[192:195], a[140:143], v[136:139], v[192:195]
 ds_write_addtid_b32 v157 offset:1280
 ds_write_addtid_b32 v158 offset:1536
 v_mfma_f32_16x16x32_bf16 v[196:199], a[144:147], v[136:139], v[196:199]
 ds_write_addtid_b32 v159 offset:1792
 ds_write_addtid_b32 v160 offset:2048
 v_mfma_f32_16x16x32_bf16 v[200:203], a[148:151], v[136:139], v[200:203]
 ds_write_addtid_b32 v161 offset:2304
 ds_write_addtid_b32 v162 offset:2560
 ds_write_addtid_b32 v163 offset:2816
 v_mfma_f32_16x16x32_bf16 v[204:207], a[152:155], v[136:139], v[204:207]
 buffer_load_dwordx4 a[80:83], v39, s[8:11], s69 offen sc1
 ds_write_addtid_b32 v164 offset:3072
 v_mfma_f32_16x16x32_bf16 v[208:211], a[156:159], v[136:139], v[208:211]
 s_waitcnt vmcnt(13)
 ds_write_addtid_b32 v165 offset:3328
 ds_write_addtid_b32 v166 offset:3584
 v_mfma_f32_16x16x32_bf16 v[192:195], a[160:163], v[140:143], v[192:195]
 ds_write_addtid_b32 v167 offset:3840
 ds_write_addtid_b32 v168 offset:4096
 v_mfma_f32_16x16x32_bf16 v[196:199], a[100:103], v[140:143], v[196:199]
 ds_write_addtid_b32 v169 offset:4352
 ds_write_addtid_b32 v170 offset:4608
 v_mfma_f32_16x16x32_bf16 v[200:203], a[104:107], v[140:143], v[200:203]
 buffer_load_dwordx4 a[84:87], v39, s[8:11], s69 offen offset:1024 sc1
 ds_write_addtid_b32 v171 offset:4864
 v_mfma_f32_16x16x32_bf16 v[204:207], a[108:111], v[140:143], v[204:207]
 v_mfma_f32_16x16x32_bf16 v[208:211], a[112:115], v[140:143], v[208:211]
 s_waitcnt vmcnt(13)
 v_mfma_f32_16x16x32_bf16 v[192:195], a[116:119], v[144:147], v[192:195]
 v_mfma_f32_16x16x32_bf16 v[196:199], v[104:107], v[144:147], v[196:199]
 s_waitcnt lgkmcnt(0)
 buffer_load_dwordx4 a[88:91], v39, s[8:11], s69 offen offset:2048 sc1
 s_barrier
 v_mfma_f32_16x16x32_bf16 v[200:203], v[108:111], v[144:147], v[200:203]
 ds_read2st64_b32 v[40:41], v222 offset0:0 offset1:1
 v_mfma_f32_16x16x32_bf16 v[204:207], v[112:115], v[144:147], v[204:207]
 ds_read2st64_b32 v[42:43], v222 offset0:2 offset1:3
 v_mfma_f32_16x16x32_bf16 v[208:211], v[116:119], v[144:147], v[208:211]
 s_waitcnt vmcnt(13)
 ds_read2st64_b32 v[44:45], v222 offset0:4 offset1:5
 v_mfma_f32_16x16x32_bf16 v[192:195], v[120:123], v[148:151], v[192:195]
 buffer_load_dwordx4 a[92:95], v39, s[8:11], s69 offen offset:3072 sc1
 ds_read2st64_b32 v[46:47], v222 offset0:6 offset1:7
 v_mfma_f32_16x16x32_bf16 v[196:199], v[124:127], v[148:151], v[196:199]
 ds_read2st64_b32 v[48:49], v222 offset0:8 offset1:9
 v_mfma_f32_16x16x32_bf16 v[200:203], v[128:131], v[148:151], v[200:203]
 ds_read2st64_b32 v[50:51], v222 offset0:10 offset1:11
 v_mfma_f32_16x16x32_bf16 v[204:207], v[132:135], v[148:151], v[204:207]
 ds_read2st64_b32 v[52:53], v222 offset0:12 offset1:13
 v_mfma_f32_16x16x32_bf16 v[208:211], v[216:219], v[148:151], v[208:211]
 ds_read2st64_b32 v[54:55], v222 offset0:14 offset1:15
 ds_read2st64_b32 v[56:57], v222 offset0:16 offset1:17
 ds_read2st64_b32 v[58:59], v222 offset0:18 offset1:19
 v_pk_add_f32 v[192:193], v[192:193], v[60:61]
 v_pk_add_f32 v[194:195], v[194:195], v[62:63]
 v_pk_add_f32 v[196:197], v[196:197], v[64:65]
 v_pk_add_f32 v[198:199], v[198:199], v[66:67]
 v_pk_add_f32 v[200:201], v[200:201], v[68:69]
 v_pk_add_f32 v[202:203], v[202:203], v[70:71]
 v_pk_add_f32 v[204:205], v[204:205], v[72:73]
 v_pk_add_f32 v[206:207], v[206:207], v[74:75]
 v_pk_add_f32 v[208:209], v[208:209], v[76:77]
 v_pk_add_f32 v[210:211], v[210:211], v[78:79]
 s_waitcnt lgkmcnt(0)
 v_pk_add_f32 v[192:193], v[192:193], v[40:41]
 v_cvt_pk_bf16_f32 v28, v192, v193
 v_pk_add_f32 v[194:195], v[194:195], v[42:43]
 v_cvt_pk_bf16_f32 v29, v194, v195
 v_pk_add_f32 v[196:197], v[196:197], v[44:45]
 v_cvt_pk_bf16_f32 v30, v196, v197
 v_pk_add_f32 v[198:199], v[198:199], v[46:47]
 v_cvt_pk_bf16_f32 v31, v198, v199
 buffer_store_dwordx4 v[28:31], v1, s[8:11], s39 offen sc1
 v_pk_add_f32 v[200:201], v[200:201], v[48:49]
 v_cvt_pk_bf16_f32 v32, v200, v201
 v_pk_add_f32 v[202:203], v[202:203], v[50:51]
 v_cvt_pk_bf16_f32 v33, v202, v203
 v_pk_add_f32 v[204:205], v[204:205], v[52:53]
 v_cvt_pk_bf16_f32 v34, v204, v205
 v_pk_add_f32 v[206:207], v[206:207], v[54:55]
 v_cvt_pk_bf16_f32 v35, v206, v207
 buffer_store_dwordx4 v[32:35], v1, s[8:11], s39 offen offset:1024 sc1
 v_pk_add_f32 v[208:209], v[208:209], v[56:57]
 v_cvt_pk_bf16_f32 v36, v208, v209
 v_pk_add_f32 v[210:211], v[210:211], v[58:59]
 v_cvt_pk_bf16_f32 v37, v210, v211
 buffer_store_dwordx2 v[36:37], v8, s[8:11], s39 offen offset:2048 sc1
 v_mov_b32 v226, 0x3f803f80
 v_dot2_f32_bf16 v224, v28, v226, 0
 v_dot2_f32_bf16 v225, v28, v28, 0
 v_dot2_f32_bf16 v224, v29, v226, v224
 v_dot2_f32_bf16 v225, v29, v29, v225
 v_dot2_f32_bf16 v224, v30, v226, v224
 v_dot2_f32_bf16 v225, v30, v30, v225
 v_dot2_f32_bf16 v224, v31, v226, v224
 v_dot2_f32_bf16 v225, v31, v31, v225
 v_dot2_f32_bf16 v224, v32, v226, v224
 v_dot2_f32_bf16 v225, v32, v32, v225
 v_dot2_f32_bf16 v224, v33, v226, v224
 v_dot2_f32_bf16 v225, v33, v33, v225
 v_dot2_f32_bf16 v224, v34, v226, v224
 v_dot2_f32_bf16 v225, v34, v34, v225
 v_dot2_f32_bf16 v224, v35, v226, v224
 v_dot2_f32_bf16 v225, v35, v35, v225
 v_dot2_f32_bf16 v224, v36, v226, v224
 v_dot2_f32_bf16 v225, v36, v36, v225
 v_dot2_f32_bf16 v224, v37, v226, v224
 v_dot2_f32_bf16 v225, v37, v37, v225
 s_nop 2
 v_permlane32_swap_b32 v224, v225
 v_add_f32 v224, v224, v225
 v_mov_b32 v226, v224
 s_nop 1
 v_permlane16_swap_b32 v224, v226
 v_add_f32 v224, v224, v226
 v_or_b32 v224, 1, v224
 buffer_store_dword v224, v9, s[8:11], s40 offen sc1
 s_barrier
 s_add_u32 m0, s28, 65536
 s_nop 0
 buffer_load_dwordx4 v3, s[8:11], s85 offen offset:1024 sc1 lds
 buffer_load_dwordx4 v3, s[8:11], s85 offen offset:2048 sc1 lds
 v_add_u32 v38, s60, v1
 s_add_u32 s30, s41, 55296
 s_add_u32 s31, s42, 55296
 s_add_u32 s32, s84, 55296
 v_mov_b32 v27, 1
 s_waitcnt vmcnt(3)
 s_mov_b64 exec, 1
 buffer_store_dword v27, off, s[8:11], s48 sc1
 s_mov_b64 exec, -1
 s_add_u32 m0, s27, 40960
 s_add_u32 s85, s64, 0
 buffer_load_dwordx4 v2, s[8:11], s85 offen sc1 lds
 s_add_u32 m0, s28, 20480
 s_add_u32 s85, s36, 0
 buffer_load_dwordx4 v3, s[8:11], s85 offen sc1 lds
 s_add_u32 m0, s28, 65536
 s_add_u32 s85, s64, 24576
 buffer_load_dwordx4 v3, s[8:11], s85 offen offset:3072 sc1 lds
 s_add_u32 m0, s27, 45056
 s_add_u32 s85, s64, 4096
 buffer_load_dwordx4 v2, s[8:11], s85 offen sc1 lds
 v_mov_b32 v130, 0
 v_mov_b32 v138, 0
 v_mov_b32 v131, 0
 v_mov_b32 v139, 0
 v_mov_b32 v134, 0
 v_mov_b32 v142, 0
 v_mov_b32 v135, 0
 v_mov_b32 v143, 0
 v_and_b32 v144, 60, v22
 buffer_load_dword v145, v144, s[8:11], s49 offen sc1
sspin_3:
 buffer_load_dword v0, v144, s[8:11], s49 offen sc1
 s_waitcnt vmcnt(1)
 v_cmp_gt_u32 vcc, 1, v145
 s_cbranch_vccz sok_4
 buffer_load_dword v145, v144, s[8:11], s49 offen sc1
 s_waitcnt vmcnt(1)
 v_cmp_gt_u32 vcc, 1, v0
 s_cbranch_vccz sok_4
 s_add_u32 s29, s29, 1
 s_cmp_lt_u32 s29, 524288
 s_cbranch_scc1 sspin_3
sok_4:
 buffer_load_dwordx4 v[160:163], v38, s[8:11], 0 offen sc1
 buffer_load_dwordx4 v[164:167], v38, s[8:11], s69 offen sc1
 buffer_load_dwordx4 v[168:171], v38, s[8:11], 0 offen offset:1024 sc1
 buffer_load_dwordx4 v[172:175], v38, s[8:11], s69 offen offset:1024 sc1
 buffer_load_dwordx4 v[176:179], v38, s[8:11], 0 offen offset:2048 sc1
 buffer_load_dwordx4 v[180:183], v38, s[8:11], s69 offen offset:2048 sc1
 buffer_load_dwordx4 v[184:187], v38, s[8:11], 0 offen offset:3072 sc1
 buffer_load_dwordx4 v[188:191], v38, s[8:11], s69 offen offset:3072 sc1
 buffer_load_dwordx4 v[192:195], v38, s[8:11], s65 offen sc1
 buffer_load_dwordx4 v[196:199], v38, s[8:11], s70 offen sc1
 s_barrier
 v_add_u32 v25, 81920, v1
 v_add_u32 v26, 122880, v1
 ds_read_b128 v[96:99], v25
 ds_read_b128 v[100:103], v25 offset:20480
 ds_read_b128 v[104:107], v26
 ds_read_b128 v[108:111], v26 offset:20480
 ds_read_b128 v[112:115], v25 offset:1024
 ds_read_b128 v[116:119], v25 offset:21504
 v_and_b32 v27, 0xf0, v1
 v_lshrrev_b32 v27, 1, v27
 s_mov_b32 s92, 0xffff0000
 s_mov_b32 s93, 0
 s_mov_b32 s94, -1
 s_mov_b32 s95, 0
 s_waitcnt lgkmcnt(4)
 s_waitcnt vmcnt(9)
 v_mfma_f32_16x16x32_bf16 v[40:43], v[96:99], v[160:163], 0
 s_waitcnt vmcnt(8)
 ds_read_b128 v[120:123], v26 offset:1024
 buffer_load_dwordx4 v[152:155], v1, s[8:11], s61 offen sc1
 buffer_load_dwordx4 v[156:159], v1, s[8:11], s61 offen offset:1024 sc1
 buffer_load_dwordx4 v[200:203], v38, s[8:11], s65 offen offset:1024 sc1
 v_mfma_f32_16x16x32_bf16 v[44:47], v[96:99], v[164:167], 0
 v_mfma_f32_16x16x32_bf16 v[48:51], v[100:103], v[160:163], 0
 ds_read_b128 v[124:127], v26 offset:21504
 v_mfma_f32_16x16x32_bf16 v[52:55], v[100:103], v[164:167], 0
 s_waitcnt lgkmcnt(4)
 buffer_load_dwordx4 v[204:207], v38, s[8:11], s70 offen offset:1024 sc1
 v_mfma_f32_16x16x32_bf16 v[56:59], v[104:107], v[160:163], 0
 ds_read_b128 v[96:99], v25 offset:2048
 v_mfma_f32_16x16x32_bf16 v[60:63], v[104:107], v[164:167], 0
 v_mfma_f32_16x16x32_bf16 v[64:67], v[108:111], v[160:163], 0
 ds_read_b128 v[100:103], v25 offset:22528
 v_mfma_f32_16x16x32_bf16 v[68:71], v[108:111], v[164:167], 0
 s_waitcnt vmcnt(11) lgkmcnt(4)
 buffer_load_dwordx4 v[208:211], v38, s[8:11], s65 offen offset:2048 sc1
 v_mfma_f32_16x16x32_bf16 v[40:43], v[112:115], v[168:171], v[40:43]
 s_waitcnt vmcnt(11)
 ds_read_b128 v[104:107], v26 offset:2048
 v_mfma_f32_16x16x32_bf16 v[44:47], v[112:115], v[172:175], v[44:47]
 v_mfma_f32_16x16x32_bf16 v[48:51], v[116:119], v[168:171], v[48:51]
 ds_read_b128 v[108:111], v26 offset:22528
 v_mfma_f32_16x16x32_bf16 v[52:55], v[116:119], v[172:175], v[52:55]
 s_waitcnt lgkmcnt(4)
 buffer_load_dwordx4 v[212:215], v38, s[8:11], s70 offen offset:2048 sc1
 v_mfma_f32_16x16x32_bf16 v[56:59], v[120:123], v[168:171], v[56:59]
 ds_read_b128 v[112:115], v25 offset:3072
 v_mfma_f32_16x16x32_bf16 v[60:63], v[120:123], v[172:175], v[60:63]
 v_mfma_f32_16x16x32_bf16 v[64:67], v[124:127], v[168:171], v[64:67]
 ds_read_b128 v[116:119], v25 offset:23552
 buffer_load_dwordx4 v[216:219], v38, s[8:11], s65 offen offset:3072 sc1
 v_mfma_f32_16x16x32_bf16 v[68:71], v[124:127], v[172:175], v[68:71]
 s_waitcnt vmcnt(12) lgkmcnt(4)
 v_mfma_f32_16x16x32_bf16 v[40:43], v[96:99], v[176:179], v[40:43]
 s_waitcnt vmcnt(11)
 ds_read_b128 v[120:123], v26 offset:3072
 v_mfma_f32_16x16x32_bf16 v[44:47], v[96:99], v[180:183], v[44:47]
 v_mfma_f32_16x16x32_bf16 v[48:51], v[100:103], v[176:179], v[48:51]
 ds_read_b128 v[124:127], v26 offset:23552
 buffer_load_dwordx4 v[220:223], v38, s[8:11], s70 offen offset:3072 sc1
 v_mfma_f32_16x16x32_bf16 v[52:55], v[100:103], v[180:183], v[52:55]
 s_waitcnt lgkmcnt(4)
 v_mfma_f32_16x16x32_bf16 v[56:59], v[104:107], v[176:179], v[56:59]
 ds_read_b128 v[96:99], v25 offset:4096
 v_mfma_f32_16x16x32_bf16 v[60:63], v[104:107], v[180:183], v[60:63]
 v_mfma_f32_16x16x32_bf16 v[64:67], v[108:111], v[176:179], v[64:67]
 ds_read_b128 v[100:103], v25 offset:24576
 buffer_load_dwordx4 v[224:227], v38, s[8:11], s66 offen sc1
 v_mfma_f32_16x16x32_bf16 v[68:71], v[108:111], v[180:183], v[68:71]
 s_waitcnt vmcnt(12) lgkmcnt(4)
 v_mfma_f32_16x16x32_bf16 v[40:43], v[112:115], v[184:187], v[40:43]
 s_waitcnt vmcnt(11)
 ds_read_b128 v[104:107], v26 offset:4096
 v_mfma_f32_16x16x32_bf16 v[44:47], v[112:115], v[188:191], v[44:47]
 buffer_load_dwordx4 v[228:231], v38, s[8:11], s71 offen sc1
 v_mfma_f32_16x16x32_bf16 v[48:51], v[116:119], v[184:187], v[48:51]
 ds_read_b128 v[108:111], v26 offset:24576
 v_mfma_f32_16x16x32_bf16 v[52:55], v[116:119], v[188:191], v[52:55]
 s_waitcnt lgkmcnt(4)
 v_mfma_f32_16x16x32_bf16 v[56:59], v[120:123], v[184:187], v[56:59]
 ds_read_b128 v[112:115], v25 offset:5120
 v_mfma_f32_16x16x32_bf16 v[60:63], v[120:123], v[188:191], v[60:63]
 buffer_load_dwordx4 v[232:235], v38, s[8:11], s66 offen offset:1024 sc1
 v_mfma_f32_16x16x32_bf16 v[64:67], v[124:127], v[184:187], v[64:67]
 ds_read_b128 v[116:119], v25 offset:25600
 v_mfma_f32_16x16x32_bf16 v[68:71], v[124:127], v[188:191], v[68:71]
 s_waitcnt vmcnt(12) lgkmcnt(4)
 v_mfma_f32_16x16x32_bf16 v[40:43], v[96:99], v[192:195], v[40:43]
 s_waitcnt vmcnt(11)
 ds_read_b128 v[120:123], v26 offset:5120
 v_mfma_f32_16x16x32_bf16 v[44:47], v[96:99], v[196:199], v[44:47]
 buffer_load_dwordx4 v[236:239], v38, s[8:11], s71 offen offset:1024 sc1
 v_mfma_f32_16x16x32_bf16 v[48:51], v[100:103], v[192:195], v[48:51]
 ds_read_b128 v[124:127], v26 offset:25600
 v_mfma_f32_16x16x32_bf16 v[52:55], v[100:103], v[196:199], v[52:55]
 s_waitcnt lgkmcnt(4)
 v_mfma_f32_16x16x32_bf16 v[56:59], v[104:107], v[192:195], v[56:59]
 s_waitcnt vmcnt(11)
 ds_read_b128 v[96:99], v25 offset:6144
 v_and_b32 v147, v152, v153
 v_mfma_f32_16x16x32_bf16 v[60:63], v[104:107], v[196:199], v[60:63]
 buffer_load_dwordx4 v[240:243], v38, s[8:11], s66 offen offset:2048 sc1
 v_bitop3_b32 v147, v147, v154, v155 bitop3:0x80
 v_mfma_f32_16x16x32_bf16 v[64:67], v[108:111], v[192:195], v[64:67]
 ds_read_b128 v[100:103], v25 offset:26624
 v_mfma_f32_16x16x32_bf16 v[68:71], v[108:111], v[196:199], v[68:71]
 s_waitcnt vmcnt(10) lgkmcnt(4)
 v_bitop3_b32 v147, v147, v156, v157 bitop3:0x80
 v_bitop3_b32 v147, v147, v158, v159 bitop3:0x80
 v_mfma_f32_16x16x32_bf16 v[40:43], v[112:115], v[200:203], v[40:43]
 s_waitcnt vmcnt(9)
 ds_read_b128 v[104:107], v26 offset:6144
 buffer_load_dwordx4 v[244:247], v38, s[8:11], s71 offen offset:2048 sc1
 v_mfma_f32_16x16x32_bf16 v[44:47], v[112:115], v[204:207], v[44:47]
 v_and_b32 v147, 1, v147
 v_mfma_f32_16x16x32_bf16 v[48:51], v[116:119], v[200:203], v[48:51]
 ds_read_b128 v[108:111], v26 offset:26624
 v_cmp_ne_u32 vcc, 1, v147
 s_cbranch_vccnz sretry_5
sback_6:
 v_mfma_f32_16x16x32_bf16 v[52:55], v[116:119], v[204:207], v[52:55]
 s_waitcnt lgkmcnt(4)
 v_add_f32 v152, v152, v153
 v_add_f32 v156, v156, v157
 v_mfma_f32_16x16x32_bf16 v[56:59], v[120:123], v[200:203], v[56:59]
 ds_read_b128 v[112:115], v25 offset:7168
 buffer_load_dwordx4 v[248:251], v38, s[8:11], s66 offen offset:3072 sc1
 v_mfma_f32_16x16x32_bf16 v[60:63], v[120:123], v[204:207], v[60:63]
 v_add_f32 v154, v154, v155
 v_mfma_f32_16x16x32_bf16 v[64:67], v[124:127], v[200:203], v[64:67]
 ds_read_b128 v[116:119], v25 offset:27648
 v_add_f32 v158, v158, v159
 v_mfma_f32_16x16x32_bf16 v[68:71], v[124:127], v[204:207], v[68:71]
 s_waitcnt vmcnt(10) lgkmcnt(4)
 v_add_f32 v154, v154, v152
 v_add_f32 v158, v158, v156
 v_mfma_f32_16x16x32_bf16 v[40:43], v[96:99], v[208:211], v[40:43]
 s_waitcnt vmcnt(9)
 ds_read_b128 v[120:123], v26 offset:7168
 buffer_load_dwordx4 v[252:255], v38, s[8:11], s71 offen offset:3072 sc1
 v_mfma_f32_16x16x32_bf16 v[44:47], v[96:99], v[212:215], v[44:47]
 v_mov_b32 v155, v154
 v_mfma_f32_16x16x32_bf16 v[48:51], v[100:103], v[208:211], v[48:51]
 ds_read_b128 v[124:127], v26 offset:27648
 v_mov_b32 v159, v158
 v_mfma_f32_16x16x32_bf16 v[52:55], v[100:103], v[212:215], v[52:55]
 s_waitcnt lgkmcnt(4)
 buffer_load_dwordx4 a[100:103], v38, s[8:11], s67 offen sc1
 v_mfma_f32_16x16x32_bf16 v[56:59], v[104:107], v[208:211], v[56:59]
 ds_read_b128 v[96:99], v25 offset:8192
 v_mfma_f32_16x16x32_bf16 v[60:63], v[104:107], v[212:215], v[60:63]
 v_permlane16_swap_b32 v154, v155
 v_mfma_f32_16x16x32_bf16 v[64:67], v[108:111], v[208:211], v[64:67]
 ds_read_b128 v[100:103], v25 offset:28672
 v_mfma_f32_16x16x32_bf16 v[68:71], v[108:111], v[212:215], v[68:71]
 s_waitcnt vmcnt(10) lgkmcnt(4)
 buffer_load_dwordx4 a[104:107], v38, s[8:11], s72 offen sc1
 v_mfma_f32_16x16x32_bf16 v[40:43], v[112:115], v[216:219], v[40:43]
 s_waitcnt vmcnt(10)
 ds_read_b128 v[104:107], v26 offset:8192
 v_mfma_f32_16x16x32_bf16 v[44:47], v[112:115], v[220:223], v[44:47]
 v_permlane16_swap_b32 v158, v159
 v_mfma_f32_16x16x32_bf16 v[48:51], v[116:119], v[216:219], v[48:51]
 ds_read_b128 v[108:111], v26 offset:28672
 v_add_f32 v154, v154, v155
 v_mfma_f32_16x16x32_bf16 v[52:55], v[116:119], v[220:223], v[52:55]
 s_waitcnt lgkmcnt(4)
 buffer_load_dwordx4 a[108:111], v38, s[8:11], s67 offen offset:1024 sc1
 v_add_f32 v158, v158, v159
 v_mfma_f32_16x16x32_bf16 v[56:59], v[120:123], v[216:219], v[56:59]
 ds_read_b128 v[112:115], v25 offset:9216
 v_mov_b32 v155, v154
 v_mfma_f32_16x16x32_bf16 v[60:63], v[120:123], v[220:223], v[60:63]
 v_mov_b32 v159, v158
 v_mfma_f32_16x16x32_bf16 v[64:67], v[124:127], v[216:219], v[64:67]
 ds_read_b128 v[116:119], v25 offset:29696
 buffer_load_dwordx4 a[112:115], v38, s[8:11], s72 offen offset:1024 sc1
 v_mfma_f32_16x16x32_bf16 v[68:71], v[124:127], v[220:223], v[68:71]
 s_waitcnt vmcnt(11) lgkmcnt(4)
 v_permlane32_swap_b32 v154, v155
 v_mfma_f32_16x16x32_bf16 v[40:43], v[96:99], v[224:227], v[40:43]
 s_waitcnt vmcnt(10)
 ds_read_b128 v[120:123], v26 offset:9216
 v_mfma_f32_16x16x32_bf16 v[44:47], v[96:99], v[228:231], v[44:47]
 v_permlane32_swap_b32 v158, v159
 v_mfma_f32_16x16x32_bf16 v[48:51], v[100:103], v[224:227], v[48:51]
 ds_read_b128 v[124:127], v26 offset:29696
 buffer_load_dwordx4 a[116:119], v38, s[8:11], s67 offen offset:2048 sc1
 v_mfma_f32_16x16x32_bf16 v[52:55], v[100:103], v[228:231], v[52:55]
 s_waitcnt lgkmcnt(4)
 v_mul_f32 v153, 0xbacccccd, v154
 v_mul_f32 v157, 0xbacccccd, v158
 v_mfma_f32_16x16x32_bf16 v[56:59], v[104:107], v[224:227], v[56:59]
 ds_read_b128 v[96:99], v25 offset:10240
 v_mul_f32 v154, v153, v153
 v_mfma_f32_16x16x32_bf16 v[60:63], v[104:107], v[228:231], v[60:63]
 v_mul_f32 v158, v157, v157
 v_fmac_f32 v154, 0xbacccccd, v155
 v_mfma_f32_16x16x32_bf16 v[64:67], v[108:111], v[224:227], v[64:67]
 ds_read_b128 v[100:103], v25 offset:30720
 buffer_load_dwordx4 a[120:123], v38, s[8:11], s72 offen offset:2048 sc1
 v_mfma_f32_16x16x32_bf16 v[68:71], v[108:111], v[228:231], v[68:71]
 s_waitcnt vmcnt(11) lgkmcnt(4)
 v_fmac_f32 v158, 0xbacccccd, v159
 v_min_f32 v154, 0, v154
 v_mfma_f32_16x16x32_bf16 v[40:43], v[112:115], v[232:235], v[40:43]
 s_waitcnt vmcnt(10)
 ds_read_b128 v[104:107], v26 offset:10240
 v_min_f32 v158, 0, v158
 v_mfma_f32_16x16x32_bf16 v[44:47], v[112:115], v[236:239], v[44:47]
 v_sub_f32 v154, 0x3727c5ac, v154
 v_sub_f32 v158, 0x3727c5ac, v158
 v_mfma_f32_16x16x32_bf16 v[48:51], v[116:119], v[232:235], v[48:51]
 ds_read_b128 v[108:111], v26 offset:30720
 buffer_load_dwordx4 a[124:127], v38, s[8:11], s67 offen offset:3072 sc1
 v_mfma_f32_16x16x32_bf16 v[52:55], v[116:119], v[236:239], v[52:55]
 s_waitcnt lgkmcnt(4)
 v_rsq_f32 v152, v154
 v_mfma_f32_16x16x32_bf16 v[56:59], v[120:123], v[232:235], v[56:59]
 ds_read_b128 v[112:115], v25 offset:11264
 v_mfma_f32_16x16x32_bf16 v[60:63], v[120:123], v[236:239], v[60:63]
 buffer_load_dwordx4 a[128:131], v38, s[8:11], s72 offen offset:3072 sc1
 v_mfma_f32_16x16x32_bf16 v[64:67], v[124:127], v[232:235], v[64:67]
 ds_read_b128 v[116:119], v25 offset:31744
 v_mfma_f32_16x16x32_bf16 v[68:71], v[124:127], v[236:239], v[68:71]
 s_waitcnt vmcnt(11) lgkmcnt(4)
 v_rsq_f32 v156, v158
 v_mfma_f32_16x16x32_bf16 v[40:43], v[96:99], v[240:243], v[40:43]
 s_waitcnt vmcnt(10)
 ds_read_b128 v[120:123], v26 offset:11264
 v_mul_f32 v154, v154, v152
 v_mfma_f32_16x16x32_bf16 v[44:47], v[96:99], v[244:247], v[44:47]
 buffer_load_dwordx4 a[132:135], v38, s[8:11], s68 offen sc1
 v_mul_f32 v158, v158, v156
 v_mfma_f32_16x16x32_bf16 v[48:51], v[100:103], v[240:243], v[48:51]
 ds_read_b128 v[124:127], v26 offset:31744
 v_cvt_pk_bf16_f32 v144, v154, v153
 v_mfma_f32_16x16x32_bf16 v[52:55], v[100:103], v[244:247], v[52:55]
 s_waitcnt lgkmcnt(4)
 v_cvt_pk_bf16_f32 v148, v158, v157
 v_and_b32 v145, 0xffff0000, v144
 v_mfma_f32_16x16x32_bf16 v[56:59], v[104:107], v[240:243], v[56:59]
 ds_read_b128 v[96:99], v25 offset:12288
 v_and_b32 v149, 0xffff0000, v148
 v_mfma_f32_16x16x32_bf16 v[60:63], v[104:107], v[244:247], v[60:63]
 buffer_load_dwordx4 a[136:139], v38, s[8:11], s73 offen sc1
 v_lshlrev_b32 v144, 16, v144
 v_mfma_f32_16x16x32_bf16 v[64:67], v[108:111], v[240:243], v[64:67]
 ds_read_b128 v[100:103], v25 offset:32768
 v_lshlrev_b32 v148, 16, v148
 v_mfma_f32_16x16x32_bf16 v[68:71], v[108:111], v[244:247], v[68:71]
 s_waitcnt vmcnt(11) lgkmcnt(4)
 v_cndmask_b32 v145, 0, v145, s[92:93]
 v_cndmask_b32 v149, 0, v149, s[92:93]
 v_mfma_f32_16x16x32_bf16 v[40:43], v[112:115], v[248:251], v[40:43]
 s_waitcnt vmcnt(10)
 ds_read_b128 v[104:107], v26 offset:12288
 buffer_load_dwordx4 a[140:143], v38, s[8:11], s68 offen offset:1024 sc1
 v_mfma_f32_16x16x32_bf16 v[44:47], v[112:115], v[252:255], v[44:47]
 v_cndmask_b32 v144, 0, v144, s[92:93]
 v_cndmask_b32 v148, 0, v148, s[92:93]
 v_mfma_f32_16x16x32_bf16 v[48:51], v[116:119], v[248:251], v[48:51]
 ds_read_b128 v[108:111], v26 offset:32768
 v_sub_f32 v145, v153, v145
 v_mfma_f32_16x16x32_bf16 v[52:55], v[116:119], v[252:255], v[52:55]
 s_waitcnt lgkmcnt(4)
 v_sub_f32 v149, v157, v149
 v_sub_f32 v144, v154, v144
 v_mfma_f32_16x16x32_bf16 v[56:59], v[120:123], v[248:251], v[56:59]
 ds_read_b128 v[112:115], v25 offset:13312
 buffer_load_dwordx4 a[144:147], v38, s[8:11], s73 offen offset:1024 sc1
 v_mfma_f32_16x16x32_bf16 v[60:63], v[120:123], v[252:255], v[60:63]
 v_sub_f32 v148, v158, v148
 v_cndmask_b32 v145, 0, v145, s[94:95]
 v_mfma_f32_16x16x32_bf16 v[64:67], v[124:127], v[248:251], v[64:67]
 ds_read_b128 v[116:119], v25 offset:33792
 v_cndmask_b32 v149, 0, v149, s[94:95]
 v_mfma_f32_16x16x32_bf16 v[68:71], v[124:127], v[252:255], v[68:71]
 s_waitcnt vmcnt(11) lgkmcnt(4)
 v_cndmask_b32 v144, 0, v144, s[94:95]
 v_mfma_f32_16x16x32_bf16 v[40:43], v[96:99], a[100:103], v[40:43]
 s_waitcnt vmcnt(10)
 ds_read_b128 v[120:123], v26 offset:13312
 buffer_load_dwordx4 a[148:151], v38, s[8:11], s68 offen offset:2048 sc1
 v_mfma_f32_16x16x32_bf16 v[44:47], v[96:99], a[104:107], v[44:47]
 ds_read_b64 v[128:129], v27 offset:256
 v_cndmask_b32 v148, 0, v148, s[94:95]
 v_mfma_f32_16x16x32_bf16 v[48:51], v[100:103], a[100:103], v[48:51]
 ds_read_b128 v[124:127], v26 offset:33792
 v_cvt_pk_bf16_f32 v136, v145, v145
 v_mfma_f32_16x16x32_bf16 v[52:55], v[100:103], a[104:107], v[52:55]
 s_waitcnt lgkmcnt(5)
 v_cvt_pk_bf16_f32 v140, v149, v149
 v_mfma_f32_16x16x32_bf16 v[56:59], v[104:107], a[100:103], v[56:59]
 ds_read_b128 v[96:99], v25 offset:14336
 buffer_load_dwordx4 a[152:155], v38, s[8:11], s73 offen offset:2048 sc1
 v_mfma_f32_16x16x32_bf16 v[60:63], v[104:107], a[104:107], v[60:63]
 v_cvt_pk_bf16_f32 v137, v144, 0
 v_cvt_pk_bf16_f32 v141, v148, 0
 v_mfma_f32_16x16x32_bf16 v[64:67], v[108:111], a[100:103], v[64:67]
 ds_read_b128 v[100:103], v25 offset:34816
 v_mfma_f32_16x16x32_bf16 v[68:71], v[108:111], a[104:107], v[68:71]
 s_waitcnt lgkmcnt(3)
 buffer_load_dwordx4 a[156:159], v38, s[8:11], s68 offen offset:3072 sc1
 v_mfma_f32_16x16x32_bf16 v[40:43], v[128:131], v[136:139], v[40:43]
 v_mfma_f32_16x16x32_bf16 v[44:47], v[128:131], v[140:143], v[44:47]
 s_waitcnt vmcnt(12)
 v_mfma_f32_16x16x32_bf16 v[40:43], v[112:115], a[108:111], v[40:43]
 s_waitcnt vmcnt(11)
 ds_read_b128 v[104:107], v26 offset:14336
 v_mfma_f32_16x16x32_bf16 v[44:47], v[112:115], a[112:115], v[44:47]
 buffer_load_dwordx4 a[160:163], v38, s[8:11], s73 offen offset:3072 sc1
 ds_read_b64 v[132:133], v27 offset:384
 v_mfma_f32_16x16x32_bf16 v[48:51], v[116:119], a[108:111], v[48:51]
 ds_read_b128 v[108:111], v26 offset:34816
 v_mfma_f32_16x16x32_bf16 v[52:55], v[116:119], a[112:115], v[52:55]
 s_waitcnt lgkmcnt(5)
 v_mfma_f32_16x16x32_bf16 v[56:59], v[120:123], a[108:111], v[56:59]
 s_add_u32 m0, s28, 20480
 ds_read_b128 v[112:115], v25 offset:15360
 s_add_u32 s85, s36, 0
 buffer_load_dwordx4 v3, s[8:11], s85 offen offset:1024 sc1 lds
 v_mfma_f32_16x16x32_bf16 v[60:63], v[120:123], a[112:115], v[60:63]
 v_mfma_f32_16x16x32_bf16 v[64:67], v[124:127], a[108:111], v[64:67]
 ds_read_b128 v[116:119], v25 offset:35840
 v_mfma_f32_16x16x32_bf16 v[68:71], v[124:127], a[112:115], v[68:71]
 s_waitcnt lgkmcnt(3)
 v_mfma_f32_16x16x32_bf16 v[48:51], v[132:135], v[136:139], v[48:51]
 buffer_load_dwordx4 v3, s[8:11], s85 offen offset:2048 sc1 lds
 v_mfma_f32_16x16x32_bf16 v[52:55], v[132:135], v[140:143], v[52:55]
 s_waitcnt vmcnt(13)
 v_mfma_f32_16x16x32_bf16 v[40:43], v[96:99], a[116:119], v[40:43]
 s_waitcnt vmcnt(12)
 ds_read_b128 v[120:123], v26 offset:15360
 v_mfma_f32_16x16x32_bf16 v[44:47], v[96:99], a[120:123], v[44:47]
 ds_read_b64 v[128:129], v27 offset:512
 v_mfma_f32_16x16x32_bf16 v[48:51], v[100:103], a[116:119], v[48:51]
 ds_read_b128 v[124:127], v26 offset:35840
 buffer_load_dwordx4 v3, s[8:11], s85 offen offset:3072 sc1 lds
 v_mfma_f32_16x16x32_bf16 v[52:55], v[100:103], a[120:123], v[52:55]
 s_waitcnt lgkmcnt(5)
 v_mfma_f32_16x16x32_bf16 v[56:59], v[104:107], a[116:119], v[56:59]
 ds_read_b128 v[96:99], v25 offset:16384
 v_mfma_f32_16x16x32_bf16 v[60:63], v[104:107], a[120:123], v[60:63]
 v_mfma_f32_16x16x32_bf16 v[64:67], v[108:111], a[116:119], v[64:67]
 s_add_u32 m0, s27, 36864
 ds_read_b128 v[100:103], v25 offset:36864
 s_add_u32 s85, s36, 16384
 buffer_load_dwordx4 v2, s[8:11], s85 offen sc1 lds
 v_mfma_f32_16x16x32_bf16 v[68:71], v[108:111], a[120:123], v[68:71]
 s_waitcnt lgkmcnt(3)
 v_mfma_f32_16x16x32_bf16 v[56:59], v[128:131], v[136:139], v[56:59]
 v_mfma_f32_16x16x32_bf16 v[60:63], v[128:131], v[140:143], v[60:63]
 s_waitcnt vmcnt(13)
 v_mfma_f32_16x16x32_bf16 v[40:43], v[112:115], a[124:127], v[40:43]
 s_waitcnt vmcnt(12)
 ds_read_b128 v[104:107], v26 offset:16384
 buffer_load_dwordx4 a[96:99], v39, s[8:11], s70 offen sc1
 v_mfma_f32_16x16x32_bf16 v[44:47], v[112:115], a[128:131], v[44:47]
 ds_read_b64 v[132:133], v27 offset:640
 v_mfma_f32_16x16x32_bf16 v[48:51], v[116:119], a[124:127], v[48:51]
 ds_read_b128 v[108:111], v26 offset:36864
 v_mfma_f32_16x16x32_bf16 v[52:55], v[116:119], a[128:131], v[52:55]
 s_waitcnt lgkmcnt(5)
 v_mfma_f32_16x16x32_bf16 v[56:59], v[120:123], a[124:127], v[56:59]
 ds_read_b128 v[112:115], v25 offset:17408
 v_mfma_f32_16x16x32_bf16 v[60:63], v[120:123], a[128:131], v[60:63]
 buffer_load_dwordx4 a[20:23], v39, s[8:11], s65 offen offset:1024 sc1
 v_mfma_f32_16x16x32_bf16 v[64:67], v[124:127], a[124:127], v[64:67]
 ds_read_b128 v[116:119], v25 offset:37888
 v_mfma_f32_16x16x32_bf16 v[68:71], v[124:127], a[128:131], v[68:71]
 s_waitcnt lgkmcnt(3)
 v_mfma_f32_16x16x32_bf16 v[64:67], v[132:135], v[136:139], v[64:67]
 buffer_load_dwordx4 a[24:27], v39, s[8:11], s65 offen offset:2048 sc1
 v_mfma_f32_16x16x32_bf16 v[68:71], v[132:135], v[140:143], v[68:71]
 s_waitcnt vmcnt(14)
 v_mfma_f32_16x16x32_bf16 v[40:43], v[96:99], a[132:135], v[40:43]
 s_waitcnt vmcnt(13)
 ds_read_b128 v[120:123], v26 offset:17408
 v_mfma_f32_16x16x32_bf16 v[44:47], v[96:99], a[136:139], v[44:47]
 ds_read_b64 v[128:129], v27 offset:768
 v_mfma_f32_16x16x32_bf16 v[48:51], v[100:103], a[132:135], v[48:51]
 ds_read_b128 v[124:127], v26 offset:37888
 v_mfma_f32_16x16x32_bf16 v[52:55], v[100:103], a[136:139], v[52:55]
 s_waitcnt lgkmcnt(5)
 buffer_load_dwordx4 a[28:31], v39, s[8:11], s65 offen offset:3072 sc1
 v_mfma_f32_16x16x32_bf16 v[56:59], v[104:107], a[132:135], v[56:59]
 ds_read_b128 v[96:99], v25 offset:18432
 v_mfma_f32_16x16x32_bf16 v[60:63], v[104:107], a[136:139], v[60:63]
 v_mfma_f32_16x16x32_bf16 v[64:67], v[108:111], a[132:135], v[64:67]
 ds_read_b128 v[100:103], v25 offset:38912
 v_mfma_f32_16x16x32_bf16 v[68:71], v[108:111], a[136:139], v[68:71]
 s_waitcnt lgkmcnt(3)
 buffer_load_dwordx4 a[32:35], v39, s[8:11], s66 offen sc1
 v_mfma_f32_16x16x32_bf16 v[72:75], v[128:131], v[136:139], 0
 v_mfma_f32_16x16x32_bf16 v[76:79], v[128:131], v[140:143], 0
 s_waitcnt vmcnt(14)
 v_mfma_f32_16x16x32_bf16 v[40:43], v[112:115], a[140:143], v[40:43]
 s_waitcnt vmcnt(13)
 ds_read_b128 v[104:107], v26 offset:18432
 v_mfma_f32_16x16x32_bf16 v[44:47], v[112:115], a[144:147], v[44:47]
 ds_read_b64 v[132:133], v27 offset:896
 buffer_load_dwordx4 a[36:39], v39, s[8:11], s66 offen offset:1024 sc1
 v_mfma_f32_16x16x32_bf16 v[48:51], v[116:119], a[140:143], v[48:51]
 ds_read_b128 v[108:111], v26 offset:38912
 v_mfma_f32_16x16x32_bf16 v[52:55], v[116:119], a[144:147], v[52:55]
 s_waitcnt lgkmcnt(5)
 v_mfma_f32_16x16x32_bf16 v[56:59], v[120:123], a[140:143], v[56:59]
 ds_read_b128 v[112:115], v25 offset:19456
 v_mfma_f32_16x16x32_bf16 v[60:63], v[120:123], a[144:147], v[60:63]
 buffer_load_dwordx4 a[0:3], v39, s[8:11], s38 offen sc1
 v_mfma_f32_16x16x32_bf16 v[64:67], v[124:127], a[140:143], v[64:67]
 ds_read_b128 v[116:119], v25 offset:39936
 v_mfma_f32_16x16x32_bf16 v[68:71], v[124:127], a[144:147], v[68:71]
 s_waitcnt lgkmcnt(3)
 v_mfma_f32_16x16x32_bf16 v[80:83], v[132:135], v[136:139], 0
 v_mfma_f32_16x16x32_bf16 v[84:87], v[132:135], v[140:143], 0
 s_waitcnt vmcnt(14)
 buffer_load_dwordx4 a[4:7], v39, s[8:11], s38 offen offset:1024 sc1
 v_mfma_f32_16x16x32_bf16 v[40:43], v[96:99], a[148:151], v[40:43]
 s_waitcnt vmcnt(14)
 ds_read_b128 v[120:123], v26 offset:19456
 v_mfma_f32_16x16x32_bf16 v[44:47], v[96:99], a[152:155], v[44:47]
 ds_read_b64 v[128:129], v27 offset:1024
 v_mfma_f32_16x16x32_bf16 v[48:51], v[100:103], a[148:151], v[48:51]
 ds_read_b128 v[124:127], v26 offset:39936
 v_mfma_f32_16x16x32_bf16 v[52:55], v[100:103], a[152:155], v[52:55]
 s_waitcnt lgkmcnt(5)
 v_mfma_f32_16x16x32_bf16 v[56:59], v[104:107], a[148:151], v[56:59]
 s_barrier
 v_add_u32 v25, 20480, v1
 ds_read_b128 v[96:99], v25 offset:24576
 v_mfma_f32_16x16x32_bf16 v[60:63], v[104:107], a[152:155], v[60:63]
 v_mfma_f32_16x16x32_bf16 v[64:67], v[108:111], a[148:151], v[64:67]
 ds_read_b128 v[100:103], v25 offset:45056
 v_mfma_f32_16x16x32_bf16 v[68:71], v[108:111], a[152:155], v[68:71]
 s_waitcnt lgkmcnt(3)
 v_mfma_f32_16x16x32_bf16 v[88:91], v[128:131], v[136:139], 0
 v_mfma_f32_16x16x32_bf16 v[92:95], v[128:131], v[140:143], 0
 s_waitcnt vmcnt(13)
 v_mfma_f32_16x16x32_bf16 v[40:43], v[112:115], a[156:159], v[40:43]
 s_waitcnt vmcnt(12)
 ds_read_b128 v[104:107], v25 offset:25600
 v_mfma_f32_16x16x32_bf16 v[44:47], v[112:115], a[160:163], v[44:47]
 v_mfma_f32_16x16x32_bf16 v[48:51], v[116:119], a[156:159], v[48:51]
 ds_read_b128 v[108:111], v25 offset:46080
 v_mfma_f32_16x16x32_bf16 v[52:55], v[116:119], a[160:163], v[52:55]
 s_waitcnt lgkmcnt(4)
 v_mfma_f32_16x16x32_bf16 v[56:59], v[120:123], a[156:159], v[56:59]
 ds_read_b128 v[112:115], v25 offset:26624
 v_mfma_f32_16x16x32_bf16 v[60:63], v[120:123], a[160:163], v[60:63]
 v_mfma_f32_16x16x32_bf16 v[64:67], v[124:127], a[156:159], v[64:67]
 ds_read_b128 v[116:119], v25 offset:47104
 v_mfma_f32_16x16x32_bf16 v[68:71], v[124:127], a[160:163], v[68:71]
 s_waitcnt lgkmcnt(4)
 v_mfma_f32_16x16x32_bf16 v[72:75], v[96:99], v[192:195], v[72:75]
 ds_read_b128 v[120:123], v25 offset:27648
 v_mfma_f32_16x16x32_bf16 v[76:79], v[96:99], v[196:199], v[76:79]
 v_mul_f32 v40, v40, v152
 v_mul_f32 v41, v41, v152
 v_mfma_f32_16x16x32_bf16 v[80:83], v[100:103], v[192:195], v[80:83]
 ds_read_b128 v[124:127], v25 offset:48128
 v_mul_f32 v42, v42, v152
 v_mul_f32 v43, v43, v152
 v_mfma_f32_16x16x32_bf16 v[84:87], v[100:103], v[196:199], v[84:87]
 s_barrier
 v_mul_f32 v40, v40, abs(v40)
 v_mul_f32 v41, v41, abs(v41)
 s_waitcnt lgkmcnt(4)
 v_mfma_f32_16x16x32_bf16 v[72:75], v[104:107], v[200:203], v[72:75]
 ds_read_b128 v[96:99], v25 offset:28672
 v_mul_f32 v42, v42, abs(v42)
 v_mfma_f32_16x16x32_bf16 v[76:79], v[104:107], v[204:207], v[76:79]
 s_add_u32 m0, s28, 81920
 s_add_u32 s85, s37, 51200
 buffer_load_dwordx4 v1, s[8:11], s85 offen sc1 lds
 v_mul_f32 v43, v43, abs(v43)
 v_mfma_f32_16x16x32_bf16 v[80:83], v[108:111], v[200:203], v[80:83]
 ds_read_b128 v[100:103], v25 offset:49152
 v_cvt_pk_bf16_f32 v144, v40, v41
 v_cvt_pk_bf16_f32 v145, v42, v43
 v_mfma_f32_16x16x32_bf16 v[84:87], v[108:111], v[204:207], v[84:87]
 s_waitcnt lgkmcnt(4)
 v_pk_max_i16 v144, v144, 0
 v_pk_max_i16 v145, v145, 0
 v_mfma_f32_16x16x32_bf16 v[72:75], v[112:115], v[208:211], v[72:75]
 ds_read_b128 v[104:107], v25 offset:29696
 v_mul_f32 v48, v48, v152
 v_mfma_f32_16x16x32_bf16 v[76:79], v[112:115], v[212:215], v[76:79]
 buffer_load_dwordx4 v1, s[8:11], s85 offen offset:1024 sc1 lds
 v_mul_f32 v49, v49, v152
 v_mul_f32 v50, v50, v152
 v_mfma_f32_16x16x32_bf16 v[80:83], v[116:119], v[208:211], v[80:83]
 ds_read_b128 v[108:111], v25 offset:50176
 v_mul_f32 v51, v51, v152
 v_mfma_f32_16x16x32_bf16 v[84:87], v[116:119], v[212:215], v[84:87]
 s_waitcnt lgkmcnt(4)
 v_mul_f32 v48, v48, abs(v48)
 v_mul_f32 v49, v49, abs(v49)
 v_mfma_f32_16x16x32_bf16 v[72:75], v[120:123], v[216:219], v[72:75]
 ds_read_b128 v[112:115], v25 offset:30720
 v_mul_f32 v50, v50, abs(v50)
 v_mfma_f32_16x16x32_bf16 v[76:79], v[120:123], v[220:223], v[76:79]
 v_mul_f32 v51, v51, abs(v51)
 v_cvt_pk_bf16_f32 v146, v48, v49
 v_cvt_pk_bf16_f32 v147, v50, v51
 v_mfma_f32_16x16x32_bf16 v[80:83], v[124:127], v[216:219], v[80:83]
 ds_read_b128 v[116:119], v25 offset:51200
 v_pk_max_i16 v146, v146, 0
 v_mfma_f32_16x16x32_bf16 v[84:87], v[124:127], v[220:223], v[84:87]
 s_waitcnt lgkmcnt(4)
 buffer_load_dwordx4 v1, s[8:11], s85 offen offset:2048 sc1 lds
 v_pk_max_i16 v147, v147, 0
 v_mfma_f32_16x16x32_bf16 v[72:75], v[96:99], v[224:227], v[72:75]
 ds_read_b128 v[120:123], v25 offset:31744
 buffer_store_dwordx4 v[144:147], v1, s[8:11], s41 offen sc1
 v_mfma_f32_16x16x32_bf16 v[76:79], v[96:99], v[228:231], v[76:79]
 v_mfma_f32_16x16x32_bf16 v[80:83], v[100:103], v[224:227], v[80:83]
 ds_read_b128 v[124:127], v25 offset:52224
 v_mfma_f32_16x16x32_bf16 v[84:87], v[100:103], v[228:231], v[84:87]
 s_waitcnt lgkmcnt(4)
 v_mul_f32 v44, v44, v156
 v_mul_f32 v45, v45, v156
 v_mul_f32 v46, v46, v156
 v_mfma_f32_16x16x32_bf16 v[72:75], v[104:107], v[232:235], v[72:75]
 ds_read_b128 v[96:99], v25 offset:32768
 v_mul_f32 v47, v47, v156
 v_mfma_f32_16x16x32_bf16 v[76:79], v[104:107], v[236:239], v[76:79]
 buffer_load_dwordx4 v1, s[8:11], s85 offen offset:3072 sc1 lds
 v_mul_f32 v44, v44, abs(v44)
 v_mfma_f32_16x16x32_bf16 v[80:83], v[108:111], v[232:235], v[80:83]
 ds_read_b128 v[100:103], v25 offset:53248
 v_mul_f32 v45, v45, abs(v45)
 v_mul_f32 v46, v46, abs(v46)
 v_mfma_f32_16x16x32_bf16 v[84:87], v[108:111], v[236:239], v[84:87]
 s_waitcnt lgkmcnt(4)
 v_mul_f32 v47, v47, abs(v47)
 v_cvt_pk_bf16_f32 v148, v44, v45
 v_mfma_f32_16x16x32_bf16 v[72:75], v[112:115], v[240:243], v[72:75]
 ds_read_b128 v[104:107], v25 offset:33792
 v_cvt_pk_bf16_f32 v149, v46, v47
 v_mfma_f32_16x16x32_bf16 v[76:79], v[112:115], v[244:247], v[76:79]
 s_add_u32 m0, s28, 98304
 s_add_u32 s85, s37, 55296
 buffer_load_dwordx4 v1, s[8:11], s85 offen sc1 lds
 v_pk_max_i16 v148, v148, 0
 v_pk_max_i16 v149, v149, 0
 v_mfma_f32_16x16x32_bf16 v[80:83], v[116:119], v[240:243], v[80:83]
 ds_read_b128 v[108:111], v25 offset:54272
 v_mul_f32 v52, v52, v156
 v_mfma_f32_16x16x32_bf16 v[84:87], v[116:119], v[244:247], v[84:87]
 s_waitcnt lgkmcnt(4)
 v_mul_f32 v53, v53, v156
 v_mul_f32 v54, v54, v156
 v_mfma_f32_16x16x32_bf16 v[72:75], v[120:123], v[248:251], v[72:75]
 ds_read_b128 v[112:115], v25 offset:34816
 v_mul_f32 v55, v55, v156
 v_mul_f32 v52, v52, abs(v52)
 v_mfma_f32_16x16x32_bf16 v[76:79], v[120:123], v[252:255], v[76:79]
 v_mul_f32 v53, v53, abs(v53)
 v_mul_f32 v54, v54, abs(v54)
 v_mfma_f32_16x16x32_bf16 v[80:83], v[124:127], v[248:251], v[80:83]
 ds_read_b128 v[116:119], v25 offset:55296
 v_mul_f32 v55, v55, abs(v55)
 v_mfma_f32_16x16x32_bf16 v[84:87], v[124:127], v[252:255], v[84:87]
 s_waitcnt lgkmcnt(4)
 buffer_load_dwordx4 v1, s[8:11], s85 offen offset:1024 sc1 lds
 v_cvt_pk_bf16_f32 v150, v52, v53
 v_cvt_pk_bf16_f32 v151, v54, v55
 v_mfma_f32_16x16x32_bf16 v[72:75], v[96:99], a[100:103], v[72:75]
 ds_read_b128 v[120:123], v25 offset:35840
 v_pk_max_i16 v150, v150, 0
 v_mfma_f32_16x16x32_bf16 v[76:79], v[96:99], a[104:107], v[76:79]
 v_pk_max_i16 v151, v151, 0
 buffer_store_dwordx4 v[148:151], v1, s[8:11], s30 offen sc1
 v_mfma_f32_16x16x32_bf16 v[80:83], v[100:103], a[100:103], v[80:83]
 ds_read_b128 v[124:127], v25 offset:56320
 v_mfma_f32_16x16x32_bf16 v[84:87], v[100:103], a[104:107], v[84:87]
 s_waitcnt lgkmcnt(4)
 v_mfma_f32_16x16x32_bf16 v[72:75], v[104:107], a[108:111], v[72:75]
 ds_read_b128 v[96:99], v25 offset:36864
 v_mul_f32 v56, v56, v152
 v_mfma_f32_16x16x32_bf16 v[76:79], v[104:107], a[112:115], v[76:79]
 buffer_load_dwordx4 v1, s[8:11], s85 offen offset:2048 sc1 lds
 v_mul_f32 v57, v57, v152
 v_mfma_f32_16x16x32_bf16 v[80:83], v[108:111], a[108:111], v[80:83]
 ds_read_b128 v[100:103], v25 offset:57344
 v_mul_f32 v58, v58, v152
 v_mul_f32 v59, v59, v152
 v_mfma_f32_16x16x32_bf16 v[84:87], v[108:111], a[112:115], v[84:87]
 s_waitcnt lgkmcnt(4)
 v_mul_f32 v56, v56, abs(v56)
 v_mul_f32 v57, v57, abs(v57)
 v_mfma_f32_16x16x32_bf16 v[72:75], v[112:115], a[116:119], v[72:75]
 ds_read_b128 v[104:107], v25 offset:37888
 v_mul_f32 v58, v58, abs(v58)
 v_mfma_f32_16x16x32_bf16 v[76:79], v[112:115], a[120:123], v[76:79]
 v_mul_f32 v59, v59, abs(v59)
 v_cvt_pk_bf16_f32 v144, v56, v57
 v_cvt_pk_bf16_f32 v145, v58, v59
 v_mfma_f32_16x16x32_bf16 v[80:83], v[116:119], a[116:119], v[80:83]
 ds_read_b128 v[108:111], v25 offset:58368
 v_pk_max_i16 v144, v144, 0
 v_mfma_f32_16x16x32_bf16 v[84:87], v[116:119], a[120:123], v[84:87]
 s_waitcnt lgkmcnt(4)
 buffer_load_dwordx4 v1, s[8:11], s85 offen offset:3072 sc1 lds
 v_pk_max_i16 v145, v145, 0
 v_mfma_f32_16x16x32_bf16 v[72:75], v[120:123], a[124:127], v[72:75]
 ds_read_b128 v[112:115], v25 offset:38912
 v_mul_f32 v64, v64, v152
 v_mul_f32 v65, v65, v152
 v_mfma_f32_16x16x32_bf16 v[76:79], v[120:123], a[128:131], v[76:79]
 v_mul_f32 v66, v66, v152
 v_mul_f32 v67, v67, v152
 v_mfma_f32_16x16x32_bf16 v[80:83], v[124:127], a[124:127], v[80:83]
 ds_read_b128 v[116:119], v25 offset:59392
 v_mul_f32 v64, v64, abs(v64)
 v_mfma_f32_16x16x32_bf16 v[84:87], v[124:127], a[128:131], v[84:87]
 s_waitcnt lgkmcnt(4)
 s_add_u32 m0, s28, 114688
 s_add_u32 s85, s37, 59392
 buffer_load_dwordx4 v1, s[8:11], s85 offen sc1 lds
 v_mul_f32 v65, v65, abs(v65)
 v_mul_f32 v66, v66, abs(v66)
 v_mfma_f32_16x16x32_bf16 v[72:75], v[96:99], a[132:135], v[72:75]
 ds_read_b128 v[120:123], v25 offset:39936
 v_mul_f32 v67, v67, abs(v67)
 v_mfma_f32_16x16x32_bf16 v[76:79], v[96:99], a[136:139], v[76:79]
 v_cvt_pk_bf16_f32 v146, v64, v65
 v_cvt_pk_bf16_f32 v147, v66, v67
 v_mfma_f32_16x16x32_bf16 v[80:83], v[100:103], a[132:135], v[80:83]
 ds_read_b128 v[124:127], v25 offset:60416
 v_pk_max_i16 v146, v146, 0
 v_pk_max_i16 v147, v147, 0
 v_mfma_f32_16x16x32_bf16 v[84:87], v[100:103], a[136:139], v[84:87]
 s_waitcnt lgkmcnt(4)
 buffer_store_dwordx4 v[144:147], v1, s[8:11], s41 offen offset:1024 sc1
 v_mfma_f32_16x16x32_bf16 v[72:75], v[104:107], a[140:143], v[72:75]
 s_waitcnt vmcnt(20)
 s_barrier
 ds_read_b128 v[96:99], v25 offset:20480
 v_mfma_f32_16x16x32_bf16 v[76:79], v[104:107], a[144:147], v[76:79]
 buffer_load_dwordx4 v1, s[8:11], s85 offen offset:1024 sc1 lds
 v_mfma_f32_16x16x32_bf16 v[80:83], v[108:111], a[140:143], v[80:83]
 ds_read_b128 v[100:103], v25 offset:40960
 v_mul_f32 v60, v60, v156
 v_mfma_f32_16x16x32_bf16 v[84:87], v[108:111], a[144:147], v[84:87]
 s_waitcnt lgkmcnt(4)
 v_mul_f32 v61, v61, v156
 v_mul_f32 v62, v62, v156
 v_mfma_f32_16x16x32_bf16 v[72:75], v[112:115], a[148:151], v[72:75]
 ds_read_b128 v[104:107], v25 offset:21504
 v_mul_f32 v63, v63, v156
 v_mfma_f32_16x16x32_bf16 v[76:79], v[112:115], a[152:155], v[76:79]
 v_mul_f32 v60, v60, abs(v60)
 v_mul_f32 v61, v61, abs(v61)
 v_mul_f32 v62, v62, abs(v62)
 v_mfma_f32_16x16x32_bf16 v[80:83], v[116:119], a[148:151], v[80:83]
 ds_read_b128 v[108:111], v25 offset:41984
 v_mul_f32 v63, v63, abs(v63)
 v_mfma_f32_16x16x32_bf16 v[84:87], v[116:119], a[152:155], v[84:87]
 s_waitcnt lgkmcnt(4)
 buffer_load_dwordx4 v1, s[8:11], s85 offen offset:2048 sc1 lds
 v_cvt_pk_bf16_f32 v148, v60, v61
 v_mfma_f32_16x16x32_bf16 v[72:75], v[120:123], a[156:159], v[72:75]
 ds_read_b128 v[112:115], v25 offset:22528
 v_cvt_pk_bf16_f32 v149, v62, v63
 v_mfma_f32_16x16x32_bf16 v[76:79], v[120:123], a[160:163], v[76:79]
 v_pk_max_i16 v148, v148, 0
 v_pk_max_i16 v149, v149, 0
 v_mul_f32 v68, v68, v156
 v_mfma_f32_16x16x32_bf16 v[80:83], v[124:127], a[156:159], v[80:83]
 ds_read_b128 v[116:119], v25 offset:43008
 v_mul_f32 v69, v69, v156
 v_mfma_f32_16x16x32_bf16 v[84:87], v[124:127], a[160:163], v[84:87]
 s_waitcnt lgkmcnt(4)
 buffer_load_dwordx4 v1, s[8:11], s85 offen offset:3072 sc1 lds
 v_mul_f32 v70, v70, v156
 v_mfma_f32_16x16x32_bf16 v[72:75], v[96:99], v[160:163], v[72:75]
 ds_read_b128 v[120:123], v25 offset:23552
 v_mul_f32 v71, v71, v156
 v_mul_f32 v68, v68, abs(v68)
 v_mfma_f32_16x16x32_bf16 v[76:79], v[96:99], v[164:167], v[76:79]
 v_mul_f32 v69, v69, abs(v69)
 v_mul_f32 v70, v70, abs(v70)
 v_mfma_f32_16x16x32_bf16 v[80:83], v[100:103], v[160:163], v[80:83]
 ds_read_b128 v[124:127], v25 offset:44032
 v_mul_f32 v71, v71, abs(v71)
 v_mfma_f32_16x16x32_bf16 v[84:87], v[100:103], v[164:167], v[84:87]
 s_waitcnt lgkmcnt(4)
 v_cvt_pk_bf16_f32 v150, v68, v69
 v_cvt_pk_bf16_f32 v151, v70, v71
 v_pk_max_i16 v150, v150, 0
 v_mfma_f32_16x16x32_bf16 v[72:75], v[104:107], v[168:171], v[72:75]
 ds_read_b128 v[96:99], v25
 v_pk_max_i16 v151, v151, 0
 v_mfma_f32_16x16x32_bf16 v[76:79], v[104:107], v[172:175], v[76:79]
 s_add_u32 m0, s28, 131072
 s_add_u32 s85, s37, 63488
 buffer_load_dwordx4 v1, s[8:11], s85 offen sc1 lds
 buffer_store_dwordx4 v[148:151], v1, s[8:11], s30 offen offset:1024 sc1
 v_mfma_f32_16x16x32_bf16 v[80:83], v[108:111], v[168:171], v[80:83]
 ds_read_b128 v[100:103], v25 offset:1024
 v_mfma_f32_16x16x32_bf16 v[84:87], v[108:111], v[172:175], v[84:87]
 s_waitcnt lgkmcnt(4)
 v_mfma_f32_16x16x32_bf16 v[72:75], v[112:115], v[176:179], v[72:75]
 ds_read_b128 v[104:107], v25 offset:2048
 v_mfma_f32_16x16x32_bf16 v[76:79], v[112:115], v[180:183], v[76:79]
 v_mfma_f32_16x16x32_bf16 v[80:83], v[116:119], v[176:179], v[80:83]
 ds_read_b128 v[108:111], v25 offset:3072
 v_mfma_f32_16x16x32_bf16 v[84:87], v[116:119], v[180:183], v[84:87]
 s_waitcnt lgkmcnt(4)
 buffer_load_dwordx4 a[8:11], v39, s[8:11], s38 offen offset:2048 sc1
 v_mfma_f32_16x16x32_bf16 v[72:75], v[120:123], v[184:187], v[72:75]
 ds_read_b128 v[112:115], v25 offset:4096
 v_mfma_f32_16x16x32_bf16 v[76:79], v[120:123], v[188:191], v[76:79]
 v_mfma_f32_16x16x32_bf16 v[80:83], v[124:127], v[184:187], v[80:83]
 ds_read_b128 v[116:119], v25 offset:5120
 v_mfma_f32_16x16x32_bf16 v[84:87], v[124:127], v[188:191], v[84:87]
 s_waitcnt lgkmcnt(4)
 v_mfma_f32_16x16x32_bf16 v[88:91], v[96:99], v[160:163], v[88:91]
 ds_read_b128 v[120:123], v25 offset:6144
 v_mfma_f32_16x16x32_bf16 v[92:95], v[96:99], v[164:167], v[92:95]
 buffer_load_dwordx4 v1, s[8:11], s85 offen offset:1024 sc1 lds
 v_mfma_f32_16x16x32_bf16 v[88:91], v[100:103], v[168:171], v[88:91]
 ds_read_b128 v[124:127], v25 offset:7168
 v_mfma_f32_16x16x32_bf16 v[92:95], v[100:103], v[172:175], v[92:95]
 s_waitcnt lgkmcnt(4)
 v_mul_f32 v72, v72, v152
 v_mul_f32 v73, v73, v152
 v_mfma_f32_16x16x32_bf16 v[88:91], v[104:107], v[176:179], v[88:91]
 ds_read_b128 v[96:99], v25 offset:8192
 v_mul_f32 v74, v74, v152
 v_mfma_f32_16x16x32_bf16 v[92:95], v[104:107], v[180:183], v[92:95]
 buffer_load_dwordx4 v1, s[8:11], s85 offen offset:2048 sc1 lds
 v_mul_f32 v75, v75, v152
 v_mul_f32 v72, v72, abs(v72)
 v_mfma_f32_16x16x32_bf16 v[88:91], v[108:111], v[184:187], v[88:91]
 ds_read_b128 v[100:103], v25 offset:9216
 v_mul_f32 v73, v73, abs(v73)
 v_mfma_f32_16x16x32_bf16 v[92:95], v[108:111], v[188:191], v[92:95]
 s_waitcnt lgkmcnt(4)
 v_mul_f32 v74, v74, abs(v74)
 v_mul_f32 v75, v75, abs(v75)
 v_mfma_f32_16x16x32_bf16 v[88:91], v[112:115], v[192:195], v[88:91]
 ds_read_b128 v[104:107], v25 offset:10240
 v_cvt_pk_bf16_f32 v144, v72, v73
 v_mfma_f32_16x16x32_bf16 v[92:95], v[112:115], v[196:199], v[92:95]
 buffer_load_dwordx4 v1, s[8:11], s85 offen offset:3072 sc1 lds
 v_cvt_pk_bf16_f32 v145, v74, v75
 v_pk_max_i16 v144, v144, 0
 v_mfma_f32_16x16x32_bf16 v[88:91], v[116:119], v[200:203], v[88:91]
 ds_read_b128 v[108:111], v25 offset:11264
 v_pk_max_i16 v145, v145, 0
 v_mfma_f32_16x16x32_bf16 v[92:95], v[116:119], v[204:207], v[92:95]
 s_waitcnt lgkmcnt(4)
 v_mul_f32 v80, v80, v152
 v_mul_f32 v81, v81, v152
 v_mfma_f32_16x16x32_bf16 v[88:91], v[120:123], v[208:211], v[88:91]
 ds_read_b128 v[112:115], v25 offset:12288
 v_mul_f32 v82, v82, v152
 v_mfma_f32_16x16x32_bf16 v[92:95], v[120:123], v[212:215], v[92:95]
 s_add_u32 m0, s28, 147456
 s_add_u32 s85, s37, 67584
 buffer_load_dwordx4 v1, s[8:11], s85 offen sc1 lds
 v_mul_f32 v83, v83, v152
 v_mfma_f32_16x16x32_bf16 v[88:91], v[124:127], v[216:219], v[88:91]
 ds_read_b128 v[116:119], v25 offset:13312
 v_mul_f32 v80, v80, abs(v80)
 v_mul_f32 v81, v81, abs(v81)
 v_mfma_f32_16x16x32_bf16 v[92:95], v[124:127], v[220:223], v[92:95]
 s_waitcnt lgkmcnt(4)
 v_mul_f32 v82, v82, abs(v82)
 v_mul_f32 v83, v83, abs(v83)
 v_mfma_f32_16x16x32_bf16 v[88:91], v[96:99], v[224:227], v[88:91]
 ds_read_b128 v[120:123], v25 offset:14336
 v_cvt_pk_bf16_f32 v146, v80, v81
 v_mfma_f32_16x16x32_bf16 v[92:95], v[96:99], v[228:231], v[92:95]
 buffer_load_dwordx4 v1, s[8:11], s85 offen offset:1024 sc1 lds
 v_cvt_pk_bf16_f32 v147, v82, v83
 v_mfma_f32_16x16x32_bf16 v[88:91], v[100:103], v[232:235], v[88:91]
 s_waitcnt vmcnt(6)
 ds_read_b128 v[124:127], v25 offset:15360
 v_mov_b32 v27, 1
 s_mov_b64 exec, 1
 buffer_store_dword v27, off, s[8:11], s50 sc1
 s_mov_b64 exec, -1
 v_mfma_f32_16x16x32_bf16 v[92:95], v[100:103], v[236:239], v[92:95]
 s_waitcnt lgkmcnt(4)
 v_pk_max_i16 v146, v146, 0
 v_pk_max_i16 v147, v147, 0
 v_mfma_f32_16x16x32_bf16 v[88:91], v[104:107], v[240:243], v[88:91]
 ds_read_b128 v[96:99], v25 offset:16384
 buffer_store_dwordx4 v[144:147], v1, s[8:11], s84 offen sc1
 v_mfma_f32_16x16x32_bf16 v[92:95], v[104:107], v[244:247], v[92:95]
 buffer_load_dwordx4 v1, s[8:11], s85 offen offset:2048 sc1 lds
 v_mfma_f32_16x16x32_bf16 v[88:91], v[108:111], v[248:251], v[88:91]
 ds_read_b128 v[100:103], v25 offset:17408
 v_mfma_f32_16x16x32_bf16 v[92:95], v[108:111], v[252:255], v[92:95]
 s_waitcnt lgkmcnt(4)
 v_mul_f32 v76, v76, v156
 v_mul_f32 v77, v77, v156
 v_mfma_f32_16x16x32_bf16 v[88:91], v[112:115], a[100:103], v[88:91]
 ds_read_b128 v[104:107], v25 offset:18432
 v_mul_f32 v78, v78, v156
 v_mfma_f32_16x16x32_bf16 v[92:95], v[112:115], a[104:107], v[92:95]
 buffer_load_dwordx4 v1, s[8:11], s85 offen offset:3072 sc1 lds
 v_mul_f32 v79, v79, v156
 v_mfma_f32_16x16x32_bf16 v[88:91], v[116:119], a[108:111], v[88:91]
 ds_read_b128 v[108:111], v25 offset:19456
 v_and_b32 v254, 28, v22
 v_mfma_f32_16x16x32_bf16 v[92:95], v[116:119], a[112:115], v[92:95]
 s_waitcnt lgkmcnt(4)
 v_mul_f32 v76, v76, abs(v76)
 v_mul_f32 v77, v77, abs(v77)
 v_mfma_f32_16x16x32_bf16 v[88:91], v[120:123], a[116:119], v[88:91]
 v_mul_f32 v78, v78, abs(v78)
 v_mul_f32 v79, v79, abs(v79)
 v_cvt_pk_bf16_f32 v148, v76, v77
 v_mfma_f32_16x16x32_bf16 v[92:95], v[120:123], a[120:123], v[92:95]
 buffer_load_dwordx4 a[12:15], v39, s[8:11], s38 offen offset:3072 sc1
 v_cvt_pk_bf16_f32 v149, v78, v79
 v_mfma_f32_16x16x32_bf16 v[88:91], v[124:127], a[124:127], v[88:91]
 v_pk_max_i16 v148, v148, 0
 v_pk_max_i16 v149, v149, 0
 v_mfma_f32_16x16x32_bf16 v[92:95], v[124:127], a[128:131], v[92:95]
 s_waitcnt lgkmcnt(2)
 v_mul_f32 v84, v84, v156
 v_mul_f32 v85, v85, v156
 v_mfma_f32_16x16x32_bf16 v[88:91], v[96:99], a[132:135], v[88:91]
 buffer_load_dword v26, v254, s[8:11], s51 offen sc1
 v_mul_f32 v86, v86, v156
 v_mfma_f32_16x16x32_bf16 v[92:95], v[96:99], a[136:139], v[92:95]
 buffer_load_dword v0, v1, s[8:11], s39 offen sc1
 v_mul_f32 v87, v87, v156
 v_mul_f32 v84, v84, abs(v84)
 v_mfma_f32_16x16x32_bf16 v[88:91], v[100:103], a[140:143], v[88:91]
 v_mul_f32 v85, v85, abs(v85)
 v_mul_f32 v86, v86, abs(v86)
 v_mfma_f32_16x16x32_bf16 v[92:95], v[100:103], a[144:147], v[92:95]
 s_waitcnt lgkmcnt(0)
 v_mul_f32 v87, v87, abs(v87)
 v_cvt_pk_bf16_f32 v150, v84, v85
 v_mfma_f32_16x16x32_bf16 v[88:91], v[104:107], a[148:151], v[88:91]
 v_cvt_pk_bf16_f32 v151, v86, v87
 v_pk_max_i16 v150, v150, 0
 v_mfma_f32_16x16x32_bf16 v[92:95], v[104:107], a[152:155], v[92:95]
 buffer_load_dword v0, v1, s[8:11], s39 offen offset:1024 sc1
 v_pk_max_i16 v151, v151, 0
 v_mfma_f32_16x16x32_bf16 v[88:91], v[108:111], a[156:159], v[88:91]
 buffer_store_dwordx4 v[148:151], v1, s[8:11], s32 offen sc1
 v_mfma_f32_16x16x32_bf16 v[92:95], v[108:111], a[160:163], v[92:95]
 v_add_u32 v244, s56, v1
 v_add_u32 v245, s57, v1
 v_add_u32 v246, s58, v1
 v_add_u32 v247, s59, v1
 s_nop 1
 v_pk_mul_f32 v[88:89], v[88:89], v[152:153] op_sel_hi:[1,0]
 v_pk_mul_f32 v[90:91], v[90:91], v[152:153] op_sel_hi:[1,0]
 v_mul_f32 v88, v88, abs(v88)
 v_mul_f32 v89, v89, abs(v89)
 v_mul_f32 v90, v90, abs(v90)
 v_mul_f32 v91, v91, abs(v91)
 v_cvt_pk_bf16_f32 v144, v88, v89
 v_cvt_pk_bf16_f32 v145, v90, v91
 v_pk_max_i16 v144, v144, 0
 v_pk_max_i16 v145, v145, 0
 buffer_store_dwordx2 v[144:145], v1, s[8:11], s42 offen sc1
 v_pk_mul_f32 v[92:93], v[92:93], v[156:157] op_sel_hi:[1,0]
 v_pk_mul_f32 v[94:95], v[94:95], v[156:157] op_sel_hi:[1,0]
 v_mul_f32 v92, v92, abs(v92)
 v_mul_f32 v93, v93, abs(v93)
 v_mul_f32 v94, v94, abs(v94)
 v_mul_f32 v95, v95, abs(v95)
 v_cvt_pk_bf16_f32 v148, v92, v93
 v_cvt_pk_bf16_f32 v149, v94, v95
 v_pk_max_i16 v148, v148, 0
 v_pk_max_i16 v149, v149, 0
 buffer_store_dwordx2 v[148:149], v1, s[8:11], s31 offen sc1
 s_waitcnt vmcnt(5)
 v_cmp_gt_u32 vcc, 1, v26
 s_cbranch_vccnz sretry_7
sback_8:
 buffer_load_dwordx4 v[160:163], v244, s[8:11], s66 offen offset:2048 sc1
 buffer_load_dwordx4 v[164:167], v245, s[8:11], s66 offen offset:2048 sc1
 buffer_load_dwordx4 v[168:171], v246, s[8:11], s66 offen offset:2048 sc1
 buffer_load_dwordx4 v[172:175], v247, s[8:11], s66 offen offset:2048 sc1
 v_add_u32 v252, 81920, v3
 v_add_u32 v253, 147456, v3
 v_add_u32 v248, s83, v1
 s_barrier
 s_add_u32 m0, s83, 0
 s_add_u32 s85, s37, 40960
 buffer_load_dwordx4 v1, s[8:11], s85 offen sc1 lds
 buffer_load_dwordx4 v1, s[8:11], s85 offen offset:1024 sc1 lds
 buffer_load_dwordx4 v1, s[8:11], s85 offen offset:2048 sc1 lds
 buffer_load_dwordx4 v1, s[8:11], s85 offen offset:3072 sc1 lds
 v_mov_b32 v27, 2
 s_waitcnt vmcnt(8)
 s_mov_b64 exec, 1
 buffer_store_dword v27, off, s[8:11], s50 sc1
 s_mov_b64 exec, -1
 ds_read_b128 v[224:227], v252
 ds_read_b128 v[228:231], v252 offset:1024
 ds_read_b128 v[232:235], v252 offset:2048
 ds_read_b128 v[236:239], v252 offset:3072
 ds_read_b128 v[240:243], v252 offset:16384
 s_add_u32 s31, s22, 3
 s_and_b32 s31, s31, 3
 s_mul_i32 s31, s31, 10240
 s_add_u32 s31, s31, 2048
 v_add_u32 v249, s31, v22
 s_add_u32 s31, s22, 2
 s_and_b32 s31, s31, 3
 s_mul_i32 s31, s31, 10240
 s_add_u32 s31, s31, 2048
 v_add_u32 v250, s31, v22
 s_add_u32 s31, s22, 1
 s_and_b32 s31, s31, 3
 s_mul_i32 s31, s31, 10240
 s_add_u32 s31, s31, 2048
 v_add_u32 v251, s31, v22
 ds_read_b128 v[184:187], v21 offset:1152
 buffer_load_dwordx4 v[176:179], v244, s[8:11], s66 offen offset:3072 sc1
 ds_read_b128 v[188:191], v21 offset:1216
 ds_read_b128 v[192:195], v21 offset:1280
 ds_read_b128 v[196:199], v21 offset:1344
 ds_read_b128 v[200:203], v21 offset:1408
 v_lshlrev_b32 v100, 16, v28
 v_and_b32 v101, 0xffff0000, v28
 v_lshlrev_b32 v102, 16, v29
 v_and_b32 v103, 0xffff0000, v29
 buffer_load_dwordx4 v[180:183], v245, s[8:11], s66 offen offset:3072 sc1
 v_lshlrev_b32 v104, 16, v30
 v_and_b32 v105, 0xffff0000, v30
 v_lshlrev_b32 v106, 16, v31
 v_and_b32 v107, 0xffff0000, v31
 v_lshlrev_b32 v108, 16, v32
 v_and_b32 v109, 0xffff0000, v32
 v_lshlrev_b32 v110, 16, v33
 v_and_b32 v111, 0xffff0000, v33
 v_lshlrev_b32 v112, 16, v34
 buffer_load_dwordx4 v[120:123], v246, s[8:11], s66 offen offset:3072 sc1
 v_and_b32 v113, 0xffff0000, v34
 v_lshlrev_b32 v114, 16, v35
 v_and_b32 v115, 0xffff0000, v35
 v_lshlrev_b32 v116, 16, v36
 v_and_b32 v117, 0xffff0000, v36
 v_lshlrev_b32 v118, 16, v37
 v_and_b32 v119, 0xffff0000, v37
 s_waitcnt lgkmcnt(4)
 v_pk_add_f32 v[100:101], v[100:101], v[184:185]
 v_pk_add_f32 v[102:103], v[102:103], v[186:187]
 buffer_load_dwordx4 v[124:127], v247, s[8:11], s66 offen offset:3072 sc1
 s_waitcnt lgkmcnt(3)
 v_pk_add_f32 v[104:105], v[104:105], v[188:189]
 v_pk_add_f32 v[106:107], v[106:107], v[190:191]
 s_waitcnt lgkmcnt(2)
 v_pk_add_f32 v[108:109], v[108:109], v[192:193]
 v_pk_add_f32 v[110:111], v[110:111], v[194:195]
 s_waitcnt lgkmcnt(1)
 v_pk_add_f32 v[112:113], v[112:113], v[196:197]
 v_pk_add_f32 v[114:115], v[114:115], v[198:199]
 s_waitcnt lgkmcnt(0)
 v_pk_add_f32 v[116:117], v[116:117], v[200:201]
 v_pk_add_f32 v[118:119], v[118:119], v[202:203]
 s_add_u32 m0, s83, 4096
 s_add_u32 s85, s37, 45056
 buffer_load_dwordx4 v1, s[8:11], s85 offen sc1 lds
 buffer_load_dwordx4 v1, s[8:11], s85 offen offset:1024 sc1 lds
 buffer_load_dwordx4 v1, s[8:11], s85 offen offset:2048 sc1 lds
 buffer_load_dwordx4 v1, s[8:11], s85 offen offset:3072 sc1 lds
 s_add_u32 m0, s83, 8192
 s_add_u32 s85, s37, 49152
 buffer_load_dwordx4 v1, s[8:11], s85 offen sc1 lds
 buffer_load_dwordx4 v1, s[8:11], s85 offen offset:1024 sc1 lds
 buffer_load_dwordx4 a[120:123], v39, s[8:11], s71 offen offset:2048 sc1
 buffer_load_dwordx4 a[124:127], v39, s[8:11], s71 offen offset:3072 sc1
 s_waitcnt vmcnt(20)
 v_mfma_f32_16x16x32_bf16 v[40:43], v[224:227], v[160:163], 0
 buffer_load_dwordx4 v[128:131], v244, s[8:11], s67 offen sc1
 ds_write_b128 v252, a[176:179]
 v_mfma_f32_16x16x32_bf16 v[44:47], v[228:231], v[160:163], 0
 ds_read_b128 a[176:179], v252 offset:17408
 v_mfma_f32_16x16x32_bf16 v[48:51], v[232:235], v[160:163], 0
 v_mfma_f32_16x16x32_bf16 v[52:55], v[236:239], v[160:163], 0
 ds_write_b128 v252, a[180:183] offset:1024
 v_mfma_f32_16x16x32_bf16 v[56:59], v[240:243], v[160:163], 0
 s_waitcnt vmcnt(20)
 buffer_load_dwordx4 v[132:135], v245, s[8:11], s67 offen sc1
 ds_read_b128 a[180:183], v252 offset:18432
 v_mfma_f32_16x16x32_bf16 v[60:63], v[224:227], v[164:167], 0
 v_mfma_f32_16x16x32_bf16 v[64:67], v[228:231], v[164:167], 0
 ds_write_b128 v252, a[184:187] offset:2048
 v_mfma_f32_16x16x32_bf16 v[68:71], v[232:235], v[164:167], 0
 ds_read_b128 a[184:187], v252 offset:19456
 buffer_load_dwordx4 a[128:131], v39, s[8:11], s72 offen sc1
 v_mfma_f32_16x16x32_bf16 v[72:75], v[236:239], v[164:167], 0
 v_mfma_f32_16x16x32_bf16 v[76:79], v[240:243], v[164:167], 0
 s_waitcnt vmcnt(21)
 buffer_load_dwordx4 v[136:139], v246, s[8:11], s67 offen sc1
 ds_write_b128 v252, a[188:191] offset:3072
 v_mfma_f32_16x16x32_bf16 v[80:83], v[224:227], v[168:171], 0
 ds_read_b128 a[188:191], v252 offset:32768
 v_mfma_f32_16x16x32_bf16 v[84:87], v[228:231], v[168:171], 0
 v_mfma_f32_16x16x32_bf16 v[88:91], v[232:235], v[168:171], 0
 ds_write_b128 v252, a[192:195] offset:16384
 v_mfma_f32_16x16x32_bf16 v[92:95], v[236:239], v[168:171], 0
 buffer_load_dwordx4 v[140:143], v247, s[8:11], s67 offen sc1
 ds_read_b128 a[192:195], v252 offset:33792
 v_mfma_f32_16x16x32_bf16 v[96:99], v[240:243], v[168:171], 0
 s_waitcnt vmcnt(22)
 v_mfma_f32_16x16x32_bf16 v[100:103], v[224:227], v[172:175], v[100:103]
 v_mfma_f32_16x16x32_bf16 v[104:107], v[228:231], v[172:175], v[104:107]
 buffer_load_dwordx4 a[132:135], v39, s[8:11], s72 offen offset:1024 sc1
 v_mfma_f32_16x16x32_bf16 v[108:111], v[232:235], v[172:175], v[108:111]
 v_mfma_f32_16x16x32_bf16 v[112:115], v[236:239], v[172:175], v[112:115]
 buffer_load_dwordx4 v[144:147], v244, s[8:11], s67 offen offset:1024 sc1
 v_mfma_f32_16x16x32_bf16 v[116:119], v[240:243], v[172:175], v[116:119]
 s_waitcnt vmcnt(18) lgkmcnt(8)
 v_mfma_f32_16x16x32_bf16 v[40:43], a[176:179], v[176:179], v[40:43]
 s_waitcnt lgkmcnt(6)
 ds_write_b128 v252, a[196:199] offset:17408
 v_mfma_f32_16x16x32_bf16 v[44:47], a[180:183], v[176:179], v[44:47]
 s_waitcnt lgkmcnt(5)
 ds_read_b128 a[196:199], v252 offset:34816
 v_mfma_f32_16x16x32_bf16 v[48:51], a[184:187], v[176:179], v[48:51]
 s_waitcnt lgkmcnt(4)
 buffer_load_dwordx4 v[148:151], v245, s[8:11], s67 offen offset:1024 sc1
 v_mfma_f32_16x16x32_bf16 v[52:55], a[188:191], v[176:179], v[52:55]
 s_waitcnt lgkmcnt(2)
 ds_write_b128 v252, a[200:203] offset:18432
 v_mfma_f32_16x16x32_bf16 v[56:59], a[192:195], v[176:179], v[56:59]
 s_waitcnt vmcnt(18)
 ds_read_b128 a[200:203], v252 offset:35840
 v_mfma_f32_16x16x32_bf16 v[60:63], a[176:179], v[180:183], v[60:63]
 v_mfma_f32_16x16x32_bf16 v[64:67], a[180:183], v[180:183], v[64:67]
 ds_write_b128 v252, a[204:207] offset:19456
 v_mfma_f32_16x16x32_bf16 v[68:71], a[184:187], v[180:183], v[68:71]
 buffer_load_dwordx4 v[152:155], v246, s[8:11], s67 offen offset:1024 sc1
 ds_read_b128 a[204:207], v252 offset:49152
 v_mfma_f32_16x16x32_bf16 v[72:75], a[188:191], v[180:183], v[72:75]
 s_add_u32 s86, s38, 4096
 buffer_load_dwordx4 a[16:19], v39, s[8:11], s86 offen sc1
 v_mfma_f32_16x16x32_bf16 v[76:79], a[192:195], v[180:183], v[76:79]
 s_waitcnt vmcnt(19)
 ds_write_b128 v252, a[208:211] offset:32768
 v_mfma_f32_16x16x32_bf16 v[80:83], a[176:179], v[120:123], v[80:83]
 ds_read_b128 a[208:211], v252 offset:50176
 v_mfma_f32_16x16x32_bf16 v[84:87], a[180:183], v[120:123], v[84:87]
 buffer_load_dwordx4 v[156:159], v247, s[8:11], s67 offen offset:1024 sc1
 v_mfma_f32_16x16x32_bf16 v[88:91], a[184:187], v[120:123], v[88:91]
 ds_write_b128 v252, a[212:215] offset:33792
 v_mfma_f32_16x16x32_bf16 v[92:95], a[188:191], v[120:123], v[92:95]
 ds_read_b128 a[212:215], v252 offset:51200
 v_mfma_f32_16x16x32_bf16 v[96:99], a[192:195], v[120:123], v[96:99]
 s_waitcnt vmcnt(19)
 v_mfma_f32_16x16x32_bf16 v[100:103], a[176:179], v[124:127], v[100:103]
 v_mfma_f32_16x16x32_bf16 v[104:107], a[180:183], v[124:127], v[104:107]
 buffer_load_dwordx4 v[160:163], v244, s[8:11], s66 offen sc1
 v_mfma_f32_16x16x32_bf16 v[108:111], a[184:187], v[124:127], v[108:111]
 buffer_load_dword v0, v8, s[8:11], s39 offen offset:2048 sc1
 v_mfma_f32_16x16x32_bf16 v[112:115], a[188:191], v[124:127], v[112:115]
 v_mfma_f32_16x16x32_bf16 v[116:119], a[192:195], v[124:127], v[116:119]
 s_waitcnt vmcnt(12) lgkmcnt(8)
 v_mfma_f32_16x16x32_bf16 v[40:43], a[196:199], v[128:131], v[40:43]
 s_waitcnt lgkmcnt(6)
 buffer_load_dwordx4 v[164:167], v245, s[8:11], s66 offen sc1
 ds_write_b128 v252, a[216:219] offset:34816
 v_mfma_f32_16x16x32_bf16 v[44:47], a[200:203], v[128:131], v[44:47]
 s_waitcnt lgkmcnt(5)
 ds_read_b128 a[216:219], v252 offset:52224
 v_mfma_f32_16x16x32_bf16 v[48:51], a[204:207], v[128:131], v[48:51]
 s_waitcnt lgkmcnt(4)
 v_mfma_f32_16x16x32_bf16 v[52:55], a[208:211], v[128:131], v[52:55]
 s_waitcnt lgkmcnt(2)
 ds_write_b128 v252, a[220:223] offset:35840
 v_mfma_f32_16x16x32_bf16 v[56:59], a[212:215], v[128:131], v[56:59]
 s_waitcnt vmcnt(12)
 ds_read_b128 a[220:223], v253
 v_mfma_f32_16x16x32_bf16 v[60:63], a[196:199], v[132:135], v[60:63]
 buffer_load_dword v26, v254, s[8:11], s51 offen sc1
 buffer_load_dwordx4 v[168:171], v246, s[8:11], s66 offen sc1
 v_mfma_f32_16x16x32_bf16 v[64:67], a[200:203], v[132:135], v[64:67]
 ds_write_b128 v252, a[224:227] offset:49152
 v_mfma_f32_16x16x32_bf16 v[68:71], a[204:207], v[132:135], v[68:71]
 ds_read_b128 a[224:227], v253 offset:1024
 v_mfma_f32_16x16x32_bf16 v[72:75], a[208:211], v[132:135], v[72:75]
 buffer_load_dword v0, v9, s[8:11], s40 offen sc1
 v_mfma_f32_16x16x32_bf16 v[76:79], a[212:215], v[132:135], v[76:79]
 s_waitcnt vmcnt(13)
 ds_write_b128 v252, a[228:231] offset:50176
 v_mfma_f32_16x16x32_bf16 v[80:83], a[196:199], v[136:139], v[80:83]
 buffer_load_dwordx4 v[172:175], v247, s[8:11], s66 offen sc1
 ds_read_b128 a[228:231], v253 offset:2048
 v_mfma_f32_16x16x32_bf16 v[84:87], a[200:203], v[136:139], v[84:87]
 v_mfma_f32_16x16x32_bf16 v[88:91], a[204:207], v[136:139], v[88:91]
 ds_write_b128 v252, a[232:235] offset:51200
 v_mfma_f32_16x16x32_bf16 v[92:95], a[208:211], v[136:139], v[92:95]
 ds_read_b128 a[232:235], v253 offset:3072
 v_mfma_f32_16x16x32_bf16 v[96:99], a[212:215], v[136:139], v[96:99]
 s_waitcnt vmcnt(13)
 buffer_load_dwordx4 v[176:179], v244, s[8:11], s66 offen offset:1024 sc1
 v_mfma_f32_16x16x32_bf16 v[100:103], a[196:199], v[140:143], v[100:103]
 v_mfma_f32_16x16x32_bf16 v[104:107], a[200:203], v[140:143], v[104:107]
 buffer_load_dwordx4 a[136:139], v39, s[8:11], s72 offen offset:2048 sc1
 v_mfma_f32_16x16x32_bf16 v[108:111], a[204:207], v[140:143], v[108:111]
 v_mfma_f32_16x16x32_bf16 v[112:115], a[208:211], v[140:143], v[112:115]
 v_mfma_f32_16x16x32_bf16 v[116:119], a[212:215], v[140:143], v[116:119]
 s_waitcnt vmcnt(13) lgkmcnt(8)
 buffer_load_dwordx4 v[180:183], v245, s[8:11], s66 offen offset:1024 sc1
 v_mfma_f32_16x16x32_bf16 v[40:43], a[216:219], v[144:147], v[40:43]
 s_waitcnt lgkmcnt(6)
 ds_write_b128 v252, a[236:239] offset:52224
 v_mfma_f32_16x16x32_bf16 v[44:47], a[220:223], v[144:147], v[44:47]
 s_waitcnt lgkmcnt(5)
 ds_read_b128 v[184:187], v248
 v_mfma_f32_16x16x32_bf16 v[48:51], a[224:227], v[144:147], v[48:51]
 s_waitcnt lgkmcnt(4)
 buffer_load_dwordx4 a[140:143], v39, s[8:11], s72 offen offset:3072 sc1
 v_mfma_f32_16x16x32_bf16 v[52:55], a[228:231], v[144:147], v[52:55]
 s_waitcnt lgkmcnt(2)
 buffer_load_dwordx4 v[120:123], v246, s[8:11], s66 offen offset:1024 sc1
 ds_write_b128 v253, a[240:243]
 v_mfma_f32_16x16x32_bf16 v[56:59], a[232:235], v[144:147], v[56:59]
 s_waitcnt vmcnt(15)
 ds_read_b128 v[188:191], v248 offset:1024
 v_mfma_f32_16x16x32_bf16 v[60:63], a[216:219], v[148:151], v[60:63]
 v_mfma_f32_16x16x32_bf16 v[64:67], a[220:223], v[148:151], v[64:67]
 ds_write_b128 v253, a[244:247] offset:1024
 v_mfma_f32_16x16x32_bf16 v[68:71], a[224:227], v[148:151], v[68:71]
 ds_read_b128 v[192:195], v248 offset:2048
 v_mfma_f32_16x16x32_bf16 v[72:75], a[228:231], v[148:151], v[72:75]
 buffer_load_dwordx4 v[124:127], v247, s[8:11], s66 offen offset:1024 sc1
 v_mfma_f32_16x16x32_bf16 v[76:79], a[232:235], v[148:151], v[76:79]
 s_waitcnt vmcnt(15)
 ds_write_b128 v253, a[248:251] offset:2048
 v_mfma_f32_16x16x32_bf16 v[80:83], a[216:219], v[152:155], v[80:83]
 ds_read_b128 v[196:199], v248 offset:3072
 buffer_load_dwordx4 a[144:147], v39, s[8:11], s73 offen sc1
 v_mfma_f32_16x16x32_bf16 v[84:87], a[220:223], v[152:155], v[84:87]
 v_mfma_f32_16x16x32_bf16 v[88:91], a[224:227], v[152:155], v[88:91]
 buffer_load_dwordx4 v[128:131], v244, s[8:11], s65 offen offset:2048 sc1
 ds_write_b128 v253, a[252:255] offset:3072
 v_mfma_f32_16x16x32_bf16 v[92:95], a[228:231], v[152:155], v[92:95]
 ds_read_b128 v[200:203], v248 offset:4096
 v_mfma_f32_16x16x32_bf16 v[96:99], a[232:235], v[152:155], v[96:99]
 s_waitcnt vmcnt(15)
 v_mfma_f32_16x16x32_bf16 v[100:103], a[216:219], v[156:159], v[100:103]
 buffer_load_dwordx4 a[148:151], v39, s[8:11], s73 offen offset:1024 sc1
 v_mfma_f32_16x16x32_bf16 v[104:107], a[220:223], v[156:159], v[104:107]
 v_mfma_f32_16x16x32_bf16 v[108:111], a[224:227], v[156:159], v[108:111]
 buffer_load_dwordx4 v[132:135], v245, s[8:11], s65 offen offset:2048 sc1
 v_mfma_f32_16x16x32_bf16 v[112:115], a[228:231], v[156:159], v[112:115]
 v_mfma_f32_16x16x32_bf16 v[116:119], a[232:235], v[156:159], v[116:119]
 s_waitcnt vmcnt(16) lgkmcnt(8)
 buffer_load_dwordx4 a[152:155], v39, s[8:11], s73 offen offset:2048 sc1
 v_mfma_f32_16x16x32_bf16 v[40:43], v[184:187], v[160:163], v[40:43]
 s_waitcnt lgkmcnt(6)
 v_mfma_f32_16x16x32_bf16 v[44:47], v[188:191], v[160:163], v[44:47]
 s_waitcnt lgkmcnt(4)
 buffer_load_dwordx4 v[136:139], v246, s[8:11], s65 offen offset:2048 sc1
 v_mfma_f32_16x16x32_bf16 v[48:51], v[192:195], v[160:163], v[48:51]
 s_waitcnt lgkmcnt(2)
 v_mfma_f32_16x16x32_bf16 v[52:55], v[196:199], v[160:163], v[52:55]
 s_waitcnt lgkmcnt(0)
 buffer_load_dwordx4 a[156:159], v39, s[8:11], s73 offen offset:3072 sc1
 v_mfma_f32_16x16x32_bf16 v[56:59], v[200:203], v[160:163], v[56:59]
 s_waitcnt vmcnt(17)
 ds_read_b128 v[204:207], v248 offset:5120
 v_mfma_f32_16x16x32_bf16 v[60:63], v[184:187], v[164:167], v[60:63]
 v_mfma_f32_16x16x32_bf16 v[64:67], v[188:191], v[164:167], v[64:67]
 buffer_load_dwordx4 v[140:143], v247, s[8:11], s65 offen offset:2048 sc1
 ds_read_b128 v[208:211], v248 offset:6144
 v_mfma_f32_16x16x32_bf16 v[68:71], v[192:195], v[164:167], v[68:71]
 v_mfma_f32_16x16x32_bf16 v[72:75], v[196:199], v[164:167], v[72:75]
 buffer_load_dwordx4 a[100:103], v39, s[8:11], s70 offen offset:1024 sc1
 v_mfma_f32_16x16x32_bf16 v[76:79], v[200:203], v[164:167], v[76:79]
 s_waitcnt vmcnt(17)
 ds_read_b128 v[212:215], v248 offset:7168
 v_mfma_f32_16x16x32_bf16 v[80:83], v[184:187], v[168:171], v[80:83]
 buffer_load_dwordx4 v[144:147], v244, s[8:11], s65 offen offset:3072 sc1
 v_mfma_f32_16x16x32_bf16 v[84:87], v[188:191], v[168:171], v[84:87]
 ds_read_b128 v[216:219], v248 offset:8192
 v_mfma_f32_16x16x32_bf16 v[88:91], v[192:195], v[168:171], v[88:91]
 v_mfma_f32_16x16x32_bf16 v[92:95], v[196:199], v[168:171], v[92:95]
 ds_read_b128 v[220:223], v248 offset:9216
 buffer_load_dwordx4 a[104:107], v39, s[8:11], s70 offen offset:2048 sc1
 v_mfma_f32_16x16x32_bf16 v[96:99], v[200:203], v[168:171], v[96:99]
 s_waitcnt vmcnt(17)
 v_mfma_f32_16x16x32_bf16 v[100:103], v[184:187], v[172:175], v[100:103]
 buffer_load_dwordx4 v[148:151], v245, s[8:11], s65 offen offset:3072 sc1
 v_mfma_f32_16x16x32_bf16 v[104:107], v[188:191], v[172:175], v[104:107]
 v_mfma_f32_16x16x32_bf16 v[108:111], v[192:195], v[172:175], v[108:111]
 buffer_load_dwordx4 a[108:111], v39, s[8:11], s70 offen offset:3072 sc1
 v_mfma_f32_16x16x32_bf16 v[112:115], v[196:199], v[172:175], v[112:115]
 v_mfma_f32_16x16x32_bf16 v[116:119], v[200:203], v[172:175], v[116:119]
 s_waitcnt vmcnt(18) lgkmcnt(4)
 v_mfma_f32_16x16x32_bf16 v[40:43], v[204:207], v[176:179], v[40:43]
 s_waitcnt lgkmcnt(3)
 buffer_load_dwordx4 v[152:155], v246, s[8:11], s65 offen offset:3072 sc1
 v_mfma_f32_16x16x32_bf16 v[44:47], v[208:211], v[176:179], v[44:47]
 s_waitcnt lgkmcnt(2)
 v_accvgpr_write_b32 a236, v224
 buffer_load_dwordx4 a[112:115], v39, s[8:11], s71 offen sc1
 v_mfma_f32_16x16x32_bf16 v[48:51], v[212:215], v[176:179], v[48:51]
 s_waitcnt lgkmcnt(1)
 v_mfma_f32_16x16x32_bf16 v[52:55], v[216:219], v[176:179], v[52:55]
 s_waitcnt lgkmcnt(0)
 v_accvgpr_write_b32 a237, v225
 v_mfma_f32_16x16x32_bf16 v[56:59], v[220:223], v[176:179], v[56:59]
 s_waitcnt vmcnt(18)
 buffer_load_dwordx4 v[156:159], v247, s[8:11], s65 offen offset:3072 sc1
 v_mfma_f32_16x16x32_bf16 v[60:63], v[204:207], v[180:183], v[60:63]
 v_mfma_f32_16x16x32_bf16 v[64:67], v[208:211], v[180:183], v[64:67]
 v_accvgpr_write_b32 a238, v226
 buffer_load_dwordx4 a[116:119], v39, s[8:11], s71 offen offset:1024 sc1
 v_mfma_f32_16x16x32_bf16 v[68:71], v[212:215], v[180:183], v[68:71]
 v_mfma_f32_16x16x32_bf16 v[72:75], v[216:219], v[180:183], v[72:75]
 v_accvgpr_write_b32 a239, v227
 v_mfma_f32_16x16x32_bf16 v[76:79], v[220:223], v[180:183], v[76:79]
 v_cmp_gt_u32 vcc, 2, v26
 s_cbranch_vccnz sretry_9
sback_10:
 buffer_load_dwordx4 v[160:163], v244, s[8:11], 0 offen offset:2048 sc1
 s_waitcnt vmcnt(19)
 v_mfma_f32_16x16x32_bf16 v[80:83], v[204:207], v[120:123], v[80:83]
 v_mfma_f32_16x16x32_bf16 v[84:87], v[208:211], v[120:123], v[84:87]
 v_accvgpr_write_b32 a240, v228
 v_mfma_f32_16x16x32_bf16 v[88:91], v[212:215], v[120:123], v[88:91]
 v_mfma_f32_16x16x32_bf16 v[92:95], v[216:219], v[120:123], v[92:95]
 buffer_load_dwordx4 v[164:167], v244, s[8:11], 0 offen offset:3072 sc1
 v_mfma_f32_16x16x32_bf16 v[96:99], v[220:223], v[120:123], v[96:99]
 s_waitcnt vmcnt(19)
 v_accvgpr_write_b32 a241, v229
 v_mfma_f32_16x16x32_bf16 v[100:103], v[204:207], v[124:127], v[100:103]
 v_mfma_f32_16x16x32_bf16 v[104:107], v[208:211], v[124:127], v[104:107]
 v_accvgpr_write_b32 a242, v230
 v_mfma_f32_16x16x32_bf16 v[108:111], v[212:215], v[124:127], v[108:111]
 v_mfma_f32_16x16x32_bf16 v[112:115], v[216:219], v[124:127], v[112:115]
 buffer_load_dwordx4 v[168:171], v244, s[8:11], s65 offen sc1
 v_mfma_f32_16x16x32_bf16 v[116:119], v[220:223], v[124:127], v[116:119]
 s_waitcnt vmcnt(18)
 v_accvgpr_write_b32 a243, v231
 v_mfma_f32_16x16x32_bf16 v[40:43], a[120:123], v[128:131], v[40:43]
 v_mfma_f32_16x16x32_bf16 v[44:47], a[124:127], v[128:131], v[44:47]
 v_accvgpr_write_b32 a244, v232
 v_mfma_f32_16x16x32_bf16 v[48:51], a[128:131], v[128:131], v[48:51]
 buffer_load_dwordx4 v[172:175], v244, s[8:11], s65 offen offset:1024 sc1
 v_mfma_f32_16x16x32_bf16 v[52:55], a[132:135], v[128:131], v[52:55]
 v_mfma_f32_16x16x32_bf16 v[56:59], a[136:139], v[128:131], v[56:59]
 s_waitcnt vmcnt(17)
 v_accvgpr_write_b32 a245, v233
 v_mfma_f32_16x16x32_bf16 v[60:63], a[120:123], v[132:135], v[60:63]
 v_mfma_f32_16x16x32_bf16 v[64:67], a[124:127], v[132:135], v[64:67]
 v_accvgpr_write_b32 a246, v234
 v_mfma_f32_16x16x32_bf16 v[68:71], a[128:131], v[132:135], v[68:71]
 buffer_load_dwordx4 v[176:179], v244, s[8:11], 0 offen offset:1024 sc1
 v_mfma_f32_16x16x32_bf16 v[72:75], a[132:135], v[132:135], v[72:75]
 v_mfma_f32_16x16x32_bf16 v[76:79], a[136:139], v[132:135], v[76:79]
 s_waitcnt vmcnt(16)
 v_accvgpr_write_b32 a247, v235
 v_mfma_f32_16x16x32_bf16 v[80:83], a[120:123], v[136:139], v[80:83]
 v_mfma_f32_16x16x32_bf16 v[84:87], a[124:127], v[136:139], v[84:87]
 buffer_load_dwordx4 v[180:183], v244, s[8:11], s38 offen sc1
 v_mfma_f32_16x16x32_bf16 v[88:91], a[128:131], v[136:139], v[88:91]
 v_accvgpr_write_b32 a248, v236
 v_mfma_f32_16x16x32_bf16 v[92:95], a[132:135], v[136:139], v[92:95]
 v_mfma_f32_16x16x32_bf16 v[96:99], a[136:139], v[136:139], v[96:99]
 s_waitcnt vmcnt(15)
 v_accvgpr_write_b32 a249, v237
 v_mfma_f32_16x16x32_bf16 v[100:103], a[120:123], v[140:143], v[100:103]
 v_mfma_f32_16x16x32_bf16 v[104:107], a[124:127], v[140:143], v[104:107]
 buffer_load_dwordx4 v[120:123], v245, s[8:11], 0 offen offset:2048 sc1
 v_accvgpr_write_b32 a250, v238
 v_mfma_f32_16x16x32_bf16 v[108:111], a[128:131], v[140:143], v[108:111]
 v_mfma_f32_16x16x32_bf16 v[112:115], a[132:135], v[140:143], v[112:115]
 v_mfma_f32_16x16x32_bf16 v[116:119], a[136:139], v[140:143], v[116:119]
 s_waitcnt vmcnt(14)
 v_accvgpr_write_b32 a251, v239
 v_mfma_f32_16x16x32_bf16 v[40:43], a[140:143], v[144:147], v[40:43]
 buffer_load_dwordx4 v[124:127], v245, s[8:11], 0 offen offset:3072 sc1
 v_mfma_f32_16x16x32_bf16 v[44:47], a[144:147], v[144:147], v[44:47]
 v_accvgpr_write_b32 a252, v240
 v_mfma_f32_16x16x32_bf16 v[48:51], a[148:151], v[144:147], v[48:51]
 v_mfma_f32_16x16x32_bf16 v[52:55], a[152:155], v[144:147], v[52:55]
 v_mfma_f32_16x16x32_bf16 v[56:59], a[156:159], v[144:147], v[56:59]
 s_waitcnt vmcnt(13)
 v_accvgpr_write_b32 a253, v241
 v_mfma_f32_16x16x32_bf16 v[60:63], a[140:143], v[148:151], v[60:63]
 buffer_load_dwordx4 v[128:131], v245, s[8:11], s65 offen sc1
 v_mfma_f32_16x16x32_bf16 v[64:67], a[144:147], v[148:151], v[64:67]
 v_accvgpr_write_b32 a254, v242
 v_mfma_f32_16x16x32_bf16 v[68:71], a[148:151], v[148:151], v[68:71]
 v_mfma_f32_16x16x32_bf16 v[72:75], a[152:155], v[148:151], v[72:75]
 v_accvgpr_write_b32 a255, v243
 v_mfma_f32_16x16x32_bf16 v[76:79], a[156:159], v[148:151], v[76:79]
 s_waitcnt vmcnt(12)
 v_mfma_f32_16x16x32_bf16 v[80:83], a[140:143], v[152:155], v[80:83]
 buffer_load_dwordx4 v[132:135], v245, s[8:11], s65 offen offset:1024 sc1
 v_mfma_f32_16x16x32_bf16 v[84:87], a[144:147], v[152:155], v[84:87]
 v_mfma_f32_16x16x32_bf16 v[88:91], a[148:151], v[152:155], v[88:91]
 v_mfma_f32_16x16x32_bf16 v[92:95], a[152:155], v[152:155], v[92:95]
 v_mfma_f32_16x16x32_bf16 v[96:99], a[156:159], v[152:155], v[96:99]
 s_waitcnt vmcnt(11)
 buffer_load_dwordx4 v[136:139], v245, s[8:11], 0 offen offset:1024 sc1
 v_mfma_f32_16x16x32_bf16 v[100:103], a[140:143], v[156:159], v[100:103]
 v_mfma_f32_16x16x32_bf16 v[104:107], a[144:147], v[156:159], v[104:107]
 v_mfma_f32_16x16x32_bf16 v[108:111], a[148:151], v[156:159], v[108:111]
 v_mfma_f32_16x16x32_bf16 v[112:115], a[152:155], v[156:159], v[112:115]
 v_mfma_f32_16x16x32_bf16 v[116:119], a[156:159], v[156:159], v[116:119]
 s_waitcnt vmcnt(10)
 buffer_load_dwordx4 v[140:143], v245, s[8:11], s38 offen sc1
 v_mfma_f32_16x16x32_bf16 v[40:43], a[40:43], v[160:163], v[40:43]
 v_mfma_f32_16x16x32_bf16 v[44:47], a[44:47], v[160:163], v[44:47]
 v_mfma_f32_16x16x32_bf16 v[48:51], a[48:51], v[160:163], v[48:51]
 v_mfma_f32_16x16x32_bf16 v[52:55], a[52:55], v[160:163], v[52:55]
 buffer_load_dwordx4 v[144:147], v246, s[8:11], 0 offen offset:2048 sc1
 v_mfma_f32_16x16x32_bf16 v[56:59], a[56:59], v[160:163], v[56:59]
 s_waitcnt vmcnt(11)
 v_mfma_f32_16x16x32_bf16 v[40:43], a[60:63], v[164:167], v[40:43]
 v_mfma_f32_16x16x32_bf16 v[44:47], a[64:67], v[164:167], v[44:47]
 v_mfma_f32_16x16x32_bf16 v[48:51], a[68:71], v[164:167], v[48:51]
 v_mfma_f32_16x16x32_bf16 v[52:55], a[72:75], v[164:167], v[52:55]
 buffer_load_dwordx4 v[148:151], v246, s[8:11], 0 offen offset:3072 sc1
 v_mfma_f32_16x16x32_bf16 v[56:59], a[76:79], v[164:167], v[56:59]
 s_waitcnt vmcnt(11)
 v_mfma_f32_16x16x32_bf16 v[40:43], a[80:83], v[168:171], v[40:43]
 v_mfma_f32_16x16x32_bf16 v[44:47], a[84:87], v[168:171], v[44:47]
 v_mfma_f32_16x16x32_bf16 v[48:51], a[88:91], v[168:171], v[48:51]
 buffer_load_dwordx4 v[152:155], v246, s[8:11], s65 offen sc1
 v_mfma_f32_16x16x32_bf16 v[52:55], a[92:95], v[168:171], v[52:55]
 v_mfma_f32_16x16x32_bf16 v[56:59], a[96:99], v[168:171], v[56:59]
 s_waitcnt vmcnt(11)
 v_mfma_f32_16x16x32_bf16 v[40:43], a[100:103], v[172:175], v[40:43]
 v_mfma_f32_16x16x32_bf16 v[44:47], a[104:107], v[172:175], v[44:47]
 v_mfma_f32_16x16x32_bf16 v[48:51], a[108:111], v[172:175], v[48:51]
 buffer_load_dwordx4 v[156:159], v246, s[8:11], s65 offen offset:1024 sc1
 v_mfma_f32_16x16x32_bf16 v[52:55], a[112:115], v[172:175], v[52:55]
 v_mfma_f32_16x16x32_bf16 v[56:59], a[116:119], v[172:175], v[56:59]
 s_waitcnt vmcnt(11)
 v_mfma_f32_16x16x32_bf16 v[40:43], a[20:23], v[176:179], v[40:43]
 v_mfma_f32_16x16x32_bf16 v[44:47], a[24:27], v[176:179], v[44:47]
 buffer_load_dwordx4 v[160:163], v246, s[8:11], 0 offen offset:1024 sc1
 v_mfma_f32_16x16x32_bf16 v[48:51], a[28:31], v[176:179], v[48:51]
 v_mfma_f32_16x16x32_bf16 v[52:55], a[32:35], v[176:179], v[52:55]
 v_mfma_f32_16x16x32_bf16 v[56:59], a[36:39], v[176:179], v[56:59]
 s_waitcnt vmcnt(11)
 v_mfma_f32_16x16x32_bf16 v[40:43], a[0:3], v[180:183], v[40:43]
 v_mfma_f32_16x16x32_bf16 v[44:47], a[4:7], v[180:183], v[44:47]
 buffer_load_dwordx4 v[164:167], v246, s[8:11], s38 offen sc1
 v_mfma_f32_16x16x32_bf16 v[48:51], a[8:11], v[180:183], v[48:51]
 v_mfma_f32_16x16x32_bf16 v[52:55], a[12:15], v[180:183], v[52:55]
 v_mfma_f32_16x16x32_bf16 v[56:59], a[16:19], v[180:183], v[56:59]
 s_waitcnt vmcnt(11)
 v_mfma_f32_16x16x32_bf16 v[60:63], a[40:43], v[120:123], v[60:63]
 buffer_load_dwordx4 v[168:171], v247, s[8:11], 0 offen offset:2048 sc1
 v_mfma_f32_16x16x32_bf16 v[64:67], a[44:47], v[120:123], v[64:67]
 v_mfma_f32_16x16x32_bf16 v[68:71], a[48:51], v[120:123], v[68:71]
 s_mov_b32 m0, s83
 s_nop 0
 ds_write_addtid_b32 v40
 v_mfma_f32_16x16x32_bf16 v[72:75], a[52:55], v[120:123], v[72:75]
 ds_write_addtid_b32 v41 offset:256
 ds_write_addtid_b32 v42 offset:512
 v_mfma_f32_16x16x32_bf16 v[76:79], a[56:59], v[120:123], v[76:79]
 s_waitcnt vmcnt(11)
 ds_write_addtid_b32 v43 offset:768
 v_mfma_f32_16x16x32_bf16 v[60:63], a[60:63], v[124:127], v[60:63]
 buffer_load_dwordx4 v[172:175], v247, s[8:11], 0 offen offset:3072 sc1
 ds_write_addtid_b32 v44 offset:1024
 v_mfma_f32_16x16x32_bf16 v[64:67], a[64:67], v[124:127], v[64:67]
 ds_write_addtid_b32 v45 offset:1280
 v_mfma_f32_16x16x32_bf16 v[68:71], a[68:71], v[124:127], v[68:71]
 ds_write_addtid_b32 v46 offset:1536
 ds_write_addtid_b32 v47 offset:1792
 v_mfma_f32_16x16x32_bf16 v[72:75], a[72:75], v[124:127], v[72:75]
 ds_write_addtid_b32 v48 offset:2048
 v_mfma_f32_16x16x32_bf16 v[76:79], a[76:79], v[124:127], v[76:79]
 s_waitcnt vmcnt(11)
 ds_write_addtid_b32 v49 offset:2304
 v_mfma_f32_16x16x32_bf16 v[60:63], a[80:83], v[128:131], v[60:63]
 buffer_load_dwordx4 v[176:179], v247, s[8:11], s65 offen sc1
 ds_write_addtid_b32 v50 offset:2560
 v_mfma_f32_16x16x32_bf16 v[64:67], a[84:87], v[128:131], v[64:67]
 ds_write_addtid_b32 v51 offset:2816
 v_mfma_f32_16x16x32_bf16 v[68:71], a[88:91], v[128:131], v[68:71]
 ds_write_addtid_b32 v52 offset:3072
 ds_write_addtid_b32 v53 offset:3328
 v_mfma_f32_16x16x32_bf16 v[72:75], a[92:95], v[128:131], v[72:75]
 ds_write_addtid_b32 v54 offset:3584
 v_mfma_f32_16x16x32_bf16 v[76:79], a[96:99], v[128:131], v[76:79]
 s_waitcnt vmcnt(11)
 buffer_load_dwordx4 v[180:183], v247, s[8:11], s65 offen offset:1024 sc1
 ds_write_addtid_b32 v55 offset:3840
 v_mfma_f32_16x16x32_bf16 v[60:63], a[100:103], v[132:135], v[60:63]
 ds_write_addtid_b32 v56 offset:4096
 v_mfma_f32_16x16x32_bf16 v[64:67], a[104:107], v[132:135], v[64:67]
 ds_write_addtid_b32 v57 offset:4352
 ds_write_addtid_b32 v58 offset:4608
 v_mfma_f32_16x16x32_bf16 v[68:71], a[108:111], v[132:135], v[68:71]
 ds_write_addtid_b32 v59 offset:4864
 v_mfma_f32_16x16x32_bf16 v[72:75], a[112:115], v[132:135], v[72:75]
 v_mfma_f32_16x16x32_bf16 v[76:79], a[116:119], v[132:135], v[76:79]
 s_waitcnt vmcnt(11)
 buffer_load_dwordx4 v[120:123], v247, s[8:11], 0 offen offset:1024 sc1
 v_mfma_f32_16x16x32_bf16 v[60:63], a[20:23], v[136:139], v[60:63]
 v_mfma_f32_16x16x32_bf16 v[64:67], a[24:27], v[136:139], v[64:67]
 s_waitcnt lgkmcnt(0)
 s_barrier
 v_mfma_f32_16x16x32_bf16 v[68:71], a[28:31], v[136:139], v[68:71]
 ds_read2st64_b32 v[224:225], v249 offset0:0 offset1:1
 v_mfma_f32_16x16x32_bf16 v[72:75], a[32:35], v[136:139], v[72:75]
 buffer_load_dwordx4 v[124:127], v247, s[8:11], s38 offen sc1
 ds_read2st64_b32 v[226:227], v249 offset0:2 offset1:3
 v_mfma_f32_16x16x32_bf16 v[76:79], a[36:39], v[136:139], v[76:79]
 s_waitcnt vmcnt(12)
 v_add_u32 v38, s62, v1
 ds_read2st64_b32 v[228:229], v249 offset0:4 offset1:5
 v_mfma_f32_16x16x32_bf16 v[60:63], a[0:3], v[140:143], v[60:63]
 buffer_load_dwordx4 a[120:123], v38, s[8:11], 0 offen sc1
 ds_read2st64_b32 v[230:231], v249 offset0:6 offset1:7
 v_mfma_f32_16x16x32_bf16 v[64:67], a[4:7], v[140:143], v[64:67]
 ds_read2st64_b32 v[232:233], v249 offset0:8 offset1:9
 v_mfma_f32_16x16x32_bf16 v[68:71], a[8:11], v[140:143], v[68:71]
 ds_read2st64_b32 v[234:235], v249 offset0:10 offset1:11
 v_mfma_f32_16x16x32_bf16 v[72:75], a[12:15], v[140:143], v[72:75]
 ds_read2st64_b32 v[236:237], v249 offset0:12 offset1:13
 v_mfma_f32_16x16x32_bf16 v[76:79], a[16:19], v[140:143], v[76:79]
 s_waitcnt vmcnt(12)
 ds_read2st64_b32 v[238:239], v249 offset0:14 offset1:15
 v_mfma_f32_16x16x32_bf16 v[80:83], a[40:43], v[144:147], v[80:83]
 buffer_load_dwordx4 a[124:127], v38, s[8:11], 0 offen offset:1024 sc1
 ds_read2st64_b32 v[240:241], v249 offset0:16 offset1:17
 v_mfma_f32_16x16x32_bf16 v[84:87], a[44:47], v[144:147], v[84:87]
 ds_read2st64_b32 v[242:243], v249 offset0:18 offset1:19
 v_mfma_f32_16x16x32_bf16 v[88:91], a[48:51], v[144:147], v[88:91]
 ds_write_addtid_b32 v60 offset:5120
 v_mfma_f32_16x16x32_bf16 v[92:95], a[52:55], v[144:147], v[92:95]
 ds_write_addtid_b32 v61 offset:5376
 ds_write_addtid_b32 v62 offset:5632
 v_mfma_f32_16x16x32_bf16 v[96:99], a[56:59], v[144:147], v[96:99]
 s_waitcnt vmcnt(12) lgkmcnt(12)
 ds_write_addtid_b32 v63 offset:5888
 v_add_f32 v100, v100, v224
 v_mfma_f32_16x16x32_bf16 v[80:83], a[60:63], v[148:151], v[80:83]
 buffer_load_dwordx4 a[128:131], v38, s[8:11], 0 offen offset:2048 sc1
 ds_write_addtid_b32 v64 offset:6144
 v_mfma_f32_16x16x32_bf16 v[84:87], a[64:67], v[148:151], v[84:87]
 ds_write_addtid_b32 v65 offset:6400
 v_add_f32 v101, v101, v225
 v_mfma_f32_16x16x32_bf16 v[88:91], a[68:71], v[148:151], v[88:91]
 ds_write_addtid_b32 v66 offset:6656
 ds_write_addtid_b32 v67 offset:6912
 v_mfma_f32_16x16x32_bf16 v[92:95], a[72:75], v[148:151], v[92:95]
 s_waitcnt lgkmcnt(14)
 ds_write_addtid_b32 v68 offset:7168
 v_add_f32 v102, v102, v226
 v_mfma_f32_16x16x32_bf16 v[96:99], a[76:79], v[148:151], v[96:99]
 s_waitcnt vmcnt(12)
 ds_write_addtid_b32 v69 offset:7424
 v_add_f32 v103, v103, v227
 v_mfma_f32_16x16x32_bf16 v[80:83], a[80:83], v[152:155], v[80:83]
 buffer_load_dwordx4 a[132:135], v38, s[8:11], 0 offen offset:3072 sc1
 ds_write_addtid_b32 v70 offset:7680
 v_mfma_f32_16x16x32_bf16 v[84:87], a[84:87], v[152:155], v[84:87]
 ds_write_addtid_b32 v71 offset:7936
 v_add_f32 v104, v104, v228
 v_mfma_f32_16x16x32_bf16 v[88:91], a[88:91], v[152:155], v[88:91]
 ds_write_addtid_b32 v72 offset:8192
 ds_write_addtid_b32 v73 offset:8448
 v_mfma_f32_16x16x32_bf16 v[92:95], a[92:95], v[152:155], v[92:95]
 ds_write_addtid_b32 v74 offset:8704
 v_add_f32 v105, v105, v229
 v_mfma_f32_16x16x32_bf16 v[96:99], a[96:99], v[152:155], v[96:99]
 s_waitcnt vmcnt(12)
 ds_write_addtid_b32 v75 offset:8960
 ds_write_addtid_b32 v76 offset:9216
 v_mfma_f32_16x16x32_bf16 v[80:83], a[100:103], v[156:159], v[80:83]
 buffer_load_dwordx4 a[136:139], v38, s[8:11], s65 offen sc1
 v_add_f32 v106, v106, v230
 v_mfma_f32_16x16x32_bf16 v[84:87], a[104:107], v[156:159], v[84:87]
 ds_write_addtid_b32 v77 offset:9472
 ds_write_addtid_b32 v78 offset:9728
 v_mfma_f32_16x16x32_bf16 v[88:91], a[108:111], v[156:159], v[88:91]
 ds_write_addtid_b32 v79 offset:9984
 v_add_f32 v107, v107, v231
 v_mfma_f32_16x16x32_bf16 v[92:95], a[112:115], v[156:159], v[92:95]
 s_waitcnt lgkmcnt(15)
 v_add_f32 v108, v108, v232
 v_add_f32 v109, v109, v233
 v_mfma_f32_16x16x32_bf16 v[96:99], a[116:119], v[156:159], v[96:99]
 s_waitcnt vmcnt(12)
 v_add_f32 v110, v110, v234
 v_add_f32 v111, v111, v235
 v_mfma_f32_16x16x32_bf16 v[80:83], a[20:23], v[160:163], v[80:83]
 buffer_load_dwordx4 a[140:143], v38, s[8:11], s65 offen offset:1024 sc1
 v_add_f32 v112, v112, v236
 v_mfma_f32_16x16x32_bf16 v[84:87], a[24:27], v[160:163], v[84:87]
 s_waitcnt lgkmcnt(0)
 s_barrier
 v_add_f32 v113, v113, v237
 v_mfma_f32_16x16x32_bf16 v[88:91], a[28:31], v[160:163], v[88:91]
 ds_read2st64_b32 v[184:185], v250 offset0:20 offset1:21
 v_add_f32 v114, v114, v238
 v_mfma_f32_16x16x32_bf16 v[92:95], a[32:35], v[160:163], v[92:95]
 ds_read2st64_b32 v[186:187], v250 offset0:22 offset1:23
 v_add_f32 v115, v115, v239
 v_mfma_f32_16x16x32_bf16 v[96:99], a[36:39], v[160:163], v[96:99]
 s_waitcnt vmcnt(12)
 ds_read2st64_b32 v[188:189], v250 offset0:24 offset1:25
 v_add_f32 v116, v116, v240
 v_mfma_f32_16x16x32_bf16 v[80:83], a[0:3], v[164:167], v[80:83]
 buffer_load_dwordx4 a[144:147], v38, s[8:11], s65 offen offset:2048 sc1
 ds_read2st64_b32 v[190:191], v250 offset0:26 offset1:27
 v_mfma_f32_16x16x32_bf16 v[84:87], a[4:7], v[164:167], v[84:87]
 ds_read2st64_b32 v[192:193], v250 offset0:28 offset1:29
 v_add_f32 v117, v117, v241
 v_mfma_f32_16x16x32_bf16 v[88:91], a[8:11], v[164:167], v[88:91]
 ds_read2st64_b32 v[194:195], v250 offset0:30 offset1:31
 v_add_f32 v118, v118, v242
 v_mfma_f32_16x16x32_bf16 v[92:95], a[12:15], v[164:167], v[92:95]
 ds_read2st64_b32 v[196:197], v250 offset0:32 offset1:33
 v_add_f32 v119, v119, v243
 v_mfma_f32_16x16x32_bf16 v[96:99], a[16:19], v[164:167], v[96:99]
 s_waitcnt vmcnt(12)
 ds_read2st64_b32 v[198:199], v250 offset0:34 offset1:35
 v_mfma_f32_16x16x32_bf16 v[100:103], a[40:43], v[168:171], v[100:103]
 buffer_load_dwordx4 a[148:151], v38, s[8:11], s65 offen offset:3072 sc1
 ds_read2st64_b32 v[200:201], v250 offset0:36 offset1:37
 v_mfma_f32_16x16x32_bf16 v[104:107], a[44:47], v[168:171], v[104:107]
 ds_read2st64_b32 v[202:203], v250 offset0:38 offset1:39
 v_mfma_f32_16x16x32_bf16 v[108:111], a[48:51], v[168:171], v[108:111]
 ds_write_addtid_b32 v80
 v_mfma_f32_16x16x32_bf16 v[112:115], a[52:55], v[168:171], v[112:115]
 ds_write_addtid_b32 v81 offset:256
 ds_write_addtid_b32 v82 offset:512
 v_mfma_f32_16x16x32_bf16 v[116:119], a[56:59], v[168:171], v[116:119]
 s_waitcnt vmcnt(12)
 ds_write_addtid_b32 v83 offset:768
 v_mfma_f32_16x16x32_bf16 v[100:103], a[60:63], v[172:175], v[100:103]
 buffer_load_dwordx4 a[152:155], v38, s[8:11], s66 offen sc1
 ds_write_addtid_b32 v84 offset:1024
 v_mfma_f32_16x16x32_bf16 v[104:107], a[64:67], v[172:175], v[104:107]
 ds_write_addtid_b32 v85 offset:1280
 v_mfma_f32_16x16x32_bf16 v[108:111], a[68:71], v[172:175], v[108:111]
 ds_write_addtid_b32 v86 offset:1536
 v_mfma_f32_16x16x32_bf16 v[112:115], a[72:75], v[172:175], v[112:115]
 ds_write_addtid_b32 v87 offset:1792
 v_mfma_f32_16x16x32_bf16 v[116:119], a[76:79], v[172:175], v[116:119]
 s_waitcnt vmcnt(12)
 ds_write_addtid_b32 v88 offset:2048
 ds_write_addtid_b32 v89 offset:2304
 v_mfma_f32_16x16x32_bf16 v[100:103], a[80:83], v[176:179], v[100:103]
 ds_write_addtid_b32 v90 offset:2560
 v_mfma_f32_16x16x32_bf16 v[104:107], a[84:87], v[176:179], v[104:107]
 ds_write_addtid_b32 v91 offset:2816
 v_mfma_f32_16x16x32_bf16 v[108:111], a[88:91], v[176:179], v[108:111]
 ds_write_addtid_b32 v92 offset:3072
 ds_write_addtid_b32 v93 offset:3328
 v_mfma_f32_16x16x32_bf16 v[112:115], a[92:95], v[176:179], v[112:115]
 ds_write_addtid_b32 v94 offset:3584
 v_mfma_f32_16x16x32_bf16 v[116:119], a[96:99], v[176:179], v[116:119]
 s_waitcnt vmcnt(11)
 ds_write_addtid_b32 v95 offset:3840
 v_mfma_f32_16x16x32_bf16 v[100:103], a[100:103], v[180:183], v[100:103]
 ds_write_addtid_b32 v96 offset:4096
 v_mfma_f32_16x16x32_bf16 v[104:107], a[104:107], v[180:183], v[104:107]
 ds_write_addtid_b32 v97 offset:4352
 ds_write_addtid_b32 v98 offset:4608
 v_mfma_f32_16x16x32_bf16 v[108:111], a[108:111], v[180:183], v[108:111]
 ds_write_addtid_b32 v99 offset:4864
 v_mfma_f32_16x16x32_bf16 v[112:115], a[112:115], v[180:183], v[112:115]
 v_mfma_f32_16x16x32_bf16 v[116:119], a[116:119], v[180:183], v[116:119]
 s_waitcnt vmcnt(10)
 v_mfma_f32_16x16x32_bf16 v[100:103], a[20:23], v[120:123], v[100:103]
 v_mfma_f32_16x16x32_bf16 v[104:107], a[24:27], v[120:123], v[104:107]
 s_waitcnt lgkmcnt(0)
 s_barrier
 v_mfma_f32_16x16x32_bf16 v[108:111], a[28:31], v[120:123], v[108:111]
 ds_read2st64_b32 v[224:225], v251 offset0:0 offset1:1
 v_mfma_f32_16x16x32_bf16 v[112:115], a[32:35], v[120:123], v[112:115]
 ds_read2st64_b32 v[226:227], v251 offset0:2 offset1:3
 v_mfma_f32_16x16x32_bf16 v[116:119], a[36:39], v[120:123], v[116:119]
 s_waitcnt vmcnt(9)
 ds_read2st64_b32 v[228:229], v251 offset0:4 offset1:5
 v_mfma_f32_16x16x32_bf16 v[100:103], a[0:3], v[124:127], v[100:103]
 ds_read2st64_b32 v[230:231], v251 offset0:6 offset1:7
 v_mfma_f32_16x16x32_bf16 v[104:107], a[4:7], v[124:127], v[104:107]
 ds_read2st64_b32 v[232:233], v251 offset0:8 offset1:9
 v_mfma_f32_16x16x32_bf16 v[108:111], a[8:11], v[124:127], v[108:111]
 ds_read2st64_b32 v[234:235], v251 offset0:10 offset1:11
 v_mfma_f32_16x16x32_bf16 v[112:115], a[12:15], v[124:127], v[112:115]
 ds_read2st64_b32 v[236:237], v251 offset0:12 offset1:13
 v_mfma_f32_16x16x32_bf16 v[116:119], a[16:19], v[124:127], v[116:119]
 ds_read2st64_b32 v[238:239], v251 offset0:14 offset1:15
 ds_read2st64_b32 v[240:241], v251 offset0:16 offset1:17
 ds_read2st64_b32 v[242:243], v251 offset0:18 offset1:19
 v_pk_add_f32 v[100:101], v[100:101], v[184:185]
 v_pk_add_f32 v[102:103], v[102:103], v[186:187]
 v_pk_add_f32 v[104:105], v[104:105], v[188:189]
 v_pk_add_f32 v[106:107], v[106:107], v[190:191]
 v_pk_add_f32 v[108:109], v[108:109], v[192:193]
 v_pk_add_f32 v[110:111], v[110:111], v[194:195]
 v_pk_add_f32 v[112:113], v[112:113], v[196:197]
 v_pk_add_f32 v[114:115], v[114:115], v[198:199]
 v_pk_add_f32 v[116:117], v[116:117], v[200:201]
 v_pk_add_f32 v[118:119], v[118:119], v[202:203]
 s_waitcnt lgkmcnt(0)
 v_pk_add_f32 v[100:101], v[100:101], v[224:225]
 v_cvt_pk_bf16_f32 v28, v100, v101
 v_pk_add_f32 v[102:103], v[102:103], v[226:227]
 v_cvt_pk_bf16_f32 v29, v102, v103
 v_pk_add_f32 v[104:105], v[104:105], v[228:229]
 v_cvt_pk_bf16_f32 v30, v104, v105
 v_pk_add_f32 v[106:107], v[106:107], v[230:231]
 v_cvt_pk_bf16_f32 v31, v106, v107
 buffer_store_dwordx4 v[28:31], v1, s[8:11], s39 offen sc1
 v_pk_add_f32 v[108:109], v[108:109], v[232:233]
 v_cvt_pk_bf16_f32 v32, v108, v109
 v_pk_add_f32 v[110:111], v[110:111], v[234:235]
 v_cvt_pk_bf16_f32 v33, v110, v111
 v_pk_add_f32 v[112:113], v[112:113], v[236:237]
 v_cvt_pk_bf16_f32 v34, v112, v113
 v_pk_add_f32 v[114:115], v[114:115], v[238:239]
 v_cvt_pk_bf16_f32 v35, v114, v115
 buffer_store_dwordx4 v[32:35], v1, s[8:11], s39 offen offset:1024 sc1
 v_pk_add_f32 v[116:117], v[116:117], v[240:241]
 v_cvt_pk_bf16_f32 v36, v116, v117
 v_pk_add_f32 v[118:119], v[118:119], v[242:243]
 v_cvt_pk_bf16_f32 v37, v118, v119
 buffer_store_dwordx2 v[36:37], v8, s[8:11], s39 offen offset:2048 sc1
 v_mov_b32 v254, 0x3f803f80
 v_dot2_f32_bf16 v252, v28, v254, 0
 v_dot2_f32_bf16 v253, v28, v28, 0
 v_dot2_f32_bf16 v252, v29, v254, v252
 v_dot2_f32_bf16 v253, v29, v29, v253
 v_dot2_f32_bf16 v252, v30, v254, v252
 v_dot2_f32_bf16 v253, v30, v30, v253
 v_dot2_f32_bf16 v252, v31, v254, v252
 v_dot2_f32_bf16 v253, v31, v31, v253
 v_dot2_f32_bf16 v252, v32, v254, v252
 v_dot2_f32_bf16 v253, v32, v32, v253
 v_dot2_f32_bf16 v252, v33, v254, v252
 v_dot2_f32_bf16 v253, v33, v33, v253
 v_dot2_f32_bf16 v252, v34, v254, v252
 v_dot2_f32_bf16 v253, v34, v34, v253
 v_dot2_f32_bf16 v252, v35, v254, v252
 v_dot2_f32_bf16 v253, v35, v35, v253
 v_dot2_f32_bf16 v252, v36, v254, v252
 v_dot2_f32_bf16 v253, v36, v36, v253
 v_dot2_f32_bf16 v252, v37, v254, v252
 v_dot2_f32_bf16 v253, v37, v37, v253
 s_nop 2
 v_permlane32_swap_b32 v252, v253
 v_add_f32 v252, v252, v253
 v_mov_b32 v254, v252
 s_nop 1
 v_permlane16_swap_b32 v252, v254
 v_add_f32 v252, v252, v254
 v_and_b32 v252, -2, v252
 buffer_store_dword v252, v9, s[8:11], s40 offen sc1
 v_mov_b32 v27, 1
 s_waitcnt vmcnt(1)
 s_mov_b64 exec, 1
 buffer_store_dword v27, off, s[8:11], s44 sc1
 s_mov_b64 exec, -1
 v_and_b32 v230, 124, v22
 buffer_load_dword v231, v230, s[8:11], s45 offen sc1
sspin_11:
 buffer_load_dword v0, v230, s[8:11], s45 offen sc1
 s_waitcnt vmcnt(1)
 v_cmp_gt_u32 vcc, 1, v231
 s_cbranch_vccz sok_12
 buffer_load_dword v231, v230, s[8:11], s45 offen sc1
 s_waitcnt vmcnt(1)
 v_cmp_gt_u32 vcc, 1, v0
 s_cbranch_vccz sok_12
 s_add_u32 s29, s29, 1
 s_cmp_lt_u32 s29, 524288
 s_cbranch_scc1 sspin_11
sok_12:
 buffer_load_dwordx4 v[104:107], v4, s[8:11], 0 offen sc1
 buffer_load_dwordx4 v[108:111], v4, s[8:11], s69 offen sc1
 buffer_load_dwordx4 v[112:115], v4, s[8:11], 0 offen offset:1024 sc1
 buffer_load_dwordx4 v[116:119], v4, s[8:11], s69 offen offset:1024 sc1
 buffer_load_dwordx4 v[120:123], v4, s[8:11], 0 offen offset:2048 sc1
 buffer_load_dwordx4 v[124:127], v4, s[8:11], s69 offen offset:2048 sc1
 buffer_load_dwordx4 v[128:131], v4, s[8:11], 0 offen offset:3072 sc1
 buffer_load_dwordx4 v[132:135], v4, s[8:11], s69 offen offset:3072 sc1
 buffer_load_dwordx4 v[136:139], v4, s[8:11], s65 offen sc1
 buffer_load_dwordx4 v[140:143], v4, s[8:11], s70 offen sc1
 v_add_u32 v25, 81920, v1
 v_add_u32 v26, 122880, v1
 s_barrier
 ds_read_b128 v[152:155], v25
 ds_read_b128 v[156:159], v25 offset:1024
 ds_read_b128 v[160:163], v25 offset:2048
 ds_read_b128 v[164:167], v25 offset:3072
 s_mov_b32 s92, 0xffff0000
 s_mov_b32 s93, 0
 s_mov_b32 s94, -1
 s_mov_b32 s95, 0
 s_waitcnt lgkmcnt(2)
 s_waitcnt vmcnt(9)
 v_mfma_f32_16x16x32_bf16 v[40:43], v[152:155], v[104:107], 0
 s_waitcnt vmcnt(8)
 ds_read_b128 v[168:171], v25 offset:4096
 v_mfma_f32_16x16x32_bf16 v[56:59], v[152:155], v[108:111], 0
 ds_read_b128 v[172:175], v25 offset:5120
 ds_read_b128 v[176:179], v25 offset:6144
 buffer_load_dwordx4 v[208:211], v1, s[8:11], s16 offen sc1
 buffer_load_dwordx4 v[144:147], v4, s[8:11], s65 offen offset:1024 sc1
 v_mfma_f32_16x16x32_bf16 v[44:47], v[156:159], v[104:107], 0
 ds_read_b128 v[180:183], v25 offset:7168
 v_and_b32 v228, 0x3c, v22
 v_mfma_f32_16x16x32_bf16 v[60:63], v[156:159], v[108:111], 0
 s_waitcnt lgkmcnt(4)
 v_mov_b32 v185, 0
 v_mfma_f32_16x16x32_bf16 v[48:51], v[160:163], v[104:107], 0
 ds_read_b128 v[152:155], v25 offset:8192
 v_mfma_f32_16x16x32_bf16 v[64:67], v[160:163], v[108:111], 0
 buffer_load_dwordx4 v[212:215], v1, s[8:11], s16 offen offset:1024 sc1
 buffer_load_dwordx4 v[148:151], v4, s[8:11], s70 offen offset:1024 sc1
 v_mfma_f32_16x16x32_bf16 v[52:55], v[164:167], v[104:107], 0
 ds_read_b128 v[156:159], v25 offset:9216
 v_mov_b32 v186, 0
 v_mfma_f32_16x16x32_bf16 v[68:71], v[164:167], v[108:111], 0
 s_waitcnt vmcnt(11) lgkmcnt(4)
 v_mfma_f32_16x16x32_bf16 v[40:43], v[168:171], v[112:115], v[40:43]
 s_waitcnt vmcnt(10)
 ds_read_b128 v[160:163], v25 offset:10240
 v_mov_b32 v187, 0
 v_mfma_f32_16x16x32_bf16 v[56:59], v[168:171], v[116:119], v[56:59]
 buffer_load_dwordx4 v[216:219], v1, s[8:11], s16 offen offset:2048 sc1
 buffer_load_dwordx4 v[104:107], v4, s[8:11], s65 offen offset:2048 sc1
 v_mfma_f32_16x16x32_bf16 v[44:47], v[172:175], v[112:115], v[44:47]
 ds_read_b128 v[164:167], v25 offset:11264
 v_mfma_f32_16x16x32_bf16 v[60:63], v[172:175], v[116:119], v[60:63]
 s_waitcnt lgkmcnt(4)
 v_mov_b32 v189, 0
 v_mfma_f32_16x16x32_bf16 v[48:51], v[176:179], v[112:115], v[48:51]
 ds_read_b128 v[168:171], v25 offset:12288
 v_mfma_f32_16x16x32_bf16 v[64:67], v[176:179], v[116:119], v[64:67]
 buffer_load_dwordx4 v[220:223], v1, s[8:11], s16 offen offset:3072 sc1
 buffer_load_dwordx4 v[108:111], v4, s[8:11], s70 offen offset:2048 sc1
 v_mfma_f32_16x16x32_bf16 v[52:55], v[180:183], v[112:115], v[52:55]
 ds_read_b128 v[172:175], v25 offset:13312
 v_mov_b32 v190, 0
 v_mfma_f32_16x16x32_bf16 v[68:71], v[180:183], v[116:119], v[68:71]
 s_waitcnt vmcnt(13) lgkmcnt(4)
 v_mov_b32 v191, 0
 v_mfma_f32_16x16x32_bf16 v[40:43], v[152:155], v[120:123], v[40:43]
 s_waitcnt vmcnt(12)
 ds_read_b128 v[176:179], v25 offset:14336
 v_mfma_f32_16x16x32_bf16 v[56:59], v[152:155], v[124:127], v[56:59]
 buffer_load_dwordx4 v[112:115], v4, s[8:11], s65 offen offset:3072 sc1
 v_mov_b32 v193, 0
 v_mfma_f32_16x16x32_bf16 v[44:47], v[156:159], v[120:123], v[44:47]
 ds_read_b128 v[180:183], v25 offset:15360
 v_mfma_f32_16x16x32_bf16 v[60:63], v[156:159], v[124:127], v[60:63]
 s_waitcnt lgkmcnt(4)
 v_mov_b32 v194, 0
 v_mfma_f32_16x16x32_bf16 v[48:51], v[160:163], v[120:123], v[48:51]
 ds_read_b128 v[152:155], v25 offset:16384
 v_mfma_f32_16x16x32_bf16 v[64:67], v[160:163], v[124:127], v[64:67]
 buffer_load_dwordx4 v[116:119], v4, s[8:11], s70 offen offset:3072 sc1
 v_mov_b32 v195, 0
 v_mfma_f32_16x16x32_bf16 v[52:55], v[164:167], v[120:123], v[52:55]
 ds_read_b128 v[156:159], v25 offset:17408
 v_mfma_f32_16x16x32_bf16 v[68:71], v[164:167], v[124:127], v[68:71]
 s_waitcnt vmcnt(13) lgkmcnt(4)
 v_mov_b32 v197, 0
 v_mfma_f32_16x16x32_bf16 v[40:43], v[168:171], v[128:131], v[40:43]
 s_waitcnt vmcnt(12)
 ds_read_b128 v[160:163], v25 offset:18432
 v_mfma_f32_16x16x32_bf16 v[56:59], v[168:171], v[132:135], v[56:59]
 buffer_load_dwordx4 v[120:123], v4, s[8:11], s66 offen sc1
 v_mov_b32 v198, 0
 v_mfma_f32_16x16x32_bf16 v[44:47], v[172:175], v[128:131], v[44:47]
 ds_read_b128 v[164:167], v25 offset:19456
 v_mfma_f32_16x16x32_bf16 v[60:63], v[172:175], v[132:135], v[60:63]
 s_waitcnt lgkmcnt(4)
 v_mov_b32 v199, 0
 v_mfma_f32_16x16x32_bf16 v[48:51], v[176:179], v[128:131], v[48:51]
 ds_read_b128 v[168:171], v25 offset:20480
 v_mfma_f32_16x16x32_bf16 v[64:67], v[176:179], v[132:135], v[64:67]
 buffer_load_dwordx4 v[124:127], v4, s[8:11], s71 offen sc1
 v_mov_b32 v201, 0
 v_mfma_f32_16x16x32_bf16 v[52:55], v[180:183], v[128:131], v[52:55]
 ds_read_b128 v[172:175], v25 offset:21504
 v_mfma_f32_16x16x32_bf16 v[68:71], v[180:183], v[132:135], v[68:71]
 s_waitcnt vmcnt(13) lgkmcnt(4)
 v_mov_b32 v202, 0
 v_mfma_f32_16x16x32_bf16 v[40:43], v[152:155], v[136:139], v[40:43]
 s_waitcnt vmcnt(12)
 ds_read_b128 v[176:179], v25 offset:22528
 v_mfma_f32_16x16x32_bf16 v[56:59], v[152:155], v[140:143], v[56:59]
 buffer_load_dwordx4 v[128:131], v4, s[8:11], s66 offen offset:1024 sc1
 v_mov_b32 v203, 0
 v_mfma_f32_16x16x32_bf16 v[44:47], v[156:159], v[136:139], v[44:47]
 ds_read_b128 v[180:183], v25 offset:23552
 v_mfma_f32_16x16x32_bf16 v[60:63], v[156:159], v[140:143], v[60:63]
 s_waitcnt lgkmcnt(4)
 v_mov_b32 v205, 0
 v_mfma_f32_16x16x32_bf16 v[48:51], v[160:163], v[136:139], v[48:51]
 ds_read_b128 v[152:155], v25 offset:24576
 v_mfma_f32_16x16x32_bf16 v[64:67], v[160:163], v[140:143], v[64:67]
 buffer_load_dwordx4 v[132:135], v4, s[8:11], s71 offen offset:1024 sc1
 v_mov_b32 v206, 0
 v_mfma_f32_16x16x32_bf16 v[52:55], v[164:167], v[136:139], v[52:55]
 ds_read_b128 v[156:159], v25 offset:25600
 v_mfma_f32_16x16x32_bf16 v[68:71], v[164:167], v[140:143], v[68:71]
 s_waitcnt vmcnt(12) lgkmcnt(4)
 v_mov_b32 v207, 0
 v_mfma_f32_16x16x32_bf16 v[40:43], v[168:171], v[144:147], v[40:43]
 s_waitcnt vmcnt(10)
 ds_read_b128 v[160:163], v25 offset:26624
 v_mfma_f32_16x16x32_bf16 v[56:59], v[168:171], v[148:151], v[56:59]
 buffer_load_dwordx4 v[136:139], v4, s[8:11], s66 offen offset:2048 sc1
 v_mfma_f32_16x16x32_bf16 v[44:47], v[172:175], v[144:147], v[44:47]
 ds_read_b128 v[164:167], v25 offset:27648
 v_mfma_f32_16x16x32_bf16 v[60:63], v[172:175], v[148:151], v[60:63]
 s_waitcnt lgkmcnt(4)
 v_mfma_f32_16x16x32_bf16 v[48:51], v[176:179], v[144:147], v[48:51]
 ds_read_b128 v[168:171], v25 offset:28672
 v_mfma_f32_16x16x32_bf16 v[64:67], v[176:179], v[148:151], v[64:67]
 buffer_load_dwordx4 v[140:143], v4, s[8:11], s71 offen offset:2048 sc1
 v_mfma_f32_16x16x32_bf16 v[52:55], v[180:183], v[144:147], v[52:55]
 ds_read_b128 v[172:175], v25 offset:29696
 v_mfma_f32_16x16x32_bf16 v[68:71], v[180:183], v[148:151], v[68:71]
 s_waitcnt vmcnt(10) lgkmcnt(4)
 v_mfma_f32_16x16x32_bf16 v[40:43], v[152:155], v[104:107], v[40:43]
 s_waitcnt vmcnt(8)
 ds_read_b128 v[176:179], v25 offset:30720
 v_mfma_f32_16x16x32_bf16 v[56:59], v[152:155], v[108:111], v[56:59]
 buffer_load_dwordx4 v[144:147], v4, s[8:11], s66 offen offset:3072 sc1
 v_mfma_f32_16x16x32_bf16 v[44:47], v[156:159], v[104:107], v[44:47]
 ds_read_b128 v[180:183], v25 offset:31744
 v_mfma_f32_16x16x32_bf16 v[60:63], v[156:159], v[108:111], v[60:63]
 s_waitcnt lgkmcnt(4)
 v_mfma_f32_16x16x32_bf16 v[48:51], v[160:163], v[104:107], v[48:51]
 ds_read_b128 v[152:155], v25 offset:32768
 v_mfma_f32_16x16x32_bf16 v[64:67], v[160:163], v[108:111], v[64:67]
 buffer_load_dwordx4 v[148:151], v4, s[8:11], s71 offen offset:3072 sc1
 v_mfma_f32_16x16x32_bf16 v[52:55], v[164:167], v[104:107], v[52:55]
 ds_read_b128 v[156:159], v25 offset:33792
 v_mfma_f32_16x16x32_bf16 v[68:71], v[164:167], v[108:111], v[68:71]
 s_waitcnt vmcnt(9) lgkmcnt(4)
 v_mfma_f32_16x16x32_bf16 v[40:43], v[168:171], v[112:115], v[40:43]
 s_waitcnt vmcnt(8)
 ds_read_b128 v[160:163], v25 offset:34816
 v_or_b32 v229, v208, v209
 v_mfma_f32_16x16x32_bf16 v[56:59], v[168:171], v[116:119], v[56:59]
 buffer_load_dwordx4 v[104:107], v4, s[8:11], s67 offen sc1
 v_or3_b32 v229, v229, v210, v211
 v_mfma_f32_16x16x32_bf16 v[44:47], v[172:175], v[112:115], v[44:47]
 ds_read_b128 v[164:167], v25 offset:35840
 v_or3_b32 v229, v229, v212, v213
 v_mfma_f32_16x16x32_bf16 v[60:63], v[172:175], v[116:119], v[60:63]
 s_waitcnt lgkmcnt(4)
 v_or3_b32 v229, v229, v214, v215
 v_or3_b32 v229, v229, v216, v217
 v_or3_b32 v229, v229, v218, v219
 v_mfma_f32_16x16x32_bf16 v[48:51], v[176:179], v[112:115], v[48:51]
 ds_read_b128 v[168:171], v25 offset:36864
 v_or3_b32 v229, v229, v220, v221
 v_mfma_f32_16x16x32_bf16 v[64:67], v[176:179], v[116:119], v[64:67]
 buffer_load_dwordx4 v[108:111], v4, s[8:11], s72 offen sc1
 v_or3_b32 v229, v229, v222, v223
 v_mfma_f32_16x16x32_bf16 v[52:55], v[180:183], v[112:115], v[52:55]
 ds_read_b128 v[172:175], v25 offset:37888
 v_and_b32 v229, 1, v229
 v_mfma_f32_16x16x32_bf16 v[68:71], v[180:183], v[116:119], v[68:71]
 v_cmp_ne_u32 vcc, 0, v229
 s_cbranch_vccnz sretry_13
sback_14:
 v_add_f32 v208, v208, v209
 s_waitcnt lgkmcnt(4)
 s_waitcnt vmcnt(9)
 v_mfma_f32_16x16x32_bf16 v[40:43], v[152:155], v[120:123], v[40:43]
 s_waitcnt vmcnt(8)
 ds_read_b128 v[176:179], v25 offset:38912
 v_add_f32 v212, v212, v213
 v_mfma_f32_16x16x32_bf16 v[56:59], v[152:155], v[124:127], v[56:59]
 buffer_load_dwordx4 v[112:115], v4, s[8:11], s67 offen offset:1024 sc1
 v_add_f32 v210, v210, v211
 v_mfma_f32_16x16x32_bf16 v[44:47], v[156:159], v[120:123], v[44:47]
 ds_read_b128 v[180:183], v25 offset:39936
 v_add_f32 v214, v214, v215
 v_mfma_f32_16x16x32_bf16 v[60:63], v[156:159], v[124:127], v[60:63]
 s_waitcnt lgkmcnt(4)
 v_add_f32 v210, v210, v208
 v_add_f32 v214, v214, v212
 v_mfma_f32_16x16x32_bf16 v[48:51], v[160:163], v[120:123], v[48:51]
 ds_read_b128 v[152:155], v26
 v_mov_b32 v211, v210
 v_mfma_f32_16x16x32_bf16 v[64:67], v[160:163], v[124:127], v[64:67]
 buffer_load_dwordx4 v[116:119], v4, s[8:11], s72 offen offset:1024 sc1
 v_mov_b32 v215, v214
 v_mfma_f32_16x16x32_bf16 v[52:55], v[164:167], v[120:123], v[52:55]
 ds_read_b128 v[156:159], v26 offset:1024
 v_permlane16_swap_b32 v210, v211
 v_mfma_f32_16x16x32_bf16 v[68:71], v[164:167], v[124:127], v[68:71]
 s_waitcnt vmcnt(9) lgkmcnt(4)
 v_permlane16_swap_b32 v214, v215
 v_mfma_f32_16x16x32_bf16 v[40:43], v[168:171], v[128:131], v[40:43]
 s_waitcnt vmcnt(8)
 ds_read_b128 v[160:163], v26 offset:2048
 v_add_f32 v210, v210, v211
 v_mfma_f32_16x16x32_bf16 v[56:59], v[168:171], v[132:135], v[56:59]
 buffer_load_dwordx4 v[120:123], v4, s[8:11], s67 offen offset:2048 sc1
 v_add_f32 v214, v214, v215
 v_mfma_f32_16x16x32_bf16 v[44:47], v[172:175], v[128:131], v[44:47]
 ds_read_b128 v[164:167], v26 offset:3072
 v_mov_b32 v211, v210
 v_mfma_f32_16x16x32_bf16 v[60:63], v[172:175], v[132:135], v[60:63]
 s_waitcnt lgkmcnt(4)
 v_mov_b32 v215, v214
 v_permlane32_swap_b32 v210, v211
 v_mfma_f32_16x16x32_bf16 v[48:51], v[176:179], v[128:131], v[48:51]
 ds_read_b128 v[168:171], v26 offset:4096
 v_mfma_f32_16x16x32_bf16 v[64:67], v[176:179], v[132:135], v[64:67]
 buffer_load_dwordx4 v[124:127], v4, s[8:11], s72 offen offset:2048 sc1
 v_permlane32_swap_b32 v214, v215
 v_mfma_f32_16x16x32_bf16 v[52:55], v[180:183], v[128:131], v[52:55]
 ds_read_b128 v[172:175], v26 offset:5120
 v_mul_f32 v209, 0xbacccccd, v210
 v_mfma_f32_16x16x32_bf16 v[68:71], v[180:183], v[132:135], v[68:71]
 s_waitcnt vmcnt(9) lgkmcnt(4)
 v_mul_f32 v213, 0xbacccccd, v214
 v_mul_f32 v210, v209, v209
 v_mfma_f32_16x16x32_bf16 v[40:43], v[152:155], v[136:139], v[40:43]
 s_waitcnt vmcnt(8)
 ds_read_b128 v[176:179], v26 offset:6144
 v_mul_f32 v214, v213, v213
 v_mfma_f32_16x16x32_bf16 v[56:59], v[152:155], v[140:143], v[56:59]
 buffer_load_dwordx4 v[128:131], v4, s[8:11], s67 offen offset:3072 sc1
 v_fmac_f32 v210, 0xbacccccd, v211
 v_mfma_f32_16x16x32_bf16 v[44:47], v[156:159], v[136:139], v[44:47]
 ds_read_b128 v[180:183], v26 offset:7168
 v_fmac_f32 v214, 0xbacccccd, v215
 v_mfma_f32_16x16x32_bf16 v[60:63], v[156:159], v[140:143], v[60:63]
 s_waitcnt lgkmcnt(4)
 v_min_f32 v210, 0, v210
 v_min_f32 v214, 0, v214
 v_mfma_f32_16x16x32_bf16 v[48:51], v[160:163], v[136:139], v[48:51]
 ds_read_b128 v[152:155], v26 offset:8192
 v_sub_f32 v210, 0x3727c5ac, v210
 v_sub_f32 v214, 0x3727c5ac, v214
 v_mfma_f32_16x16x32_bf16 v[64:67], v[160:163], v[140:143], v[64:67]
 buffer_load_dwordx4 v[132:135], v4, s[8:11], s72 offen offset:3072 sc1
 v_mfma_f32_16x16x32_bf16 v[52:55], v[164:167], v[136:139], v[52:55]
 ds_read_b128 v[156:159], v26 offset:9216
 v_rsq_f32 v208, v210
 v_mfma_f32_16x16x32_bf16 v[68:71], v[164:167], v[140:143], v[68:71]
 s_waitcnt vmcnt(9) lgkmcnt(4)
 v_rsq_f32 v212, v214
 v_mfma_f32_16x16x32_bf16 v[40:43], v[168:171], v[144:147], v[40:43]
 s_waitcnt vmcnt(8)
 ds_read_b128 v[160:163], v26 offset:10240
 v_cvt_pk_bf16_f32 v210, v209, v209
 v_mfma_f32_16x16x32_bf16 v[56:59], v[168:171], v[148:151], v[56:59]
 buffer_load_dwordx4 v[136:139], v4, s[8:11], s68 offen sc1
 v_cvt_pk_bf16_f32 v214, v213, v213
 v_mfma_f32_16x16x32_bf16 v[44:47], v[172:175], v[144:147], v[44:47]
 ds_read_b128 v[164:167], v26 offset:11264
 v_and_b32 v210, 0xffff0000, v210
 v_mfma_f32_16x16x32_bf16 v[60:63], v[172:175], v[148:151], v[60:63]
 s_waitcnt lgkmcnt(4)
 v_and_b32 v214, 0xffff0000, v214
 v_cndmask_b32 v210, 0, v210, s[92:93]
 v_mfma_f32_16x16x32_bf16 v[48:51], v[176:179], v[144:147], v[48:51]
 ds_read_b128 v[168:171], v26 offset:12288
 v_cndmask_b32 v214, 0, v214, s[92:93]
 v_sub_f32 v210, v209, v210
 v_mfma_f32_16x16x32_bf16 v[64:67], v[176:179], v[148:151], v[64:67]
 buffer_load_dwordx4 v[140:143], v4, s[8:11], s73 offen sc1
 v_sub_f32 v214, v213, v214
 v_mfma_f32_16x16x32_bf16 v[52:55], v[180:183], v[144:147], v[52:55]
 ds_read_b128 v[172:175], v26 offset:13312
 v_cndmask_b32 v210, 0, v210, s[94:95]
 v_mfma_f32_16x16x32_bf16 v[68:71], v[180:183], v[148:151], v[68:71]
 s_waitcnt vmcnt(9) lgkmcnt(4)
 v_cndmask_b32 v214, 0, v214, s[94:95]
 v_cvt_pk_bf16_f32 v184, v210, v210
 v_mfma_f32_16x16x32_bf16 v[40:43], v[152:155], v[104:107], v[40:43]
 s_waitcnt vmcnt(8)
 ds_read_b128 v[176:179], v26 offset:14336
 v_cvt_pk_bf16_f32 v188, v214, v214
 v_mfma_f32_16x16x32_bf16 v[56:59], v[152:155], v[108:111], v[56:59]
 buffer_load_dwordx4 v[144:147], v4, s[8:11], s68 offen offset:1024 sc1
 v_cndmask_b32 v209, 1.0, v208, s[92:93]
 v_mfma_f32_16x16x32_bf16 v[44:47], v[156:159], v[104:107], v[44:47]
 ds_read_b128 v[180:183], v26 offset:15360
 v_cndmask_b32 v213, 1.0, v212, s[92:93]
 v_mfma_f32_16x16x32_bf16 v[60:63], v[156:159], v[108:111], v[60:63]
 s_waitcnt lgkmcnt(4)
 v_add_f32 v216, v216, v217
 v_add_f32 v220, v220, v221
 v_mfma_f32_16x16x32_bf16 v[48:51], v[160:163], v[104:107], v[48:51]
 ds_read_b128 v[152:155], v26 offset:16384
 v_add_f32 v218, v218, v219
 v_add_f32 v222, v222, v223
 v_mfma_f32_16x16x32_bf16 v[64:67], v[160:163], v[108:111], v[64:67]
 buffer_load_dwordx4 v[148:151], v4, s[8:11], s73 offen offset:1024 sc1
 v_add_f32 v218, v218, v216
 v_mfma_f32_16x16x32_bf16 v[52:55], v[164:167], v[104:107], v[52:55]
 ds_read_b128 v[156:159], v26 offset:17408
 v_add_f32 v222, v222, v220
 v_mfma_f32_16x16x32_bf16 v[68:71], v[164:167], v[108:111], v[68:71]
 s_waitcnt vmcnt(9) lgkmcnt(4)
 v_mov_b32 v219, v218
 v_mov_b32 v223, v222
 v_mfma_f32_16x16x32_bf16 v[40:43], v[168:171], v[112:115], v[40:43]
 s_waitcnt vmcnt(8)
 ds_read_b128 v[160:163], v26 offset:18432
 v_permlane16_swap_b32 v218, v219
 v_mfma_f32_16x16x32_bf16 v[56:59], v[168:171], v[116:119], v[56:59]
 buffer_load_dwordx4 v[104:107], v4, s[8:11], s68 offen offset:2048 sc1
 v_mfma_f32_16x16x32_bf16 v[44:47], v[172:175], v[112:115], v[44:47]
 ds_read_b128 v[164:167], v26 offset:19456
 v_permlane16_swap_b32 v222, v223
 v_mfma_f32_16x16x32_bf16 v[60:63], v[172:175], v[116:119], v[60:63]
 s_waitcnt lgkmcnt(4)
 v_add_f32 v218, v218, v219
 v_add_f32 v222, v222, v223
 v_mfma_f32_16x16x32_bf16 v[48:51], v[176:179], v[112:115], v[48:51]
 ds_read_b128 v[168:171], v26 offset:20480
 v_mov_b32 v219, v218
 v_mfma_f32_16x16x32_bf16 v[64:67], v[176:179], v[116:119], v[64:67]
 buffer_load_dwordx4 v[108:111], v4, s[8:11], s73 offen offset:2048 sc1
 v_mov_b32 v223, v222
 v_mfma_f32_16x16x32_bf16 v[52:55], v[180:183], v[112:115], v[52:55]
 ds_read_b128 v[172:175], v26 offset:21504
 v_mfma_f32_16x16x32_bf16 v[68:71], v[180:183], v[116:119], v[68:71]
 s_waitcnt vmcnt(9) lgkmcnt(4)
 v_permlane32_swap_b32 v218, v219
 v_permlane32_swap_b32 v222, v223
 v_mfma_f32_16x16x32_bf16 v[40:43], v[152:155], v[120:123], v[40:43]
 s_waitcnt vmcnt(8)
 ds_read_b128 v[176:179], v26 offset:22528
 v_mfma_f32_16x16x32_bf16 v[56:59], v[152:155], v[124:127], v[56:59]
 buffer_load_dwordx4 v[112:115], v4, s[8:11], s68 offen offset:3072 sc1
 v_mul_f32 v217, 0xbacccccd, v218
 v_mfma_f32_16x16x32_bf16 v[44:47], v[156:159], v[120:123], v[44:47]
 ds_read_b128 v[180:183], v26 offset:23552
 v_mul_f32 v221, 0xbacccccd, v222
 v_mfma_f32_16x16x32_bf16 v[60:63], v[156:159], v[124:127], v[60:63]
 s_waitcnt lgkmcnt(4)
 v_mul_f32 v218, v217, v217
 v_mul_f32 v222, v221, v221
 v_fmac_f32 v218, 0xbacccccd, v219
 v_mfma_f32_16x16x32_bf16 v[48:51], v[160:163], v[120:123], v[48:51]
 ds_read_b128 v[152:155], v26 offset:24576
 v_fmac_f32 v222, 0xbacccccd, v223
 v_mfma_f32_16x16x32_bf16 v[64:67], v[160:163], v[124:127], v[64:67]
 buffer_load_dwordx4 v[116:119], v4, s[8:11], s73 offen offset:3072 sc1
 v_min_f32 v218, 0, v218
 v_mfma_f32_16x16x32_bf16 v[52:55], v[164:167], v[120:123], v[52:55]
 ds_read_b128 v[156:159], v26 offset:25600
 v_min_f32 v222, 0, v222
 v_mfma_f32_16x16x32_bf16 v[68:71], v[164:167], v[124:127], v[68:71]
 s_waitcnt vmcnt(9) lgkmcnt(4)
 v_sub_f32 v218, 0x3727c5ac, v218
 v_sub_f32 v222, 0x3727c5ac, v222
 v_mfma_f32_16x16x32_bf16 v[40:43], v[168:171], v[128:131], v[40:43]
 s_waitcnt vmcnt(8)
 ds_read_b128 v[160:163], v26 offset:26624
 v_rsq_f32 v216, v218
 v_mfma_f32_16x16x32_bf16 v[56:59], v[168:171], v[132:135], v[56:59]
 buffer_load_dwordx4 v[120:123], v5, s[8:11], 0 offen sc1
 v_mfma_f32_16x16x32_bf16 v[44:47], v[172:175], v[128:131], v[44:47]
 ds_read_b128 v[164:167], v26 offset:27648
 v_rsq_f32 v220, v222
 v_mfma_f32_16x16x32_bf16 v[60:63], v[172:175], v[132:135], v[60:63]
 s_waitcnt lgkmcnt(4)
 v_cvt_pk_bf16_f32 v218, v217, v217
 v_cvt_pk_bf16_f32 v222, v221, v221
 v_mfma_f32_16x16x32_bf16 v[48:51], v[176:179], v[128:131], v[48:51]
 ds_read_b128 v[168:171], v26 offset:28672
 v_and_b32 v218, 0xffff0000, v218
 v_mfma_f32_16x16x32_bf16 v[64:67], v[176:179], v[132:135], v[64:67]
 buffer_load_dwordx4 v[124:127], v5, s[8:11], s69 offen sc1
 v_and_b32 v222, 0xffff0000, v222
 v_mfma_f32_16x16x32_bf16 v[52:55], v[180:183], v[128:131], v[52:55]
 ds_read_b128 v[172:175], v26 offset:29696
 v_cndmask_b32 v218, 0, v218, s[92:93]
 v_mfma_f32_16x16x32_bf16 v[68:71], v[180:183], v[132:135], v[68:71]
 s_waitcnt vmcnt(9) lgkmcnt(4)
 v_cndmask_b32 v222, 0, v222, s[92:93]
 v_sub_f32 v218, v217, v218
 v_mfma_f32_16x16x32_bf16 v[40:43], v[152:155], v[136:139], v[40:43]
 s_waitcnt vmcnt(8)
 ds_read_b128 v[176:179], v26 offset:30720
 v_sub_f32 v222, v221, v222
 v_mfma_f32_16x16x32_bf16 v[56:59], v[152:155], v[140:143], v[56:59]
 buffer_load_dwordx4 v[128:131], v5, s[8:11], 0 offen offset:1024 sc1
 ds_read_b32 v200, v228
 v_mfma_f32_16x16x32_bf16 v[44:47], v[156:159], v[136:139], v[44:47]
 ds_read_b128 v[180:183], v26 offset:31744
 v_cndmask_b32 v218, 0, v218, s[94:95]
 v_cndmask_b32 v222, 0, v222, s[94:95]
 v_mfma_f32_16x16x32_bf16 v[60:63], v[156:159], v[140:143], v[60:63]
 s_waitcnt lgkmcnt(5)
 v_cvt_pk_bf16_f32 v192, v218, v218
 v_cvt_pk_bf16_f32 v196, v222, v222
 v_mfma_f32_16x16x32_bf16 v[48:51], v[160:163], v[136:139], v[48:51]
 ds_read_b128 v[152:155], v26 offset:32768
 v_cndmask_b32 v217, 1.0, v216, s[92:93]
 v_mfma_f32_16x16x32_bf16 v[64:67], v[160:163], v[140:143], v[64:67]
 buffer_load_dwordx4 v[132:135], v5, s[8:11], s69 offen offset:1024 sc1
 v_cndmask_b32 v221, 1.0, v220, s[92:93]
 v_mfma_f32_16x16x32_bf16 v[52:55], v[164:167], v[136:139], v[52:55]
 ds_read_b128 v[156:159], v26 offset:33792
 v_mfma_f32_16x16x32_bf16 v[68:71], v[164:167], v[140:143], v[68:71]
 s_waitcnt lgkmcnt(3)
 v_mfma_f32_16x16x32_bf16 v[40:43], v[200:203], v[184:187], v[40:43]
 s_mov_b32 s93, 0xffff0000
 v_mfma_f32_16x16x32_bf16 v[56:59], v[200:203], v[188:191], v[56:59]
 v_cndmask_b32 v225, v208, v212, s[92:93]
 v_mfma_f32_16x16x32_bf16 v[72:75], v[200:203], v[192:195], 0
 v_mfma_f32_16x16x32_bf16 v[88:91], v[200:203], v[196:199], 0
 s_waitcnt vmcnt(9)
 v_mul_f32 v225, 0x3fb8aa3b, v225
 v_mfma_f32_16x16x32_bf16 v[40:43], v[168:171], v[144:147], v[40:43]
 s_waitcnt vmcnt(8)
 ds_read_b128 v[160:163], v26 offset:34816
 v_mfma_f32_16x16x32_bf16 v[56:59], v[168:171], v[148:151], v[56:59]
 buffer_load_dwordx4 v[136:139], v5, s[8:11], 0 offen offset:2048 sc1
 ds_read_b32 v204, v228 offset:64
 v_mfma_f32_16x16x32_bf16 v[44:47], v[172:175], v[144:147], v[44:47]
 ds_read_b128 v[164:167], v26 offset:35840
 v_mfma_f32_16x16x32_bf16 v[60:63], v[172:175], v[148:151], v[60:63]
 s_waitcnt lgkmcnt(5)
 v_cndmask_b32 v227, v216, v220, s[92:93]
 v_mfma_f32_16x16x32_bf16 v[48:51], v[176:179], v[144:147], v[48:51]
 ds_read_b128 v[168:171], v26 offset:36864
 v_mfma_f32_16x16x32_bf16 v[64:67], v[176:179], v[148:151], v[64:67]
 buffer_load_dwordx4 v[140:143], v5, s[8:11], s69 offen offset:2048 sc1
 v_mfma_f32_16x16x32_bf16 v[52:55], v[180:183], v[144:147], v[52:55]
 ds_read_b128 v[172:175], v26 offset:37888
 v_mfma_f32_16x16x32_bf16 v[68:71], v[180:183], v[148:151], v[68:71]
 s_waitcnt lgkmcnt(3)
 v_mul_f32 v227, 0x3fb8aa3b, v227
 v_mfma_f32_16x16x32_bf16 v[44:47], v[204:207], v[184:187], v[44:47]
 v_mfma_f32_16x16x32_bf16 v[60:63], v[204:207], v[188:191], v[60:63]
 v_mfma_f32_16x16x32_bf16 v[76:79], v[204:207], v[192:195], 0
 v_mfma_f32_16x16x32_bf16 v[92:95], v[204:207], v[196:199], 0
 s_waitcnt vmcnt(9)
 v_mfma_f32_16x16x32_bf16 v[40:43], v[152:155], v[104:107], v[40:43]
 s_waitcnt vmcnt(8)
 ds_read_b128 v[176:179], v26 offset:38912
 v_mfma_f32_16x16x32_bf16 v[56:59], v[152:155], v[108:111], v[56:59]
 buffer_load_dwordx4 v[144:147], v5, s[8:11], 0 offen offset:3072 sc1
 ds_read_b32 v200, v228 offset:128
 v_mfma_f32_16x16x32_bf16 v[44:47], v[156:159], v[104:107], v[44:47]
 ds_read_b128 v[180:183], v26 offset:39936
 v_mfma_f32_16x16x32_bf16 v[60:63], v[156:159], v[108:111], v[60:63]
 s_waitcnt lgkmcnt(5)
 v_mfma_f32_16x16x32_bf16 v[48:51], v[160:163], v[104:107], v[48:51]
 ds_read_b128 v[152:155], v25
 v_mfma_f32_16x16x32_bf16 v[64:67], v[160:163], v[108:111], v[64:67]
 buffer_load_dwordx4 v[148:151], v5, s[8:11], s69 offen offset:3072 sc1
 v_mfma_f32_16x16x32_bf16 v[52:55], v[164:167], v[104:107], v[52:55]
 ds_read_b128 v[156:159], v25 offset:1024
 v_mfma_f32_16x16x32_bf16 v[68:71], v[164:167], v[108:111], v[68:71]
 s_waitcnt lgkmcnt(3)
 v_mfma_f32_16x16x32_bf16 v[48:51], v[200:203], v[184:187], v[48:51]
 v_mfma_f32_16x16x32_bf16 v[64:67], v[200:203], v[188:191], v[64:67]
 v_mfma_f32_16x16x32_bf16 v[80:83], v[200:203], v[192:195], 0
 v_mfma_f32_16x16x32_bf16 v[96:99], v[200:203], v[196:199], 0
 s_waitcnt vmcnt(9)
 v_mfma_f32_16x16x32_bf16 v[40:43], v[168:171], v[112:115], v[40:43]
 s_waitcnt vmcnt(8)
 ds_read_b128 v[160:163], v25 offset:2048
 v_mfma_f32_16x16x32_bf16 v[56:59], v[168:171], v[116:119], v[56:59]
 buffer_load_dwordx4 v[104:107], v5, s[8:11], s65 offen sc1
 ds_read_b32 v204, v228 offset:192
 v_mfma_f32_16x16x32_bf16 v[44:47], v[172:175], v[112:115], v[44:47]
 ds_read_b128 v[164:167], v25 offset:3072
 v_mfma_f32_16x16x32_bf16 v[60:63], v[172:175], v[116:119], v[60:63]
 s_waitcnt lgkmcnt(5)
 v_mfma_f32_16x16x32_bf16 v[48:51], v[176:179], v[112:115], v[48:51]
 ds_read_b128 v[168:171], v25 offset:4096
 v_mfma_f32_16x16x32_bf16 v[64:67], v[176:179], v[116:119], v[64:67]
 buffer_load_dwordx4 v[108:111], v5, s[8:11], s70 offen sc1
 v_mfma_f32_16x16x32_bf16 v[52:55], v[180:183], v[112:115], v[52:55]
 ds_read_b128 v[172:175], v25 offset:5120
 v_mfma_f32_16x16x32_bf16 v[68:71], v[180:183], v[116:119], v[68:71]
 s_waitcnt lgkmcnt(3)
 v_mfma_f32_16x16x32_bf16 v[52:55], v[204:207], v[184:187], v[52:55]
 v_mfma_f32_16x16x32_bf16 v[68:71], v[204:207], v[188:191], v[68:71]
 v_mfma_f32_16x16x32_bf16 v[84:87], v[204:207], v[192:195], 0
 v_mfma_f32_16x16x32_bf16 v[100:103], v[204:207], v[196:199], 0
 s_waitcnt vmcnt(9)
 v_mfma_f32_16x16x32_bf16 v[72:75], v[152:155], v[120:123], v[72:75]
 s_waitcnt vmcnt(8)
 ds_read_b128 v[176:179], v25 offset:6144
 buffer_load_dwordx4 v[112:115], v5, s[8:11], s65 offen offset:1024 sc1
 v_mfma_f32_16x16x32_bf16 v[88:91], v[152:155], v[124:127], v[88:91]
 v_mfma_f32_16x16x32_bf16 v[76:79], v[156:159], v[120:123], v[76:79]
 v_mfma_f32_16x16x32_bf16 v[92:95], v[156:159], v[124:127], v[92:95]
 s_waitcnt lgkmcnt(3)
 ds_read_b128 v[180:183], v25 offset:7168
 ds_read_b128 v[152:155], v25 offset:8192
 v_mfma_f32_16x16x32_bf16 v[80:83], v[160:163], v[120:123], v[80:83]
 v_cvt_pk_bf16_f32 v236, v40, v41
 v_cvt_pk_bf16_f32 v237, v42, v43
 v_mfma_f32_16x16x32_bf16 v[96:99], v[160:163], v[124:127], v[96:99]
 ds_read_b128 v[156:159], v25 offset:9216
 buffer_load_dwordx4 v[116:119], v5, s[8:11], s70 offen offset:1024 sc1
 v_mfma_f32_16x16x32_bf16 v[84:87], v[164:167], v[120:123], v[84:87]
 v_cvt_pk_bf16_f32 v238, v56, v57
 v_cvt_pk_bf16_f32 v239, v58, v59
 v_mfma_f32_16x16x32_bf16 v[100:103], v[164:167], v[124:127], v[100:103]
 s_waitcnt vmcnt(9) lgkmcnt(4)
 v_mul_f32 v52, v52, v209
 v_mul_f32 v53, v53, v209
 v_mfma_f32_16x16x32_bf16 v[72:75], v[168:171], v[128:131], v[72:75]
 s_waitcnt vmcnt(8)
 ds_read_b128 v[160:163], v25 offset:10240
 buffer_load_dwordx4 v[120:123], v5, s[8:11], s65 offen offset:2048 sc1
 v_mfma_f32_16x16x32_bf16 v[88:91], v[168:171], v[132:135], v[88:91]
 v_mul_f32 v54, v54, v209
 v_mul_f32 v55, v55, v209
 v_mfma_f32_16x16x32_bf16 v[76:79], v[172:175], v[128:131], v[76:79]
 v_permlane16_swap_b32 v236, v238
 v_mfma_f32_16x16x32_bf16 v[92:95], v[172:175], v[132:135], v[92:95]
 s_waitcnt lgkmcnt(3)
 ds_read_b128 v[164:167], v25 offset:11264
 ds_read_b128 v[168:171], v25 offset:12288
 v_mfma_f32_16x16x32_bf16 v[80:83], v[176:179], v[128:131], v[80:83]
 v_permlane16_swap_b32 v237, v239
 v_mfma_f32_16x16x32_bf16 v[96:99], v[176:179], v[132:135], v[96:99]
 ds_read_b128 v[172:175], v25 offset:13312
 buffer_load_dwordx4 v[124:127], v5, s[8:11], s70 offen offset:2048 sc1
 v_mfma_f32_16x16x32_bf16 v[84:87], v[180:183], v[128:131], v[84:87]
 v_cvt_pk_bf16_f32 v248, v52, v53
 v_cvt_pk_bf16_f32 v249, v54, v55
 v_mfma_f32_16x16x32_bf16 v[100:103], v[180:183], v[132:135], v[100:103]
 v_mul_f32 v68, v68, v213
 v_mul_f32 v69, v69, v213
 v_mfma_f32_32x32x16_bf16 v[184:199], a[164:167], v[236:239], 0
 s_waitcnt vmcnt(9) lgkmcnt(4)
 v_mfma_f32_16x16x32_bf16 v[72:75], v[152:155], v[136:139], v[72:75]
 s_waitcnt vmcnt(8)
 ds_read_b128 v[176:179], v25 offset:14336
 buffer_load_dwordx4 v[128:131], v5, s[8:11], s65 offen offset:3072 sc1
 v_mfma_f32_16x16x32_bf16 v[88:91], v[152:155], v[140:143], v[88:91]
 v_mul_f32 v70, v70, v213
 v_mul_f32 v71, v71, v213
 v_mfma_f32_16x16x32_bf16 v[76:79], v[156:159], v[136:139], v[76:79]
 v_cvt_pk_bf16_f32 v250, v68, v69
 v_cvt_pk_bf16_f32 v251, v70, v71
 v_mfma_f32_16x16x32_bf16 v[92:95], v[156:159], v[140:143], v[92:95]
 s_waitcnt lgkmcnt(3)
 ds_read_b128 v[180:183], v25 offset:15360
 ds_read_b128 v[152:155], v25 offset:16384
 v_mfma_f32_16x16x32_bf16 v[80:83], v[160:163], v[136:139], v[80:83]
 v_mul_f32 v44, v44, v208
 v_mul_f32 v45, v45, v208
 v_mfma_f32_16x16x32_bf16 v[96:99], v[160:163], v[140:143], v[96:99]
 ds_read_b128 v[156:159], v25 offset:17408
 buffer_load_dwordx4 v[132:135], v5, s[8:11], s70 offen offset:3072 sc1
 v_mfma_f32_16x16x32_bf16 v[84:87], v[164:167], v[136:139], v[84:87]
 v_permlane16_swap_b32 v248, v250
 v_mfma_f32_16x16x32_bf16 v[100:103], v[164:167], v[140:143], v[100:103]
 s_waitcnt vmcnt(9) lgkmcnt(4)
 v_permlane16_swap_b32 v249, v251
 v_mfma_f32_16x16x32_bf16 v[72:75], v[168:171], v[144:147], v[72:75]
 s_waitcnt vmcnt(8)
 ds_read_b128 v[160:163], v25 offset:18432
 buffer_load_dwordx4 v[136:139], v5, s[8:11], s66 offen sc1
 v_mfma_f32_16x16x32_bf16 v[88:91], v[168:171], v[148:151], v[88:91]
 v_or_b32 v250, v23, v250
 v_mul_f32 v46, v46, v208
 v_mfma_f32_16x16x32_bf16 v[76:79], v[172:175], v[144:147], v[76:79]
 v_mul_f32 v47, v47, v208
 v_mfma_f32_32x32x16_bf16 v[184:199], a[168:171], v[248:251], v[184:199]
 v_mfma_f32_16x16x32_bf16 v[92:95], v[172:175], v[148:151], v[92:95]
 s_waitcnt lgkmcnt(3)
 ds_read_b128 v[164:167], v25 offset:19456
 ds_read_b128 v[168:171], v25 offset:20480
 v_mfma_f32_16x16x32_bf16 v[80:83], v[176:179], v[144:147], v[80:83]
 ds_write_b64 v14, v[250:251] offset:21120
 v_mfma_f32_16x16x32_bf16 v[96:99], v[176:179], v[148:151], v[96:99]
 ds_read_b128 v[172:175], v25 offset:21504
 buffer_load_dwordx4 v[140:143], v5, s[8:11], s71 offen sc1
 v_mfma_f32_16x16x32_bf16 v[84:87], v[180:183], v[144:147], v[84:87]
 v_cvt_pk_bf16_f32 v240, v44, v45
 v_cvt_pk_bf16_f32 v241, v46, v47
 v_mfma_f32_16x16x32_bf16 v[100:103], v[180:183], v[148:151], v[100:103]
 s_barrier
 v_mul_f32 v60, v60, v212
 v_mul_f32 v61, v61, v212
 s_waitcnt lgkmcnt(5)
 s_waitcnt vmcnt(9)
 v_mfma_f32_16x16x32_bf16 v[72:75], v[152:155], v[104:107], v[72:75]
 s_waitcnt vmcnt(8)
 ds_read_b128 v[176:179], v25 offset:22528
 buffer_load_dwordx4 v[144:147], v5, s[8:11], s66 offen offset:1024 sc1
 v_mfma_f32_16x16x32_bf16 v[88:91], v[152:155], v[108:111], v[88:91]
 v_mul_f32 v62, v62, v212
 v_mul_f32 v63, v63, v212
 v_mfma_f32_16x16x32_bf16 v[76:79], v[156:159], v[104:107], v[76:79]
 v_cvt_pk_bf16_f32 v242, v60, v61
 v_cvt_pk_bf16_f32 v243, v62, v63
 v_mfma_f32_16x16x32_bf16 v[92:95], v[156:159], v[108:111], v[92:95]
 s_waitcnt lgkmcnt(4)
 ds_read_b128 v[180:183], v25 offset:23552
 ds_read_b128 v[152:155], v25 offset:24576
 v_mfma_f32_16x16x32_bf16 v[80:83], v[160:163], v[104:107], v[80:83]
 v_cvt_pk_bf16_f32 v244, v48, v49
 v_cvt_pk_bf16_f32 v245, v50, v51
 v_mfma_f32_16x16x32_bf16 v[96:99], v[160:163], v[108:111], v[96:99]
 ds_read_b128 v[156:159], v25 offset:25600
 buffer_load_dwordx4 v[148:151], v5, s[8:11], s71 offen offset:1024 sc1
 v_mfma_f32_16x16x32_bf16 v[84:87], v[164:167], v[104:107], v[84:87]
 v_permlane16_swap_b32 v240, v242
 v_mfma_f32_16x16x32_bf16 v[100:103], v[164:167], v[108:111], v[100:103]
 s_waitcnt vmcnt(9) lgkmcnt(4)
 v_permlane16_swap_b32 v241, v243
 v_mfma_f32_16x16x32_bf16 v[72:75], v[168:171], v[112:115], v[72:75]
 s_waitcnt vmcnt(8)
 ds_read_b128 v[160:163], v25 offset:26624
 buffer_load_dwordx4 v[104:107], v5, s[8:11], s66 offen offset:2048 sc1
 v_mfma_f32_16x16x32_bf16 v[88:91], v[168:171], v[116:119], v[88:91]
 v_cvt_pk_bf16_f32 v246, v64, v65
 v_cvt_pk_bf16_f32 v247, v66, v67
 v_mfma_f32_16x16x32_bf16 v[76:79], v[172:175], v[112:115], v[76:79]
 ds_write_b128 v13, v[240:243] offset:16896
 v_mfma_f32_16x16x32_bf16 v[92:95], v[172:175], v[116:119], v[92:95]
 s_waitcnt lgkmcnt(4)
 ds_read_b128 v[164:167], v25 offset:27648
 ds_read_b128 v[168:171], v25 offset:28672
 v_mfma_f32_16x16x32_bf16 v[80:83], v[176:179], v[112:115], v[80:83]
 v_permlane16_swap_b32 v244, v246
 v_mfma_f32_16x16x32_bf16 v[96:99], v[176:179], v[116:119], v[96:99]
 ds_read_b128 v[172:175], v25 offset:29696
 buffer_load_dwordx4 v[108:111], v5, s[8:11], s71 offen offset:2048 sc1
 v_mfma_f32_16x16x32_bf16 v[84:87], v[180:183], v[112:115], v[84:87]
 v_permlane16_swap_b32 v245, v247
 v_mfma_f32_16x16x32_bf16 v[100:103], v[180:183], v[116:119], v[100:103]
 s_waitcnt vmcnt(9) lgkmcnt(5)
 v_max3_f32 v60, v184, v185, v186
 v_max3_f32 v61, -v184, -v185, -v186
 v_mfma_f32_16x16x32_bf16 v[72:75], v[152:155], v[120:123], v[72:75]
 s_waitcnt vmcnt(8)
 ds_read_b128 v[176:179], v25 offset:30720
 buffer_load_dwordx4 v[112:115], v5, s[8:11], s66 offen offset:3072 sc1
 v_mfma_f32_16x16x32_bf16 v[88:91], v[152:155], v[124:127], v[88:91]
 v_max3_f32 v60, v60, v187, v188
 v_max3_f32 v61, v61, -v187, -v188
 v_mfma_f32_16x16x32_bf16 v[76:79], v[156:159], v[120:123], v[76:79]
 v_max3_f32 v60, v60, v189, v190
 v_max3_f32 v61, v61, -v189, -v190
 v_mfma_f32_16x16x32_bf16 v[92:95], v[156:159], v[124:127], v[92:95]
 s_waitcnt lgkmcnt(3)
 ds_read_b128 v[180:183], v25 offset:31744
 ds_read_b128 v[152:155], v25 offset:32768
 v_mfma_f32_16x16x32_bf16 v[80:83], v[160:163], v[120:123], v[80:83]
 v_max3_f32 v60, v60, v191, v192
 v_max3_f32 v61, v61, -v191, -v192
 v_mfma_f32_16x16x32_bf16 v[96:99], v[160:163], v[124:127], v[96:99]
 ds_read_b128 v[156:159], v25 offset:33792
 buffer_load_dwordx4 v[116:119], v5, s[8:11], s71 offen offset:3072 sc1
 v_mfma_f32_16x16x32_bf16 v[84:87], v[164:167], v[120:123], v[84:87]
 v_max_f32 v60, v60, v193
 v_max_f32 v61, v61, -v193
 v_mfma_f32_16x16x32_bf16 v[100:103], v[164:167], v[124:127], v[100:103]
 s_waitcnt vmcnt(9) lgkmcnt(4)
 s_nop 0
 v_permlane32_swap_b32 v60, v61
 v_mfma_f32_16x16x32_bf16 v[72:75], v[168:171], v[128:131], v[72:75]
 s_waitcnt vmcnt(8)
 ds_read_b128 v[160:163], v25 offset:34816
 buffer_load_dwordx4 v[120:123], v5, s[8:11], s67 offen sc1
 v_mfma_f32_16x16x32_bf16 v[88:91], v[168:171], v[132:135], v[88:91]
 v_max_f32 v62, v60, v61
 v_mul_f32 v60, -v62, v225
 v_mfma_f32_16x16x32_bf16 v[76:79], v[172:175], v[128:131], v[76:79]
 v_mul_f32 v61, -v62, v225
 v_mfma_f32_16x16x32_bf16 v[92:95], v[172:175], v[132:135], v[92:95]
 s_waitcnt lgkmcnt(3)
 ds_read_b128 v[164:167], v25 offset:35840
 ds_read_b128 v[168:171], v25 offset:36864
 v_mfma_f32_16x16x32_bf16 v[80:83], v[176:179], v[128:131], v[80:83]
 v_permlane32_swap_b32 v60, v61
 v_mfma_f32_16x16x32_bf16 v[96:99], v[176:179], v[132:135], v[96:99]
 ds_read_b128 v[172:175], v25 offset:37888
 buffer_load_dwordx4 v[124:127], v5, s[8:11], s72 offen sc1
 v_mfma_f32_16x16x32_bf16 v[84:87], v[180:183], v[128:131], v[84:87]
 v_fma_f32 v40, v184, v225, v60
 v_fma_f32 v50, -v184, v225, v61
 v_mfma_f32_16x16x32_bf16 v[100:103], v[180:183], v[132:135], v[100:103]
 s_barrier
 v_fma_f32 v41, v185, v225, v60
 v_fma_f32 v51, -v185, v225, v61
 s_waitcnt lgkmcnt(4)
 s_waitcnt vmcnt(9)
 v_mfma_f32_16x16x32_bf16 v[72:75], v[152:155], v[136:139], v[72:75]
 s_waitcnt vmcnt(8)
 ds_read_b128 v[176:179], v25 offset:38912
 buffer_load_dwordx4 v[128:131], v5, s[8:11], s67 offen offset:1024 sc1
 v_mfma_f32_16x16x32_bf16 v[88:91], v[152:155], v[140:143], v[88:91]
 v_fma_f32 v42, v186, v225, v60
 v_fma_f32 v52, -v186, v225, v61
 v_mfma_f32_16x16x32_bf16 v[76:79], v[156:159], v[136:139], v[76:79]
 v_fma_f32 v43, v187, v225, v60
 v_fma_f32 v53, -v187, v225, v61
 v_mfma_f32_16x16x32_bf16 v[92:95], v[156:159], v[140:143], v[92:95]
 s_waitcnt lgkmcnt(3)
 ds_read_b128 v[180:183], v25 offset:39936
 ds_read_b128 v[152:155], v26
 v_mfma_f32_16x16x32_bf16 v[80:83], v[160:163], v[136:139], v[80:83]
 v_fma_f32 v44, v188, v225, v60
 v_fma_f32 v54, -v188, v225, v61
 v_mfma_f32_16x16x32_bf16 v[96:99], v[160:163], v[140:143], v[96:99]
 ds_read_b128 v[156:159], v26 offset:1024
 buffer_load_dwordx4 v[132:135], v5, s[8:11], s72 offen offset:1024 sc1
 v_mfma_f32_16x16x32_bf16 v[84:87], v[164:167], v[136:139], v[84:87]
 v_fma_f32 v45, v189, v225, v60
 v_fma_f32 v55, -v189, v225, v61
 v_mfma_f32_16x16x32_bf16 v[100:103], v[164:167], v[140:143], v[100:103]
 s_waitcnt vmcnt(9) lgkmcnt(4)
 v_fma_f32 v46, v190, v225, v60
 v_fma_f32 v56, -v190, v225, v61
 v_mfma_f32_16x16x32_bf16 v[72:75], v[168:171], v[144:147], v[72:75]
 s_waitcnt vmcnt(8)
 ds_read_b128 v[160:163], v26 offset:2048
 buffer_load_dwordx4 v[136:139], v5, s[8:11], s67 offen offset:2048 sc1
 v_mfma_f32_16x16x32_bf16 v[88:91], v[168:171], v[148:151], v[88:91]
 v_fma_f32 v47, v191, v225, v60
 v_fma_f32 v57, -v191, v225, v61
 v_mfma_f32_16x16x32_bf16 v[76:79], v[172:175], v[144:147], v[76:79]
 v_fma_f32 v48, v192, v225, v60
 v_fma_f32 v58, -v192, v225, v61
 v_mfma_f32_16x16x32_bf16 v[92:95], v[172:175], v[148:151], v[92:95]
 s_waitcnt lgkmcnt(3)
 ds_read_b128 v[164:167], v26 offset:3072
 ds_read_b128 v[168:171], v26 offset:4096
 v_mfma_f32_16x16x32_bf16 v[80:83], v[176:179], v[144:147], v[80:83]
 v_fma_f32 v49, v193, v225, v60
 v_fma_f32 v59, -v193, v225, v61
 v_mfma_f32_16x16x32_bf16 v[96:99], v[176:179], v[148:151], v[96:99]
 ds_read_b128 v[172:175], v26 offset:5120
 buffer_load_dwordx4 v[140:143], v5, s[8:11], s72 offen offset:2048 sc1
 v_mfma_f32_16x16x32_bf16 v[84:87], v[180:183], v[144:147], v[84:87]
 v_exp_f32 v40, v40
 v_mfma_f32_16x16x32_bf16 v[100:103], v[180:183], v[148:151], v[100:103]
 s_waitcnt vmcnt(9) lgkmcnt(4)
 v_exp_f32 v41, v41
 v_mfma_f32_16x16x32_bf16 v[72:75], v[152:155], v[104:107], v[72:75]
 s_waitcnt vmcnt(8)
 ds_read_b128 v[176:179], v26 offset:6144
 buffer_load_dwordx4 v[144:147], v5, s[8:11], s67 offen offset:3072 sc1
 v_mfma_f32_16x16x32_bf16 v[88:91], v[152:155], v[108:111], v[88:91]
 v_exp_f32 v42, v42
 v_mfma_f32_16x16x32_bf16 v[76:79], v[156:159], v[104:107], v[76:79]
 v_exp_f32 v43, v43
 v_mfma_f32_16x16x32_bf16 v[92:95], v[156:159], v[108:111], v[92:95]
 s_waitcnt lgkmcnt(3)
 ds_read_b128 v[180:183], v26 offset:7168
 ds_read_b128 v[152:155], v26 offset:8192
 v_mfma_f32_16x16x32_bf16 v[80:83], v[160:163], v[104:107], v[80:83]
 v_exp_f32 v44, v44
 v_mfma_f32_16x16x32_bf16 v[96:99], v[160:163], v[108:111], v[96:99]
 ds_read_b128 v[156:159], v26 offset:9216
 buffer_load_dwordx4 v[148:151], v5, s[8:11], s72 offen offset:3072 sc1
 v_mfma_f32_16x16x32_bf16 v[84:87], v[164:167], v[104:107], v[84:87]
 v_exp_f32 v45, v45
 v_mfma_f32_16x16x32_bf16 v[100:103], v[164:167], v[108:111], v[100:103]
 s_waitcnt vmcnt(9) lgkmcnt(4)
 v_exp_f32 v46, v46
 v_mfma_f32_16x16x32_bf16 v[72:75], v[168:171], v[112:115], v[72:75]
 s_waitcnt vmcnt(8)
 ds_read_b128 v[160:163], v26 offset:10240
 buffer_load_dwordx4 v[104:107], v5, s[8:11], s68 offen sc1
 v_mfma_f32_16x16x32_bf16 v[88:91], v[168:171], v[116:119], v[88:91]
 v_exp_f32 v47, v47
 v_mfma_f32_16x16x32_bf16 v[76:79], v[172:175], v[112:115], v[76:79]
 v_exp_f32 v48, v48
 v_mfma_f32_16x16x32_bf16 v[92:95], v[172:175], v[116:119], v[92:95]
 s_waitcnt lgkmcnt(3)
 ds_read_b128 v[164:167], v26 offset:11264
 ds_read_b128 v[168:171], v26 offset:12288
 v_mfma_f32_16x16x32_bf16 v[80:83], v[176:179], v[112:115], v[80:83]
 v_exp_f32 v49, v49
 v_mfma_f32_16x16x32_bf16 v[96:99], v[176:179], v[116:119], v[96:99]
 ds_read_b128 v[172:175], v26 offset:13312
 buffer_load_dwordx4 v[108:111], v5, s[8:11], s73 offen sc1
 v_mfma_f32_16x16x32_bf16 v[84:87], v[180:183], v[112:115], v[84:87]
 v_exp_f32 v50, v50
 v_mfma_f32_16x16x32_bf16 v[100:103], v[180:183], v[116:119], v[100:103]
 s_barrier
 v_exp_f32 v51, v51
 s_waitcnt lgkmcnt(4)
 s_waitcnt vmcnt(9)
 v_mfma_f32_16x16x32_bf16 v[72:75], v[152:155], v[120:123], v[72:75]
 s_waitcnt vmcnt(8)
 ds_read_b128 v[176:179], v26 offset:14336
 buffer_load_dwordx4 v[112:115], v5, s[8:11], s68 offen offset:1024 sc1
 v_mfma_f32_16x16x32_bf16 v[88:91], v[152:155], v[124:127], v[88:91]
 v_exp_f32 v52, v52
 v_mfma_f32_16x16x32_bf16 v[76:79], v[156:159], v[120:123], v[76:79]
 v_exp_f32 v53, v53
 v_mfma_f32_16x16x32_bf16 v[92:95], v[156:159], v[124:127], v[92:95]
 s_waitcnt lgkmcnt(3)
 ds_read_b128 v[180:183], v26 offset:15360
 ds_read_b128 v[152:155], v26 offset:16384
 v_mfma_f32_16x16x32_bf16 v[80:83], v[160:163], v[120:123], v[80:83]
 v_exp_f32 v54, v54
 v_mfma_f32_16x16x32_bf16 v[96:99], v[160:163], v[124:127], v[96:99]
 ds_read_b128 v[156:159], v26 offset:17408
 buffer_load_dwordx4 v[116:119], v5, s[8:11], s73 offen offset:1024 sc1
 v_mfma_f32_16x16x32_bf16 v[84:87], v[164:167], v[120:123], v[84:87]
 v_exp_f32 v55, v55
 v_mfma_f32_16x16x32_bf16 v[100:103], v[164:167], v[124:127], v[100:103]
 s_waitcnt vmcnt(9) lgkmcnt(4)
 v_exp_f32 v56, v56
 v_mfma_f32_16x16x32_bf16 v[72:75], v[168:171], v[128:131], v[72:75]
 s_waitcnt vmcnt(8)
 ds_read_b128 v[160:163], v26 offset:18432
 buffer_load_dwordx4 v[120:123], v5, s[8:11], s68 offen offset:2048 sc1
 v_mfma_f32_16x16x32_bf16 v[88:91], v[168:171], v[132:135], v[88:91]
 v_exp_f32 v57, v57
 v_mfma_f32_16x16x32_bf16 v[76:79], v[172:175], v[128:131], v[76:79]
 v_exp_f32 v58, v58
 v_mfma_f32_16x16x32_bf16 v[92:95], v[172:175], v[132:135], v[92:95]
 s_waitcnt lgkmcnt(3)
 ds_read_b128 v[164:167], v26 offset:19456
 ds_read_b128 v[168:171], v26 offset:20480
 v_mfma_f32_16x16x32_bf16 v[80:83], v[176:179], v[128:131], v[80:83]
 v_exp_f32 v59, v59
 v_mfma_f32_16x16x32_bf16 v[96:99], v[176:179], v[132:135], v[96:99]
 ds_read_b128 v[172:175], v26 offset:21504
 buffer_load_dwordx4 v[124:127], v5, s[8:11], s73 offen offset:2048 sc1
 v_mfma_f32_16x16x32_bf16 v[84:87], v[180:183], v[128:131], v[84:87]
 v_add_f32 v60, v40, v42
 v_add_f32 v61, v41, v43
 v_mfma_f32_16x16x32_bf16 v[100:103], v[180:183], v[132:135], v[100:103]
 s_waitcnt vmcnt(9) lgkmcnt(4)
 v_add_f32 v62, v50, v52
 v_add_f32 v63, v51, v53
 v_mfma_f32_16x16x32_bf16 v[72:75], v[152:155], v[136:139], v[72:75]
 s_waitcnt vmcnt(8)
 ds_read_b128 v[176:179], v26 offset:22528
 buffer_load_dwordx4 v[128:131], v5, s[8:11], s68 offen offset:3072 sc1
 v_mfma_f32_16x16x32_bf16 v[88:91], v[152:155], v[140:143], v[88:91]
 v_add_f32 v60, v60, v44
 v_add_f32 v61, v61, v45
 v_mfma_f32_16x16x32_bf16 v[76:79], v[156:159], v[136:139], v[76:79]
 v_add_f32 v62, v62, v54
 v_add_f32 v63, v63, v55
 v_mfma_f32_16x16x32_bf16 v[92:95], v[156:159], v[140:143], v[92:95]
 s_waitcnt lgkmcnt(3)
 ds_read_b128 v[180:183], v26 offset:23552
 ds_read_b128 v[152:155], v26 offset:24576
 v_mfma_f32_16x16x32_bf16 v[80:83], v[160:163], v[136:139], v[80:83]
 v_add_f32 v60, v60, v46
 v_add_f32 v61, v61, v47
 v_mfma_f32_16x16x32_bf16 v[96:99], v[160:163], v[140:143], v[96:99]
 ds_read_b128 v[156:159], v26 offset:25600
 buffer_load_dwordx4 v[132:135], v5, s[8:11], s73 offen offset:3072 sc1
 v_mfma_f32_16x16x32_bf16 v[84:87], v[164:167], v[136:139], v[84:87]
 v_add_f32 v62, v62, v56
 v_add_f32 v63, v63, v57
 v_mfma_f32_16x16x32_bf16 v[100:103], v[164:167], v[140:143], v[100:103]
 s_waitcnt vmcnt(9) lgkmcnt(4)
 v_add_f32 v60, v60, v48
 v_add_f32 v61, v61, v49
 v_mfma_f32_16x16x32_bf16 v[72:75], v[168:171], v[144:147], v[72:75]
 s_waitcnt vmcnt(8)
 ds_read_b128 v[160:163], v26 offset:26624
 v_add_f32 v62, v62, v58
 v_mfma_f32_16x16x32_bf16 v[88:91], v[168:171], v[148:151], v[88:91]
 v_add_f32 v63, v63, v59
 v_add_f32 v60, v60, v61
 v_mfma_f32_16x16x32_bf16 v[76:79], v[172:175], v[144:147], v[76:79]
 v_add_f32 v61, v62, v63
 v_mfma_f32_16x16x32_bf16 v[92:95], v[172:175], v[148:151], v[92:95]
 s_waitcnt lgkmcnt(3)
 ds_read_b128 v[164:167], v26 offset:27648
 ds_read_b128 v[168:171], v26 offset:28672
 v_mfma_f32_16x16x32_bf16 v[80:83], v[176:179], v[144:147], v[80:83]
 v_permlane32_swap_b32 v60, v61
 v_mfma_f32_16x16x32_bf16 v[96:99], v[176:179], v[148:151], v[96:99]
 ds_read_b128 v[172:175], v26 offset:29696
 v_add_f32 v60, v60, v61
 v_mfma_f32_16x16x32_bf16 v[84:87], v[180:183], v[144:147], v[84:87]
 v_rcp_f32 v60, v60
 v_mfma_f32_16x16x32_bf16 v[100:103], v[180:183], v[148:151], v[100:103]
 s_barrier
 v_mov_b32 v61, v60
 s_waitcnt lgkmcnt(4)
 s_waitcnt vmcnt(7)
 v_mfma_f32_16x16x32_bf16 v[72:75], v[152:155], v[104:107], v[72:75]
 s_waitcnt vmcnt(6)
 s_add_u32 m0, s28, 98304
 ds_read_b128 v[176:179], v26 offset:30720
 s_add_u32 s85, s35, 16384
 buffer_load_dwordx4 v3, s[8:11], s85 offen offset:1024 sc1 lds
 v_mfma_f32_16x16x32_bf16 v[88:91], v[152:155], v[108:111], v[88:91]
 v_permlane32_swap_b32 v60, v61
 v_mfma_f32_16x16x32_bf16 v[76:79], v[156:159], v[104:107], v[76:79]
 v_mul_f32 v40, v60, v40
 v_mul_f32 v41, v60, v41
 v_mfma_f32_16x16x32_bf16 v[92:95], v[156:159], v[108:111], v[92:95]
 s_waitcnt lgkmcnt(3)
 ds_read_b128 v[180:183], v26 offset:31744
 ds_read_b128 v[152:155], v26 offset:32768
 v_mfma_f32_16x16x32_bf16 v[80:83], v[160:163], v[104:107], v[80:83]
 s_add_u32 m0, s28, 81920
 s_add_u32 s85, s35, 0
 buffer_load_dwordx4 v3, s[8:11], s85 offen sc1 lds
 v_cvt_pk_bf16_f32 v236, v40, v41
 v_mfma_f32_16x16x32_bf16 v[96:99], v[160:163], v[108:111], v[96:99]
 ds_read_b128 v[156:159], v26 offset:33792
 v_mul_f32 v42, v60, v42
 v_mfma_f32_16x16x32_bf16 v[84:87], v[164:167], v[104:107], v[84:87]
 v_mul_f32 v43, v60, v43
 v_cvt_pk_bf16_f32 v237, v42, v43
 v_mfma_f32_16x16x32_bf16 v[100:103], v[164:167], v[108:111], v[100:103]
 s_waitcnt vmcnt(7) lgkmcnt(4)
 v_mul_f32 v44, v60, v44
 v_mul_f32 v45, v60, v45
 v_mfma_f32_16x16x32_bf16 v[72:75], v[168:171], v[112:115], v[72:75]
 s_waitcnt vmcnt(6)
 s_add_u32 m0, s28, 98304
 ds_read_b128 v[160:163], v26 offset:34816
 s_add_u32 s85, s35, 16384
 buffer_load_dwordx4 v3, s[8:11], s85 offen offset:2048 sc1 lds
 v_mfma_f32_16x16x32_bf16 v[88:91], v[168:171], v[116:119], v[88:91]
 v_cvt_pk_bf16_f32 v238, v44, v45
 v_mul_f32 v46, v60, v46
 v_mfma_f32_16x16x32_bf16 v[76:79], v[172:175], v[112:115], v[76:79]
 s_add_u32 m0, s28, 81920
 s_add_u32 s85, s35, 0
 buffer_load_dwordx4 v3, s[8:11], s85 offen offset:1024 sc1 lds
 v_mul_f32 v47, v60, v47
 v_mfma_f32_16x16x32_bf16 v[92:95], v[172:175], v[116:119], v[92:95]
 s_waitcnt lgkmcnt(3)
 ds_read_b128 v[164:167], v26 offset:35840
 ds_read_b128 v[168:171], v26 offset:36864
 v_mfma_f32_16x16x32_bf16 v[80:83], v[176:179], v[112:115], v[80:83]
 v_cvt_pk_bf16_f32 v239, v46, v47
 v_mfma_f32_16x16x32_bf16 v[96:99], v[176:179], v[116:119], v[96:99]
 ds_read_b128 v[172:175], v26 offset:37888
 v_mfma_f32_16x16x32_bf16 v[84:87], v[180:183], v[112:115], v[84:87]
 ds_write_b128 v12, v[236:239]
 v_mfma_f32_16x16x32_bf16 v[100:103], v[180:183], v[116:119], v[100:103]
 s_waitcnt vmcnt(7) lgkmcnt(5)
 v_mul_f32 v48, v60, v48
 v_mul_f32 v49, v60, v49
 v_mfma_f32_16x16x32_bf16 v[72:75], v[152:155], v[120:123], v[72:75]
 s_waitcnt vmcnt(6)
 s_add_u32 m0, s28, 98304
 ds_read_b128 v[176:179], v26 offset:38912
 s_add_u32 s85, s35, 16384
 buffer_load_dwordx4 v3, s[8:11], s85 offen offset:3072 sc1 lds
 v_mfma_f32_16x16x32_bf16 v[88:91], v[152:155], v[124:127], v[88:91]
 v_cvt_pk_bf16_f32 v240, v48, v49
 v_mul_f32 v50, v61, v50
 v_mfma_f32_16x16x32_bf16 v[76:79], v[156:159], v[120:123], v[76:79]
 s_add_u32 m0, s28, 81920
 s_add_u32 s85, s35, 0
 buffer_load_dwordx4 v3, s[8:11], s85 offen offset:2048 sc1 lds
 v_mul_f32 v51, v61, v51
 v_mfma_f32_16x16x32_bf16 v[92:95], v[156:159], v[124:127], v[92:95]
 s_waitcnt lgkmcnt(4)
 ds_read_b128 v[180:183], v26 offset:39936
 v_cvt_pk_bf16_f32 v241, v50, v51
 v_mfma_f32_16x16x32_bf16 v[80:83], v[160:163], v[120:123], v[80:83]
 v_mul_f32 v52, v61, v52
 v_mul_f32 v53, v61, v53
 v_mfma_f32_16x16x32_bf16 v[96:99], v[160:163], v[124:127], v[96:99]
 v_cvt_pk_bf16_f32 v242, v52, v53
 v_mul_f32 v54, v61, v54
 v_mfma_f32_16x16x32_bf16 v[84:87], v[164:167], v[120:123], v[84:87]
 v_mul_f32 v55, v61, v55
 v_cvt_pk_bf16_f32 v243, v54, v55
 v_mfma_f32_16x16x32_bf16 v[100:103], v[164:167], v[124:127], v[100:103]
 s_waitcnt vmcnt(7) lgkmcnt(3)
 buffer_load_dwordx4 v3, s[8:11], s85 offen offset:3072 sc1 lds
 v_mfma_f32_16x16x32_bf16 v[72:75], v[168:171], v[128:131], v[72:75]
 s_waitcnt vmcnt(7)
 s_add_u32 m0, s28, 114688
 s_add_u32 s85, s35, 32768
 buffer_load_dwordx4 v3, s[8:11], s85 offen sc1 lds
 v_mfma_f32_16x16x32_bf16 v[88:91], v[168:171], v[132:135], v[88:91]
 ds_write_b128 v12, v[240:243] offset:8448
 v_mfma_f32_16x16x32_bf16 v[76:79], v[172:175], v[128:131], v[76:79]
 v_mul_f32 v56, v61, v56
 v_mul_f32 v57, v61, v57
 v_mfma_f32_16x16x32_bf16 v[92:95], v[172:175], v[132:135], v[92:95]
 s_waitcnt lgkmcnt(1)
 v_cvt_pk_bf16_f32 v64, v56, v57
 v_mul_f32 v58, v61, v58
 v_mfma_f32_16x16x32_bf16 v[80:83], v[176:179], v[128:131], v[80:83]
 v_mul_f32 v59, v61, v59
 v_cvt_pk_bf16_f32 v65, v58, v59
 v_mfma_f32_16x16x32_bf16 v[96:99], v[176:179], v[132:135], v[96:99]
 s_add_u32 m0, s28, 98304
 s_add_u32 s85, s35, 16384
 buffer_load_dwordx4 v3, s[8:11], s85 offen sc1 lds
 v_mfma_f32_16x16x32_bf16 v[84:87], v[180:183], v[128:131], v[84:87]
 ds_write_b64 v14, v[64:65] offset:29568
 v_mfma_f32_16x16x32_bf16 v[100:103], v[180:183], v[132:135], v[100:103]
 v_cvt_pk_bf16_f32 v104, v72, v73
 buffer_load_dwordx4 a[100:103], v38, s[8:11], s66 offen offset:3072 sc1
 v_cvt_pk_bf16_f32 v105, v74, v75
 v_cvt_pk_bf16_f32 v106, v88, v89
 v_cvt_pk_bf16_f32 v107, v90, v91
 s_nop 0
 v_mul_f32 v84, v84, v217
 v_mul_f32 v85, v85, v217
 v_mul_f32 v86, v86, v217
 v_mul_f32 v87, v87, v217
 v_permlane16_swap_b32 v104, v106
 v_permlane16_swap_b32 v105, v107
 v_cvt_pk_bf16_f32 v116, v84, v85
 v_cvt_pk_bf16_f32 v117, v86, v87
 v_mul_f32 v100, v100, v221
 v_mul_f32 v101, v101, v221
 v_mfma_f32_32x32x16_bf16 v[136:151], a[164:167], v[104:107], 0
 v_mul_f32 v102, v102, v221
 v_mul_f32 v103, v103, v221
 v_cvt_pk_bf16_f32 v118, v100, v101
 v_cvt_pk_bf16_f32 v119, v102, v103
 v_mul_f32 v76, v76, v216
 v_mul_f32 v77, v77, v216
 v_permlane16_swap_b32 v116, v118
 v_permlane16_swap_b32 v117, v119
 v_or_b32 v118, v23, v118
 v_mul_f32 v78, v78, v216
 s_add_u32 m0, s28, 114688
 s_add_u32 s85, s35, 32768
 buffer_load_dwordx4 v3, s[8:11], s85 offen offset:1024 sc1 lds
 v_mul_f32 v79, v79, v216
 v_mfma_f32_32x32x16_bf16 v[136:151], a[168:171], v[116:119], v[136:151]
 ds_write_b64 v14, v[118:119] offset:21632
 v_cvt_pk_bf16_f32 v108, v76, v77
 v_cvt_pk_bf16_f32 v109, v78, v79
 v_mul_f32 v92, v92, v220
 v_mul_f32 v93, v93, v220
 v_mul_f32 v94, v94, v220
 v_mul_f32 v95, v95, v220
 v_cvt_pk_bf16_f32 v110, v92, v93
 v_cvt_pk_bf16_f32 v111, v94, v95
 v_cvt_pk_bf16_f32 v112, v80, v81
 v_cvt_pk_bf16_f32 v113, v82, v83
 v_permlane16_swap_b32 v108, v110
 v_permlane16_swap_b32 v109, v111
 v_cvt_pk_bf16_f32 v114, v96, v97
 v_cvt_pk_bf16_f32 v115, v98, v99
 ds_write_b128 v13, v[108:111] offset:17408
 v_permlane16_swap_b32 v112, v114
 v_permlane16_swap_b32 v113, v115
 v_max3_f32 v172, v136, v137, v138
 v_max3_f32 v173, -v136, -v137, -v138
 v_max3_f32 v172, v172, v139, v140
 v_max3_f32 v173, v173, -v139, -v140
 buffer_load_dwordx4 v3, s[8:11], s85 offen offset:2048 sc1 lds
 v_max3_f32 v172, v172, v141, v142
 v_max3_f32 v173, v173, -v141, -v142
 v_max3_f32 v172, v172, v143, v144
 v_max3_f32 v173, v173, -v143, -v144
 v_max_f32 v172, v172, v145
 v_max_f32 v173, v173, -v145
 s_nop 1
 v_permlane32_swap_b32 v172, v173
 v_max_f32 v174, v172, v173
 v_mul_f32 v172, -v174, v227
 v_mul_f32 v173, -v174, v227
 s_nop 1
 v_permlane32_swap_b32 v172, v173
 v_pk_fma_f32 v[152:153], v[226:227], v[136:137], v[172:173] op_sel:[1,0,0] op_sel_hi:[1,1,0]
 v_pk_fma_f32 v[162:163], v[226:227], v[136:137], v[172:173] op_sel:[1,0,1] op_sel_hi:[1,1,1] neg_lo:[1,0,0] neg_hi:[1,0,0]
 v_pk_fma_f32 v[154:155], v[226:227], v[138:139], v[172:173] op_sel:[1,0,0] op_sel_hi:[1,1,0]
 v_pk_fma_f32 v[164:165], v[226:227], v[138:139], v[172:173] op_sel:[1,0,1] op_sel_hi:[1,1,1] neg_lo:[1,0,0] neg_hi:[1,0,0]
 v_pk_fma_f32 v[156:157], v[226:227], v[140:141], v[172:173] op_sel:[1,0,0] op_sel_hi:[1,1,0]
 v_pk_fma_f32 v[166:167], v[226:227], v[140:141], v[172:173] op_sel:[1,0,1] op_sel_hi:[1,1,1] neg_lo:[1,0,0] neg_hi:[1,0,0]
 v_pk_fma_f32 v[158:159], v[226:227], v[142:143], v[172:173] op_sel:[1,0,0] op_sel_hi:[1,1,0]
 v_pk_fma_f32 v[168:169], v[226:227], v[142:143], v[172:173] op_sel:[1,0,1] op_sel_hi:[1,1,1] neg_lo:[1,0,0] neg_hi:[1,0,0]
 v_pk_fma_f32 v[160:161], v[226:227], v[144:145], v[172:173] op_sel:[1,0,0] op_sel_hi:[1,1,0]
 v_pk_fma_f32 v[170:171], v[226:227], v[144:145], v[172:173] op_sel:[1,0,1] op_sel_hi:[1,1,1] neg_lo:[1,0,0] neg_hi:[1,0,0]
 v_exp_f32 v152, v152
 v_exp_f32 v153, v153
 v_exp_f32 v154, v154
 buffer_load_dwordx4 v3, s[8:11], s85 offen offset:3072 sc1 lds
 v_exp_f32 v155, v155
 v_exp_f32 v156, v156
 v_exp_f32 v157, v157
 v_exp_f32 v158, v158
 v_exp_f32 v159, v159
 v_exp_f32 v160, v160
 v_exp_f32 v161, v161
 v_exp_f32 v162, v162
 v_exp_f32 v163, v163
 v_exp_f32 v164, v164
 v_exp_f32 v165, v165
 v_exp_f32 v166, v166
 v_exp_f32 v167, v167
 v_exp_f32 v168, v168
 v_exp_f32 v169, v169
 v_exp_f32 v170, v170
 v_exp_f32 v171, v171
 v_pk_add_f32 v[172:173], v[152:153], v[154:155]
 v_pk_add_f32 v[174:175], v[162:163], v[164:165]
 v_pk_add_f32 v[172:173], v[172:173], v[156:157]
 v_pk_add_f32 v[174:175], v[174:175], v[166:167]
 v_pk_add_f32 v[172:173], v[172:173], v[158:159]
 v_pk_add_f32 v[174:175], v[174:175], v[168:169]
 v_pk_add_f32 v[172:173], v[172:173], v[160:161]
 v_pk_add_f32 v[174:175], v[174:175], v[170:171]
 v_add_f32 v172, v172, v173
 v_add_f32 v173, v174, v175
 s_nop 1
 v_permlane32_swap_b32 v172, v173
 v_add_f32 v172, v172, v173
 v_rcp_f32 v172, v172
 s_nop 0
 v_mov_b32 v173, v172
 s_nop 1
 v_permlane32_swap_b32 v172, v173
 v_pk_mul_f32 v[152:153], v[172:173], v[152:153] op_sel_hi:[0,1]
 v_cvt_pk_bf16_f32 v104, v152, v153
 v_pk_mul_f32 v[154:155], v[172:173], v[154:155] op_sel_hi:[0,1]
 v_cvt_pk_bf16_f32 v105, v154, v155
 v_pk_mul_f32 v[156:157], v[172:173], v[156:157] op_sel_hi:[0,1]
 v_cvt_pk_bf16_f32 v106, v156, v157
 v_pk_mul_f32 v[158:159], v[172:173], v[158:159] op_sel_hi:[0,1]
 v_cvt_pk_bf16_f32 v107, v158, v159
 ds_write_b128 v12, v[104:107] offset:512
 v_pk_mul_f32 v[160:161], v[172:173], v[160:161] op_sel_hi:[0,1]
 v_cvt_pk_bf16_f32 v108, v160, v161
 v_pk_mul_f32 v[162:163], v[172:173], v[162:163] op_sel:[1,0] op_sel_hi:[1,1]
 v_cvt_pk_bf16_f32 v109, v162, v163
 v_pk_mul_f32 v[164:165], v[172:173], v[164:165] op_sel:[1,0] op_sel_hi:[1,1]
 v_cvt_pk_bf16_f32 v110, v164, v165
 v_pk_mul_f32 v[166:167], v[172:173], v[166:167] op_sel:[1,0] op_sel_hi:[1,1]
 v_cvt_pk_bf16_f32 v111, v166, v167
 ds_write_b128 v12, v[108:111] offset:8960
 v_pk_mul_f32 v[168:169], v[172:173], v[168:169] op_sel:[1,0] op_sel_hi:[1,1]
 v_cvt_pk_bf16_f32 v120, v168, v169
 v_pk_mul_f32 v[170:171], v[172:173], v[170:171] op_sel:[1,0] op_sel_hi:[1,1]
 v_cvt_pk_bf16_f32 v121, v170, v171
 ds_write_b64 v14, v[120:121] offset:30080
 v_mfma_f32_32x32x16_bf16 v[184:199], a[164:167], v[244:247], 0
 v_mfma_f32_32x32x16_bf16 v[184:199], a[172:175], v[248:251], v[184:199]
 v_mfma_f32_32x32x16_bf16 v[136:151], a[164:167], v[112:115], 0
 v_mfma_f32_32x32x16_bf16 v[136:151], a[172:175], v[116:119], v[136:151]
 s_waitcnt lgkmcnt(0)
 s_barrier
 s_add_u32 s43, s43, 0x80000
 v_add_u32 v19, 0x80000, v19
 v_min_u32 v25, 1920, v18
 v_lshrrev_b32 v26, 1, v2
 s_cmp_eq_u32 s22, 3
 s_cbranch_scc1 snokv_15
 ds_read_b64_tr_b16 v[40:41], v15
 ds_read_b64_tr_b16 v[42:43], v15 offset:256
 ds_read_b64_tr_b16 v[44:45], v16
 ds_read_b64_tr_b16 v[46:47], v16 offset:256
 ds_read_b64_tr_b16 v[48:49], v17
 ds_read_b64_tr_b16 v[50:51], v17 offset:256
 ds_read_b64_tr_b16 v[52:53], v15 offset:512
 ds_read_b64_tr_b16 v[54:55], v15 offset:768
 ds_read_b64_tr_b16 v[56:57], v16 offset:512
 ds_read_b64_tr_b16 v[58:59], v16 offset:768
 ds_read_b64_tr_b16 v[60:61], v17 offset:512
 ds_read_b64_tr_b16 v[62:63], v17 offset:768
 s_waitcnt lgkmcnt(8)
 v_mfma_f32_16x16x32_bf16 v[176:179], v[40:43], v[44:47], 0
 s_waitcnt lgkmcnt(6)
 ds_read_b64_tr_b16 v[64:65], v15 offset:1024
 ds_read_b64_tr_b16 v[66:67], v15 offset:1280
 ds_read_b64_tr_b16 v[68:69], v16 offset:1024
 v_mfma_f32_16x16x32_bf16 v[180:183], v[40:43], v[48:51], 0
 s_waitcnt lgkmcnt(5)
 ds_read_b64_tr_b16 v[70:71], v16 offset:1280
 ds_read_b64_tr_b16 v[72:73], v17 offset:1024
 ds_read_b64_tr_b16 v[74:75], v17 offset:1280
 v_mfma_f32_16x16x32_bf16 v[176:179], v[52:55], v[56:59], v[176:179]
 s_waitcnt lgkmcnt(6)
 ds_read_b64_tr_b16 v[76:77], v15 offset:1536
 ds_read_b64_tr_b16 v[78:79], v15 offset:1792
 ds_read_b64_tr_b16 v[80:81], v16 offset:1536
 v_mfma_f32_16x16x32_bf16 v[180:183], v[52:55], v[60:63], v[180:183]
 s_waitcnt lgkmcnt(5)
 ds_read_b64_tr_b16 v[82:83], v16 offset:1792
 ds_read_b64_tr_b16 v[84:85], v17 offset:1536
 ds_read_b64_tr_b16 v[86:87], v17 offset:1792
 v_mfma_f32_16x16x32_bf16 v[176:179], v[64:67], v[68:71], v[176:179]
 s_waitcnt lgkmcnt(6)
 ds_read_b64_tr_b16 v[40:41], v15 offset:2048
 ds_read_b64_tr_b16 v[42:43], v15 offset:2304
 ds_read_b64_tr_b16 v[44:45], v16 offset:2048
 v_mfma_f32_16x16x32_bf16 v[180:183], v[64:67], v[72:75], v[180:183]
 s_waitcnt lgkmcnt(5)
 ds_read_b64_tr_b16 v[46:47], v16 offset:2304
 ds_read_b64_tr_b16 v[48:49], v17 offset:2048
 ds_read_b64_tr_b16 v[50:51], v17 offset:2304
 v_mfma_f32_16x16x32_bf16 v[176:179], v[76:79], v[80:83], v[176:179]
 s_waitcnt lgkmcnt(6)
 ds_read_b64_tr_b16 v[52:53], v15 offset:2560
 ds_read_b64_tr_b16 v[54:55], v15 offset:2816
 ds_read_b64_tr_b16 v[56:57], v16 offset:2560
 v_mfma_f32_16x16x32_bf16 v[180:183], v[76:79], v[84:87], v[180:183]
 s_waitcnt lgkmcnt(5)
 ds_read_b64_tr_b16 v[58:59], v16 offset:2816
 ds_read_b64_tr_b16 v[60:61], v17 offset:2560
 ds_read_b64_tr_b16 v[62:63], v17 offset:2816
 v_mfma_f32_16x16x32_bf16 v[176:179], v[40:43], v[44:47], v[176:179]
 s_waitcnt lgkmcnt(6)
 ds_read_b64_tr_b16 v[64:65], v15 offset:3072
 ds_read_b64_tr_b16 v[66:67], v15 offset:3328
 ds_read_b64_tr_b16 v[68:69], v16 offset:3072
 v_mfma_f32_16x16x32_bf16 v[180:183], v[40:43], v[48:51], v[180:183]
 s_waitcnt lgkmcnt(5)
 ds_read_b64_tr_b16 v[70:71], v16 offset:3328
 ds_read_b64_tr_b16 v[72:73], v17 offset:3072
 ds_read_b64_tr_b16 v[74:75], v17 offset:3328
 v_mfma_f32_16x16x32_bf16 v[176:179], v[52:55], v[56:59], v[176:179]
 s_waitcnt lgkmcnt(6)
 ds_read_b64_tr_b16 v[76:77], v15 offset:3584
 ds_read_b64_tr_b16 v[78:79], v15 offset:3840
 ds_read_b64_tr_b16 v[80:81], v16 offset:3584
 v_mfma_f32_16x16x32_bf16 v[180:183], v[52:55], v[60:63], v[180:183]
 s_waitcnt lgkmcnt(5)
 ds_read_b64_tr_b16 v[82:83], v16 offset:3840
 ds_read_b64_tr_b16 v[84:85], v17 offset:3584
 ds_read_b64_tr_b16 v[86:87], v17 offset:3840
 v_mfma_f32_16x16x32_bf16 v[176:179], v[64:67], v[68:71], v[176:179]
 s_waitcnt lgkmcnt(6)
 v_mfma_f32_16x16x32_bf16 v[180:183], v[64:67], v[72:75], v[180:183]
 s_waitcnt lgkmcnt(2)
 v_mfma_f32_16x16x32_bf16 v[176:179], v[76:79], v[80:83], v[176:179]
 s_waitcnt lgkmcnt(0)
 v_mfma_f32_16x16x32_bf16 v[180:183], v[76:79], v[84:87], v[180:183]
 s_nop 5
 v_cvt_pk_bf16_f32 v84, v176, v177
 v_cvt_pk_bf16_f32 v85, v178, v179
 v_cvt_pk_bf16_f32 v86, v180, v181
 v_cvt_pk_bf16_f32 v87, v182, v183
snokv_15:
 v_min_u32 v84, -2, v84
 v_min_u32 v85, -2, v85
 v_min_u32 v86, -2, v86
 v_min_u32 v87, -2, v87
 buffer_store_dwordx4 v[84:87], v18, s[8:11], s43 offen sc1
 ds_write_b128 v25, v[84:87] offset:39424
 v_max3_f32 v172, v184, v185, v186
 buffer_load_dword v0, v6, s[8:11], 0 offen sc1
 v_max3_f32 v220, v136, v137, v138
 v_max3_f32 v173, -v184, -v185, -v186
 buffer_load_dword v0, v7, s[8:11], 0 offen sc1
 v_max3_f32 v221, -v136, -v137, -v138
 v_max3_f32 v172, v172, v187, v188
 v_max3_f32 v220, v220, v139, v140
 buffer_load_dword v0, v6, s[8:11], s0 offen sc1
 v_max3_f32 v173, v173, -v187, -v188
 v_max3_f32 v221, v221, -v139, -v140
 buffer_load_dword v0, v7, s[8:11], s0 offen sc1
 v_max3_f32 v172, v172, v189, v190
 v_max3_f32 v220, v220, v141, v142
 v_max3_f32 v173, v173, -v189, -v190
 buffer_load_dwordx4 a[104:107], v38, s[8:11], s67 offen sc1
 v_max3_f32 v221, v221, -v141, -v142
 v_max3_f32 v172, v172, v191, v192
 buffer_load_dwordx4 a[108:111], v38, s[8:11], s67 offen offset:1024 sc1
 v_max3_f32 v220, v220, v143, v144
 v_max3_f32 v173, v173, -v191, -v192
 v_max3_f32 v221, v221, -v143, -v144
 buffer_load_dwordx4 a[112:115], v38, s[8:11], s67 offen offset:2048 sc1
 v_max_f32 v172, v172, v193
 v_max_f32 v220, v220, v145
 buffer_load_dwordx4 a[116:119], v38, s[8:11], s67 offen offset:3072 sc1
 v_max_f32 v173, v173, -v193
 v_max_f32 v221, v221, -v145
 s_waitcnt lgkmcnt(0)
 s_barrier
 ds_read_b64 v[88:89], v26 offset:39424
 buffer_load_dwordx4 v[104:107], v38, s[8:11], s68 offen sc1
 v_permlane32_swap_b32 v172, v173
 v_permlane32_swap_b32 v220, v221
 buffer_load_dwordx4 v[108:111], v38, s[8:11], s68 offen offset:1024 sc1
 v_max_f32 v174, v172, v173
 v_max_f32 v222, v220, v221
 v_mul_f32 v172, -v174, v225
 buffer_load_dwordx4 v[112:115], v38, s[8:11], s68 offen offset:2048 sc1
 v_mul_f32 v220, -v222, v227
 v_mul_f32 v173, -v174, v225
 buffer_load_dwordx4 v[116:119], v38, s[8:11], s68 offen offset:3072 sc1
 v_mul_f32 v221, -v222, v227
 v_permlane32_swap_b32 v172, v173
 s_nop 0
 v_permlane32_swap_b32 v220, v221
 buffer_load_dwordx4 v[120:123], v38, s[8:11], s69 offen sc1
 v_pk_fma_f32 v[152:153], v[224:225], v[184:185], v[172:173] op_sel:[1,0,0] op_sel_hi:[1,1,0]
 v_pk_fma_f32 v[40:41], v[226:227], v[136:137], v[220:221] op_sel:[1,0,0] op_sel_hi:[1,1,0]
 v_pk_fma_f32 v[162:163], v[224:225], v[184:185], v[172:173] op_sel:[1,0,1] op_sel_hi:[1,1,1] neg_lo:[1,0,0] neg_hi:[1,0,0]
 v_pk_fma_f32 v[50:51], v[226:227], v[136:137], v[220:221] op_sel:[1,0,1] op_sel_hi:[1,1,1] neg_lo:[1,0,0] neg_hi:[1,0,0]
 v_pk_fma_f32 v[154:155], v[224:225], v[186:187], v[172:173] op_sel:[1,0,0] op_sel_hi:[1,1,0]
 v_pk_fma_f32 v[42:43], v[226:227], v[138:139], v[220:221] op_sel:[1,0,0] op_sel_hi:[1,1,0]
 v_pk_fma_f32 v[164:165], v[224:225], v[186:187], v[172:173] op_sel:[1,0,1] op_sel_hi:[1,1,1] neg_lo:[1,0,0] neg_hi:[1,0,0]
 v_pk_fma_f32 v[52:53], v[226:227], v[138:139], v[220:221] op_sel:[1,0,1] op_sel_hi:[1,1,1] neg_lo:[1,0,0] neg_hi:[1,0,0]
 v_pk_fma_f32 v[156:157], v[224:225], v[188:189], v[172:173] op_sel:[1,0,0] op_sel_hi:[1,1,0]
 v_pk_fma_f32 v[44:45], v[226:227], v[140:141], v[220:221] op_sel:[1,0,0] op_sel_hi:[1,1,0]
 v_pk_fma_f32 v[166:167], v[224:225], v[188:189], v[172:173] op_sel:[1,0,1] op_sel_hi:[1,1,1] neg_lo:[1,0,0] neg_hi:[1,0,0]
 v_pk_fma_f32 v[54:55], v[226:227], v[140:141], v[220:221] op_sel:[1,0,1] op_sel_hi:[1,1,1] neg_lo:[1,0,0] neg_hi:[1,0,0]
 v_pk_fma_f32 v[158:159], v[224:225], v[190:191], v[172:173] op_sel:[1,0,0] op_sel_hi:[1,1,0]
 v_pk_fma_f32 v[46:47], v[226:227], v[142:143], v[220:221] op_sel:[1,0,0] op_sel_hi:[1,1,0]
 v_pk_fma_f32 v[168:169], v[224:225], v[190:191], v[172:173] op_sel:[1,0,1] op_sel_hi:[1,1,1] neg_lo:[1,0,0] neg_hi:[1,0,0]
 v_pk_fma_f32 v[56:57], v[226:227], v[142:143], v[220:221] op_sel:[1,0,1] op_sel_hi:[1,1,1] neg_lo:[1,0,0] neg_hi:[1,0,0]
 v_pk_fma_f32 v[160:161], v[224:225], v[192:193], v[172:173] op_sel:[1,0,0] op_sel_hi:[1,1,0]
 v_pk_fma_f32 v[48:49], v[226:227], v[144:145], v[220:221] op_sel:[1,0,0] op_sel_hi:[1,1,0]
 v_pk_fma_f32 v[170:171], v[224:225], v[192:193], v[172:173] op_sel:[1,0,1] op_sel_hi:[1,1,1] neg_lo:[1,0,0] neg_hi:[1,0,0]
 v_pk_fma_f32 v[58:59], v[226:227], v[144:145], v[220:221] op_sel:[1,0,1] op_sel_hi:[1,1,1] neg_lo:[1,0,0] neg_hi:[1,0,0]
 v_exp_f32 v152, v152
 v_exp_f32 v40, v40
 v_exp_f32 v153, v153
 v_exp_f32 v41, v41
 v_exp_f32 v154, v154
 v_exp_f32 v42, v42
 v_exp_f32 v155, v155
 v_exp_f32 v43, v43
 v_exp_f32 v156, v156
 v_exp_f32 v44, v44
 v_exp_f32 v157, v157
 v_exp_f32 v45, v45
 v_exp_f32 v158, v158
 v_exp_f32 v46, v46
 v_exp_f32 v159, v159
 v_exp_f32 v47, v47
 s_xor_b32 s86, s4, 2048
 buffer_load_dwordx2 v[90:91], v19, s[8:11], s86 offen sc1
 s_xor_b32 s86, s4, 4096
 buffer_load_dwordx2 v[92:93], v19, s[8:11], s86 offen sc1
 s_xor_b32 s86, s4, 6144
 buffer_load_dwordx2 v[94:95], v19, s[8:11], s86 offen sc1
 s_xor_b32 s86, s4, 8192
 buffer_load_dwordx2 v[96:97], v19, s[8:11], s86 offen sc1
 s_xor_b32 s86, s4, 10240
 buffer_load_dwordx2 v[98:99], v19, s[8:11], s86 offen sc1
 s_xor_b32 s86, s4, 12288
 buffer_load_dwordx2 v[100:101], v19, s[8:11], s86 offen sc1
 s_xor_b32 s86, s4, 14336
 buffer_load_dwordx2 v[102:103], v19, s[8:11], s86 offen sc1
 v_exp_f32 v160, v160
 v_exp_f32 v48, v48
 v_exp_f32 v161, v161
 v_exp_f32 v49, v49
 v_exp_f32 v162, v162
 v_exp_f32 v50, v50
 v_exp_f32 v163, v163
 v_exp_f32 v51, v51
 v_exp_f32 v164, v164
 v_exp_f32 v52, v52
 v_exp_f32 v165, v165
 v_exp_f32 v53, v53
 v_exp_f32 v166, v166
 v_exp_f32 v54, v54
 v_exp_f32 v167, v167
 v_exp_f32 v55, v55
 v_exp_f32 v168, v168
 v_exp_f32 v56, v56
 v_exp_f32 v169, v169
 v_exp_f32 v57, v57
 v_exp_f32 v170, v170
 v_exp_f32 v58, v58
 v_exp_f32 v171, v171
 v_exp_f32 v59, v59
 v_pk_add_f32 v[172:173], v[152:153], v[154:155]
 v_pk_add_f32 v[220:221], v[40:41], v[42:43]
 v_pk_add_f32 v[174:175], v[162:163], v[164:165]
 v_pk_add_f32 v[222:223], v[50:51], v[52:53]
 v_pk_add_f32 v[172:173], v[172:173], v[156:157]
 v_pk_add_f32 v[220:221], v[220:221], v[44:45]
 v_pk_add_f32 v[174:175], v[174:175], v[166:167]
 v_pk_add_f32 v[222:223], v[222:223], v[54:55]
 v_pk_add_f32 v[172:173], v[172:173], v[158:159]
 v_pk_add_f32 v[220:221], v[220:221], v[46:47]
 v_pk_add_f32 v[174:175], v[174:175], v[168:169]
 v_pk_add_f32 v[222:223], v[222:223], v[56:57]
 v_pk_add_f32 v[172:173], v[172:173], v[160:161]
 v_pk_add_f32 v[220:221], v[220:221], v[48:49]
 v_pk_add_f32 v[174:175], v[174:175], v[170:171]
 v_pk_add_f32 v[222:223], v[222:223], v[58:59]
 v_add_f32 v172, v172, v173
 v_add_f32 v220, v220, v221
 v_add_f32 v173, v174, v175
 v_add_f32 v221, v222, v223
 s_nop 0
 v_permlane32_swap_b32 v172, v173
 v_permlane32_swap_b32 v220, v221
 v_add_f32 v172, v172, v173
 v_add_f32 v220, v220, v221
 v_rcp_f32 v172, v172
 v_rcp_f32 v220, v220
 v_mov_b32 v173, v172
 v_mov_b32 v221, v220
 s_nop 0
 v_permlane32_swap_b32 v172, v173
 v_permlane32_swap_b32 v220, v221
 v_pk_mul_f32 v[152:153], v[172:173], v[152:153] op_sel_hi:[0,1]
 v_pk_mul_f32 v[40:41], v[220:221], v[40:41] op_sel_hi:[0,1]
 v_cvt_pk_bf16_f32 v232, v152, v153
 v_cvt_pk_bf16_f32 v244, v40, v41
 v_pk_mul_f32 v[154:155], v[172:173], v[154:155] op_sel_hi:[0,1]
 v_pk_mul_f32 v[42:43], v[220:221], v[42:43] op_sel_hi:[0,1]
 v_cvt_pk_bf16_f32 v233, v154, v155
 v_cvt_pk_bf16_f32 v245, v42, v43
 v_pk_mul_f32 v[156:157], v[172:173], v[156:157] op_sel_hi:[0,1]
 v_pk_mul_f32 v[44:45], v[220:221], v[44:45] op_sel_hi:[0,1]
 v_cvt_pk_bf16_f32 v234, v156, v157
 v_cvt_pk_bf16_f32 v246, v44, v45
 v_pk_mul_f32 v[158:159], v[172:173], v[158:159] op_sel_hi:[0,1]
 v_pk_mul_f32 v[46:47], v[220:221], v[46:47] op_sel_hi:[0,1]
 v_cvt_pk_bf16_f32 v235, v158, v159
 v_cvt_pk_bf16_f32 v247, v46, v47
 v_pk_mul_f32 v[160:161], v[172:173], v[160:161] op_sel_hi:[0,1]
 v_pk_mul_f32 v[48:49], v[220:221], v[48:49] op_sel_hi:[0,1]
 v_cvt_pk_bf16_f32 v236, v160, v161
 v_cvt_pk_bf16_f32 v248, v48, v49
 v_pk_mul_f32 v[162:163], v[172:173], v[162:163] op_sel:[1,0] op_sel_hi:[1,1]
 v_pk_mul_f32 v[50:51], v[220:221], v[50:51] op_sel:[1,0] op_sel_hi:[1,1]
 v_cvt_pk_bf16_f32 v237, v162, v163
 v_cvt_pk_bf16_f32 v249, v50, v51
 v_pk_mul_f32 v[164:165], v[172:173], v[164:165] op_sel:[1,0] op_sel_hi:[1,1]
 v_pk_mul_f32 v[52:53], v[220:221], v[52:53] op_sel:[1,0] op_sel_hi:[1,1]
 v_cvt_pk_bf16_f32 v238, v164, v165
 v_cvt_pk_bf16_f32 v250, v52, v53
 v_pk_mul_f32 v[166:167], v[172:173], v[166:167] op_sel:[1,0] op_sel_hi:[1,1]
 v_pk_mul_f32 v[54:55], v[220:221], v[54:55] op_sel:[1,0] op_sel_hi:[1,1]
 v_cvt_pk_bf16_f32 v239, v166, v167
 v_cvt_pk_bf16_f32 v251, v54, v55
 v_pk_mul_f32 v[168:169], v[172:173], v[168:169] op_sel:[1,0] op_sel_hi:[1,1]
 v_pk_mul_f32 v[56:57], v[220:221], v[56:57] op_sel:[1,0] op_sel_hi:[1,1]
 v_cvt_pk_bf16_f32 v240, v168, v169
 v_cvt_pk_bf16_f32 v252, v56, v57
 v_pk_mul_f32 v[170:171], v[172:173], v[170:171] op_sel:[1,0] op_sel_hi:[1,1]
 v_pk_mul_f32 v[58:59], v[220:221], v[58:59] op_sel:[1,0] op_sel_hi:[1,1]
 v_cvt_pk_bf16_f32 v241, v170, v171
 v_cvt_pk_bf16_f32 v253, v58, v59
 v_mov_b32 v242, 0
 v_mov_b32 v254, 0
 v_mov_b32 v243, 0
 v_mov_b32 v255, 0
 v_mov_b32 v25, 0x3f80
 v_mov_b32 v26, 0x3f800000
 v_mov_b32 v74, 0
 v_mov_b32 v75, 0
skvspin_16:
 s_waitcnt lgkmcnt(0)
 v_dot2_f32_bf16 v60, v88, v25, 0
 v_dot2_f32_bf16 v61, v88, v26, 0
 v_dot2_f32_bf16 v62, v89, v25, 0
 v_dot2_f32_bf16 v63, v89, v26, 0
 s_waitcnt vmcnt(6)
 v_max3_u32 v172, 0, v90, v91
 v_dot2_f32_bf16 v60, v90, v25, v60
 v_dot2_f32_bf16 v61, v90, v26, v61
 v_dot2_f32_bf16 v62, v91, v25, v62
 v_dot2_f32_bf16 v63, v91, v26, v63
 s_waitcnt vmcnt(5)
 v_max3_u32 v172, v172, v92, v93
 v_dot2_f32_bf16 v60, v92, v25, v60
 v_dot2_f32_bf16 v61, v92, v26, v61
 v_dot2_f32_bf16 v62, v93, v25, v62
 v_dot2_f32_bf16 v63, v93, v26, v63
 s_waitcnt vmcnt(4)
 v_max3_u32 v172, v172, v94, v95
 v_dot2_f32_bf16 v60, v94, v25, v60
 v_dot2_f32_bf16 v61, v94, v26, v61
 v_dot2_f32_bf16 v62, v95, v25, v62
 v_dot2_f32_bf16 v63, v95, v26, v63
 s_waitcnt vmcnt(3)
 v_max3_u32 v172, v172, v96, v97
 v_dot2_f32_bf16 v60, v96, v25, v60
 v_dot2_f32_bf16 v61, v96, v26, v61
 v_dot2_f32_bf16 v62, v97, v25, v62
 v_dot2_f32_bf16 v63, v97, v26, v63
 s_waitcnt vmcnt(2)
 v_max3_u32 v172, v172, v98, v99
 v_dot2_f32_bf16 v60, v98, v25, v60
 v_dot2_f32_bf16 v61, v98, v26, v61
 v_dot2_f32_bf16 v62, v99, v25, v62
 v_dot2_f32_bf16 v63, v99, v26, v63
 s_waitcnt vmcnt(1)
 v_max3_u32 v172, v172, v100, v101
 v_dot2_f32_bf16 v60, v100, v25, v60
 v_dot2_f32_bf16 v61, v100, v26, v61
 v_dot2_f32_bf16 v62, v101, v25, v62
 v_dot2_f32_bf16 v63, v101, v26, v63
 s_waitcnt vmcnt(0)
 v_max3_u32 v172, v172, v102, v103
 v_cmp_eq_u32 vcc, -1, v172
 v_dot2_f32_bf16 v60, v102, v25, v60
 v_dot2_f32_bf16 v61, v102, v26, v61
 v_dot2_f32_bf16 v62, v103, v25, v62
 v_dot2_f32_bf16 v63, v103, v26, v63
 s_cbranch_vccz skvok_17
skvretry_18:
 s_xor_b32 s86, s4, 2048
 buffer_load_dwordx2 v[90:91], v19, s[8:11], s86 offen sc1
 s_xor_b32 s86, s4, 4096
 buffer_load_dwordx2 v[92:93], v19, s[8:11], s86 offen sc1
 s_xor_b32 s86, s4, 6144
 buffer_load_dwordx2 v[94:95], v19, s[8:11], s86 offen sc1
 s_xor_b32 s86, s4, 8192
 buffer_load_dwordx2 v[96:97], v19, s[8:11], s86 offen sc1
 s_xor_b32 s86, s4, 10240
 buffer_load_dwordx2 v[98:99], v19, s[8:11], s86 offen sc1
 s_xor_b32 s86, s4, 12288
 buffer_load_dwordx2 v[100:101], v19, s[8:11], s86 offen sc1
 s_xor_b32 s86, s4, 14336
 buffer_load_dwordx2 v[102:103], v19, s[8:11], s86 offen sc1
 s_waitcnt vmcnt(6)
 v_max3_u32 v172, 0, v90, v91
 s_waitcnt vmcnt(5)
 v_max3_u32 v172, v172, v92, v93
 s_waitcnt vmcnt(4)
 v_max3_u32 v172, v172, v94, v95
 s_waitcnt vmcnt(3)
 v_max3_u32 v172, v172, v96, v97
 s_waitcnt vmcnt(2)
 v_max3_u32 v172, v172, v98, v99
 s_waitcnt vmcnt(1)
 v_max3_u32 v172, v172, v100, v101
 s_waitcnt vmcnt(0)
 v_max3_u32 v172, v172, v102, v103
 v_cmp_eq_u32 vcc, -1, v172
 s_cbranch_vccz skvspin_16
 s_add_u32 s29, s29, 1
 s_cmp_lt_u32 s29, 524288
 s_cbranch_scc1 skvretry_18
skvok_17:
 s_nop 1
 v_cvt_pk_bf16_f32 v88, v60, v61
 v_cvt_pk_bf16_f32 v89, v62, v63
 ds_write_b64 v20, v[88:89]
 buffer_load_dwordx4 a[156:159], v38, s[8:11], s66 offen offset:1024 sc1
 buffer_load_dwordx4 a[160:163], v38, s[8:11], s66 offen offset:2048 sc1
 buffer_load_dwordx4 v[124:127], v38, s[8:11], s69 offen offset:1024 sc1
 buffer_load_dwordx4 v[128:131], v38, s[8:11], s69 offen offset:2048 sc1
 s_waitcnt lgkmcnt(0)
 s_barrier
 ds_read_b128 v[64:67], v1 offset:35840
 ds_read_b128 v[68:71], v1 offset:36864
 ds_read_b64 v[72:73], v1 offset:37888
 s_waitcnt lgkmcnt(2)
 v_mfma_f32_32x32x16_bf16 v[184:199], v[64:67], v[232:235], 0
 s_waitcnt lgkmcnt(1)
 v_mfma_f32_32x32x16_bf16 v[184:199], v[68:71], v[236:239], v[184:199]
 s_waitcnt lgkmcnt(0)
 v_mfma_f32_32x32x16_bf16 v[184:199], v[72:75], v[240:243], v[184:199]
 v_mfma_f32_32x32x16_bf16 v[136:151], v[64:67], v[244:247], 0
 v_mfma_f32_32x32x16_bf16 v[136:151], v[68:71], v[248:251], v[136:151]
 v_mfma_f32_32x32x16_bf16 v[136:151], v[72:75], v[252:255], v[136:151]
 s_nop 8
 v_add_f32 v196, 0x358637bd, v196
 v_rcp_f32 v196, v196
 s_nop 0
 v_mul_f32 v184, v184, v196
 v_mul_f32 v185, v185, v196
 v_cvt_pk_bf16_f32 v40, v184, v185
 v_mul_f32 v186, v186, v196
 v_mul_f32 v187, v187, v196
 v_cvt_pk_bf16_f32 v41, v186, v187
 v_mul_f32 v188, v188, v196
 v_mul_f32 v189, v189, v196
 v_cvt_pk_bf16_f32 v42, v188, v189
 v_pk_mul_f32 v[190:191], v[190:191], v[196:197] op_sel_hi:[1,0]
 v_cvt_pk_bf16_f32 v43, v190, v191
 buffer_store_dwordx4 v[40:43], v6, s[8:11], 0 offen sc1
 v_pk_mul_f32 v[192:193], v[192:193], v[196:197] op_sel_hi:[1,0]
 v_cvt_pk_bf16_f32 v44, v192, v193
 v_pk_mul_f32 v[194:195], v[194:195], v[196:197] op_sel_hi:[1,0]
 v_cvt_pk_bf16_f32 v45, v194, v195
 buffer_store_dwordx2 v[44:45], v7, s[8:11], 0 offen sc1
 v_add_f32 v148, 0x358637bd, v148
 v_rcp_f32 v148, v148
 s_nop 0
 v_pk_mul_f32 v[136:137], v[136:137], v[148:149] op_sel_hi:[1,0]
 v_cvt_pk_bf16_f32 v48, v136, v137
 v_pk_mul_f32 v[138:139], v[138:139], v[148:149] op_sel_hi:[1,0]
 v_cvt_pk_bf16_f32 v49, v138, v139
 v_pk_mul_f32 v[140:141], v[140:141], v[148:149] op_sel_hi:[1,0]
 v_cvt_pk_bf16_f32 v50, v140, v141
 v_pk_mul_f32 v[142:143], v[142:143], v[148:149] op_sel_hi:[1,0]
 v_cvt_pk_bf16_f32 v51, v142, v143
 buffer_store_dwordx4 v[48:51], v6, s[8:11], s0 offen sc1
 v_pk_mul_f32 v[144:145], v[144:145], v[148:149] op_sel_hi:[1,0]
 v_cvt_pk_bf16_f32 v52, v144, v145
 v_pk_mul_f32 v[146:147], v[146:147], v[148:149] op_sel_hi:[1,0]
 v_cvt_pk_bf16_f32 v53, v146, v147
 buffer_store_dwordx2 v[52:53], v7, s[8:11], s0 offen sc1
 s_add_u32 m0, s28, 147456
 s_add_u32 s85, s35, 65536
 buffer_load_dwordx4 v3, s[8:11], s85 offen sc1 lds
 buffer_load_dwordx4 v3, s[8:11], s85 offen offset:1024 sc1 lds
 s_add_u32 s31, s22, 3
 s_and_b32 s31, s31, 3
 s_mul_i32 s31, s31, 5120
 s_add_u32 s31, s31, 2048
 v_add_u32 v220, s31, v22
 s_add_u32 s31, s22, 2
 s_and_b32 s31, s31, 3
 s_mul_i32 s31, s31, 5120
 s_add_u32 s31, s31, 2048
 v_add_u32 v221, s31, v22
 s_add_u32 s31, s22, 1
 s_and_b32 s31, s31, 3
 s_mul_i32 s31, s31, 5120
 s_add_u32 s31, s31, 2048
 v_add_u32 v222, s31, v22
 v_lshlrev_b32 v192, 16, v28
 v_and_b32 v193, 0xffff0000, v28
 v_lshlrev_b32 v194, 16, v29
 v_and_b32 v195, 0xffff0000, v29
 v_lshlrev_b32 v196, 16, v30
 v_and_b32 v197, 0xffff0000, v30
 v_lshlrev_b32 v198, 16, v31
 v_and_b32 v199, 0xffff0000, v31
 v_lshlrev_b32 v200, 16, v32
 v_and_b32 v201, 0xffff0000, v32
 v_lshlrev_b32 v202, 16, v33
 v_and_b32 v203, 0xffff0000, v33
 v_lshlrev_b32 v204, 16, v34
 v_and_b32 v205, 0xffff0000, v34
 v_lshlrev_b32 v206, 16, v35
 v_and_b32 v207, 0xffff0000, v35
 v_lshlrev_b32 v208, 16, v36
 v_and_b32 v209, 0xffff0000, v36
 v_lshlrev_b32 v210, 16, v37
 v_and_b32 v211, 0xffff0000, v37
 s_add_u32 s30, s52, 4096
 s_add_u32 s31, s53, 4096
 s_add_u32 s32, s54, 4096
 s_add_u32 s33, s55, 4096
 v_mov_b32 v27, 2
 s_waitcnt vmcnt(2)
 s_mov_b64 exec, 1
 buffer_store_dword v27, off, s[8:11], s46 sc1
 s_mov_b64 exec, -1
 buffer_load_dwordx4 v[132:135], v38, s[8:11], s69 offen offset:3072 sc1
 buffer_load_dwordx4 v[216:219], v38, s[8:11], s70 offen sc1
 v_and_b32 v25, 28, v22
 buffer_load_dword v26, v25, s[8:11], s47 offen sc1
sspin_19:
 buffer_load_dword v0, v25, s[8:11], s47 offen sc1
 s_waitcnt vmcnt(1)
 v_cmp_gt_u32 vcc, 2, v26
 s_cbranch_vccz sok_20
 buffer_load_dword v26, v25, s[8:11], s47 offen sc1
 s_waitcnt vmcnt(1)
 v_cmp_gt_u32 vcc, 2, v0
 s_cbranch_vccz sok_20
 s_add_u32 s29, s29, 1
 s_cmp_lt_u32 s29, 524288
 s_cbranch_scc1 sspin_19
sok_20:
 buffer_load_dwordx4 v[40:43], v1, s[8:11], s52 offen sc1
 buffer_load_dwordx4 v[44:47], v1, s[8:11], s52 offen offset:1024 sc1
 buffer_load_dwordx4 v[48:51], v1, s[8:11], s52 offen offset:2048 sc1
 buffer_load_dwordx4 v[52:55], v1, s[8:11], s52 offen offset:3072 sc1
 s_waitcnt vmcnt(3)
 v_mfma_f32_16x16x32_bf16 v[152:155], a[120:123], v[40:43], 0
 buffer_load_dwordx4 v[56:59], v1, s[8:11], s30 offen sc1
 v_mfma_f32_16x16x32_bf16 v[156:159], a[124:127], v[40:43], 0
 v_mfma_f32_16x16x32_bf16 v[160:163], a[128:131], v[40:43], 0
 v_mfma_f32_16x16x32_bf16 v[164:167], a[132:135], v[40:43], 0
 v_mfma_f32_16x16x32_bf16 v[168:171], a[136:139], v[40:43], 0
 s_waitcnt vmcnt(3)
 buffer_load_dwordx4 v[60:63], v1, s[8:11], s53 offen sc1
 v_mfma_f32_16x16x32_bf16 v[152:155], a[140:143], v[44:47], v[152:155]
 v_mfma_f32_16x16x32_bf16 v[156:159], a[144:147], v[44:47], v[156:159]
 v_mfma_f32_16x16x32_bf16 v[160:163], a[148:151], v[44:47], v[160:163]
 v_mfma_f32_16x16x32_bf16 v[164:167], a[152:155], v[44:47], v[164:167]
 buffer_load_dwordx4 v[64:67], v1, s[8:11], s53 offen offset:1024 sc1
 v_mfma_f32_16x16x32_bf16 v[168:171], a[156:159], v[44:47], v[168:171]
 s_waitcnt vmcnt(4)
 v_mfma_f32_16x16x32_bf16 v[152:155], a[160:163], v[48:51], v[152:155]
 v_mfma_f32_16x16x32_bf16 v[156:159], a[100:103], v[48:51], v[156:159]
 v_mfma_f32_16x16x32_bf16 v[160:163], a[104:107], v[48:51], v[160:163]
 buffer_load_dwordx4 v[68:71], v1, s[8:11], s53 offen offset:2048 sc1
 v_mfma_f32_16x16x32_bf16 v[164:167], a[108:111], v[48:51], v[164:167]
 v_mfma_f32_16x16x32_bf16 v[168:171], a[112:115], v[48:51], v[168:171]
 s_waitcnt vmcnt(4)
 v_mfma_f32_16x16x32_bf16 v[152:155], a[116:119], v[52:55], v[152:155]
 v_mfma_f32_16x16x32_bf16 v[156:159], v[104:107], v[52:55], v[156:159]
 buffer_load_dwordx4 v[72:75], v1, s[8:11], s53 offen offset:3072 sc1
 v_mfma_f32_16x16x32_bf16 v[160:163], v[108:111], v[52:55], v[160:163]
 v_mfma_f32_16x16x32_bf16 v[164:167], v[112:115], v[52:55], v[164:167]
 v_mfma_f32_16x16x32_bf16 v[168:171], v[116:119], v[52:55], v[168:171]
 s_waitcnt vmcnt(4)
 v_mfma_f32_16x16x32_bf16 v[152:155], v[120:123], v[56:59], v[152:155]
 buffer_load_dwordx4 v[76:79], v1, s[8:11], s31 offen sc1
 v_mfma_f32_16x16x32_bf16 v[156:159], v[124:127], v[56:59], v[156:159]
 v_mfma_f32_16x16x32_bf16 v[160:163], v[128:131], v[56:59], v[160:163]
 v_mfma_f32_16x16x32_bf16 v[164:167], v[132:135], v[56:59], v[164:167]
 v_mfma_f32_16x16x32_bf16 v[168:171], v[216:219], v[56:59], v[168:171]
 s_waitcnt vmcnt(4)
 buffer_load_dwordx4 v[80:83], v1, s[8:11], s54 offen sc1
 v_mfma_f32_16x16x32_bf16 v[172:175], a[120:123], v[60:63], 0
 v_mfma_f32_16x16x32_bf16 v[176:179], a[124:127], v[60:63], 0
 v_mfma_f32_16x16x32_bf16 v[180:183], a[128:131], v[60:63], 0
 s_mov_b32 m0, s7
 s_nop 0
 ds_write_addtid_b32 v152
 ds_write_addtid_b32 v153 offset:256
 v_mfma_f32_16x16x32_bf16 v[184:187], a[132:135], v[60:63], 0
 buffer_load_dwordx4 v[84:87], v1, s[8:11], s54 offen offset:1024 sc1
 ds_write_addtid_b32 v154 offset:512
 v_mfma_f32_16x16x32_bf16 v[188:191], a[136:139], v[60:63], 0
 s_waitcnt vmcnt(5)
 ds_write_addtid_b32 v155 offset:768
 ds_write_addtid_b32 v156 offset:1024
 v_mfma_f32_16x16x32_bf16 v[172:175], a[140:143], v[64:67], v[172:175]
 ds_write_addtid_b32 v157 offset:1280
 ds_write_addtid_b32 v158 offset:1536
 v_mfma_f32_16x16x32_bf16 v[176:179], a[144:147], v[64:67], v[176:179]
 ds_write_addtid_b32 v159 offset:1792
 ds_write_addtid_b32 v160 offset:2048
 v_mfma_f32_16x16x32_bf16 v[180:183], a[148:151], v[64:67], v[180:183]
 buffer_load_dwordx4 v[88:91], v1, s[8:11], s54 offen offset:2048 sc1
 ds_write_addtid_b32 v161 offset:2304
 ds_write_addtid_b32 v162 offset:2560
 v_mfma_f32_16x16x32_bf16 v[184:187], a[152:155], v[64:67], v[184:187]
 ds_write_addtid_b32 v163 offset:2816
 ds_write_addtid_b32 v164 offset:3072
 v_mfma_f32_16x16x32_bf16 v[188:191], a[156:159], v[64:67], v[188:191]
 s_waitcnt vmcnt(5)
 ds_write_addtid_b32 v165 offset:3328
 ds_write_addtid_b32 v166 offset:3584
 v_mfma_f32_16x16x32_bf16 v[172:175], a[160:163], v[68:71], v[172:175]
 ds_write_addtid_b32 v167 offset:3840
 ds_write_addtid_b32 v168 offset:4096
 v_mfma_f32_16x16x32_bf16 v[176:179], a[100:103], v[68:71], v[176:179]
 buffer_load_dwordx4 v[92:95], v1, s[8:11], s54 offen offset:3072 sc1
 ds_write_addtid_b32 v169 offset:4352
 v_mfma_f32_16x16x32_bf16 v[180:183], a[104:107], v[68:71], v[180:183]
 ds_write_addtid_b32 v170 offset:4608
 ds_write_addtid_b32 v171 offset:4864
 v_mfma_f32_16x16x32_bf16 v[184:187], a[108:111], v[68:71], v[184:187]
 v_mfma_f32_16x16x32_bf16 v[188:191], a[112:115], v[68:71], v[188:191]
 s_waitcnt vmcnt(5)
 v_mfma_f32_16x16x32_bf16 v[172:175], a[116:119], v[72:75], v[172:175]
 buffer_load_dwordx4 v[96:99], v1, s[8:11], s32 offen sc1
 v_mfma_f32_16x16x32_bf16 v[176:179], v[104:107], v[72:75], v[176:179]
 s_waitcnt lgkmcnt(0)
 s_barrier
 v_mfma_f32_16x16x32_bf16 v[180:183], v[108:111], v[72:75], v[180:183]
 ds_read2st64_b32 v[40:41], v220 offset0:0 offset1:1
 v_mfma_f32_16x16x32_bf16 v[184:187], v[112:115], v[72:75], v[184:187]
 ds_read2st64_b32 v[42:43], v220 offset0:2 offset1:3
 v_mfma_f32_16x16x32_bf16 v[188:191], v[116:119], v[72:75], v[188:191]
 s_waitcnt vmcnt(5)
 buffer_load_dwordx4 v[100:103], v1, s[8:11], s55 offen sc1
 ds_read2st64_b32 v[44:45], v220 offset0:4 offset1:5
 v_mfma_f32_16x16x32_bf16 v[172:175], v[120:123], v[76:79], v[172:175]
 ds_read2st64_b32 v[46:47], v220 offset0:6 offset1:7
 v_mfma_f32_16x16x32_bf16 v[176:179], v[124:127], v[76:79], v[176:179]
 ds_read2st64_b32 v[48:49], v220 offset0:8 offset1:9
 v_mfma_f32_16x16x32_bf16 v[180:183], v[128:131], v[76:79], v[180:183]
 ds_read2st64_b32 v[50:51], v220 offset0:10 offset1:11
 v_mfma_f32_16x16x32_bf16 v[184:187], v[132:135], v[76:79], v[184:187]
 buffer_load_dwordx4 v[136:139], v1, s[8:11], s55 offen offset:1024 sc1
 ds_read2st64_b32 v[52:53], v220 offset0:12 offset1:13
 v_mfma_f32_16x16x32_bf16 v[188:191], v[216:219], v[76:79], v[188:191]
 s_waitcnt vmcnt(6)
 ds_read2st64_b32 v[54:55], v220 offset0:14 offset1:15
 v_mfma_f32_16x16x32_bf16 v[152:155], a[120:123], v[80:83], 0
 ds_read2st64_b32 v[56:57], v220 offset0:16 offset1:17
 v_mfma_f32_16x16x32_bf16 v[156:159], a[124:127], v[80:83], 0
 ds_read2st64_b32 v[58:59], v220 offset0:18 offset1:19
 v_mfma_f32_16x16x32_bf16 v[160:163], a[128:131], v[80:83], 0
 buffer_load_dwordx4 v[140:143], v1, s[8:11], s55 offen offset:2048 sc1
 ds_write_addtid_b32 v172 offset:20480
 v_mfma_f32_16x16x32_bf16 v[164:167], a[132:135], v[80:83], 0
 ds_write_addtid_b32 v173 offset:20736
 ds_write_addtid_b32 v174 offset:20992
 v_mfma_f32_16x16x32_bf16 v[168:171], a[136:139], v[80:83], 0
 s_waitcnt vmcnt(6) lgkmcnt(12)
 ds_write_addtid_b32 v175 offset:21248
 ds_write_addtid_b32 v176 offset:21504
 ds_write_addtid_b32 v177 offset:21760
 v_add_f32 v192, v192, v40
 v_mfma_f32_16x16x32_bf16 v[152:155], a[140:143], v[84:87], v[152:155]
 ds_write_addtid_b32 v178 offset:22016
 ds_write_addtid_b32 v179 offset:22272
 v_mfma_f32_16x16x32_bf16 v[156:159], a[144:147], v[84:87], v[156:159]
 buffer_load_dwordx4 v[144:147], v1, s[8:11], s55 offen offset:3072 sc1
 ds_write_addtid_b32 v180 offset:22528
 v_add_f32 v193, v193, v41
 v_mfma_f32_16x16x32_bf16 v[160:163], a[148:151], v[84:87], v[160:163]
 ds_write_addtid_b32 v181 offset:22784
 ds_write_addtid_b32 v182 offset:23040
 v_mfma_f32_16x16x32_bf16 v[164:167], a[152:155], v[84:87], v[164:167]
 ds_write_addtid_b32 v183 offset:23296
 ds_write_addtid_b32 v184 offset:23552
 v_mfma_f32_16x16x32_bf16 v[168:171], a[156:159], v[84:87], v[168:171]
 s_waitcnt vmcnt(6) lgkmcnt(13)
 ds_write_addtid_b32 v185 offset:23808
 ds_write_addtid_b32 v186 offset:24064
 v_add_f32 v194, v194, v42
 v_mfma_f32_16x16x32_bf16 v[152:155], a[160:163], v[88:91], v[152:155]
 buffer_load_dwordx4 v[148:151], v1, s[8:11], s33 offen sc1
 ds_write_addtid_b32 v187 offset:24320
 ds_write_addtid_b32 v188 offset:24576
 v_mfma_f32_16x16x32_bf16 v[156:159], a[100:103], v[88:91], v[156:159]
 s_add_u32 m0, s28, 131072
 s_add_u32 s85, s35, 49152
 buffer_load_dwordx4 v3, s[8:11], s85 offen sc1 lds
 s_mov_b32 m0, s7
 s_nop 0
 ds_write_addtid_b32 v189 offset:24832
 v_add_f32 v195, v195, v43
 v_mfma_f32_16x16x32_bf16 v[160:163], a[104:107], v[88:91], v[160:163]
 ds_write_addtid_b32 v190 offset:25088
 ds_write_addtid_b32 v191 offset:25344
 v_mfma_f32_16x16x32_bf16 v[164:167], a[108:111], v[88:91], v[164:167]
 v_add_f32 v196, v196, v44
 v_add_f32 v197, v197, v45
 v_mfma_f32_16x16x32_bf16 v[168:171], a[112:115], v[88:91], v[168:171]
 s_waitcnt vmcnt(7)
 s_add_u32 m0, s28, 131072
 s_nop 0
 buffer_load_dwordx4 v3, s[8:11], s85 offen offset:1024 sc1 lds
 v_add_f32 v198, v198, v46
 v_add_f32 v199, v199, v47
 v_mfma_f32_16x16x32_bf16 v[152:155], a[116:119], v[92:95], v[152:155]
 v_add_f32 v200, v200, v48
 v_add_f32 v201, v201, v49
 v_mfma_f32_16x16x32_bf16 v[156:159], v[104:107], v[92:95], v[156:159]
 s_waitcnt lgkmcnt(0)
 s_barrier
 v_add_f32 v202, v202, v50
 v_add_f32 v203, v203, v51
 v_mfma_f32_16x16x32_bf16 v[160:163], v[108:111], v[92:95], v[160:163]
 ds_read2st64_b32 v[60:61], v221 offset0:80 offset1:81
 v_add_f32 v204, v204, v52
 v_add_f32 v205, v205, v53
 v_mfma_f32_16x16x32_bf16 v[164:167], v[112:115], v[92:95], v[164:167]
 buffer_load_dwordx4 v3, s[8:11], s85 offen offset:2048 sc1 lds
 ds_read2st64_b32 v[62:63], v221 offset0:82 offset1:83
 v_mfma_f32_16x16x32_bf16 v[168:171], v[116:119], v[92:95], v[168:171]
 s_waitcnt vmcnt(8)
 ds_read2st64_b32 v[64:65], v221 offset0:84 offset1:85
 v_add_f32 v206, v206, v54
 v_mfma_f32_16x16x32_bf16 v[152:155], v[120:123], v[96:99], v[152:155]
 ds_read2st64_b32 v[66:67], v221 offset0:86 offset1:87
 v_add_f32 v207, v207, v55
 v_add_f32 v208, v208, v56
 v_mfma_f32_16x16x32_bf16 v[156:159], v[124:127], v[96:99], v[156:159]
 buffer_load_dwordx4 v3, s[8:11], s85 offen offset:3072 sc1 lds
 ds_read2st64_b32 v[68:69], v221 offset0:88 offset1:89
 v_mfma_f32_16x16x32_bf16 v[160:163], v[128:131], v[96:99], v[160:163]
 ds_read2st64_b32 v[70:71], v221 offset0:90 offset1:91
 v_add_f32 v209, v209, v57
 v_add_f32 v210, v210, v58
 v_mfma_f32_16x16x32_bf16 v[164:167], v[132:135], v[96:99], v[164:167]
 ds_read2st64_b32 v[72:73], v221 offset0:92 offset1:93
 v_add_f32 v211, v211, v59
 v_mfma_f32_16x16x32_bf16 v[168:171], v[216:219], v[96:99], v[168:171]
 s_waitcnt vmcnt(8)
 ds_read2st64_b32 v[74:75], v221 offset0:94 offset1:95
 v_mfma_f32_16x16x32_bf16 v[192:195], a[120:123], v[100:103], v[192:195]
 s_add_u32 m0, s28, 147456
 s_add_u32 s85, s35, 65536
 buffer_load_dwordx4 v3, s[8:11], s85 offen offset:2048 sc1 lds
 ds_read2st64_b32 v[76:77], v221 offset0:96 offset1:97
 v_mfma_f32_16x16x32_bf16 v[196:199], a[124:127], v[100:103], v[196:199]
 ds_read2st64_b32 v[78:79], v221 offset0:98 offset1:99
 v_mfma_f32_16x16x32_bf16 v[200:203], a[128:131], v[100:103], v[200:203]
 s_mov_b32 m0, s7
 s_nop 0
 ds_write_addtid_b32 v152
 ds_write_addtid_b32 v153 offset:256
 v_mfma_f32_16x16x32_bf16 v[204:207], a[132:135], v[100:103], v[204:207]
 ds_write_addtid_b32 v154 offset:512
 ds_write_addtid_b32 v155 offset:768
 v_mfma_f32_16x16x32_bf16 v[208:211], a[136:139], v[100:103], v[208:211]
 s_waitcnt vmcnt(8)
 ds_write_addtid_b32 v156 offset:1024
 ds_write_addtid_b32 v157 offset:1280
 v_mfma_f32_16x16x32_bf16 v[192:195], a[140:143], v[136:139], v[192:195]
 ds_write_addtid_b32 v158 offset:1536
 ds_write_addtid_b32 v159 offset:1792
 v_mfma_f32_16x16x32_bf16 v[196:199], a[144:147], v[136:139], v[196:199]
 ds_write_addtid_b32 v160 offset:2048
 ds_write_addtid_b32 v161 offset:2304
 v_mfma_f32_16x16x32_bf16 v[200:203], a[148:151], v[136:139], v[200:203]
 ds_write_addtid_b32 v162 offset:2560
 v_mfma_f32_16x16x32_bf16 v[204:207], a[152:155], v[136:139], v[204:207]
 ds_write_addtid_b32 v163 offset:2816
 ds_write_addtid_b32 v164 offset:3072
 v_mfma_f32_16x16x32_bf16 v[208:211], a[156:159], v[136:139], v[208:211]
 s_waitcnt vmcnt(7)
 ds_write_addtid_b32 v165 offset:3328
 ds_write_addtid_b32 v166 offset:3584
 v_mfma_f32_16x16x32_bf16 v[192:195], a[160:163], v[140:143], v[192:195]
 ds_write_addtid_b32 v167 offset:3840
 ds_write_addtid_b32 v168 offset:4096
 v_mfma_f32_16x16x32_bf16 v[196:199], a[100:103], v[140:143], v[196:199]
 ds_write_addtid_b32 v169 offset:4352
 ds_write_addtid_b32 v170 offset:4608
 v_mfma_f32_16x16x32_bf16 v[200:203], a[104:107], v[140:143], v[200:203]
 s_add_u32 m0, s28, 147456
 s_nop 0
 buffer_load_dwordx4 v3, s[8:11], s85 offen offset:3072 sc1 lds
 s_mov_b32 m0, s7
 s_nop 0
 ds_write_addtid_b32 v171 offset:4864
 v_mfma_f32_16x16x32_bf16 v[204:207], a[108:111], v[140:143], v[204:207]
 v_mfma_f32_16x16x32_bf16 v[208:211], a[112:115], v[140:143], v[208:211]
 s_waitcnt vmcnt(7)
 v_mfma_f32_16x16x32_bf16 v[192:195], a[116:119], v[144:147], v[192:195]
 v_mfma_f32_16x16x32_bf16 v[196:199], v[104:107], v[144:147], v[196:199]
 s_waitcnt lgkmcnt(0)
 s_barrier
 v_mfma_f32_16x16x32_bf16 v[200:203], v[108:111], v[144:147], v[200:203]
 ds_read2st64_b32 v[40:41], v222 offset0:0 offset1:1
 v_mfma_f32_16x16x32_bf16 v[204:207], v[112:115], v[144:147], v[204:207]
 ds_read2st64_b32 v[42:43], v222 offset0:2 offset1:3
 v_mfma_f32_16x16x32_bf16 v[208:211], v[116:119], v[144:147], v[208:211]
 s_waitcnt vmcnt(6)
 ds_read2st64_b32 v[44:45], v222 offset0:4 offset1:5
 v_mfma_f32_16x16x32_bf16 v[192:195], v[120:123], v[148:151], v[192:195]
 ds_read2st64_b32 v[46:47], v222 offset0:6 offset1:7
 v_mfma_f32_16x16x32_bf16 v[196:199], v[124:127], v[148:151], v[196:199]
 ds_read2st64_b32 v[48:49], v222 offset0:8 offset1:9
 v_mfma_f32_16x16x32_bf16 v[200:203], v[128:131], v[148:151], v[200:203]
 ds_read2st64_b32 v[50:51], v222 offset0:10 offset1:11
 v_mfma_f32_16x16x32_bf16 v[204:207], v[132:135], v[148:151], v[204:207]
 ds_read2st64_b32 v[52:53], v222 offset0:12 offset1:13
 v_mfma_f32_16x16x32_bf16 v[208:211], v[216:219], v[148:151], v[208:211]
 ds_read2st64_b32 v[54:55], v222 offset0:14 offset1:15
 ds_read2st64_b32 v[56:57], v222 offset0:16 offset1:17
 ds_read2st64_b32 v[58:59], v222 offset0:18 offset1:19
 v_pk_add_f32 v[192:193], v[192:193], v[60:61]
 v_pk_add_f32 v[194:195], v[194:195], v[62:63]
 v_pk_add_f32 v[196:197], v[196:197], v[64:65]
 v_pk_add_f32 v[198:199], v[198:199], v[66:67]
 v_pk_add_f32 v[200:201], v[200:201], v[68:69]
 v_pk_add_f32 v[202:203], v[202:203], v[70:71]
 v_pk_add_f32 v[204:205], v[204:205], v[72:73]
 v_pk_add_f32 v[206:207], v[206:207], v[74:75]
 v_pk_add_f32 v[208:209], v[208:209], v[76:77]
 v_pk_add_f32 v[210:211], v[210:211], v[78:79]
 s_waitcnt lgkmcnt(0)
 v_pk_add_f32 v[192:193], v[192:193], v[40:41]
 v_cvt_pk_bf16_f32 v28, v192, v193
 v_pk_add_f32 v[194:195], v[194:195], v[42:43]
 v_cvt_pk_bf16_f32 v29, v194, v195
 v_pk_add_f32 v[196:197], v[196:197], v[44:45]
 v_cvt_pk_bf16_f32 v30, v196, v197
 v_pk_add_f32 v[198:199], v[198:199], v[46:47]
 v_cvt_pk_bf16_f32 v31, v198, v199
 buffer_store_dwordx4 v[28:31], v1, s[8:11], s39 offen sc1
 v_pk_add_f32 v[200:201], v[200:201], v[48:49]
 v_cvt_pk_bf16_f32 v32, v200, v201
 v_pk_add_f32 v[202:203], v[202:203], v[50:51]
 v_cvt_pk_bf16_f32 v33, v202, v203
 v_pk_add_f32 v[204:205], v[204:205], v[52:53]
 v_cvt_pk_bf16_f32 v34, v204, v205
 v_pk_add_f32 v[206:207], v[206:207], v[54:55]
 v_cvt_pk_bf16_f32 v35, v206, v207
 buffer_store_dwordx4 v[32:35], v1, s[8:11], s39 offen offset:1024 sc1
 v_pk_add_f32 v[208:209], v[208:209], v[56:57]
 v_cvt_pk_bf16_f32 v36, v208, v209
 v_pk_add_f32 v[210:211], v[210:211], v[58:59]
 v_cvt_pk_bf16_f32 v37, v210, v211
 buffer_store_dwordx2 v[36:37], v8, s[8:11], s39 offen offset:2048 sc1
 v_mov_b32 v226, 0x3f803f80
 v_dot2_f32_bf16 v224, v28, v226, 0
 v_dot2_f32_bf16 v225, v28, v28, 0
 v_dot2_f32_bf16 v224, v29, v226, v224
 v_dot2_f32_bf16 v225, v29, v29, v225
 v_dot2_f32_bf16 v224, v30, v226, v224
 v_dot2_f32_bf16 v225, v30, v30, v225
 v_dot2_f32_bf16 v224, v31, v226, v224
 v_dot2_f32_bf16 v225, v31, v31, v225
 v_dot2_f32_bf16 v224, v32, v226, v224
 v_dot2_f32_bf16 v225, v32, v32, v225
 v_dot2_f32_bf16 v224, v33, v226, v224
 v_dot2_f32_bf16 v225, v33, v33, v225
 v_dot2_f32_bf16 v224, v34, v226, v224
 v_dot2_f32_bf16 v225, v34, v34, v225
 v_dot2_f32_bf16 v224, v35, v226, v224
 v_dot2_f32_bf16 v225, v35, v35, v225
 v_dot2_f32_bf16 v224, v36, v226, v224
 v_dot2_f32_bf16 v225, v36, v36, v225
 v_dot2_f32_bf16 v224, v37, v226, v224
 v_dot2_f32_bf16 v225, v37, v37, v225
 s_nop 2
 v_permlane32_swap_b32 v224, v225
 v_add_f32 v224, v224, v225
 v_mov_b32 v226, v224
 s_nop 1
 v_permlane16_swap_b32 v224, v226
 v_add_f32 v224, v224, v226
 v_or_b32 v224, 1, v224
 buffer_store_dword v224, v9, s[8:11], s40 offen sc1
 s_barrier
 v_add_u32 v38, s60, v1
 s_add_u32 s30, s41, 55296
 s_add_u32 s31, s42, 55296
 s_add_u32 s32, s84, 55296
 v_mov_b32 v27, 2
 s_waitcnt vmcnt(1)
 s_mov_b64 exec, 1
 buffer_store_dword v27, off, s[8:11], s48 sc1
 s_mov_b64 exec, -1
 v_mov_b32 v130, 0
 v_mov_b32 v138, 0
 v_mov_b32 v131, 0
 v_mov_b32 v139, 0
 v_mov_b32 v134, 0
 v_mov_b32 v142, 0
 v_mov_b32 v135, 0
 v_mov_b32 v143, 0
 v_and_b32 v144, 60, v22
 buffer_load_dword v145, v144, s[8:11], s49 offen sc1
sspin_21:
 buffer_load_dword v0, v144, s[8:11], s49 offen sc1
 s_waitcnt vmcnt(1)
 v_cmp_gt_u32 vcc, 2, v145
 s_cbranch_vccz sok_22
 buffer_load_dword v145, v144, s[8:11], s49 offen sc1
 s_waitcnt vmcnt(1)
 v_cmp_gt_u32 vcc, 2, v0
 s_cbranch_vccz sok_22
 s_add_u32 s29, s29, 1
 s_cmp_lt_u32 s29, 524288
 s_cbranch_scc1 sspin_21
sok_22:
 buffer_load_dwordx4 v[160:163], v38, s[8:11], 0 offen sc1
 buffer_load_dwordx4 v[164:167], v38, s[8:11], s69 offen sc1
 buffer_load_dwordx4 v[168:171], v38, s[8:11], 0 offen offset:1024 sc1
 buffer_load_dwordx4 v[172:175], v38, s[8:11], s69 offen offset:1024 sc1
 buffer_load_dwordx4 v[176:179], v38, s[8:11], 0 offen offset:2048 sc1
 buffer_load_dwordx4 v[180:183], v38, s[8:11], s69 offen offset:2048 sc1
 buffer_load_dwordx4 v[184:187], v38, s[8:11], 0 offen offset:3072 sc1
 buffer_load_dwordx4 v[188:191], v38, s[8:11], s69 offen offset:3072 sc1
 s_barrier
 v_add_u32 v25, 81920, v1
 v_add_u32 v26, 122880, v1
 ds_read_b128 v[96:99], v25
 ds_read_b128 v[100:103], v25 offset:20480
 ds_read_b128 v[104:107], v26
 ds_read_b128 v[108:111], v26 offset:20480
 ds_read_b128 v[112:115], v25 offset:1024
 ds_read_b128 v[116:119], v25 offset:21504
 v_and_b32 v27, 0xf0, v1
 v_lshrrev_b32 v27, 1, v27
 s_mov_b32 s92, 0xffff0000
 s_mov_b32 s93, 0
 s_mov_b32 s94, -1
 s_mov_b32 s95, 0
 s_waitcnt lgkmcnt(4)
 s_waitcnt vmcnt(7)
 v_mfma_f32_16x16x32_bf16 v[40:43], v[96:99], v[160:163], 0
 s_waitcnt vmcnt(6)
 ds_read_b128 v[120:123], v26 offset:1024
 buffer_load_dwordx4 v[192:195], v38, s[8:11], s65 offen sc1
 v_mfma_f32_16x16x32_bf16 v[44:47], v[96:99], v[164:167], 0
 v_mfma_f32_16x16x32_bf16 v[48:51], v[100:103], v[160:163], 0
 ds_read_b128 v[124:127], v26 offset:21504
 v_mfma_f32_16x16x32_bf16 v[52:55], v[100:103], v[164:167], 0
 s_waitcnt lgkmcnt(4)
 buffer_load_dwordx4 v[196:199], v38, s[8:11], s70 offen sc1
 v_mfma_f32_16x16x32_bf16 v[56:59], v[104:107], v[160:163], 0
 ds_read_b128 v[96:99], v25 offset:2048
 v_mfma_f32_16x16x32_bf16 v[60:63], v[104:107], v[164:167], 0
 v_mfma_f32_16x16x32_bf16 v[64:67], v[108:111], v[160:163], 0
 ds_read_b128 v[100:103], v25 offset:22528
 v_mfma_f32_16x16x32_bf16 v[68:71], v[108:111], v[164:167], 0
 s_waitcnt vmcnt(7) lgkmcnt(4)
 buffer_load_dwordx4 v[152:155], v1, s[8:11], s61 offen sc1
 buffer_load_dwordx4 v[156:159], v1, s[8:11], s61 offen offset:1024 sc1
 buffer_load_dwordx4 v[200:203], v38, s[8:11], s65 offen offset:1024 sc1
 v_mfma_f32_16x16x32_bf16 v[40:43], v[112:115], v[168:171], v[40:43]
 s_waitcnt vmcnt(9)
 ds_read_b128 v[104:107], v26 offset:2048
 v_mfma_f32_16x16x32_bf16 v[44:47], v[112:115], v[172:175], v[44:47]
 v_mfma_f32_16x16x32_bf16 v[48:51], v[116:119], v[168:171], v[48:51]
 ds_read_b128 v[108:111], v26 offset:22528
 v_mfma_f32_16x16x32_bf16 v[52:55], v[116:119], v[172:175], v[52:55]
 s_waitcnt lgkmcnt(4)
 buffer_load_dwordx4 v[204:207], v38, s[8:11], s70 offen offset:1024 sc1
 v_mfma_f32_16x16x32_bf16 v[56:59], v[120:123], v[168:171], v[56:59]
 ds_read_b128 v[112:115], v25 offset:3072
 v_mfma_f32_16x16x32_bf16 v[60:63], v[120:123], v[172:175], v[60:63]
 v_mfma_f32_16x16x32_bf16 v[64:67], v[124:127], v[168:171], v[64:67]
 ds_read_b128 v[116:119], v25 offset:23552
 buffer_load_dwordx4 v[208:211], v38, s[8:11], s65 offen offset:2048 sc1
 v_mfma_f32_16x16x32_bf16 v[68:71], v[124:127], v[172:175], v[68:71]
 s_waitcnt vmcnt(10) lgkmcnt(4)
 v_mfma_f32_16x16x32_bf16 v[40:43], v[96:99], v[176:179], v[40:43]
 s_waitcnt vmcnt(9)
 ds_read_b128 v[120:123], v26 offset:3072
 v_mfma_f32_16x16x32_bf16 v[44:47], v[96:99], v[180:183], v[44:47]
 v_mfma_f32_16x16x32_bf16 v[48:51], v[100:103], v[176:179], v[48:51]
 ds_read_b128 v[124:127], v26 offset:23552
 buffer_load_dwordx4 v[212:215], v38, s[8:11], s70 offen offset:2048 sc1
 v_mfma_f32_16x16x32_bf16 v[52:55], v[100:103], v[180:183], v[52:55]
 s_waitcnt lgkmcnt(4)
 v_mfma_f32_16x16x32_bf16 v[56:59], v[104:107], v[176:179], v[56:59]
 ds_read_b128 v[96:99], v25 offset:4096
 v_mfma_f32_16x16x32_bf16 v[60:63], v[104:107], v[180:183], v[60:63]
 v_mfma_f32_16x16x32_bf16 v[64:67], v[108:111], v[176:179], v[64:67]
 ds_read_b128 v[100:103], v25 offset:24576
 buffer_load_dwordx4 v[216:219], v38, s[8:11], s65 offen offset:3072 sc1
 v_mfma_f32_16x16x32_bf16 v[68:71], v[108:111], v[180:183], v[68:71]
 s_waitcnt vmcnt(10) lgkmcnt(4)
 v_mfma_f32_16x16x32_bf16 v[40:43], v[112:115], v[184:187], v[40:43]
 s_waitcnt vmcnt(9)
 ds_read_b128 v[104:107], v26 offset:4096
 v_mfma_f32_16x16x32_bf16 v[44:47], v[112:115], v[188:191], v[44:47]
 buffer_load_dwordx4 v[220:223], v38, s[8:11], s70 offen offset:3072 sc1
 v_mfma_f32_16x16x32_bf16 v[48:51], v[116:119], v[184:187], v[48:51]
 ds_read_b128 v[108:111], v26 offset:24576
 v_mfma_f32_16x16x32_bf16 v[52:55], v[116:119], v[188:191], v[52:55]
 s_waitcnt lgkmcnt(4)
 v_mfma_f32_16x16x32_bf16 v[56:59], v[120:123], v[184:187], v[56:59]
 ds_read_b128 v[112:115], v25 offset:5120
 v_mfma_f32_16x16x32_bf16 v[60:63], v[120:123], v[188:191], v[60:63]
 buffer_load_dwordx4 v[224:227], v38, s[8:11], s66 offen sc1
 v_mfma_f32_16x16x32_bf16 v[64:67], v[124:127], v[184:187], v[64:67]
 ds_read_b128 v[116:119], v25 offset:25600
 v_mfma_f32_16x16x32_bf16 v[68:71], v[124:127], v[188:191], v[68:71]
 s_waitcnt vmcnt(10) lgkmcnt(4)
 v_mfma_f32_16x16x32_bf16 v[40:43], v[96:99], v[192:195], v[40:43]
 s_waitcnt vmcnt(9)
 ds_read_b128 v[120:123], v26 offset:5120
 v_mfma_f32_16x16x32_bf16 v[44:47], v[96:99], v[196:199], v[44:47]
 buffer_load_dwordx4 v[228:231], v38, s[8:11], s71 offen sc1
 v_mfma_f32_16x16x32_bf16 v[48:51], v[100:103], v[192:195], v[48:51]
 ds_read_b128 v[124:127], v26 offset:25600
 v_mfma_f32_16x16x32_bf16 v[52:55], v[100:103], v[196:199], v[52:55]
 s_waitcnt lgkmcnt(4)
 v_mfma_f32_16x16x32_bf16 v[56:59], v[104:107], v[192:195], v[56:59]
 s_waitcnt vmcnt(9)
 ds_read_b128 v[96:99], v25 offset:6144
 v_and_b32 v147, v152, v153
 v_mfma_f32_16x16x32_bf16 v[60:63], v[104:107], v[196:199], v[60:63]
 buffer_load_dwordx4 v[232:235], v38, s[8:11], s66 offen offset:1024 sc1
 v_bitop3_b32 v147, v147, v154, v155 bitop3:0x80
 v_mfma_f32_16x16x32_bf16 v[64:67], v[108:111], v[192:195], v[64:67]
 ds_read_b128 v[100:103], v25 offset:26624
 v_mfma_f32_16x16x32_bf16 v[68:71], v[108:111], v[196:199], v[68:71]
 s_waitcnt vmcnt(8) lgkmcnt(4)
 v_bitop3_b32 v147, v147, v156, v157 bitop3:0x80
 v_bitop3_b32 v147, v147, v158, v159 bitop3:0x80
 v_mfma_f32_16x16x32_bf16 v[40:43], v[112:115], v[200:203], v[40:43]
 s_waitcnt vmcnt(7)
 ds_read_b128 v[104:107], v26 offset:6144
 buffer_load_dwordx4 v[236:239], v38, s[8:11], s71 offen offset:1024 sc1
 v_mfma_f32_16x16x32_bf16 v[44:47], v[112:115], v[204:207], v[44:47]
 v_and_b32 v147, 1, v147
 v_mfma_f32_16x16x32_bf16 v[48:51], v[116:119], v[200:203], v[48:51]
 ds_read_b128 v[108:111], v26 offset:26624
 v_cmp_ne_u32 vcc, 1, v147
 s_cbranch_vccnz sretry_23
sback_24:
 v_mfma_f32_16x16x32_bf16 v[52:55], v[116:119], v[204:207], v[52:55]
 s_waitcnt lgkmcnt(4)
 v_add_f32 v152, v152, v153
 v_add_f32 v156, v156, v157
 v_mfma_f32_16x16x32_bf16 v[56:59], v[120:123], v[200:203], v[56:59]
 ds_read_b128 v[112:115], v25 offset:7168
 buffer_load_dwordx4 v[240:243], v38, s[8:11], s66 offen offset:2048 sc1
 v_mfma_f32_16x16x32_bf16 v[60:63], v[120:123], v[204:207], v[60:63]
 v_add_f32 v154, v154, v155
 v_mfma_f32_16x16x32_bf16 v[64:67], v[124:127], v[200:203], v[64:67]
 ds_read_b128 v[116:119], v25 offset:27648
 v_add_f32 v158, v158, v159
 v_mfma_f32_16x16x32_bf16 v[68:71], v[124:127], v[204:207], v[68:71]
 s_waitcnt vmcnt(8) lgkmcnt(4)
 v_add_f32 v154, v154, v152
 v_add_f32 v158, v158, v156
 v_mfma_f32_16x16x32_bf16 v[40:43], v[96:99], v[208:211], v[40:43]
 s_waitcnt vmcnt(7)
 ds_read_b128 v[120:123], v26 offset:7168
 buffer_load_dwordx4 v[244:247], v38, s[8:11], s71 offen offset:2048 sc1
 v_mfma_f32_16x16x32_bf16 v[44:47], v[96:99], v[212:215], v[44:47]
 v_mov_b32 v155, v154
 v_mfma_f32_16x16x32_bf16 v[48:51], v[100:103], v[208:211], v[48:51]
 ds_read_b128 v[124:127], v26 offset:27648
 v_mov_b32 v159, v158
 v_mfma_f32_16x16x32_bf16 v[52:55], v[100:103], v[212:215], v[52:55]
 s_waitcnt lgkmcnt(4)
 buffer_load_dwordx4 v[248:251], v38, s[8:11], s66 offen offset:3072 sc1
 v_mfma_f32_16x16x32_bf16 v[56:59], v[104:107], v[208:211], v[56:59]
 ds_read_b128 v[96:99], v25 offset:8192
 v_mfma_f32_16x16x32_bf16 v[60:63], v[104:107], v[212:215], v[60:63]
 v_permlane16_swap_b32 v154, v155
 v_mfma_f32_16x16x32_bf16 v[64:67], v[108:111], v[208:211], v[64:67]
 ds_read_b128 v[100:103], v25 offset:28672
 v_mfma_f32_16x16x32_bf16 v[68:71], v[108:111], v[212:215], v[68:71]
 s_waitcnt vmcnt(8) lgkmcnt(4)
 buffer_load_dwordx4 v[252:255], v38, s[8:11], s71 offen offset:3072 sc1
 v_mfma_f32_16x16x32_bf16 v[40:43], v[112:115], v[216:219], v[40:43]
 s_waitcnt vmcnt(8)
 ds_read_b128 v[104:107], v26 offset:8192
 v_mfma_f32_16x16x32_bf16 v[44:47], v[112:115], v[220:223], v[44:47]
 v_permlane16_swap_b32 v158, v159
 v_mfma_f32_16x16x32_bf16 v[48:51], v[116:119], v[216:219], v[48:51]
 ds_read_b128 v[108:111], v26 offset:28672
 v_add_f32 v154, v154, v155
 v_mfma_f32_16x16x32_bf16 v[52:55], v[116:119], v[220:223], v[52:55]
 s_waitcnt lgkmcnt(4)
 buffer_load_dwordx4 a[100:103], v38, s[8:11], s67 offen sc1
 v_add_f32 v158, v158, v159
 v_mfma_f32_16x16x32_bf16 v[56:59], v[120:123], v[216:219], v[56:59]
 ds_read_b128 v[112:115], v25 offset:9216
 v_mov_b32 v155, v154
 v_mfma_f32_16x16x32_bf16 v[60:63], v[120:123], v[220:223], v[60:63]
 v_mov_b32 v159, v158
 v_mfma_f32_16x16x32_bf16 v[64:67], v[124:127], v[216:219], v[64:67]
 ds_read_b128 v[116:119], v25 offset:29696
 buffer_load_dwordx4 a[104:107], v38, s[8:11], s72 offen sc1
 v_mfma_f32_16x16x32_bf16 v[68:71], v[124:127], v[220:223], v[68:71]
 s_waitcnt vmcnt(9) lgkmcnt(4)
 v_permlane32_swap_b32 v154, v155
 v_mfma_f32_16x16x32_bf16 v[40:43], v[96:99], v[224:227], v[40:43]
 s_waitcnt vmcnt(8)
 ds_read_b128 v[120:123], v26 offset:9216
 v_mfma_f32_16x16x32_bf16 v[44:47], v[96:99], v[228:231], v[44:47]
 v_permlane32_swap_b32 v158, v159
 v_mfma_f32_16x16x32_bf16 v[48:51], v[100:103], v[224:227], v[48:51]
 ds_read_b128 v[124:127], v26 offset:29696
 buffer_load_dwordx4 a[108:111], v38, s[8:11], s67 offen offset:1024 sc1
 v_mfma_f32_16x16x32_bf16 v[52:55], v[100:103], v[228:231], v[52:55]
 s_waitcnt lgkmcnt(4)
 v_mul_f32 v153, 0xbacccccd, v154
 v_mul_f32 v157, 0xbacccccd, v158
 v_mfma_f32_16x16x32_bf16 v[56:59], v[104:107], v[224:227], v[56:59]
 ds_read_b128 v[96:99], v25 offset:10240
 v_mul_f32 v154, v153, v153
 v_mfma_f32_16x16x32_bf16 v[60:63], v[104:107], v[228:231], v[60:63]
 v_mul_f32 v158, v157, v157
 v_fmac_f32 v154, 0xbacccccd, v155
 v_mfma_f32_16x16x32_bf16 v[64:67], v[108:111], v[224:227], v[64:67]
 ds_read_b128 v[100:103], v25 offset:30720
 buffer_load_dwordx4 a[112:115], v38, s[8:11], s72 offen offset:1024 sc1
 v_mfma_f32_16x16x32_bf16 v[68:71], v[108:111], v[228:231], v[68:71]
 s_waitcnt vmcnt(9) lgkmcnt(4)
 v_fmac_f32 v158, 0xbacccccd, v159
 v_min_f32 v154, 0, v154
 v_mfma_f32_16x16x32_bf16 v[40:43], v[112:115], v[232:235], v[40:43]
 s_waitcnt vmcnt(8)
 ds_read_b128 v[104:107], v26 offset:10240
 v_min_f32 v158, 0, v158
 v_mfma_f32_16x16x32_bf16 v[44:47], v[112:115], v[236:239], v[44:47]
 v_sub_f32 v154, 0x3727c5ac, v154
 v_sub_f32 v158, 0x3727c5ac, v158
 v_mfma_f32_16x16x32_bf16 v[48:51], v[116:119], v[232:235], v[48:51]
 ds_read_b128 v[108:111], v26 offset:30720
 buffer_load_dwordx4 a[116:119], v38, s[8:11], s67 offen offset:2048 sc1
 v_mfma_f32_16x16x32_bf16 v[52:55], v[116:119], v[236:239], v[52:55]
 s_waitcnt lgkmcnt(4)
 v_rsq_f32 v152, v154
 v_mfma_f32_16x16x32_bf16 v[56:59], v[120:123], v[232:235], v[56:59]
 ds_read_b128 v[112:115], v25 offset:11264
 v_mfma_f32_16x16x32_bf16 v[60:63], v[120:123], v[236:239], v[60:63]
 buffer_load_dwordx4 a[120:123], v38, s[8:11], s72 offen offset:2048 sc1
 v_mfma_f32_16x16x32_bf16 v[64:67], v[124:127], v[232:235], v[64:67]
 ds_read_b128 v[116:119], v25 offset:31744
 v_mfma_f32_16x16x32_bf16 v[68:71], v[124:127], v[236:239], v[68:71]
 s_waitcnt vmcnt(9) lgkmcnt(4)
 v_rsq_f32 v156, v158
 v_mfma_f32_16x16x32_bf16 v[40:43], v[96:99], v[240:243], v[40:43]
 s_waitcnt vmcnt(8)
 ds_read_b128 v[120:123], v26 offset:11264
 v_mul_f32 v154, v154, v152
 v_mfma_f32_16x16x32_bf16 v[44:47], v[96:99], v[244:247], v[44:47]
 buffer_load_dwordx4 a[124:127], v38, s[8:11], s67 offen offset:3072 sc1
 v_mul_f32 v158, v158, v156
 v_mfma_f32_16x16x32_bf16 v[48:51], v[100:103], v[240:243], v[48:51]
 ds_read_b128 v[124:127], v26 offset:31744
 v_cvt_pk_bf16_f32 v144, v154, v153
 v_mfma_f32_16x16x32_bf16 v[52:55], v[100:103], v[244:247], v[52:55]
 s_waitcnt lgkmcnt(4)
 v_cvt_pk_bf16_f32 v148, v158, v157
 v_and_b32 v145, 0xffff0000, v144
 v_mfma_f32_16x16x32_bf16 v[56:59], v[104:107], v[240:243], v[56:59]
 ds_read_b128 v[96:99], v25 offset:12288
 v_and_b32 v149, 0xffff0000, v148
 v_mfma_f32_16x16x32_bf16 v[60:63], v[104:107], v[244:247], v[60:63]
 buffer_load_dwordx4 a[128:131], v38, s[8:11], s72 offen offset:3072 sc1
 v_lshlrev_b32 v144, 16, v144
 v_mfma_f32_16x16x32_bf16 v[64:67], v[108:111], v[240:243], v[64:67]
 ds_read_b128 v[100:103], v25 offset:32768
 v_lshlrev_b32 v148, 16, v148
 v_mfma_f32_16x16x32_bf16 v[68:71], v[108:111], v[244:247], v[68:71]
 s_waitcnt vmcnt(9) lgkmcnt(4)
 v_cndmask_b32 v145, 0, v145, s[92:93]
 v_cndmask_b32 v149, 0, v149, s[92:93]
 v_mfma_f32_16x16x32_bf16 v[40:43], v[112:115], v[248:251], v[40:43]
 s_waitcnt vmcnt(8)
 ds_read_b128 v[104:107], v26 offset:12288
 buffer_load_dwordx4 a[132:135], v38, s[8:11], s68 offen sc1
 v_mfma_f32_16x16x32_bf16 v[44:47], v[112:115], v[252:255], v[44:47]
 v_cndmask_b32 v144, 0, v144, s[92:93]
 v_cndmask_b32 v148, 0, v148, s[92:93]
 v_mfma_f32_16x16x32_bf16 v[48:51], v[116:119], v[248:251], v[48:51]
 ds_read_b128 v[108:111], v26 offset:32768
 v_sub_f32 v145, v153, v145
 v_mfma_f32_16x16x32_bf16 v[52:55], v[116:119], v[252:255], v[52:55]
 s_waitcnt lgkmcnt(4)
 v_sub_f32 v149, v157, v149
 v_sub_f32 v144, v154, v144
 v_mfma_f32_16x16x32_bf16 v[56:59], v[120:123], v[248:251], v[56:59]
 ds_read_b128 v[112:115], v25 offset:13312
 buffer_load_dwordx4 a[136:139], v38, s[8:11], s73 offen sc1
 v_mfma_f32_16x16x32_bf16 v[60:63], v[120:123], v[252:255], v[60:63]
 v_sub_f32 v148, v158, v148
 v_cndmask_b32 v145, 0, v145, s[94:95]
 v_mfma_f32_16x16x32_bf16 v[64:67], v[124:127], v[248:251], v[64:67]
 ds_read_b128 v[116:119], v25 offset:33792
 v_cndmask_b32 v149, 0, v149, s[94:95]
 v_mfma_f32_16x16x32_bf16 v[68:71], v[124:127], v[252:255], v[68:71]
 s_waitcnt vmcnt(9) lgkmcnt(4)
 v_cndmask_b32 v144, 0, v144, s[94:95]
 v_mfma_f32_16x16x32_bf16 v[40:43], v[96:99], a[100:103], v[40:43]
 s_waitcnt vmcnt(8)
 ds_read_b128 v[120:123], v26 offset:13312
 buffer_load_dwordx4 a[140:143], v38, s[8:11], s68 offen offset:1024 sc1
 v_mfma_f32_16x16x32_bf16 v[44:47], v[96:99], a[104:107], v[44:47]
 ds_read_b64 v[128:129], v27 offset:256
 v_cndmask_b32 v148, 0, v148, s[94:95]
 v_mfma_f32_16x16x32_bf16 v[48:51], v[100:103], a[100:103], v[48:51]
 ds_read_b128 v[124:127], v26 offset:33792
 v_cvt_pk_bf16_f32 v136, v145, v145
 v_mfma_f32_16x16x32_bf16 v[52:55], v[100:103], a[104:107], v[52:55]
 s_waitcnt lgkmcnt(5)
 v_cvt_pk_bf16_f32 v140, v149, v149
 v_mfma_f32_16x16x32_bf16 v[56:59], v[104:107], a[100:103], v[56:59]
 ds_read_b128 v[96:99], v25 offset:14336
 buffer_load_dwordx4 a[144:147], v38, s[8:11], s73 offen offset:1024 sc1
 v_mfma_f32_16x16x32_bf16 v[60:63], v[104:107], a[104:107], v[60:63]
 v_cvt_pk_bf16_f32 v137, v144, 0
 v_cvt_pk_bf16_f32 v141, v148, 0
 v_mfma_f32_16x16x32_bf16 v[64:67], v[108:111], a[100:103], v[64:67]
 ds_read_b128 v[100:103], v25 offset:34816
 v_mfma_f32_16x16x32_bf16 v[68:71], v[108:111], a[104:107], v[68:71]
 s_waitcnt lgkmcnt(3)
 buffer_load_dwordx4 a[148:151], v38, s[8:11], s68 offen offset:2048 sc1
 v_mfma_f32_16x16x32_bf16 v[40:43], v[128:131], v[136:139], v[40:43]
 v_mfma_f32_16x16x32_bf16 v[44:47], v[128:131], v[140:143], v[44:47]
 s_waitcnt vmcnt(10)
 v_mfma_f32_16x16x32_bf16 v[40:43], v[112:115], a[108:111], v[40:43]
 s_waitcnt vmcnt(9)
 ds_read_b128 v[104:107], v26 offset:14336
 v_mfma_f32_16x16x32_bf16 v[44:47], v[112:115], a[112:115], v[44:47]
 buffer_load_dwordx4 a[152:155], v38, s[8:11], s73 offen offset:2048 sc1
 ds_read_b64 v[132:133], v27 offset:384
 v_mfma_f32_16x16x32_bf16 v[48:51], v[116:119], a[108:111], v[48:51]
 ds_read_b128 v[108:111], v26 offset:34816
 v_mfma_f32_16x16x32_bf16 v[52:55], v[116:119], a[112:115], v[52:55]
 s_waitcnt lgkmcnt(5)
 v_mfma_f32_16x16x32_bf16 v[56:59], v[120:123], a[108:111], v[56:59]
 ds_read_b128 v[112:115], v25 offset:15360
 v_mfma_f32_16x16x32_bf16 v[60:63], v[120:123], a[112:115], v[60:63]
 buffer_load_dwordx4 a[156:159], v38, s[8:11], s68 offen offset:3072 sc1
 v_mfma_f32_16x16x32_bf16 v[64:67], v[124:127], a[108:111], v[64:67]
 ds_read_b128 v[116:119], v25 offset:35840
 v_mfma_f32_16x16x32_bf16 v[68:71], v[124:127], a[112:115], v[68:71]
 s_waitcnt lgkmcnt(3)
 v_mfma_f32_16x16x32_bf16 v[48:51], v[132:135], v[136:139], v[48:51]
 buffer_load_dwordx4 a[160:163], v38, s[8:11], s73 offen offset:3072 sc1
 v_mfma_f32_16x16x32_bf16 v[52:55], v[132:135], v[140:143], v[52:55]
 s_waitcnt vmcnt(11)
 v_mfma_f32_16x16x32_bf16 v[40:43], v[96:99], a[116:119], v[40:43]
 s_waitcnt vmcnt(10)
 ds_read_b128 v[120:123], v26 offset:15360
 v_mfma_f32_16x16x32_bf16 v[44:47], v[96:99], a[120:123], v[44:47]
 ds_read_b64 v[128:129], v27 offset:512
 v_mfma_f32_16x16x32_bf16 v[48:51], v[100:103], a[116:119], v[48:51]
 ds_read_b128 v[124:127], v26 offset:35840
 v_mfma_f32_16x16x32_bf16 v[52:55], v[100:103], a[120:123], v[52:55]
 s_waitcnt lgkmcnt(5)
 s_add_u32 m0, s27, 40960
 s_add_u32 s85, s64, 0
 buffer_load_dwordx4 v2, s[8:11], s85 offen sc1 lds
 v_mfma_f32_16x16x32_bf16 v[56:59], v[104:107], a[116:119], v[56:59]
 ds_read_b128 v[96:99], v25 offset:16384
 v_mfma_f32_16x16x32_bf16 v[60:63], v[104:107], a[120:123], v[60:63]
 v_mfma_f32_16x16x32_bf16 v[64:67], v[108:111], a[116:119], v[64:67]
 ds_read_b128 v[100:103], v25 offset:36864
 v_mfma_f32_16x16x32_bf16 v[68:71], v[108:111], a[120:123], v[68:71]
 s_waitcnt lgkmcnt(3)
 v_mfma_f32_16x16x32_bf16 v[56:59], v[128:131], v[136:139], v[56:59]
 v_mfma_f32_16x16x32_bf16 v[60:63], v[128:131], v[140:143], v[60:63]
 s_waitcnt vmcnt(10)
 s_add_u32 m0, s28, 20480
 s_add_u32 s85, s36, 0
 buffer_load_dwordx4 v3, s[8:11], s85 offen sc1 lds
 v_mfma_f32_16x16x32_bf16 v[40:43], v[112:115], a[124:127], v[40:43]
 s_waitcnt vmcnt(10)
 ds_read_b128 v[104:107], v26 offset:16384
 v_mfma_f32_16x16x32_bf16 v[44:47], v[112:115], a[128:131], v[44:47]
 ds_read_b64 v[132:133], v27 offset:640
 v_mfma_f32_16x16x32_bf16 v[48:51], v[116:119], a[124:127], v[48:51]
 ds_read_b128 v[108:111], v26 offset:36864
 v_mfma_f32_16x16x32_bf16 v[52:55], v[116:119], a[128:131], v[52:55]
 s_waitcnt lgkmcnt(5)
 v_mfma_f32_16x16x32_bf16 v[56:59], v[120:123], a[124:127], v[56:59]
 ds_read_b128 v[112:115], v25 offset:17408
 v_mfma_f32_16x16x32_bf16 v[60:63], v[120:123], a[128:131], v[60:63]
 v_mfma_f32_16x16x32_bf16 v[64:67], v[124:127], a[124:127], v[64:67]
 ds_read_b128 v[116:119], v25 offset:37888
 v_mfma_f32_16x16x32_bf16 v[68:71], v[124:127], a[128:131], v[68:71]
 s_waitcnt lgkmcnt(3)
 buffer_load_dwordx4 v3, s[8:11], s85 offen offset:1024 sc1 lds
 v_mfma_f32_16x16x32_bf16 v[64:67], v[132:135], v[136:139], v[64:67]
 v_mfma_f32_16x16x32_bf16 v[68:71], v[132:135], v[140:143], v[68:71]
 s_waitcnt vmcnt(10)
 v_mfma_f32_16x16x32_bf16 v[40:43], v[96:99], a[132:135], v[40:43]
 s_waitcnt vmcnt(9)
 ds_read_b128 v[120:123], v26 offset:17408
 v_mfma_f32_16x16x32_bf16 v[44:47], v[96:99], a[136:139], v[44:47]
 ds_read_b64 v[128:129], v27 offset:768
 v_mfma_f32_16x16x32_bf16 v[48:51], v[100:103], a[132:135], v[48:51]
 ds_read_b128 v[124:127], v26 offset:37888
 v_mfma_f32_16x16x32_bf16 v[52:55], v[100:103], a[136:139], v[52:55]
 s_waitcnt lgkmcnt(5)
 v_mfma_f32_16x16x32_bf16 v[56:59], v[104:107], a[132:135], v[56:59]
 ds_read_b128 v[96:99], v25 offset:18432
 buffer_load_dwordx4 v3, s[8:11], s85 offen offset:2048 sc1 lds
 v_mfma_f32_16x16x32_bf16 v[60:63], v[104:107], a[136:139], v[60:63]
 v_mfma_f32_16x16x32_bf16 v[64:67], v[108:111], a[132:135], v[64:67]
 ds_read_b128 v[100:103], v25 offset:38912
 v_mfma_f32_16x16x32_bf16 v[68:71], v[108:111], a[136:139], v[68:71]
 s_waitcnt lgkmcnt(3)
 v_mfma_f32_16x16x32_bf16 v[72:75], v[128:131], v[136:139], 0
 v_mfma_f32_16x16x32_bf16 v[76:79], v[128:131], v[140:143], 0
 s_waitcnt vmcnt(9)
 v_mfma_f32_16x16x32_bf16 v[40:43], v[112:115], a[140:143], v[40:43]
 s_waitcnt vmcnt(8)
 ds_read_b128 v[104:107], v26 offset:18432
 v_mfma_f32_16x16x32_bf16 v[44:47], v[112:115], a[144:147], v[44:47]
 ds_read_b64 v[132:133], v27 offset:896
 buffer_load_dwordx4 v3, s[8:11], s85 offen offset:3072 sc1 lds
 v_mfma_f32_16x16x32_bf16 v[48:51], v[116:119], a[140:143], v[48:51]
 ds_read_b128 v[108:111], v26 offset:38912
 v_mfma_f32_16x16x32_bf16 v[52:55], v[116:119], a[144:147], v[52:55]
 s_waitcnt lgkmcnt(5)
 v_mfma_f32_16x16x32_bf16 v[56:59], v[120:123], a[140:143], v[56:59]
 ds_read_b128 v[112:115], v25 offset:19456
 v_mfma_f32_16x16x32_bf16 v[60:63], v[120:123], a[144:147], v[60:63]
 v_mfma_f32_16x16x32_bf16 v[64:67], v[124:127], a[140:143], v[64:67]
 ds_read_b128 v[116:119], v25 offset:39936
 v_mfma_f32_16x16x32_bf16 v[68:71], v[124:127], a[144:147], v[68:71]
 s_waitcnt lgkmcnt(3)
 v_mfma_f32_16x16x32_bf16 v[80:83], v[132:135], v[136:139], 0
 s_add_u32 m0, s27, 36864
 s_add_u32 s85, s36, 16384
 buffer_load_dwordx4 v2, s[8:11], s85 offen sc1 lds
 v_mfma_f32_16x16x32_bf16 v[84:87], v[132:135], v[140:143], 0
 s_waitcnt vmcnt(9)
 v_mfma_f32_16x16x32_bf16 v[40:43], v[96:99], a[148:151], v[40:43]
 s_waitcnt vmcnt(8)
 ds_read_b128 v[120:123], v26 offset:19456
 v_mfma_f32_16x16x32_bf16 v[44:47], v[96:99], a[152:155], v[44:47]
 ds_read_b64 v[128:129], v27 offset:1024
 v_mfma_f32_16x16x32_bf16 v[48:51], v[100:103], a[148:151], v[48:51]
 ds_read_b128 v[124:127], v26 offset:39936
 v_mfma_f32_16x16x32_bf16 v[52:55], v[100:103], a[152:155], v[52:55]
 s_waitcnt lgkmcnt(5)
 v_mfma_f32_16x16x32_bf16 v[56:59], v[104:107], a[148:151], v[56:59]
 s_barrier
 v_add_u32 v25, 20480, v1
 ds_read_b128 v[96:99], v25 offset:24576
 v_mfma_f32_16x16x32_bf16 v[60:63], v[104:107], a[152:155], v[60:63]
 v_mfma_f32_16x16x32_bf16 v[64:67], v[108:111], a[148:151], v[64:67]
 ds_read_b128 v[100:103], v25 offset:45056
 v_mfma_f32_16x16x32_bf16 v[68:71], v[108:111], a[152:155], v[68:71]
 s_waitcnt lgkmcnt(3)
 v_mfma_f32_16x16x32_bf16 v[88:91], v[128:131], v[136:139], 0
 v_mfma_f32_16x16x32_bf16 v[92:95], v[128:131], v[140:143], 0
 s_waitcnt vmcnt(7)
 v_mfma_f32_16x16x32_bf16 v[40:43], v[112:115], a[156:159], v[40:43]
 s_waitcnt vmcnt(6)
 ds_read_b128 v[104:107], v25 offset:25600
 v_mfma_f32_16x16x32_bf16 v[44:47], v[112:115], a[160:163], v[44:47]
 v_mfma_f32_16x16x32_bf16 v[48:51], v[116:119], a[156:159], v[48:51]
 ds_read_b128 v[108:111], v25 offset:46080
 v_mfma_f32_16x16x32_bf16 v[52:55], v[116:119], a[160:163], v[52:55]
 s_waitcnt lgkmcnt(4)
 v_mfma_f32_16x16x32_bf16 v[56:59], v[120:123], a[156:159], v[56:59]
 ds_read_b128 v[112:115], v25 offset:26624
 v_mfma_f32_16x16x32_bf16 v[60:63], v[120:123], a[160:163], v[60:63]
 v_mfma_f32_16x16x32_bf16 v[64:67], v[124:127], a[156:159], v[64:67]
 ds_read_b128 v[116:119], v25 offset:47104
 v_mfma_f32_16x16x32_bf16 v[68:71], v[124:127], a[160:163], v[68:71]
 s_waitcnt lgkmcnt(4)
 v_mfma_f32_16x16x32_bf16 v[72:75], v[96:99], v[192:195], v[72:75]
 ds_read_b128 v[120:123], v25 offset:27648
 v_mfma_f32_16x16x32_bf16 v[76:79], v[96:99], v[196:199], v[76:79]
 v_mul_f32 v40, v40, v152
 v_mul_f32 v41, v41, v152
 v_mfma_f32_16x16x32_bf16 v[80:83], v[100:103], v[192:195], v[80:83]
 ds_read_b128 v[124:127], v25 offset:48128
 v_mul_f32 v42, v42, v152
 v_mul_f32 v43, v43, v152
 v_mfma_f32_16x16x32_bf16 v[84:87], v[100:103], v[196:199], v[84:87]
 s_barrier
 v_mul_f32 v40, v40, abs(v40)
 v_mul_f32 v41, v41, abs(v41)
 s_waitcnt lgkmcnt(4)
 v_mfma_f32_16x16x32_bf16 v[72:75], v[104:107], v[200:203], v[72:75]
 ds_read_b128 v[96:99], v25 offset:28672
 v_mul_f32 v42, v42, abs(v42)
 v_mfma_f32_16x16x32_bf16 v[76:79], v[104:107], v[204:207], v[76:79]
 s_add_u32 m0, s28, 81920
 s_add_u32 s85, s37, 30720
 buffer_load_dwordx4 v1, s[8:11], s85 offen sc1 lds
 v_mul_f32 v43, v43, abs(v43)
 v_cvt_pk_bf16_f32 v144, v40, v41
 v_mfma_f32_16x16x32_bf16 v[80:83], v[108:111], v[200:203], v[80:83]
 ds_read_b128 v[100:103], v25 offset:49152
 v_cvt_pk_bf16_f32 v145, v42, v43
 v_mfma_f32_16x16x32_bf16 v[84:87], v[108:111], v[204:207], v[84:87]
 s_waitcnt lgkmcnt(4)
 v_pk_max_i16 v144, v144, 0
 v_pk_max_i16 v145, v145, 0
 v_mul_f32 v48, v48, v152
 v_mfma_f32_16x16x32_bf16 v[72:75], v[112:115], v[208:211], v[72:75]
 ds_read_b128 v[104:107], v25 offset:29696
 v_mul_f32 v49, v49, v152
 v_mfma_f32_16x16x32_bf16 v[76:79], v[112:115], v[212:215], v[76:79]
 buffer_load_dwordx4 v1, s[8:11], s85 offen offset:1024 sc1 lds
 v_mul_f32 v50, v50, v152
 v_mul_f32 v51, v51, v152
 v_mfma_f32_16x16x32_bf16 v[80:83], v[116:119], v[208:211], v[80:83]
 ds_read_b128 v[108:111], v25 offset:50176
 v_mul_f32 v48, v48, abs(v48)
 v_mfma_f32_16x16x32_bf16 v[84:87], v[116:119], v[212:215], v[84:87]
 s_waitcnt lgkmcnt(4)
 v_mul_f32 v49, v49, abs(v49)
 v_mul_f32 v50, v50, abs(v50)
 v_mul_f32 v51, v51, abs(v51)
 v_mfma_f32_16x16x32_bf16 v[72:75], v[120:123], v[216:219], v[72:75]
 ds_read_b128 v[112:115], v25 offset:30720
 v_cvt_pk_bf16_f32 v146, v48, v49
 v_mfma_f32_16x16x32_bf16 v[76:79], v[120:123], v[220:223], v[76:79]
 v_cvt_pk_bf16_f32 v147, v50, v51
 v_pk_max_i16 v146, v146, 0
 v_pk_max_i16 v147, v147, 0
 v_mfma_f32_16x16x32_bf16 v[80:83], v[124:127], v[216:219], v[80:83]
 ds_read_b128 v[116:119], v25 offset:51200
 buffer_store_dwordx4 v[144:147], v1, s[8:11], s41 offen sc1
 v_mfma_f32_16x16x32_bf16 v[84:87], v[124:127], v[220:223], v[84:87]
 s_waitcnt lgkmcnt(4)
 buffer_load_dwordx4 v1, s[8:11], s85 offen offset:2048 sc1 lds
 v_mfma_f32_16x16x32_bf16 v[72:75], v[96:99], v[224:227], v[72:75]
 ds_read_b128 v[120:123], v25 offset:31744
 v_mfma_f32_16x16x32_bf16 v[76:79], v[96:99], v[228:231], v[76:79]
 v_mul_f32 v44, v44, v156
 v_mfma_f32_16x16x32_bf16 v[80:83], v[100:103], v[224:227], v[80:83]
 ds_read_b128 v[124:127], v25 offset:52224
 v_mul_f32 v45, v45, v156
 v_mul_f32 v46, v46, v156
 v_mfma_f32_16x16x32_bf16 v[84:87], v[100:103], v[228:231], v[84:87]
 s_waitcnt lgkmcnt(4)
 v_mul_f32 v47, v47, v156
 v_mul_f32 v44, v44, abs(v44)
 v_mfma_f32_16x16x32_bf16 v[72:75], v[104:107], v[232:235], v[72:75]
 ds_read_b128 v[96:99], v25 offset:32768
 v_mul_f32 v45, v45, abs(v45)
 v_mul_f32 v46, v46, abs(v46)
 v_mfma_f32_16x16x32_bf16 v[76:79], v[104:107], v[236:239], v[76:79]
 buffer_load_dwordx4 v1, s[8:11], s85 offen offset:3072 sc1 lds
 v_mul_f32 v47, v47, abs(v47)
 v_mfma_f32_16x16x32_bf16 v[80:83], v[108:111], v[232:235], v[80:83]
 ds_read_b128 v[100:103], v25 offset:53248
 v_cvt_pk_bf16_f32 v148, v44, v45
 v_cvt_pk_bf16_f32 v149, v46, v47
 v_mfma_f32_16x16x32_bf16 v[84:87], v[108:111], v[236:239], v[84:87]
 s_waitcnt lgkmcnt(4)
 v_pk_max_i16 v148, v148, 0
 v_pk_max_i16 v149, v149, 0
 v_mfma_f32_16x16x32_bf16 v[72:75], v[112:115], v[240:243], v[72:75]
 ds_read_b128 v[104:107], v25 offset:33792
 v_mul_f32 v52, v52, v156
 v_mul_f32 v53, v53, v156
 v_mfma_f32_16x16x32_bf16 v[76:79], v[112:115], v[244:247], v[76:79]
 v_mul_f32 v54, v54, v156
 v_mul_f32 v55, v55, v156
 v_mfma_f32_16x16x32_bf16 v[80:83], v[116:119], v[240:243], v[80:83]
 ds_read_b128 v[108:111], v25 offset:54272
 v_mul_f32 v52, v52, abs(v52)
 v_mul_f32 v53, v53, abs(v53)
 v_mfma_f32_16x16x32_bf16 v[84:87], v[116:119], v[244:247], v[84:87]
 s_waitcnt lgkmcnt(4)
 s_add_u32 m0, s28, 98304
 s_add_u32 s85, s37, 34816
 buffer_load_dwordx4 v1, s[8:11], s85 offen sc1 lds
 v_mul_f32 v54, v54, abs(v54)
 v_mfma_f32_16x16x32_bf16 v[72:75], v[120:123], v[248:251], v[72:75]
 ds_read_b128 v[112:115], v25 offset:34816
 v_mul_f32 v55, v55, abs(v55)
 v_mfma_f32_16x16x32_bf16 v[76:79], v[120:123], v[252:255], v[76:79]
 v_cvt_pk_bf16_f32 v150, v52, v53
 v_cvt_pk_bf16_f32 v151, v54, v55
 v_pk_max_i16 v150, v150, 0
 v_mfma_f32_16x16x32_bf16 v[80:83], v[124:127], v[248:251], v[80:83]
 ds_read_b128 v[116:119], v25 offset:55296
 v_pk_max_i16 v151, v151, 0
 v_mfma_f32_16x16x32_bf16 v[84:87], v[124:127], v[252:255], v[84:87]
 s_waitcnt lgkmcnt(4)
 buffer_store_dwordx4 v[148:151], v1, s[8:11], s30 offen sc1
 v_mfma_f32_16x16x32_bf16 v[72:75], v[96:99], a[100:103], v[72:75]
 ds_read_b128 v[120:123], v25 offset:35840
 v_mfma_f32_16x16x32_bf16 v[76:79], v[96:99], a[104:107], v[76:79]
 buffer_load_dwordx4 v1, s[8:11], s85 offen offset:1024 sc1 lds
 v_mul_f32 v56, v56, v152
 v_mfma_f32_16x16x32_bf16 v[80:83], v[100:103], a[100:103], v[80:83]
 ds_read_b128 v[124:127], v25 offset:56320
 v_mul_f32 v57, v57, v152
 v_mfma_f32_16x16x32_bf16 v[84:87], v[100:103], a[104:107], v[84:87]
 s_waitcnt lgkmcnt(4)
 v_mul_f32 v58, v58, v152
 v_mul_f32 v59, v59, v152
 v_mul_f32 v56, v56, abs(v56)
 v_mfma_f32_16x16x32_bf16 v[72:75], v[104:107], a[108:111], v[72:75]
 ds_read_b128 v[96:99], v25 offset:36864
 v_mul_f32 v57, v57, abs(v57)
 v_mfma_f32_16x16x32_bf16 v[76:79], v[104:107], a[112:115], v[76:79]
 v_mul_f32 v58, v58, abs(v58)
 v_mul_f32 v59, v59, abs(v59)
 v_cvt_pk_bf16_f32 v144, v56, v57
 v_mfma_f32_16x16x32_bf16 v[80:83], v[108:111], a[108:111], v[80:83]
 ds_read_b128 v[100:103], v25 offset:57344
 v_cvt_pk_bf16_f32 v145, v58, v59
 v_mfma_f32_16x16x32_bf16 v[84:87], v[108:111], a[112:115], v[84:87]
 s_waitcnt lgkmcnt(4)
 buffer_load_dwordx4 v1, s[8:11], s85 offen offset:2048 sc1 lds
 v_pk_max_i16 v144, v144, 0
 v_mfma_f32_16x16x32_bf16 v[72:75], v[112:115], a[116:119], v[72:75]
 ds_read_b128 v[104:107], v25 offset:37888
 v_pk_max_i16 v145, v145, 0
 v_mul_f32 v64, v64, v152
 v_mfma_f32_16x16x32_bf16 v[76:79], v[112:115], a[120:123], v[76:79]
 v_mul_f32 v65, v65, v152
 v_mul_f32 v66, v66, v152
 v_mfma_f32_16x16x32_bf16 v[80:83], v[116:119], a[116:119], v[80:83]
 ds_read_b128 v[108:111], v25 offset:58368
 v_mul_f32 v67, v67, v152
 v_mul_f32 v64, v64, abs(v64)
 v_mfma_f32_16x16x32_bf16 v[84:87], v[116:119], a[120:123], v[84:87]
 s_waitcnt lgkmcnt(4)
 v_mul_f32 v65, v65, abs(v65)
 v_mul_f32 v66, v66, abs(v66)
 v_mfma_f32_16x16x32_bf16 v[72:75], v[120:123], a[124:127], v[72:75]
 ds_read_b128 v[112:115], v25 offset:38912
 v_mul_f32 v67, v67, abs(v67)
 v_cvt_pk_bf16_f32 v146, v64, v65
 v_mfma_f32_16x16x32_bf16 v[76:79], v[120:123], a[128:131], v[76:79]
 buffer_load_dwordx4 v1, s[8:11], s85 offen offset:3072 sc1 lds
 v_cvt_pk_bf16_f32 v147, v66, v67
 v_mfma_f32_16x16x32_bf16 v[80:83], v[124:127], a[124:127], v[80:83]
 ds_read_b128 v[116:119], v25 offset:59392
 v_pk_max_i16 v146, v146, 0
 v_pk_max_i16 v147, v147, 0
 v_mfma_f32_16x16x32_bf16 v[84:87], v[124:127], a[128:131], v[84:87]
 s_waitcnt lgkmcnt(4)
 buffer_store_dwordx4 v[144:147], v1, s[8:11], s41 offen offset:1024 sc1
 v_mfma_f32_16x16x32_bf16 v[72:75], v[96:99], a[132:135], v[72:75]
 ds_read_b128 v[120:123], v25 offset:39936
 v_mfma_f32_16x16x32_bf16 v[76:79], v[96:99], a[136:139], v[76:79]
 v_mul_f32 v60, v60, v156
 v_mfma_f32_16x16x32_bf16 v[80:83], v[100:103], a[132:135], v[80:83]
 ds_read_b128 v[124:127], v25 offset:60416
 v_mul_f32 v61, v61, v156
 v_mfma_f32_16x16x32_bf16 v[84:87], v[100:103], a[136:139], v[84:87]
 s_waitcnt lgkmcnt(4)
 s_add_u32 m0, s28, 114688
 s_add_u32 s85, s37, 38912
 buffer_load_dwordx4 v1, s[8:11], s85 offen sc1 lds
 v_mul_f32 v62, v62, v156
 v_mul_f32 v63, v63, v156
 v_mfma_f32_16x16x32_bf16 v[72:75], v[104:107], a[140:143], v[72:75]
 s_waitcnt vmcnt(12)
 s_barrier
 ds_read_b128 v[96:99], v25 offset:20480
 v_mul_f32 v60, v60, abs(v60)
 v_mfma_f32_16x16x32_bf16 v[76:79], v[104:107], a[144:147], v[76:79]
 v_mul_f32 v61, v61, abs(v61)
 v_mul_f32 v62, v62, abs(v62)
 v_mul_f32 v63, v63, abs(v63)
 v_mfma_f32_16x16x32_bf16 v[80:83], v[108:111], a[140:143], v[80:83]
 ds_read_b128 v[100:103], v25 offset:40960
 v_cvt_pk_bf16_f32 v148, v60, v61
 v_mfma_f32_16x16x32_bf16 v[84:87], v[108:111], a[144:147], v[84:87]
 s_waitcnt lgkmcnt(4)
 v_cvt_pk_bf16_f32 v149, v62, v63
 v_pk_max_i16 v148, v148, 0
 v_mfma_f32_16x16x32_bf16 v[72:75], v[112:115], a[148:151], v[72:75]
 ds_read_b128 v[104:107], v25 offset:21504
 v_pk_max_i16 v149, v149, 0
 v_mul_f32 v68, v68, v156
 v_mfma_f32_16x16x32_bf16 v[76:79], v[112:115], a[152:155], v[76:79]
 buffer_load_dwordx4 v1, s[8:11], s85 offen offset:1024 sc1 lds
 v_mul_f32 v69, v69, v156
 v_mfma_f32_16x16x32_bf16 v[80:83], v[116:119], a[148:151], v[80:83]
 ds_read_b128 v[108:111], v25 offset:41984
 v_mul_f32 v70, v70, v156
 v_mul_f32 v71, v71, v156
 v_mfma_f32_16x16x32_bf16 v[84:87], v[116:119], a[152:155], v[84:87]
 s_waitcnt lgkmcnt(4)
 v_mul_f32 v68, v68, abs(v68)
 v_mul_f32 v69, v69, abs(v69)
 v_mfma_f32_16x16x32_bf16 v[72:75], v[120:123], a[156:159], v[72:75]
 ds_read_b128 v[112:115], v25 offset:22528
 v_mul_f32 v70, v70, abs(v70)
 v_mul_f32 v71, v71, abs(v71)
 v_mfma_f32_16x16x32_bf16 v[76:79], v[120:123], a[160:163], v[76:79]
 v_cvt_pk_bf16_f32 v150, v68, v69
 v_cvt_pk_bf16_f32 v151, v70, v71
 v_mfma_f32_16x16x32_bf16 v[80:83], v[124:127], a[156:159], v[80:83]
 ds_read_b128 v[116:119], v25 offset:43008
 v_pk_max_i16 v150, v150, 0
 v_pk_max_i16 v151, v151, 0
 v_mfma_f32_16x16x32_bf16 v[84:87], v[124:127], a[160:163], v[84:87]
 s_waitcnt lgkmcnt(4)
 buffer_load_dwordx4 v1, s[8:11], s85 offen offset:2048 sc1 lds
 buffer_store_dwordx4 v[148:151], v1, s[8:11], s30 offen offset:1024 sc1
 v_mfma_f32_16x16x32_bf16 v[72:75], v[96:99], v[160:163], v[72:75]
 ds_read_b128 v[120:123], v25 offset:23552
 v_mfma_f32_16x16x32_bf16 v[76:79], v[96:99], v[164:167], v[76:79]
 v_mfma_f32_16x16x32_bf16 v[80:83], v[100:103], v[160:163], v[80:83]
 ds_read_b128 v[124:127], v25 offset:44032
 v_mfma_f32_16x16x32_bf16 v[84:87], v[100:103], v[164:167], v[84:87]
 s_waitcnt lgkmcnt(4)
 v_mfma_f32_16x16x32_bf16 v[72:75], v[104:107], v[168:171], v[72:75]
 ds_read_b128 v[96:99], v25
 v_mfma_f32_16x16x32_bf16 v[76:79], v[104:107], v[172:175], v[76:79]
 buffer_load_dwordx4 v1, s[8:11], s85 offen offset:3072 sc1 lds
 v_mfma_f32_16x16x32_bf16 v[80:83], v[108:111], v[168:171], v[80:83]
 ds_read_b128 v[100:103], v25 offset:1024
 v_mfma_f32_16x16x32_bf16 v[84:87], v[108:111], v[172:175], v[84:87]
 s_waitcnt lgkmcnt(4)
 v_mfma_f32_16x16x32_bf16 v[72:75], v[112:115], v[176:179], v[72:75]
 ds_read_b128 v[104:107], v25 offset:2048
 v_mfma_f32_16x16x32_bf16 v[76:79], v[112:115], v[180:183], v[76:79]
 v_mfma_f32_16x16x32_bf16 v[80:83], v[116:119], v[176:179], v[80:83]
 ds_read_b128 v[108:111], v25 offset:3072
 v_mfma_f32_16x16x32_bf16 v[84:87], v[116:119], v[180:183], v[84:87]
 s_waitcnt lgkmcnt(4)
 s_add_u32 m0, s28, 131072
 s_add_u32 s85, s37, 43008
 buffer_load_dwordx4 v1, s[8:11], s85 offen sc1 lds
 v_mfma_f32_16x16x32_bf16 v[72:75], v[120:123], v[184:187], v[72:75]
 ds_read_b128 v[112:115], v25 offset:4096
 v_mfma_f32_16x16x32_bf16 v[76:79], v[120:123], v[188:191], v[76:79]
 v_mfma_f32_16x16x32_bf16 v[80:83], v[124:127], v[184:187], v[80:83]
 ds_read_b128 v[116:119], v25 offset:5120
 v_mfma_f32_16x16x32_bf16 v[84:87], v[124:127], v[188:191], v[84:87]
 s_waitcnt lgkmcnt(4)
 v_mfma_f32_16x16x32_bf16 v[88:91], v[96:99], v[160:163], v[88:91]
 ds_read_b128 v[120:123], v25 offset:6144
 v_mfma_f32_16x16x32_bf16 v[92:95], v[96:99], v[164:167], v[92:95]
 buffer_load_dwordx4 v1, s[8:11], s85 offen offset:1024 sc1 lds
 v_mfma_f32_16x16x32_bf16 v[88:91], v[100:103], v[168:171], v[88:91]
 ds_read_b128 v[124:127], v25 offset:7168
 v_mfma_f32_16x16x32_bf16 v[92:95], v[100:103], v[172:175], v[92:95]
 s_waitcnt lgkmcnt(4)
 v_mul_f32 v72, v72, v152
 v_mul_f32 v73, v73, v152
 v_mfma_f32_16x16x32_bf16 v[88:91], v[104:107], v[176:179], v[88:91]
 ds_read_b128 v[96:99], v25 offset:8192
 v_mul_f32 v74, v74, v152
 v_mfma_f32_16x16x32_bf16 v[92:95], v[104:107], v[180:183], v[92:95]
 buffer_load_dwordx4 v1, s[8:11], s85 offen offset:2048 sc1 lds
 v_mul_f32 v75, v75, v152
 v_mfma_f32_16x16x32_bf16 v[88:91], v[108:111], v[184:187], v[88:91]
 ds_read_b128 v[100:103], v25 offset:9216
 v_mul_f32 v72, v72, abs(v72)
 v_mul_f32 v73, v73, abs(v73)
 v_mfma_f32_16x16x32_bf16 v[92:95], v[108:111], v[188:191], v[92:95]
 s_waitcnt lgkmcnt(4)
 v_mul_f32 v74, v74, abs(v74)
 v_mul_f32 v75, v75, abs(v75)
 v_mfma_f32_16x16x32_bf16 v[88:91], v[112:115], v[192:195], v[88:91]
 ds_read_b128 v[104:107], v25 offset:10240
 v_cvt_pk_bf16_f32 v144, v72, v73
 v_mfma_f32_16x16x32_bf16 v[92:95], v[112:115], v[196:199], v[92:95]
 v_cvt_pk_bf16_f32 v145, v74, v75
 v_pk_max_i16 v144, v144, 0
 v_mfma_f32_16x16x32_bf16 v[88:91], v[116:119], v[200:203], v[88:91]
 ds_read_b128 v[108:111], v25 offset:11264
 v_pk_max_i16 v145, v145, 0
 v_mfma_f32_16x16x32_bf16 v[92:95], v[116:119], v[204:207], v[92:95]
 s_waitcnt lgkmcnt(4)
 buffer_load_dwordx4 v1, s[8:11], s85 offen offset:3072 sc1 lds
 v_mul_f32 v80, v80, v152
 v_mfma_f32_16x16x32_bf16 v[88:91], v[120:123], v[208:211], v[88:91]
 ds_read_b128 v[112:115], v25 offset:12288
 v_mul_f32 v81, v81, v152
 v_mfma_f32_16x16x32_bf16 v[92:95], v[120:123], v[212:215], v[92:95]
 v_mul_f32 v82, v82, v152
 v_mul_f32 v83, v83, v152
 v_mfma_f32_16x16x32_bf16 v[88:91], v[124:127], v[216:219], v[88:91]
 s_waitcnt vmcnt(5)
 ds_read_b128 v[116:119], v25 offset:13312
 v_mov_b32 v27, 3
 s_mov_b64 exec, 1
 buffer_store_dword v27, off, s[8:11], s50 sc1
 s_mov_b64 exec, -1
 v_mul_f32 v80, v80, abs(v80)
 v_mfma_f32_16x16x32_bf16 v[92:95], v[124:127], v[220:223], v[92:95]
 s_waitcnt lgkmcnt(4)
 v_mul_f32 v81, v81, abs(v81)
 v_mul_f32 v82, v82, abs(v82)
 v_mfma_f32_16x16x32_bf16 v[88:91], v[96:99], v[224:227], v[88:91]
 ds_read_b128 v[120:123], v25 offset:14336
 v_mul_f32 v83, v83, abs(v83)
 v_mfma_f32_16x16x32_bf16 v[92:95], v[96:99], v[228:231], v[92:95]
 s_add_u32 m0, s28, 147456
 s_add_u32 s85, s37, 47104
 buffer_load_dwordx4 v1, s[8:11], s85 offen sc1 lds
 v_cvt_pk_bf16_f32 v146, v80, v81
 v_mfma_f32_16x16x32_bf16 v[88:91], v[100:103], v[232:235], v[88:91]
 ds_read_b128 v[124:127], v25 offset:15360
 v_cvt_pk_bf16_f32 v147, v82, v83
 v_mfma_f32_16x16x32_bf16 v[92:95], v[100:103], v[236:239], v[92:95]
 s_waitcnt lgkmcnt(4)
 v_pk_max_i16 v146, v146, 0
 v_pk_max_i16 v147, v147, 0
 v_mfma_f32_16x16x32_bf16 v[88:91], v[104:107], v[240:243], v[88:91]
 ds_read_b128 v[96:99], v25 offset:16384
 buffer_store_dwordx4 v[144:147], v1, s[8:11], s84 offen sc1
 v_mfma_f32_16x16x32_bf16 v[92:95], v[104:107], v[244:247], v[92:95]
 v_mfma_f32_16x16x32_bf16 v[88:91], v[108:111], v[248:251], v[88:91]
 ds_read_b128 v[100:103], v25 offset:17408
 v_mfma_f32_16x16x32_bf16 v[92:95], v[108:111], v[252:255], v[92:95]
 s_waitcnt lgkmcnt(4)
 buffer_load_dwordx4 v1, s[8:11], s85 offen offset:1024 sc1 lds
 v_mul_f32 v76, v76, v156
 v_mfma_f32_16x16x32_bf16 v[88:91], v[112:115], a[100:103], v[88:91]
 ds_read_b128 v[104:107], v25 offset:18432
 v_mul_f32 v77, v77, v156
 v_mfma_f32_16x16x32_bf16 v[92:95], v[112:115], a[104:107], v[92:95]
 v_mul_f32 v78, v78, v156
 v_mul_f32 v79, v79, v156
 v_mfma_f32_16x16x32_bf16 v[88:91], v[116:119], a[108:111], v[88:91]
 ds_read_b128 v[108:111], v25 offset:19456
 v_and_b32 v254, 28, v22
 v_mfma_f32_16x16x32_bf16 v[92:95], v[116:119], a[112:115], v[92:95]
 s_waitcnt lgkmcnt(4)
 v_mul_f32 v76, v76, abs(v76)
 v_mul_f32 v77, v77, abs(v77)
 v_mfma_f32_16x16x32_bf16 v[88:91], v[120:123], a[116:119], v[88:91]
 v_mul_f32 v78, v78, abs(v78)
 v_mul_f32 v79, v79, abs(v79)
 v_cvt_pk_bf16_f32 v148, v76, v77
 v_mfma_f32_16x16x32_bf16 v[92:95], v[120:123], a[120:123], v[92:95]
 buffer_load_dwordx4 v1, s[8:11], s85 offen offset:2048 sc1 lds
 buffer_load_dword v26, v254, s[8:11], s51 offen sc1
 v_mfma_f32_16x16x32_bf16 v[88:91], v[124:127], a[124:127], v[88:91]
 v_cvt_pk_bf16_f32 v149, v78, v79
 v_pk_max_i16 v148, v148, 0
 v_mfma_f32_16x16x32_bf16 v[92:95], v[124:127], a[128:131], v[92:95]
 s_waitcnt lgkmcnt(2)
 v_pk_max_i16 v149, v149, 0
 v_mul_f32 v84, v84, v156
 v_mfma_f32_16x16x32_bf16 v[88:91], v[96:99], a[132:135], v[88:91]
 v_mul_f32 v85, v85, v156
 v_mul_f32 v86, v86, v156
 v_mfma_f32_16x16x32_bf16 v[92:95], v[96:99], a[136:139], v[92:95]
 v_mul_f32 v87, v87, v156
 v_mul_f32 v84, v84, abs(v84)
 v_mfma_f32_16x16x32_bf16 v[88:91], v[100:103], a[140:143], v[88:91]
 v_mul_f32 v85, v85, abs(v85)
 v_mul_f32 v86, v86, abs(v86)
 v_mfma_f32_16x16x32_bf16 v[92:95], v[100:103], a[144:147], v[92:95]
 s_waitcnt lgkmcnt(0)
 buffer_load_dwordx4 v1, s[8:11], s85 offen offset:3072 sc1 lds
 v_mul_f32 v87, v87, abs(v87)
 v_mfma_f32_16x16x32_bf16 v[88:91], v[104:107], a[148:151], v[88:91]
 v_cvt_pk_bf16_f32 v150, v84, v85
 v_cvt_pk_bf16_f32 v151, v86, v87
 v_pk_max_i16 v150, v150, 0
 v_mfma_f32_16x16x32_bf16 v[92:95], v[104:107], a[152:155], v[92:95]
 v_pk_max_i16 v151, v151, 0
 v_mfma_f32_16x16x32_bf16 v[88:91], v[108:111], a[156:159], v[88:91]
 buffer_store_dwordx4 v[148:151], v1, s[8:11], s32 offen sc1
 v_mfma_f32_16x16x32_bf16 v[92:95], v[108:111], a[160:163], v[92:95]
 v_add_u32 v244, s56, v1
 v_add_u32 v245, s57, v1
 v_add_u32 v246, s58, v1
 v_add_u32 v247, s59, v1
 s_nop 1
 v_pk_mul_f32 v[88:89], v[88:89], v[152:153] op_sel_hi:[1,0]
 v_pk_mul_f32 v[90:91], v[90:91], v[152:153] op_sel_hi:[1,0]
 v_mul_f32 v88, v88, abs(v88)
 v_mul_f32 v89, v89, abs(v89)
 v_mul_f32 v90, v90, abs(v90)
 v_mul_f32 v91, v91, abs(v91)
 v_cvt_pk_bf16_f32 v144, v88, v89
 v_cvt_pk_bf16_f32 v145, v90, v91
 v_pk_max_i16 v144, v144, 0
 v_pk_max_i16 v145, v145, 0
 buffer_store_dwordx2 v[144:145], v1, s[8:11], s42 offen sc1
 v_pk_mul_f32 v[92:93], v[92:93], v[156:157] op_sel_hi:[1,0]
 v_pk_mul_f32 v[94:95], v[94:95], v[156:157] op_sel_hi:[1,0]
 v_mul_f32 v92, v92, abs(v92)
 v_mul_f32 v93, v93, abs(v93)
 v_mul_f32 v94, v94, abs(v94)
 v_mul_f32 v95, v95, abs(v95)
 v_cvt_pk_bf16_f32 v148, v92, v93
 v_cvt_pk_bf16_f32 v149, v94, v95
 v_pk_max_i16 v148, v148, 0
 v_pk_max_i16 v149, v149, 0
 buffer_store_dwordx2 v[148:149], v1, s[8:11], s31 offen sc1
 s_waitcnt vmcnt(4)
 v_cmp_gt_u32 vcc, 3, v26
 s_cbranch_vccnz sretry_25
sback_26:
 buffer_load_dwordx4 v[160:163], v244, s[8:11], s66 offen offset:2048 sc1
 buffer_load_dwordx4 v[164:167], v245, s[8:11], s66 offen offset:2048 sc1
 buffer_load_dwordx4 v[168:171], v246, s[8:11], s66 offen offset:2048 sc1
 buffer_load_dwordx4 v[172:175], v247, s[8:11], s66 offen offset:2048 sc1
 v_add_u32 v252, 81920, v3
 v_add_u32 v253, 147456, v3
 v_add_u32 v248, s83, v1
 s_barrier
 buffer_load_dwordx4 a[100:103], v39, s[8:11], s70 offen offset:1024 sc1
 buffer_load_dwordx4 a[104:107], v39, s[8:11], s70 offen offset:2048 sc1
 v_mov_b32 v27, 4
 s_waitcnt vmcnt(6)
 s_mov_b64 exec, 1
 buffer_store_dword v27, off, s[8:11], s50 sc1
 s_mov_b64 exec, -1
 s_add_u32 s31, s22, 3
 s_and_b32 s31, s31, 3
 s_mul_i32 s31, s31, 10240
 s_add_u32 s31, s31, 2048
 v_add_u32 v249, s31, v22
 s_add_u32 s31, s22, 2
 s_and_b32 s31, s31, 3
 s_mul_i32 s31, s31, 10240
 s_add_u32 s31, s31, 2048
 v_add_u32 v250, s31, v22
 s_add_u32 s31, s22, 1
 s_and_b32 s31, s31, 3
 s_mul_i32 s31, s31, 10240
 s_add_u32 s31, s31, 2048
 v_add_u32 v251, s31, v22
 ds_read_b128 v[184:187], v21 offset:1152
 buffer_load_dwordx4 v[176:179], v244, s[8:11], s66 offen offset:3072 sc1
 ds_read_b128 v[188:191], v21 offset:1216
 ds_read_b128 v[192:195], v21 offset:1280
 ds_read_b128 v[196:199], v21 offset:1344
 ds_read_b128 v[200:203], v21 offset:1408
 v_lshlrev_b32 v100, 16, v28
 v_and_b32 v101, 0xffff0000, v28
 v_lshlrev_b32 v102, 16, v29
 v_and_b32 v103, 0xffff0000, v29
 buffer_load_dwordx4 v[180:183], v245, s[8:11], s66 offen offset:3072 sc1
 v_lshlrev_b32 v104, 16, v30
 v_and_b32 v105, 0xffff0000, v30
 v_lshlrev_b32 v106, 16, v31
 v_and_b32 v107, 0xffff0000, v31
 v_lshlrev_b32 v108, 16, v32
 v_and_b32 v109, 0xffff0000, v32
 v_lshlrev_b32 v110, 16, v33
 v_and_b32 v111, 0xffff0000, v33
 v_lshlrev_b32 v112, 16, v34
 buffer_load_dwordx4 v[120:123], v246, s[8:11], s66 offen offset:3072 sc1
 v_and_b32 v113, 0xffff0000, v34
 v_lshlrev_b32 v114, 16, v35
 v_and_b32 v115, 0xffff0000, v35
 v_lshlrev_b32 v116, 16, v36
 v_and_b32 v117, 0xffff0000, v36
 v_lshlrev_b32 v118, 16, v37
 v_and_b32 v119, 0xffff0000, v37
 s_waitcnt lgkmcnt(4)
 v_pk_add_f32 v[100:101], v[100:101], v[184:185]
 v_pk_add_f32 v[102:103], v[102:103], v[186:187]
 buffer_load_dwordx4 v[124:127], v247, s[8:11], s66 offen offset:3072 sc1
 s_waitcnt lgkmcnt(3)
 v_pk_add_f32 v[104:105], v[104:105], v[188:189]
 v_pk_add_f32 v[106:107], v[106:107], v[190:191]
 s_waitcnt lgkmcnt(2)
 v_pk_add_f32 v[108:109], v[108:109], v[192:193]
 v_pk_add_f32 v[110:111], v[110:111], v[194:195]
 s_waitcnt lgkmcnt(1)
 v_pk_add_f32 v[112:113], v[112:113], v[196:197]
 v_pk_add_f32 v[114:115], v[114:115], v[198:199]
 s_waitcnt lgkmcnt(0)
 v_pk_add_f32 v[116:117], v[116:117], v[200:201]
 v_pk_add_f32 v[118:119], v[118:119], v[202:203]
 s_waitcnt vmcnt(10)
 v_mfma_f32_16x16x32_bf16 v[40:43], a[236:239], v[160:163], 0
 buffer_load_dwordx4 v[128:131], v244, s[8:11], s67 offen sc1
 v_mfma_f32_16x16x32_bf16 v[44:47], a[240:243], v[160:163], 0
 v_mfma_f32_16x16x32_bf16 v[48:51], a[244:247], v[160:163], 0
 v_mfma_f32_16x16x32_bf16 v[52:55], a[248:251], v[160:163], 0
 v_mfma_f32_16x16x32_bf16 v[56:59], a[252:255], v[160:163], 0
 s_waitcnt vmcnt(10)
 buffer_load_dwordx4 v[132:135], v245, s[8:11], s67 offen sc1
 v_mfma_f32_16x16x32_bf16 v[60:63], a[236:239], v[164:167], 0
 v_mfma_f32_16x16x32_bf16 v[64:67], a[240:243], v[164:167], 0
 v_mfma_f32_16x16x32_bf16 v[68:71], a[244:247], v[164:167], 0
 v_mfma_f32_16x16x32_bf16 v[72:75], a[248:251], v[164:167], 0
 v_mfma_f32_16x16x32_bf16 v[76:79], a[252:255], v[164:167], 0
 s_waitcnt vmcnt(10)
 buffer_load_dwordx4 v[136:139], v246, s[8:11], s67 offen sc1
 v_mfma_f32_16x16x32_bf16 v[80:83], a[236:239], v[168:171], 0
 v_mfma_f32_16x16x32_bf16 v[84:87], a[240:243], v[168:171], 0
 v_mfma_f32_16x16x32_bf16 v[88:91], a[244:247], v[168:171], 0
 v_mfma_f32_16x16x32_bf16 v[92:95], a[248:251], v[168:171], 0
 buffer_load_dwordx4 v[140:143], v247, s[8:11], s67 offen sc1
 v_mfma_f32_16x16x32_bf16 v[96:99], a[252:255], v[168:171], 0
 s_waitcnt vmcnt(11)
 v_mfma_f32_16x16x32_bf16 v[100:103], a[236:239], v[172:175], v[100:103]
 v_mfma_f32_16x16x32_bf16 v[104:107], a[240:243], v[172:175], v[104:107]
 v_mfma_f32_16x16x32_bf16 v[108:111], a[244:247], v[172:175], v[108:111]
 v_mfma_f32_16x16x32_bf16 v[112:115], a[248:251], v[172:175], v[112:115]
 buffer_load_dwordx4 v[144:147], v244, s[8:11], s67 offen offset:1024 sc1
 v_mfma_f32_16x16x32_bf16 v[116:119], a[252:255], v[172:175], v[116:119]
 s_waitcnt vmcnt(8)
 v_mfma_f32_16x16x32_bf16 v[40:43], a[176:179], v[176:179], v[40:43]
 v_mfma_f32_16x16x32_bf16 v[44:47], a[180:183], v[176:179], v[44:47]
 v_mfma_f32_16x16x32_bf16 v[48:51], a[184:187], v[176:179], v[48:51]
 buffer_load_dwordx4 v[148:151], v245, s[8:11], s67 offen offset:1024 sc1
 v_mfma_f32_16x16x32_bf16 v[52:55], a[188:191], v[176:179], v[52:55]
 v_mfma_f32_16x16x32_bf16 v[56:59], a[192:195], v[176:179], v[56:59]
 s_waitcnt vmcnt(8)
 v_mfma_f32_16x16x32_bf16 v[60:63], a[176:179], v[180:183], v[60:63]
 v_mfma_f32_16x16x32_bf16 v[64:67], a[180:183], v[180:183], v[64:67]
 v_mfma_f32_16x16x32_bf16 v[68:71], a[184:187], v[180:183], v[68:71]
 buffer_load_dwordx4 v[152:155], v246, s[8:11], s67 offen offset:1024 sc1
 v_mfma_f32_16x16x32_bf16 v[72:75], a[188:191], v[180:183], v[72:75]
 v_mfma_f32_16x16x32_bf16 v[76:79], a[192:195], v[180:183], v[76:79]
 s_waitcnt vmcnt(8)
 v_mfma_f32_16x16x32_bf16 v[80:83], a[176:179], v[120:123], v[80:83]
 v_mfma_f32_16x16x32_bf16 v[84:87], a[180:183], v[120:123], v[84:87]
 buffer_load_dwordx4 v[156:159], v247, s[8:11], s67 offen offset:1024 sc1
 v_mfma_f32_16x16x32_bf16 v[88:91], a[184:187], v[120:123], v[88:91]
 v_mfma_f32_16x16x32_bf16 v[92:95], a[188:191], v[120:123], v[92:95]
 v_mfma_f32_16x16x32_bf16 v[96:99], a[192:195], v[120:123], v[96:99]
 s_waitcnt vmcnt(8)
 v_mfma_f32_16x16x32_bf16 v[100:103], a[176:179], v[124:127], v[100:103]
 v_mfma_f32_16x16x32_bf16 v[104:107], a[180:183], v[124:127], v[104:107]
 buffer_load_dwordx4 v[160:163], v244, s[8:11], s65 offen offset:2048 sc1
 v_mfma_f32_16x16x32_bf16 v[108:111], a[184:187], v[124:127], v[108:111]
 v_mfma_f32_16x16x32_bf16 v[112:115], a[188:191], v[124:127], v[112:115]
 v_mfma_f32_16x16x32_bf16 v[116:119], a[192:195], v[124:127], v[116:119]
 s_waitcnt vmcnt(8)
 v_mfma_f32_16x16x32_bf16 v[40:43], a[196:199], v[128:131], v[40:43]
 buffer_load_dwordx4 v[164:167], v245, s[8:11], s65 offen offset:2048 sc1
 v_mfma_f32_16x16x32_bf16 v[44:47], a[200:203], v[128:131], v[44:47]
 v_mfma_f32_16x16x32_bf16 v[48:51], a[204:207], v[128:131], v[48:51]
 v_mfma_f32_16x16x32_bf16 v[52:55], a[208:211], v[128:131], v[52:55]
 v_mfma_f32_16x16x32_bf16 v[56:59], a[212:215], v[128:131], v[56:59]
 s_waitcnt vmcnt(8)
 buffer_load_dwordx4 a[108:111], v39, s[8:11], s70 offen offset:3072 sc1
 v_mfma_f32_16x16x32_bf16 v[60:63], a[196:199], v[132:135], v[60:63]
 buffer_load_dword v26, v254, s[8:11], s51 offen sc1
 buffer_load_dwordx4 v[168:171], v246, s[8:11], s65 offen offset:2048 sc1
 v_mfma_f32_16x16x32_bf16 v[64:67], a[200:203], v[132:135], v[64:67]
 v_mfma_f32_16x16x32_bf16 v[68:71], a[204:207], v[132:135], v[68:71]
 v_mfma_f32_16x16x32_bf16 v[72:75], a[208:211], v[132:135], v[72:75]
 v_mfma_f32_16x16x32_bf16 v[76:79], a[212:215], v[132:135], v[76:79]
 s_waitcnt vmcnt(10)
 v_mfma_f32_16x16x32_bf16 v[80:83], a[196:199], v[136:139], v[80:83]
 buffer_load_dwordx4 v[172:175], v247, s[8:11], s65 offen offset:2048 sc1
 v_mfma_f32_16x16x32_bf16 v[84:87], a[200:203], v[136:139], v[84:87]
 v_mfma_f32_16x16x32_bf16 v[88:91], a[204:207], v[136:139], v[88:91]
 v_mfma_f32_16x16x32_bf16 v[92:95], a[208:211], v[136:139], v[92:95]
 v_mfma_f32_16x16x32_bf16 v[96:99], a[212:215], v[136:139], v[96:99]
 s_waitcnt vmcnt(10)
 buffer_load_dwordx4 v[176:179], v244, s[8:11], s65 offen offset:3072 sc1
 v_mfma_f32_16x16x32_bf16 v[100:103], a[196:199], v[140:143], v[100:103]
 v_mfma_f32_16x16x32_bf16 v[104:107], a[200:203], v[140:143], v[104:107]
 v_mfma_f32_16x16x32_bf16 v[108:111], a[204:207], v[140:143], v[108:111]
 v_mfma_f32_16x16x32_bf16 v[112:115], a[208:211], v[140:143], v[112:115]
 v_mfma_f32_16x16x32_bf16 v[116:119], a[212:215], v[140:143], v[116:119]
 s_waitcnt vmcnt(10)
 buffer_load_dwordx4 v[180:183], v245, s[8:11], s65 offen offset:3072 sc1
 v_mfma_f32_16x16x32_bf16 v[40:43], a[216:219], v[144:147], v[40:43]
 v_mfma_f32_16x16x32_bf16 v[44:47], a[220:223], v[144:147], v[44:47]
 v_mfma_f32_16x16x32_bf16 v[48:51], a[224:227], v[144:147], v[48:51]
 buffer_load_dwordx4 a[112:115], v39, s[8:11], s71 offen sc1
 v_mfma_f32_16x16x32_bf16 v[52:55], a[228:231], v[144:147], v[52:55]
 buffer_load_dwordx4 v[120:123], v246, s[8:11], s65 offen offset:3072 sc1
 v_mfma_f32_16x16x32_bf16 v[56:59], a[232:235], v[144:147], v[56:59]
 s_waitcnt vmcnt(12)
 ds_read_b128 v[184:187], v252
 v_mfma_f32_16x16x32_bf16 v[60:63], a[216:219], v[148:151], v[60:63]
 v_mfma_f32_16x16x32_bf16 v[64:67], a[220:223], v[148:151], v[64:67]
 ds_read_b128 v[188:191], v252 offset:1024
 v_mfma_f32_16x16x32_bf16 v[68:71], a[224:227], v[148:151], v[68:71]
 v_mfma_f32_16x16x32_bf16 v[72:75], a[228:231], v[148:151], v[72:75]
 buffer_load_dwordx4 v[124:127], v247, s[8:11], s65 offen offset:3072 sc1
 v_mfma_f32_16x16x32_bf16 v[76:79], a[232:235], v[148:151], v[76:79]
 s_waitcnt vmcnt(12)
 ds_read_b128 v[192:195], v252 offset:2048
 v_mfma_f32_16x16x32_bf16 v[80:83], a[216:219], v[152:155], v[80:83]
 v_mfma_f32_16x16x32_bf16 v[84:87], a[220:223], v[152:155], v[84:87]
 ds_read_b128 v[196:199], v252 offset:3072
 v_mfma_f32_16x16x32_bf16 v[88:91], a[224:227], v[152:155], v[88:91]
 buffer_load_dwordx4 v[128:131], v244, s[8:11], s66 offen sc1
 v_mfma_f32_16x16x32_bf16 v[92:95], a[228:231], v[152:155], v[92:95]
 ds_read_b128 v[200:203], v252 offset:16384
 v_mfma_f32_16x16x32_bf16 v[96:99], a[232:235], v[152:155], v[96:99]
 s_waitcnt vmcnt(12)
 v_mfma_f32_16x16x32_bf16 v[100:103], a[216:219], v[156:159], v[100:103]
 v_mfma_f32_16x16x32_bf16 v[104:107], a[220:223], v[156:159], v[104:107]
 v_mfma_f32_16x16x32_bf16 v[108:111], a[224:227], v[156:159], v[108:111]
 buffer_load_dwordx4 v[132:135], v245, s[8:11], s66 offen sc1
 v_mfma_f32_16x16x32_bf16 v[112:115], a[228:231], v[156:159], v[112:115]
 v_mfma_f32_16x16x32_bf16 v[116:119], a[232:235], v[156:159], v[116:119]
 s_waitcnt vmcnt(12) lgkmcnt(4)
 v_mfma_f32_16x16x32_bf16 v[40:43], v[184:187], v[160:163], v[40:43]
 s_waitcnt lgkmcnt(3)
 v_mfma_f32_16x16x32_bf16 v[44:47], v[188:191], v[160:163], v[44:47]
 s_waitcnt lgkmcnt(2)
 buffer_load_dwordx4 v[136:139], v246, s[8:11], s66 offen sc1
 v_mfma_f32_16x16x32_bf16 v[48:51], v[192:195], v[160:163], v[48:51]
 s_waitcnt lgkmcnt(1)
 v_mfma_f32_16x16x32_bf16 v[52:55], v[196:199], v[160:163], v[52:55]
 s_waitcnt lgkmcnt(0)
 buffer_load_dwordx4 a[116:119], v39, s[8:11], s71 offen offset:1024 sc1
 v_mfma_f32_16x16x32_bf16 v[56:59], v[200:203], v[160:163], v[56:59]
 s_waitcnt vmcnt(13)
 ds_read_b128 v[204:207], v252 offset:17408
 v_mfma_f32_16x16x32_bf16 v[60:63], v[184:187], v[164:167], v[60:63]
 v_mfma_f32_16x16x32_bf16 v[64:67], v[188:191], v[164:167], v[64:67]
 buffer_load_dwordx4 v[140:143], v247, s[8:11], s66 offen sc1
 ds_read_b128 v[208:211], v252 offset:18432
 v_mfma_f32_16x16x32_bf16 v[68:71], v[192:195], v[164:167], v[68:71]
 v_mfma_f32_16x16x32_bf16 v[72:75], v[196:199], v[164:167], v[72:75]
 v_mfma_f32_16x16x32_bf16 v[76:79], v[200:203], v[164:167], v[76:79]
 s_waitcnt vmcnt(11)
 ds_read_b128 v[212:215], v252 offset:19456
 v_mfma_f32_16x16x32_bf16 v[80:83], v[184:187], v[168:171], v[80:83]
 buffer_load_dwordx4 v[144:147], v244, s[8:11], s66 offen offset:1024 sc1
 v_mfma_f32_16x16x32_bf16 v[84:87], v[188:191], v[168:171], v[84:87]
 ds_read_b128 v[216:219], v252 offset:32768
 v_mfma_f32_16x16x32_bf16 v[88:91], v[192:195], v[168:171], v[88:91]
 v_mfma_f32_16x16x32_bf16 v[92:95], v[196:199], v[168:171], v[92:95]
 ds_read_b128 v[220:223], v252 offset:33792
 v_mfma_f32_16x16x32_bf16 v[96:99], v[200:203], v[168:171], v[96:99]
 s_waitcnt vmcnt(11)
 v_mfma_f32_16x16x32_bf16 v[100:103], v[184:187], v[172:175], v[100:103]
 buffer_load_dwordx4 v[148:151], v245, s[8:11], s66 offen offset:1024 sc1
 v_mfma_f32_16x16x32_bf16 v[104:107], v[188:191], v[172:175], v[104:107]
 v_mfma_f32_16x16x32_bf16 v[108:111], v[192:195], v[172:175], v[108:111]
 v_mfma_f32_16x16x32_bf16 v[112:115], v[196:199], v[172:175], v[112:115]
 v_mfma_f32_16x16x32_bf16 v[116:119], v[200:203], v[172:175], v[116:119]
 s_waitcnt vmcnt(11) lgkmcnt(4)
 v_mfma_f32_16x16x32_bf16 v[40:43], v[204:207], v[176:179], v[40:43]
 s_waitcnt lgkmcnt(3)
 buffer_load_dwordx4 v[152:155], v246, s[8:11], s66 offen offset:1024 sc1
 v_mfma_f32_16x16x32_bf16 v[44:47], v[208:211], v[176:179], v[44:47]
 s_waitcnt lgkmcnt(2)
 v_mfma_f32_16x16x32_bf16 v[48:51], v[212:215], v[176:179], v[48:51]
 s_waitcnt lgkmcnt(1)
 v_mfma_f32_16x16x32_bf16 v[52:55], v[216:219], v[176:179], v[52:55]
 s_waitcnt lgkmcnt(0)
 v_mfma_f32_16x16x32_bf16 v[56:59], v[220:223], v[176:179], v[56:59]
 s_waitcnt vmcnt(11)
 buffer_load_dwordx4 v[156:159], v247, s[8:11], s66 offen offset:1024 sc1
 ds_read_b128 v[184:187], v252 offset:34816
 v_mfma_f32_16x16x32_bf16 v[60:63], v[204:207], v[180:183], v[60:63]
 v_mfma_f32_16x16x32_bf16 v[64:67], v[208:211], v[180:183], v[64:67]
 ds_read_b128 v[188:191], v252 offset:35840
 v_mfma_f32_16x16x32_bf16 v[68:71], v[212:215], v[180:183], v[68:71]
 v_mfma_f32_16x16x32_bf16 v[72:75], v[216:219], v[180:183], v[72:75]
 ds_read_b128 v[192:195], v252 offset:49152
 v_mfma_f32_16x16x32_bf16 v[76:79], v[220:223], v[180:183], v[76:79]
 v_cmp_gt_u32 vcc, 4, v26
 s_cbranch_vccnz sretry_27
sback_28:
 buffer_load_dwordx4 v[160:163], v244, s[8:11], 0 offen offset:2048 sc1
 s_waitcnt vmcnt(11)
 v_mfma_f32_16x16x32_bf16 v[80:83], v[204:207], v[120:123], v[80:83]
 v_mfma_f32_16x16x32_bf16 v[84:87], v[208:211], v[120:123], v[84:87]
 ds_read_b128 v[196:199], v252 offset:50176
 v_mfma_f32_16x16x32_bf16 v[88:91], v[212:215], v[120:123], v[88:91]
 v_mfma_f32_16x16x32_bf16 v[92:95], v[216:219], v[120:123], v[92:95]
 buffer_load_dwordx4 v[164:167], v244, s[8:11], 0 offen offset:3072 sc1
 v_mfma_f32_16x16x32_bf16 v[96:99], v[220:223], v[120:123], v[96:99]
 s_waitcnt vmcnt(11)
 ds_read_b128 v[200:203], v252 offset:51200
 v_mfma_f32_16x16x32_bf16 v[100:103], v[204:207], v[124:127], v[100:103]
 v_mfma_f32_16x16x32_bf16 v[104:107], v[208:211], v[124:127], v[104:107]
 v_mfma_f32_16x16x32_bf16 v[108:111], v[212:215], v[124:127], v[108:111]
 v_mfma_f32_16x16x32_bf16 v[112:115], v[216:219], v[124:127], v[112:115]
 buffer_load_dwordx4 v[168:171], v244, s[8:11], s65 offen sc1
 v_mfma_f32_16x16x32_bf16 v[116:119], v[220:223], v[124:127], v[116:119]
 s_waitcnt vmcnt(11) lgkmcnt(4)
 v_mfma_f32_16x16x32_bf16 v[40:43], v[184:187], v[128:131], v[40:43]
 s_waitcnt lgkmcnt(3)
 v_mfma_f32_16x16x32_bf16 v[44:47], v[188:191], v[128:131], v[44:47]
 s_waitcnt lgkmcnt(2)
 v_mfma_f32_16x16x32_bf16 v[48:51], v[192:195], v[128:131], v[48:51]
 s_waitcnt lgkmcnt(1)
 buffer_load_dwordx4 v[172:175], v244, s[8:11], s65 offen offset:1024 sc1
 v_mfma_f32_16x16x32_bf16 v[52:55], v[196:199], v[128:131], v[52:55]
 s_waitcnt lgkmcnt(0)
 v_mfma_f32_16x16x32_bf16 v[56:59], v[200:203], v[128:131], v[56:59]
 s_waitcnt vmcnt(11)
 ds_read_b128 v[204:207], v252 offset:52224
 v_mfma_f32_16x16x32_bf16 v[60:63], v[184:187], v[132:135], v[60:63]
 v_mfma_f32_16x16x32_bf16 v[64:67], v[188:191], v[132:135], v[64:67]
 ds_read_b128 v[208:211], v253
 v_mfma_f32_16x16x32_bf16 v[68:71], v[192:195], v[132:135], v[68:71]
 buffer_load_dwordx4 v[176:179], v244, s[8:11], 0 offen offset:1024 sc1
 v_mfma_f32_16x16x32_bf16 v[72:75], v[196:199], v[132:135], v[72:75]
 v_mfma_f32_16x16x32_bf16 v[76:79], v[200:203], v[132:135], v[76:79]
 s_waitcnt vmcnt(11)
 ds_read_b128 v[212:215], v253 offset:1024
 v_mfma_f32_16x16x32_bf16 v[80:83], v[184:187], v[136:139], v[80:83]
 v_mfma_f32_16x16x32_bf16 v[84:87], v[188:191], v[136:139], v[84:87]
 buffer_load_dwordx4 v[180:183], v244, s[8:11], s38 offen sc1
 ds_read_b128 v[216:219], v253 offset:2048
 v_mfma_f32_16x16x32_bf16 v[88:91], v[192:195], v[136:139], v[88:91]
 v_mfma_f32_16x16x32_bf16 v[92:95], v[196:199], v[136:139], v[92:95]
 ds_read_b128 v[220:223], v253 offset:3072
 v_mfma_f32_16x16x32_bf16 v[96:99], v[200:203], v[136:139], v[96:99]
 s_waitcnt vmcnt(10)
 v_mfma_f32_16x16x32_bf16 v[100:103], v[184:187], v[140:143], v[100:103]
 v_mfma_f32_16x16x32_bf16 v[104:107], v[188:191], v[140:143], v[104:107]
 buffer_load_dwordx4 v[120:123], v245, s[8:11], 0 offen offset:2048 sc1
 v_mfma_f32_16x16x32_bf16 v[108:111], v[192:195], v[140:143], v[108:111]
 v_mfma_f32_16x16x32_bf16 v[112:115], v[196:199], v[140:143], v[112:115]
 v_mfma_f32_16x16x32_bf16 v[116:119], v[200:203], v[140:143], v[116:119]
 s_waitcnt vmcnt(10) lgkmcnt(4)
 v_mfma_f32_16x16x32_bf16 v[40:43], v[204:207], v[144:147], v[40:43]
 s_waitcnt lgkmcnt(3)
 buffer_load_dwordx4 v[124:127], v245, s[8:11], 0 offen offset:3072 sc1
 v_mfma_f32_16x16x32_bf16 v[44:47], v[208:211], v[144:147], v[44:47]
 s_waitcnt lgkmcnt(2)
 v_mfma_f32_16x16x32_bf16 v[48:51], v[212:215], v[144:147], v[48:51]
 s_waitcnt lgkmcnt(1)
 v_mfma_f32_16x16x32_bf16 v[52:55], v[216:219], v[144:147], v[52:55]
 s_waitcnt lgkmcnt(0)
 v_mfma_f32_16x16x32_bf16 v[56:59], v[220:223], v[144:147], v[56:59]
 s_waitcnt vmcnt(10)
 v_mfma_f32_16x16x32_bf16 v[60:63], v[204:207], v[148:151], v[60:63]
 buffer_load_dwordx4 v[128:131], v245, s[8:11], s65 offen sc1
 v_mfma_f32_16x16x32_bf16 v[64:67], v[208:211], v[148:151], v[64:67]
 v_mfma_f32_16x16x32_bf16 v[68:71], v[212:215], v[148:151], v[68:71]
 v_mfma_f32_16x16x32_bf16 v[72:75], v[216:219], v[148:151], v[72:75]
 v_mfma_f32_16x16x32_bf16 v[76:79], v[220:223], v[148:151], v[76:79]
 s_waitcnt vmcnt(10)
 v_mfma_f32_16x16x32_bf16 v[80:83], v[204:207], v[152:155], v[80:83]
 buffer_load_dwordx4 v[132:135], v245, s[8:11], s65 offen offset:1024 sc1
 v_mfma_f32_16x16x32_bf16 v[84:87], v[208:211], v[152:155], v[84:87]
 v_mfma_f32_16x16x32_bf16 v[88:91], v[212:215], v[152:155], v[88:91]
 v_mfma_f32_16x16x32_bf16 v[92:95], v[216:219], v[152:155], v[92:95]
 v_mfma_f32_16x16x32_bf16 v[96:99], v[220:223], v[152:155], v[96:99]
 s_waitcnt vmcnt(10)
 buffer_load_dwordx4 v[136:139], v245, s[8:11], 0 offen offset:1024 sc1
 v_mfma_f32_16x16x32_bf16 v[100:103], v[204:207], v[156:159], v[100:103]
 v_mfma_f32_16x16x32_bf16 v[104:107], v[208:211], v[156:159], v[104:107]
 v_mfma_f32_16x16x32_bf16 v[108:111], v[212:215], v[156:159], v[108:111]
 v_mfma_f32_16x16x32_bf16 v[112:115], v[216:219], v[156:159], v[112:115]
 v_mfma_f32_16x16x32_bf16 v[116:119], v[220:223], v[156:159], v[116:119]
 s_waitcnt vmcnt(10)
 buffer_load_dwordx4 v[140:143], v245, s[8:11], s38 offen sc1
 v_mfma_f32_16x16x32_bf16 v[40:43], a[40:43], v[160:163], v[40:43]
 v_mfma_f32_16x16x32_bf16 v[44:47], a[44:47], v[160:163], v[44:47]
 v_mfma_f32_16x16x32_bf16 v[48:51], a[48:51], v[160:163], v[48:51]
 v_mfma_f32_16x16x32_bf16 v[52:55], a[52:55], v[160:163], v[52:55]
 buffer_load_dwordx4 v[144:147], v246, s[8:11], 0 offen offset:2048 sc1
 v_mfma_f32_16x16x32_bf16 v[56:59], a[56:59], v[160:163], v[56:59]
 s_waitcnt vmcnt(11)
 v_mfma_f32_16x16x32_bf16 v[40:43], a[60:63], v[164:167], v[40:43]
 v_mfma_f32_16x16x32_bf16 v[44:47], a[64:67], v[164:167], v[44:47]
 v_lshrrev_b32 v254, 4, v22
 v_mfma_f32_16x16x32_bf16 v[48:51], a[68:71], v[164:167], v[48:51]
 v_mfma_f32_16x16x32_bf16 v[52:55], a[72:75], v[164:167], v[52:55]
 buffer_load_dwordx4 v[148:151], v246, s[8:11], 0 offen offset:3072 sc1
 v_mfma_f32_16x16x32_bf16 v[56:59], a[76:79], v[164:167], v[56:59]
 s_waitcnt vmcnt(11)
 v_mul_u32_u24 v252, 1280, v254
 v_mfma_f32_16x16x32_bf16 v[40:43], a[80:83], v[168:171], v[40:43]
 v_mfma_f32_16x16x32_bf16 v[44:47], a[84:87], v[168:171], v[44:47]
 v_and_b32 v25, 12, v22
 v_mfma_f32_16x16x32_bf16 v[48:51], a[88:91], v[168:171], v[48:51]
 buffer_load_dwordx4 v[152:155], v246, s[8:11], s65 offen sc1
 v_mfma_f32_16x16x32_bf16 v[52:55], a[92:95], v[168:171], v[52:55]
 v_mfma_f32_16x16x32_bf16 v[56:59], a[96:99], v[168:171], v[56:59]
 s_waitcnt vmcnt(11)
 v_mfma_f32_16x16x32_bf16 v[40:43], a[100:103], v[172:175], v[40:43]
 v_lshl_add_u32 v253, v25, 2, v252
 v_mfma_f32_16x16x32_bf16 v[44:47], a[104:107], v[172:175], v[44:47]
 v_mfma_f32_16x16x32_bf16 v[48:51], a[108:111], v[172:175], v[48:51]
 buffer_load_dwordx4 v[156:159], v246, s[8:11], s65 offen offset:1024 sc1
 v_mfma_f32_16x16x32_bf16 v[52:55], a[112:115], v[172:175], v[52:55]
 v_lshl_add_u32 v252, v25, 1, v252
 v_mfma_f32_16x16x32_bf16 v[56:59], a[116:119], v[172:175], v[56:59]
 s_waitcnt vmcnt(11)
 v_mfma_f32_16x16x32_bf16 v[40:43], a[20:23], v[176:179], v[40:43]
 v_lshlrev_b32 v254, 2, v254
 v_mfma_f32_16x16x32_bf16 v[44:47], a[24:27], v[176:179], v[44:47]
 buffer_load_dwordx4 v[160:163], v246, s[8:11], 0 offen offset:1024 sc1
 v_mfma_f32_16x16x32_bf16 v[48:51], a[28:31], v[176:179], v[48:51]
 v_mfma_f32_16x16x32_bf16 v[52:55], a[32:35], v[176:179], v[52:55]
 v_lshl_add_u32 v254, v25, 4, v254
 v_mfma_f32_16x16x32_bf16 v[56:59], a[36:39], v[176:179], v[56:59]
 s_waitcnt vmcnt(11)
 v_mfma_f32_16x16x32_bf16 v[40:43], a[0:3], v[180:183], v[40:43]
 v_mfma_f32_16x16x32_bf16 v[44:47], a[4:7], v[180:183], v[44:47]
 buffer_load_dwordx4 v[164:167], v246, s[8:11], s38 offen sc1
 v_mfma_f32_16x16x32_bf16 v[48:51], a[8:11], v[180:183], v[48:51]
 v_mfma_f32_16x16x32_bf16 v[52:55], a[12:15], v[180:183], v[52:55]
 v_mfma_f32_16x16x32_bf16 v[56:59], a[16:19], v[180:183], v[56:59]
 s_waitcnt vmcnt(11)
 v_mfma_f32_16x16x32_bf16 v[60:63], a[40:43], v[120:123], v[60:63]
 buffer_load_dwordx4 v[168:171], v247, s[8:11], 0 offen offset:2048 sc1
 v_mfma_f32_16x16x32_bf16 v[64:67], a[44:47], v[120:123], v[64:67]
 v_mfma_f32_16x16x32_bf16 v[68:71], a[48:51], v[120:123], v[68:71]
 s_mov_b32 m0, s83
 s_nop 0
 ds_write_addtid_b32 v40
 v_mfma_f32_16x16x32_bf16 v[72:75], a[52:55], v[120:123], v[72:75]
 ds_write_addtid_b32 v41 offset:256
 ds_write_addtid_b32 v42 offset:512
 v_mfma_f32_16x16x32_bf16 v[76:79], a[56:59], v[120:123], v[76:79]
 s_waitcnt vmcnt(11)
 ds_write_addtid_b32 v43 offset:768
 v_mfma_f32_16x16x32_bf16 v[60:63], a[60:63], v[124:127], v[60:63]
 buffer_load_dwordx4 v[172:175], v247, s[8:11], 0 offen offset:3072 sc1
 ds_write_addtid_b32 v44 offset:1024
 v_mfma_f32_16x16x32_bf16 v[64:67], a[64:67], v[124:127], v[64:67]
 ds_write_addtid_b32 v45 offset:1280
 v_mfma_f32_16x16x32_bf16 v[68:71], a[68:71], v[124:127], v[68:71]
 ds_write_addtid_b32 v46 offset:1536
 ds_write_addtid_b32 v47 offset:1792
 v_mfma_f32_16x16x32_bf16 v[72:75], a[72:75], v[124:127], v[72:75]
 ds_write_addtid_b32 v48 offset:2048
 v_mfma_f32_16x16x32_bf16 v[76:79], a[76:79], v[124:127], v[76:79]
 s_waitcnt vmcnt(11)
 ds_write_addtid_b32 v49 offset:2304
 v_mfma_f32_16x16x32_bf16 v[60:63], a[80:83], v[128:131], v[60:63]
 buffer_load_dwordx4 v[176:179], v247, s[8:11], s65 offen sc1
 ds_write_addtid_b32 v50 offset:2560
 v_mfma_f32_16x16x32_bf16 v[64:67], a[84:87], v[128:131], v[64:67]
 ds_write_addtid_b32 v51 offset:2816
 v_mfma_f32_16x16x32_bf16 v[68:71], a[88:91], v[128:131], v[68:71]
 ds_write_addtid_b32 v52 offset:3072
 ds_write_addtid_b32 v53 offset:3328
 v_mfma_f32_16x16x32_bf16 v[72:75], a[92:95], v[128:131], v[72:75]
 ds_write_addtid_b32 v54 offset:3584
 v_mfma_f32_16x16x32_bf16 v[76:79], a[96:99], v[128:131], v[76:79]
 s_waitcnt vmcnt(11)
 buffer_load_dwordx4 v[180:183], v247, s[8:11], s65 offen offset:1024 sc1
 ds_write_addtid_b32 v55 offset:3840
 v_mfma_f32_16x16x32_bf16 v[60:63], a[100:103], v[132:135], v[60:63]
 ds_write_addtid_b32 v56 offset:4096
 v_mfma_f32_16x16x32_bf16 v[64:67], a[104:107], v[132:135], v[64:67]
 ds_write_addtid_b32 v57 offset:4352
 ds_write_addtid_b32 v58 offset:4608
 v_mfma_f32_16x16x32_bf16 v[68:71], a[108:111], v[132:135], v[68:71]
 ds_write_addtid_b32 v59 offset:4864
 v_mfma_f32_16x16x32_bf16 v[72:75], a[112:115], v[132:135], v[72:75]
 v_mfma_f32_16x16x32_bf16 v[76:79], a[116:119], v[132:135], v[76:79]
 s_waitcnt vmcnt(11)
 buffer_load_dwordx4 v[120:123], v247, s[8:11], 0 offen offset:1024 sc1
 v_mfma_f32_16x16x32_bf16 v[60:63], a[20:23], v[136:139], v[60:63]
 v_mfma_f32_16x16x32_bf16 v[64:67], a[24:27], v[136:139], v[64:67]
 s_waitcnt lgkmcnt(0)
 s_barrier
 v_mfma_f32_16x16x32_bf16 v[68:71], a[28:31], v[136:139], v[68:71]
 ds_read2st64_b32 v[224:225], v249 offset0:0 offset1:1
 v_mfma_f32_16x16x32_bf16 v[72:75], a[32:35], v[136:139], v[72:75]
 buffer_load_dwordx4 v[124:127], v247, s[8:11], s38 offen sc1
 ds_read2st64_b32 v[226:227], v249 offset0:2 offset1:3
 v_mfma_f32_16x16x32_bf16 v[76:79], a[36:39], v[136:139], v[76:79]
 s_waitcnt vmcnt(12)
 ds_read2st64_b32 v[228:229], v249 offset0:4 offset1:5
 v_mfma_f32_16x16x32_bf16 v[60:63], a[0:3], v[140:143], v[60:63]
 ds_read2st64_b32 v[230:231], v249 offset0:6 offset1:7
 v_mfma_f32_16x16x32_bf16 v[64:67], a[4:7], v[140:143], v[64:67]
 ds_read2st64_b32 v[232:233], v249 offset0:8 offset1:9
 v_mfma_f32_16x16x32_bf16 v[68:71], a[8:11], v[140:143], v[68:71]
 ds_read2st64_b32 v[234:235], v249 offset0:10 offset1:11
 v_mfma_f32_16x16x32_bf16 v[72:75], a[12:15], v[140:143], v[72:75]
 ds_read2st64_b32 v[236:237], v249 offset0:12 offset1:13
 v_mfma_f32_16x16x32_bf16 v[76:79], a[16:19], v[140:143], v[76:79]
 s_waitcnt vmcnt(11)
 ds_read2st64_b32 v[238:239], v249 offset0:14 offset1:15
 v_mfma_f32_16x16x32_bf16 v[80:83], a[40:43], v[144:147], v[80:83]
 ds_read2st64_b32 v[240:241], v249 offset0:16 offset1:17
 v_mfma_f32_16x16x32_bf16 v[84:87], a[44:47], v[144:147], v[84:87]
 ds_read2st64_b32 v[242:243], v249 offset0:18 offset1:19
 v_mfma_f32_16x16x32_bf16 v[88:91], a[48:51], v[144:147], v[88:91]
 ds_write_addtid_b32 v60 offset:5120
 v_mfma_f32_16x16x32_bf16 v[92:95], a[52:55], v[144:147], v[92:95]
 s_waitcnt lgkmcnt(10)
 ds_write_addtid_b32 v61 offset:5376
 v_add_f32 v100, v100, v224
 v_mfma_f32_16x16x32_bf16 v[96:99], a[56:59], v[144:147], v[96:99]
 s_waitcnt vmcnt(10)
 ds_write_addtid_b32 v62 offset:5632
 ds_write_addtid_b32 v63 offset:5888
 v_mfma_f32_16x16x32_bf16 v[80:83], a[60:63], v[148:151], v[80:83]
 ds_write_addtid_b32 v64 offset:6144
 v_add_f32 v101, v101, v225
 v_mfma_f32_16x16x32_bf16 v[84:87], a[64:67], v[148:151], v[84:87]
 ds_write_addtid_b32 v65 offset:6400
 v_mfma_f32_16x16x32_bf16 v[88:91], a[68:71], v[148:151], v[88:91]
 s_waitcnt lgkmcnt(14)
 ds_write_addtid_b32 v66 offset:6656
 v_add_f32 v102, v102, v226
 v_mfma_f32_16x16x32_bf16 v[92:95], a[72:75], v[148:151], v[92:95]
 ds_write_addtid_b32 v67 offset:6912
 ds_write_addtid_b32 v68 offset:7168
 v_mfma_f32_16x16x32_bf16 v[96:99], a[76:79], v[148:151], v[96:99]
 s_waitcnt vmcnt(9)
 ds_write_addtid_b32 v69 offset:7424
 v_add_f32 v103, v103, v227
 v_mfma_f32_16x16x32_bf16 v[80:83], a[80:83], v[152:155], v[80:83]
 s_waitcnt lgkmcnt(14)
 ds_write_addtid_b32 v70 offset:7680
 v_add_f32 v104, v104, v228
 v_mfma_f32_16x16x32_bf16 v[84:87], a[84:87], v[152:155], v[84:87]
 ds_write_addtid_b32 v71 offset:7936
 v_mfma_f32_16x16x32_bf16 v[88:91], a[88:91], v[152:155], v[88:91]
 ds_write_addtid_b32 v72 offset:8192
 ds_write_addtid_b32 v73 offset:8448
 v_mfma_f32_16x16x32_bf16 v[92:95], a[92:95], v[152:155], v[92:95]
 ds_write_addtid_b32 v74 offset:8704
 v_add_f32 v105, v105, v229
 v_mfma_f32_16x16x32_bf16 v[96:99], a[96:99], v[152:155], v[96:99]
 s_waitcnt vmcnt(8)
 ds_write_addtid_b32 v75 offset:8960
 v_add_f32 v106, v106, v230
 v_mfma_f32_16x16x32_bf16 v[80:83], a[100:103], v[156:159], v[80:83]
 ds_write_addtid_b32 v76 offset:9216
 v_add_f32 v107, v107, v231
 v_mfma_f32_16x16x32_bf16 v[84:87], a[104:107], v[156:159], v[84:87]
 ds_write_addtid_b32 v77 offset:9472
 ds_write_addtid_b32 v78 offset:9728
 v_mfma_f32_16x16x32_bf16 v[88:91], a[108:111], v[156:159], v[88:91]
 ds_write_addtid_b32 v79 offset:9984
 v_add_f32 v108, v108, v232
 v_mfma_f32_16x16x32_bf16 v[92:95], a[112:115], v[156:159], v[92:95]
 v_add_f32 v109, v109, v233
 v_mfma_f32_16x16x32_bf16 v[96:99], a[116:119], v[156:159], v[96:99]
 s_waitcnt vmcnt(7)
 v_add_f32 v110, v110, v234
 v_add_f32 v111, v111, v235
 v_mfma_f32_16x16x32_bf16 v[80:83], a[20:23], v[160:163], v[80:83]
 s_waitcnt lgkmcnt(15)
 v_add_f32 v112, v112, v236
 v_mfma_f32_16x16x32_bf16 v[84:87], a[24:27], v[160:163], v[84:87]
 s_waitcnt lgkmcnt(0)
 s_barrier
 v_add_f32 v113, v113, v237
 v_add_f32 v114, v114, v238
 v_mfma_f32_16x16x32_bf16 v[88:91], a[28:31], v[160:163], v[88:91]
 ds_read2st64_b32 v[184:185], v250 offset0:20 offset1:21
 v_mfma_f32_16x16x32_bf16 v[92:95], a[32:35], v[160:163], v[92:95]
 ds_read2st64_b32 v[186:187], v250 offset0:22 offset1:23
 v_add_f32 v115, v115, v239
 v_mfma_f32_16x16x32_bf16 v[96:99], a[36:39], v[160:163], v[96:99]
 s_waitcnt vmcnt(6)
 ds_read2st64_b32 v[188:189], v250 offset0:24 offset1:25
 v_add_f32 v116, v116, v240
 v_mfma_f32_16x16x32_bf16 v[80:83], a[0:3], v[164:167], v[80:83]
 ds_read2st64_b32 v[190:191], v250 offset0:26 offset1:27
 v_add_f32 v117, v117, v241
 v_mfma_f32_16x16x32_bf16 v[84:87], a[4:7], v[164:167], v[84:87]
 ds_read2st64_b32 v[192:193], v250 offset0:28 offset1:29
 v_mfma_f32_16x16x32_bf16 v[88:91], a[8:11], v[164:167], v[88:91]
 ds_read2st64_b32 v[194:195], v250 offset0:30 offset1:31
 v_add_f32 v118, v118, v242
 v_mfma_f32_16x16x32_bf16 v[92:95], a[12:15], v[164:167], v[92:95]
 ds_read2st64_b32 v[196:197], v250 offset0:32 offset1:33
 v_add_f32 v119, v119, v243
 v_mfma_f32_16x16x32_bf16 v[96:99], a[16:19], v[164:167], v[96:99]
 s_waitcnt vmcnt(5)
 ds_read2st64_b32 v[198:199], v250 offset0:34 offset1:35
 v_mfma_f32_16x16x32_bf16 v[100:103], a[40:43], v[168:171], v[100:103]
 ds_read2st64_b32 v[200:201], v250 offset0:36 offset1:37
 v_mfma_f32_16x16x32_bf16 v[104:107], a[44:47], v[168:171], v[104:107]
 ds_read2st64_b32 v[202:203], v250 offset0:38 offset1:39
 v_mfma_f32_16x16x32_bf16 v[108:111], a[48:51], v[168:171], v[108:111]
 ds_write_addtid_b32 v80
 v_mfma_f32_16x16x32_bf16 v[112:115], a[52:55], v[168:171], v[112:115]
 ds_write_addtid_b32 v81 offset:256
 v_mfma_f32_16x16x32_bf16 v[116:119], a[56:59], v[168:171], v[116:119]
 s_waitcnt vmcnt(4)
 ds_write_addtid_b32 v82 offset:512
 ds_write_addtid_b32 v83 offset:768
 v_mfma_f32_16x16x32_bf16 v[100:103], a[60:63], v[172:175], v[100:103]
 ds_write_addtid_b32 v84 offset:1024
 v_mfma_f32_16x16x32_bf16 v[104:107], a[64:67], v[172:175], v[104:107]
 ds_write_addtid_b32 v85 offset:1280
 v_mfma_f32_16x16x32_bf16 v[108:111], a[68:71], v[172:175], v[108:111]
 ds_write_addtid_b32 v86 offset:1536
 v_mfma_f32_16x16x32_bf16 v[112:115], a[72:75], v[172:175], v[112:115]
 ds_write_addtid_b32 v87 offset:1792
 ds_write_addtid_b32 v88 offset:2048
 v_mfma_f32_16x16x32_bf16 v[116:119], a[76:79], v[172:175], v[116:119]
 s_waitcnt vmcnt(3)
 ds_write_addtid_b32 v89 offset:2304
 v_mfma_f32_16x16x32_bf16 v[100:103], a[80:83], v[176:179], v[100:103]
 ds_write_addtid_b32 v90 offset:2560
 v_mfma_f32_16x16x32_bf16 v[104:107], a[84:87], v[176:179], v[104:107]
 ds_write_addtid_b32 v91 offset:2816
 v_mfma_f32_16x16x32_bf16 v[108:111], a[88:91], v[176:179], v[108:111]
 ds_write_addtid_b32 v92 offset:3072
 ds_write_addtid_b32 v93 offset:3328
 v_mfma_f32_16x16x32_bf16 v[112:115], a[92:95], v[176:179], v[112:115]
 ds_write_addtid_b32 v94 offset:3584
 v_mfma_f32_16x16x32_bf16 v[116:119], a[96:99], v[176:179], v[116:119]
 s_waitcnt vmcnt(2)
 ds_write_addtid_b32 v95 offset:3840
 v_mfma_f32_16x16x32_bf16 v[100:103], a[100:103], v[180:183], v[100:103]
 ds_write_addtid_b32 v96 offset:4096
 v_mfma_f32_16x16x32_bf16 v[104:107], a[104:107], v[180:183], v[104:107]
 ds_write_addtid_b32 v97 offset:4352
 ds_write_addtid_b32 v98 offset:4608
 v_mfma_f32_16x16x32_bf16 v[108:111], a[108:111], v[180:183], v[108:111]
 ds_write_addtid_b32 v99 offset:4864
 v_mfma_f32_16x16x32_bf16 v[112:115], a[112:115], v[180:183], v[112:115]
 v_mfma_f32_16x16x32_bf16 v[116:119], a[116:119], v[180:183], v[116:119]
 s_waitcnt vmcnt(1)
 v_mfma_f32_16x16x32_bf16 v[100:103], a[20:23], v[120:123], v[100:103]
 v_mfma_f32_16x16x32_bf16 v[104:107], a[24:27], v[120:123], v[104:107]
 s_waitcnt lgkmcnt(0)
 s_barrier
 v_mfma_f32_16x16x32_bf16 v[108:111], a[28:31], v[120:123], v[108:111]
 ds_read2st64_b32 v[224:225], v251 offset0:0 offset1:1
 v_mfma_f32_16x16x32_bf16 v[112:115], a[32:35], v[120:123], v[112:115]
 ds_read2st64_b32 v[226:227], v251 offset0:2 offset1:3
 v_mfma_f32_16x16x32_bf16 v[116:119], a[36:39], v[120:123], v[116:119]
 s_waitcnt vmcnt(0)
 ds_read2st64_b32 v[228:229], v251 offset0:4 offset1:5
 v_mfma_f32_16x16x32_bf16 v[100:103], a[0:3], v[124:127], v[100:103]
 ds_read2st64_b32 v[230:231], v251 offset0:6 offset1:7
 v_mfma_f32_16x16x32_bf16 v[104:107], a[4:7], v[124:127], v[104:107]
 ds_read2st64_b32 v[232:233], v251 offset0:8 offset1:9
 v_mfma_f32_16x16x32_bf16 v[108:111], a[8:11], v[124:127], v[108:111]
 ds_read2st64_b32 v[234:235], v251 offset0:10 offset1:11
 v_mfma_f32_16x16x32_bf16 v[112:115], a[12:15], v[124:127], v[112:115]
 ds_read2st64_b32 v[236:237], v251 offset0:12 offset1:13
 v_mfma_f32_16x16x32_bf16 v[116:119], a[16:19], v[124:127], v[116:119]
 ds_read2st64_b32 v[238:239], v251 offset0:14 offset1:15
 ds_read2st64_b32 v[240:241], v251 offset0:16 offset1:17
 ds_read2st64_b32 v[242:243], v251 offset0:18 offset1:19
 v_pk_add_f32 v[100:101], v[100:101], v[184:185]
 v_pk_add_f32 v[102:103], v[102:103], v[186:187]
 v_pk_add_f32 v[104:105], v[104:105], v[188:189]
 v_pk_add_f32 v[106:107], v[106:107], v[190:191]
 v_pk_add_f32 v[108:109], v[108:109], v[192:193]
 v_pk_add_f32 v[110:111], v[110:111], v[194:195]
 v_pk_add_f32 v[112:113], v[112:113], v[196:197]
 v_pk_add_f32 v[114:115], v[114:115], v[198:199]
 v_pk_add_f32 v[116:117], v[116:117], v[200:201]
 v_pk_add_f32 v[118:119], v[118:119], v[202:203]
 s_waitcnt lgkmcnt(0)
 v_pk_add_f32 v[100:101], v[100:101], v[224:225]
 v_cvt_pk_bf16_f32 v28, v100, v101
 ds_bpermute_b32 v28, v254, v28
 v_pk_add_f32 v[102:103], v[102:103], v[226:227]
 v_cvt_pk_bf16_f32 v29, v102, v103
 ds_bpermute_b32 v29, v254, v29
 v_pk_add_f32 v[104:105], v[104:105], v[228:229]
 v_cvt_pk_bf16_f32 v30, v104, v105
 ds_bpermute_b32 v30, v254, v30
 v_pk_add_f32 v[106:107], v[106:107], v[230:231]
 v_cvt_pk_bf16_f32 v31, v106, v107
 ds_bpermute_b32 v31, v254, v31
 v_pk_add_f32 v[108:109], v[108:109], v[232:233]
 v_cvt_pk_bf16_f32 v32, v108, v109
 ds_bpermute_b32 v32, v254, v32
 v_pk_add_f32 v[110:111], v[110:111], v[234:235]
 v_cvt_pk_bf16_f32 v33, v110, v111
 ds_bpermute_b32 v33, v254, v33
 v_pk_add_f32 v[112:113], v[112:113], v[236:237]
 v_cvt_pk_bf16_f32 v34, v112, v113
 ds_bpermute_b32 v34, v254, v34
 v_pk_add_f32 v[114:115], v[114:115], v[238:239]
 v_cvt_pk_bf16_f32 v35, v114, v115
 ds_bpermute_b32 v35, v254, v35
 v_pk_add_f32 v[116:117], v[116:117], v[240:241]
 v_cvt_pk_bf16_f32 v36, v116, v117
 ds_bpermute_b32 v36, v254, v36
 v_pk_add_f32 v[118:119], v[118:119], v[242:243]
 v_cvt_pk_bf16_f32 v37, v118, v119
 ds_bpermute_b32 v37, v254, v37
 s_waitcnt lgkmcnt(6)
 buffer_store_dwordx4 v[28:31], v253, s[12:15], s63 offen sc1
 s_waitcnt lgkmcnt(2)
 buffer_store_dwordx4 v[32:35], v253, s[12:15], s63 offen offset:64 sc1
 s_waitcnt lgkmcnt(0)
 buffer_store_dwordx2 v[36:37], v252, s[12:15], s63 offen offset:128 sc1
 s_add_u32 s3, s3, 1
 v_mov_b32 v27, s3
 s_or_b32 s31, s2, s22
 s_mov_b32 s30, 13991936
 s_cselect_b32 s30, 33554432, s30
 s_mov_b64 exec, 1
 buffer_store_dword v27, off, s[8:11], s30 sc1
 s_endpgm
sretry_5:
 buffer_load_dwordx4 v[152:155], v1, s[8:11], s61 offen sc1
 buffer_load_dwordx4 v[156:159], v1, s[8:11], s61 offen offset:1024 sc1
 s_waitcnt vmcnt(0)
 v_and_b32 v147, v152, v153
 v_bitop3_b32 v147, v147, v154, v155 bitop3:0x80
 v_bitop3_b32 v147, v147, v156, v157 bitop3:0x80
 v_bitop3_b32 v147, v147, v158, v159 bitop3:0x80
 v_and_b32 v147, 1, v147
 v_cmp_ne_u32 vcc, 1, v147
 s_cbranch_vccz sback_6
 s_add_u32 s29, s29, 1
 s_cmp_lt_u32 s29, 524288
 s_cbranch_scc1 sretry_5
 s_branch sback_6
sretry_7:
 buffer_load_dword v26, v254, s[8:11], s51 offen sc1
 s_waitcnt vmcnt(0)
 v_cmp_gt_u32 vcc, 1, v26
 s_cbranch_vccz sback_8
 s_add_u32 s29, s29, 1
 s_cmp_lt_u32 s29, 524288
 s_cbranch_scc1 sretry_7
 s_branch sback_8
sretry_9:
 buffer_load_dword v26, v254, s[8:11], s51 offen sc1
 s_waitcnt vmcnt(0)
 v_cmp_gt_u32 vcc, 2, v26
 s_cbranch_vccz sback_10
 s_add_u32 s29, s29, 1
 s_cmp_lt_u32 s29, 524288
 s_cbranch_scc1 sretry_9
 s_branch sback_10
sretry_13:
 buffer_load_dwordx4 v[208:211], v1, s[8:11], s16 offen sc1
 buffer_load_dwordx4 v[212:215], v1, s[8:11], s16 offen offset:1024 sc1
 buffer_load_dwordx4 v[216:219], v1, s[8:11], s16 offen offset:2048 sc1
 buffer_load_dwordx4 v[220:223], v1, s[8:11], s16 offen offset:3072 sc1
 s_waitcnt vmcnt(0)
 v_or_b32 v229, v208, v209
 v_or3_b32 v229, v229, v210, v211
 v_or3_b32 v229, v229, v212, v213
 v_or3_b32 v229, v229, v214, v215
 v_or3_b32 v229, v229, v216, v217
 v_or3_b32 v229, v229, v218, v219
 v_or3_b32 v229, v229, v220, v221
 v_or3_b32 v229, v229, v222, v223
 v_and_b32 v229, 1, v229
 v_cmp_ne_u32 vcc, 0, v229
 s_cbranch_vccz sback_14
 s_add_u32 s29, s29, 1
 s_cmp_lt_u32 s29, 524288
 s_cbranch_scc1 sretry_13
 s_branch sback_14
sretry_23:
 buffer_load_dwordx4 v[152:155], v1, s[8:11], s61 offen sc1
 buffer_load_dwordx4 v[156:159], v1, s[8:11], s61 offen offset:1024 sc1
 s_waitcnt vmcnt(0)
 v_and_b32 v147, v152, v153
 v_bitop3_b32 v147, v147, v154, v155 bitop3:0x80
 v_bitop3_b32 v147, v147, v156, v157 bitop3:0x80
 v_bitop3_b32 v147, v147, v158, v159 bitop3:0x80
 v_and_b32 v147, 1, v147
 v_cmp_ne_u32 vcc, 1, v147
 s_cbranch_vccz sback_24
 s_add_u32 s29, s29, 1
 s_cmp_lt_u32 s29, 524288
 s_cbranch_scc1 sretry_23
 s_branch sback_24
sretry_25:
 buffer_load_dword v26, v254, s[8:11], s51 offen sc1
 s_waitcnt vmcnt(0)
 v_cmp_gt_u32 vcc, 3, v26
 s_cbranch_vccz sback_26
 s_add_u32 s29, s29, 1
 s_cmp_lt_u32 s29, 524288
 s_cbranch_scc1 sretry_25
 s_branch sback_26
sretry_27:
 buffer_load_dword v26, v254, s[8:11], s51 offen sc1
 s_waitcnt vmcnt(0)
 v_cmp_gt_u32 vcc, 4, v26
 s_cbranch_vccz sback_28
 s_add_u32 s29, s29, 1
 s_cmp_lt_u32 s29, 524288
 s_cbranch_scc1 sretry_27
 s_branch sback_28
k_done:
 s_endpgm
.fill 5120, 4, 0xbf810000
.section .rodata,"a"
.p2align 6
.amdhsa_kernel interleave_layers__linear_kernel_hedgehog__dense_activation_squared_relu__prompt_kernel
  .amdhsa_next_free_vgpr 512
  .amdhsa_next_free_sgpr 102
  .amdhsa_accum_offset 256
  .amdhsa_group_segment_fixed_size 0
  .amdhsa_kernarg_size 96
  .amdhsa_user_sgpr_count 2
  .amdhsa_user_sgpr_kernarg_segment_ptr 1
  .amdhsa_system_sgpr_workgroup_id_x 1
  .amdhsa_float_denorm_mode_32 3
.end_amdhsa_kernel
```
